```python
import torch

def _softmax(x, axis=-1):
    return torch.softmax(x, dim=axis)

def _gelu(x):
    return torch.nn.functional.gelu(x, approximate='tanh')

def _silu(x):
    return torch.nn.functional.silu(x)

def _sigmoid(x):
    return torch.sigmoid(x)

def _layernorm(x, axis=-1, eps=1e-05):
    m = x.mean(dim=axis, keepdim=True)
    v = x.var(dim=axis, keepdim=True, unbiased=False)
    return (x - m) / torch.sqrt(v + eps)

def _scatter_add(tgt, idx, src, axis=0):
    return tgt.clone().index_add_(axis, idx, src)

def _segment_sum(src, seg, n):
    out = torch.zeros((n,) + src.shape[1:], dtype=src.dtype)
    return out.index_add_(0, seg, src)

def _pad(x, pw):
    flat = tuple((v for pair in reversed(pw) for v in pair))
    return torch.nn.functional.pad(x, flat)
kernel_name = 'sequential_preLN__memory_aug_recurrent_mem_tr__glu_gated_geglu__prompt'

def setup_inputs():

    _w = lambda a: (lambda t: t.to(torch.bfloat16) if t.is_floating_point() else t)(torch.as_tensor(a))

    def _A_setup():
        B, S, Dm = (1, 2048, 512)
        H, Dh = (32, 128)
        M, seg = (8, 32)
        seg = min(seg, S)
        S = S // seg * seg
        return {'x': _w((lambda *s: torch.randn(*s, dtype=torch.bfloat16) * 0.05)(B, S, Dm)), 'mem0': _w((lambda *s: torch.randn(*s, dtype=torch.bfloat16) * 0.2)(B, M, Dm)), 'Wq': _w((lambda *s: torch.randn(*s, dtype=torch.bfloat16) * 1.6)(Dm, H, Dh) * Dm ** (-0.5)), 'Wk': _w((lambda *s: torch.randn(*s, dtype=torch.bfloat16) * 1.6)(Dm, H, Dh) * Dm ** (-0.5)), 'Wv': _w((lambda *s: torch.randn(*s, dtype=torch.bfloat16) * 0.2)(Dm, H, Dh) * Dm ** (-0.5)), 'Wo': _w((lambda *s: torch.randn(*s, dtype=torch.bfloat16) * 0.2)(H, Dh, Dm) * (H * Dh) ** (-0.5)), 'seg_len': seg}
    _A_in = _A_setup()

    def _B_setup():
        B, S, Dm, Df = (1, 2048, 512, 1792)
        return {'x': _w((lambda *s: torch.randn(*s, dtype=torch.bfloat16) * 0.05)(B, S, Dm)), 'w_gate': _w((lambda *s: torch.randn(*s, dtype=torch.bfloat16) * 0.4)(Dm, Df) * Dm ** (-0.5)), 'w_up': _w((lambda *s: torch.randn(*s, dtype=torch.bfloat16) * 0.4)(Dm, Df) * Dm ** (-0.5)), 'w_down': _w((lambda *s: torch.randn(*s, dtype=torch.bfloat16) * 0.4)(Df, Dm) * Df ** (-0.5))}
    _B_in = _B_setup()
    return {'A_x': _A_in['x'], 'A_mem0': _A_in['mem0'], 'A_Wq': _A_in['Wq'], 'A_Wk': _A_in['Wk'], 'A_Wv': _A_in['Wv'], 'A_Wo': _A_in['Wo'], 'A_seg_len': _A_in['seg_len'], 'B_x': _B_in['x'], 'B_w_gate': _B_in['w_gate'], 'B_w_up': _B_in['w_up'], 'B_w_down': _B_in['w_down']}

def reference(A_x, A_mem0, A_Wq, A_Wk, A_Wv, A_Wo, A_seg_len, B_x, B_w_gate, B_w_up, B_w_down):

    def _A_ref(x, mem0, Wq, Wk, Wv, Wo, seg_len):
        B, S, Dm = x.shape
        H, Dh = (Wq.shape[1], Wq.shape[2])
        M = mem0.shape[1]
        scale = Dh ** (-0.5)
        n_seg = S // seg_len
        L = M + seg_len
        idx = torch.arange(L)
        mask = (idx[:, None] < M) | (idx[:, None] >= idx[None, :])
        mem = mem0
        outs = []
        for s in range(n_seg):
            xs = x[:, s * seg_len:(s + 1) * seg_len, :].clone()
            h = torch.concatenate([mem, xs], axis=1)
            q = torch.einsum('btd,dhe->bhte', h, Wq)
            k = torch.einsum('btd,dhe->bhte', h, Wk)
            v = torch.einsum('btd,dhe->bhte', h, Wv)
            scores = torch.einsum('bhqe,bhke->bhqk', q, k) * scale
            scores = torch.where(mask[None, None], scores, -1000000000.0)
            p = _softmax(scores, axis=-1)
            o = torch.einsum('bhqk,bhke->bhqe', p, v)
            o = torch.einsum('bhte,hed->btd', o, Wo)
            mem = o[:, :M, :].clone()
            outs.append(o[:, M:, :])
        return torch.concatenate(outs, axis=1)

    def _B_ref(x, w_gate, w_up, w_down):
        g = torch.einsum('bsd,df->bsf', x, w_gate)
        u = torch.einsum('bsd,df->bsf', x, w_up)
        h = _gelu(g) * u
        return torch.einsum('bsf,fd->bsd', h, w_down)
    x = A_x
    h = x + _A_ref(_layernorm(x, axis=-1), A_mem0, A_Wq, A_Wk, A_Wv, A_Wo, A_seg_len)
    h2 = h + _B_ref(_layernorm(h, axis=-1), B_w_gate, B_w_up, B_w_down)
    return h2
```

```asm
; @launch grid=(256,1,1) block=(256,1,1) lds=163840
.amdgcn_target "amdgcn-amd-amdhsa--gfx950"
.text
.globl sequential_preLN__memory_aug_recurrent_mem_tr__glu_gated_geglu__prompt_kernel
.p2align 8
.type sequential_preLN__memory_aug_recurrent_mem_tr__glu_gated_geglu__prompt_kernel,@function
sequential_preLN__memory_aug_recurrent_mem_tr__glu_gated_geglu__prompt_kernel:
    s_cmp_ge_u32 s2, 256
    s_cbranch_scc1 L_end
    s_mov_b32 s3, s2
    s_getpc_b64 s[20:21]
L_pc:
    s_lshr_b32 s22, s2, 3
    s_and_b32 s22, s22, 1
    s_lshl_b32 s22, s22, 15
    v_lshlrev_b32 v1, 7, v0
    v_add_u32 v1, s22, v1
    v_min_u32 v1, L_fast_end-L_pc-4, v1
    global_load_dword v120, v1, s[20:21]
    s_load_dwordx16 s[64:79], s[0:1], 0
    s_load_dwordx8 s[80:87], s[0:1], 64
    s_load_dwordx4 s[88:91], s[0:1], 96
    s_getreg_b32 s18, hwreg(HW_REG_XCC_ID, 0, 4)
    v_lshrrev_b32 v1, 6, v0
    s_nop 0
    v_readfirstlane_b32 s17, v1
    v_and_b32 v0, 63, v0
    s_waitcnt lgkmcnt(0)
    s_mov_b32 s4, s88
    s_mov_b32 s5, s89
    s_mov_b32 s6, 256
    s_mov_b32 s7, 0x00020000
    s_mov_b32 s8, s90
    s_mov_b32 s9, s91
    s_mov_b32 s10, 268435456
    s_mov_b32 s11, 0x00020000
    s_cmp_gt_u32 s18, 7
    s_cbranch_scc1 L_nomap
    s_lshl_b32 s96, s18, 2
    s_lshr_b32 s18, 593823508, s96
    s_and_b32 s18, s18, 15
L_nomap:
    s_mov_b32 s23, 0
    v_mov_b32 v1, 0
    s_mov_b32 s99, 1
    s_cmp_lg_u32 s17, 0
    s_cbranch_scc1 L_norank0
    s_mov_b32 s96, 204
    s_cmp_eq_u32 s18, 0
    s_cselect_b32 s96, 0, s96
    s_cmp_eq_u32 s18, 1
    s_cselect_b32 s96, 64, s96
    s_cmp_eq_u32 s18, 2
    s_cselect_b32 s96, 68, s96
    s_cmp_eq_u32 s18, 3
    s_cselect_b32 s96, 128, s96
    s_cmp_eq_u32 s18, 4
    s_cselect_b32 s96, 132, s96
    s_cmp_eq_u32 s18, 5
    s_cselect_b32 s96, 192, s96
    s_cmp_eq_u32 s18, 6
    s_cselect_b32 s96, 196, s96
    s_cmp_eq_u32 s18, 7
    s_cselect_b32 s96, 200, s96
    s_atomic_add s99, s[88:89], s96 glc
L_norank0:
    v_mov_b32 v4, -1
    v_mov_b32 v5, -1
    v_mov_b32 v6, -1
    v_mov_b32 v7, -1
    v_lshlrev_b32 v2, 4, v0
    s_lshl_b32 s96, s3, 2
    s_add_u32 s96, s96, s17
    s_lshr_b32 s97, s96, 9
    s_lshl_b32 s97, s97, 20
    s_and_b32 s98, s96, 511
    s_lshl_b32 s98, s98, 10
    s_add_u32 s97, s97, s98
    s_add_u32 s97, s97, 62914560
    s_cmp_lt_u32 s98, 266240
    s_cbranch_scc0 L_noinb
    buffer_store_dwordx4 v[4:7], v2, s[8:11], s97 offen sc1
L_noinb:
    s_cmp_lt_u32 s96, 16
    s_cbranch_scc0 L_nom
    s_lshl_b32 s97, s96, 10
    s_add_u32 s97, s97, 65011712
    buffer_store_dwordx4 v[4:7], v2, s[8:11], s97 offen sc1
L_nom:
    s_lshl_b32 s97, s96, 10
    s_add_u32 s97, s97, 59899904
    buffer_store_dwordx4 v[4:7], v2, s[8:11], s97 offen sc1
    s_cmp_lg_u32 s17, 1
    s_cbranch_scc1 L_nofl
    v_and_b32 v3, 31, v0
    v_lshlrev_b32 v3, 2, v3
    v_lshrrev_b32 v8, 5, v0
    v_lshl_add_u32 v3, v8, 15, v3
    s_lshl_b32 s97, s3, 7
    s_add_u32 s97, s97, 65077248
    buffer_store_dword v1, v3, s[8:11], s97 offen sc1
L_nofl:
    s_cmp_gt_u32 s18, 2
    s_cbranch_scc1 L_nohead
    s_lshr_b32 s16, s3, 3
    v_lshrrev_b32 v28, 4, v0
    v_and_b32 v29, 15, v0
    v_and_b32 v30, 1, v28
    v_lshlrev_b32 v30, 1, v30
    v_xor_b32 v29, v29, v30
    v_lshlrev_b32 v28, 13, v28
    v_xor_b32 v30, 0, v29
    v_lshl_add_u32 v30, v30, 4, v28
    v_add_u32 v16, 0, v30
    v_xor_b32 v30, 4, v29
    v_lshl_add_u32 v30, v30, 4, v28
    v_add_u32 v17, 31744, v30
    v_xor_b32 v30, 8, v29
    v_lshl_add_u32 v30, v30, 4, v28
    v_add_u32 v18, 63488, v30
    v_xor_b32 v30, 12, v29
    v_lshl_add_u32 v30, v30, 4, v28
    v_add_u32 v19, 95232, v30
    v_lshrrev_b32 v28, 5, v0
    v_lshlrev_b32 v28, 4, v28
    v_bfe_u32 v29, v0, 4, 1
    v_lshl_add_u32 v28, v29, 2, v28
    v_bfe_u32 v30, v0, 2, 1
    v_add_u32 v28, v28, v30
    v_bfe_u32 v31, v0, 3, 1
    v_lshl_add_u32 v28, v31, 3, v28
    v_lshl_add_u32 v30, v29, 1, v30
    v_lshl_add_u32 v30, v31, 2, v30
    v_lshlrev_b32 v30, 1, v30
    v_bfe_u32 v29, v0, 1, 1
    s_lshl_b32 s21, s17, 2
    v_add_u32 v29, s21, v29
    v_xor_b32 v29, v29, v30
    v_lshlrev_b32 v28, 8, v28
    v_and_b32 v31, 1, v0
    v_lshl_add_u32 v28, v31, 3, v28
    v_lshl_add_u32 v20, v29, 4, v28
    v_xor_b32 v21, 32, v20
    v_add_u32 v22, 0x10000, v20
    v_add_u32 v23, 0x10000, v21
    s_mov_b32 s12, s70
    s_mov_b32 s13, s71
    s_mov_b32 s14, 4194304
    s_mov_b32 s15, 0x00020000
    s_lshl_b32 s21, s17, 18
    s_lshl_b32 s22, s16, 8
    s_add_u32 s21, s21, s22
    s_add_u32 s20, s21, 0
    s_lshl_b32 s21, s17, 13
    s_add_u32 m0, s21, 98304
    s_nop 0
    buffer_load_dwordx4 v16, s[12:15], s20 offen offset:0  lds
    buffer_load_dwordx4 v17, s[12:15], s20 offen offset:1024  lds
    buffer_load_dwordx4 v18, s[12:15], s20 offen offset:2048  lds
    buffer_load_dwordx4 v19, s[12:15], s20 offen offset:3072  lds
    s_lshl_b32 s21, s17, 18
    s_lshl_b32 s22, s16, 8
    s_add_u32 s21, s21, s22
    s_add_u32 s20, s21, 131072
    s_lshl_b32 s21, s17, 13
    s_add_u32 m0, s21, 102400
    s_nop 0
    buffer_load_dwordx4 v16, s[12:15], s20 offen offset:0  lds
    buffer_load_dwordx4 v17, s[12:15], s20 offen offset:1024  lds
    buffer_load_dwordx4 v18, s[12:15], s20 offen offset:2048  lds
    buffer_load_dwordx4 v19, s[12:15], s20 offen offset:3072  lds
L_nohead:
    s_cmp_lg_u32 s17, 0
    s_cbranch_scc1 L_norank
    s_waitcnt lgkmcnt(0)
    v_mov_b32 v16, s99
    ds_write_b32 v1, v16
    s_waitcnt lgkmcnt(0)
L_norank:
    s_barrier
    ds_read_b32 v2, v1
    s_waitcnt lgkmcnt(0)
    v_readfirstlane_b32 s16, v2
    s_barrier
L_role:
    v_mbcnt_lo_u32_b32 v0, -1, 0
    v_mbcnt_hi_u32_b32 v0, -1, v0
    s_cmp_ge_u32 s16, 32
    s_cbranch_scc1 L_none
    s_cmp_gt_u32 s18, 7
    s_cbranch_scc1 L_none
    s_cmp_eq_u32 s18, 0
    s_cbranch_scc1 L_R
    s_cmp_le_u32 s18, 2
    s_cbranch_scc1 L_P
    s_sub_u32 s19, s18, 3
    s_mov_b32 s24, s19
    s_mov_b32 s25, 0
    s_mul_i32 s21, s24, 786432
    s_mul_i32 s22, s16, 24576
    s_add_u32 s21, s21, s22
    s_add_u32 s26, s21, 2097152
    s_mul_i32 s21, s24, 131072
    s_lshl_b32 s22, s16, 12
    s_add_u32 s21, s21, s22
    s_add_u32 s27, s21, 52559872
    s_mul_i32 s21, s19, 4194304
    s_lshl_b32 s22, s17, 8
    s_add_u32 s21, s21, s22
    s_add_u32 s21, s21, 67108864
    s_lshl_b32 s22, s16, 10
    s_add_u32 s28, s21, s22
    s_mul_i32 s22, s16, 32896
    s_add_u32 s29, s21, s22
    s_lshl_b32 s21, s19, 15
    s_lshl_b32 s22, s17, 12
    s_add_u32 s21, s21, s22
    s_add_u32 s31, s21, 92274688
    s_lshr_b32 s21, s16, 4
    s_lshl_b32 s21, s21, 14
    s_and_b32 s22, s16, 15
    s_lshl_b32 s22, s22, 7
    s_add_u32 s21, s21, s22
    s_add_u32 s30, s31, s21
    s_mul_i32 s21, s19, 2048
    s_lshl_b32 s22, s17, 7
    s_add_u32 s21, s21, s22
    s_add_u32 s33, s21, 65093632
    s_lshl_b32 s22, s16, 2
    s_add_u32 s32, s33, s22
    s_lshl_b32 s21, s16, 7
    s_add_u32 s34, s21, 65077248
    s_add_u32 s35, s21, 65085440
    s_lshl_b32 s21, s24, 5
    s_add_u32 s21, s21, s16
    s_lshl_b32 s21, s21, 10
    s_lshl_b32 s22, s17, 8
    s_add_u32 s36, s21, s22
    s_mov_b32 s38, 1040356334
    s_mov_b32 s39, 1040356334
    s_mov_b32 s44, s64
    s_mov_b32 s45, s65
    s_mov_b32 s46, 2097152
    s_mov_b32 s47, 0x00020000
    s_mov_b32 s48, s86
    s_mov_b32 s49, s87
    s_mov_b32 s50, 2097152
    s_mov_b32 s51, 0x00020000
    s_cmp_eq_u32 s19, 0
    s_cbranch_scc1 L_noln
    s_sub_u32 s96, s19, 1
    s_lshl_b32 s96, s96, 5
    s_add_u32 s96, s96, s16
    s_mov_b32 s12, s64
    s_mov_b32 s13, s65
    s_mov_b32 s14, 2097152
    s_mov_b32 s15, 0x00020000
    v_and_b32 v1, 15, v0
    v_lshrrev_b32 v2, 4, v0
    v_lshlrev_b32 v3, 10, v1
    v_lshl_add_u32 v3, v2, 6, v3
    s_lshl_b32 s21, s96, 14
    s_lshl_b32 s22, s17, 8
    s_add_u32 s20, s21, s22
    buffer_load_dwordx4 v[16:19], v3, s[12:15], s20 offen offset:0
    buffer_load_dwordx4 v[20:23], v3, s[12:15], s20 offen offset:16
    buffer_load_dwordx4 v[24:27], v3, s[12:15], s20 offen offset:32
    buffer_load_dwordx4 v[28:31], v3, s[12:15], s20 offen offset:48
    s_waitcnt vmcnt(0)
    v_lshlrev_b32 v32, 16, v16
    v_and_b32 v33, 0xffff0000, v16
    v_lshlrev_b32 v34, 16, v17
    v_and_b32 v35, 0xffff0000, v17
    v_lshlrev_b32 v36, 16, v18
    v_and_b32 v37, 0xffff0000, v18
    v_lshlrev_b32 v38, 16, v19
    v_and_b32 v39, 0xffff0000, v19
    v_lshlrev_b32 v40, 16, v20
    v_and_b32 v41, 0xffff0000, v20
    v_lshlrev_b32 v42, 16, v21
    v_and_b32 v43, 0xffff0000, v21
    v_lshlrev_b32 v44, 16, v22
    v_and_b32 v45, 0xffff0000, v22
    v_lshlrev_b32 v46, 16, v23
    v_and_b32 v47, 0xffff0000, v23
    v_lshlrev_b32 v48, 16, v24
    v_and_b32 v49, 0xffff0000, v24
    v_lshlrev_b32 v50, 16, v25
    v_and_b32 v51, 0xffff0000, v25
    v_lshlrev_b32 v52, 16, v26
    v_and_b32 v53, 0xffff0000, v26
    v_lshlrev_b32 v54, 16, v27
    v_and_b32 v55, 0xffff0000, v27
    v_lshlrev_b32 v56, 16, v28
    v_and_b32 v57, 0xffff0000, v28
    v_lshlrev_b32 v58, 16, v29
    v_and_b32 v59, 0xffff0000, v29
    v_lshlrev_b32 v60, 16, v30
    v_and_b32 v61, 0xffff0000, v30
    v_lshlrev_b32 v62, 16, v31
    v_and_b32 v63, 0xffff0000, v31
    v_pk_add_f32 v[4:5], v[32:33], v[34:35]
    v_pk_add_f32 v[4:5], v[4:5], v[36:37]
    v_pk_add_f32 v[4:5], v[4:5], v[38:39]
    v_pk_add_f32 v[4:5], v[4:5], v[40:41]
    v_pk_add_f32 v[4:5], v[4:5], v[42:43]
    v_pk_add_f32 v[4:5], v[4:5], v[44:45]
    v_pk_add_f32 v[4:5], v[4:5], v[46:47]
    v_pk_add_f32 v[4:5], v[4:5], v[48:49]
    v_pk_add_f32 v[4:5], v[4:5], v[50:51]
    v_pk_add_f32 v[4:5], v[4:5], v[52:53]
    v_pk_add_f32 v[4:5], v[4:5], v[54:55]
    v_pk_add_f32 v[4:5], v[4:5], v[56:57]
    v_pk_add_f32 v[4:5], v[4:5], v[58:59]
    v_pk_add_f32 v[4:5], v[4:5], v[60:61]
    v_pk_add_f32 v[4:5], v[4:5], v[62:63]
    v_add_f32 v4, v4, v5
    v_mov_b32 v5, v4
    s_nop 1
    v_permlane16_swap_b32 v4, v5
    v_add_f32 v4, v4, v5
    v_mov_b32 v5, v4
    s_nop 1
    v_permlane32_swap_b32 v4, v5
    v_add_f32 v4, v4, v5
    v_mul_f32 v4, 1006632960, v4
    v_pk_add_f32 v[64:65], v[32:33], v[4:5] op_sel_hi:[1,0] neg_lo:[0,1] neg_hi:[0,1]
    v_pk_mul_f32 v[6:7], v[64:65], v[64:65]
    v_pk_add_f32 v[64:65], v[34:35], v[4:5] op_sel_hi:[1,0] neg_lo:[0,1] neg_hi:[0,1]
    v_pk_fma_f32 v[6:7], v[64:65], v[64:65], v[6:7]
    v_pk_add_f32 v[64:65], v[36:37], v[4:5] op_sel_hi:[1,0] neg_lo:[0,1] neg_hi:[0,1]
    v_pk_fma_f32 v[6:7], v[64:65], v[64:65], v[6:7]
    v_pk_add_f32 v[64:65], v[38:39], v[4:5] op_sel_hi:[1,0] neg_lo:[0,1] neg_hi:[0,1]
    v_pk_fma_f32 v[6:7], v[64:65], v[64:65], v[6:7]
    v_pk_add_f32 v[64:65], v[40:41], v[4:5] op_sel_hi:[1,0] neg_lo:[0,1] neg_hi:[0,1]
    v_pk_fma_f32 v[6:7], v[64:65], v[64:65], v[6:7]
    v_pk_add_f32 v[64:65], v[42:43], v[4:5] op_sel_hi:[1,0] neg_lo:[0,1] neg_hi:[0,1]
    v_pk_fma_f32 v[6:7], v[64:65], v[64:65], v[6:7]
    v_pk_add_f32 v[64:65], v[44:45], v[4:5] op_sel_hi:[1,0] neg_lo:[0,1] neg_hi:[0,1]
    v_pk_fma_f32 v[6:7], v[64:65], v[64:65], v[6:7]
    v_pk_add_f32 v[64:65], v[46:47], v[4:5] op_sel_hi:[1,0] neg_lo:[0,1] neg_hi:[0,1]
    v_pk_fma_f32 v[6:7], v[64:65], v[64:65], v[6:7]
    v_pk_add_f32 v[64:65], v[48:49], v[4:5] op_sel_hi:[1,0] neg_lo:[0,1] neg_hi:[0,1]
    v_pk_fma_f32 v[6:7], v[64:65], v[64:65], v[6:7]
    v_pk_add_f32 v[64:65], v[50:51], v[4:5] op_sel_hi:[1,0] neg_lo:[0,1] neg_hi:[0,1]
    v_pk_fma_f32 v[6:7], v[64:65], v[64:65], v[6:7]
    v_pk_add_f32 v[64:65], v[52:53], v[4:5] op_sel_hi:[1,0] neg_lo:[0,1] neg_hi:[0,1]
    v_pk_fma_f32 v[6:7], v[64:65], v[64:65], v[6:7]
    v_pk_add_f32 v[64:65], v[54:55], v[4:5] op_sel_hi:[1,0] neg_lo:[0,1] neg_hi:[0,1]
    v_pk_fma_f32 v[6:7], v[64:65], v[64:65], v[6:7]
    v_pk_add_f32 v[64:65], v[56:57], v[4:5] op_sel_hi:[1,0] neg_lo:[0,1] neg_hi:[0,1]
    v_pk_fma_f32 v[6:7], v[64:65], v[64:65], v[6:7]
    v_pk_add_f32 v[64:65], v[58:59], v[4:5] op_sel_hi:[1,0] neg_lo:[0,1] neg_hi:[0,1]
    v_pk_fma_f32 v[6:7], v[64:65], v[64:65], v[6:7]
    v_pk_add_f32 v[64:65], v[60:61], v[4:5] op_sel_hi:[1,0] neg_lo:[0,1] neg_hi:[0,1]
    v_pk_fma_f32 v[6:7], v[64:65], v[64:65], v[6:7]
    v_pk_add_f32 v[64:65], v[62:63], v[4:5] op_sel_hi:[1,0] neg_lo:[0,1] neg_hi:[0,1]
    v_pk_fma_f32 v[6:7], v[64:65], v[64:65], v[6:7]
    v_add_f32 v5, v6, v7
    v_mov_b32 v6, v5
    s_nop 1
    v_permlane16_swap_b32 v5, v6
    v_add_f32 v5, v5, v6
    v_mov_b32 v6, v5
    s_nop 1
    v_permlane32_swap_b32 v5, v6
    v_add_f32 v5, v5, v6
    s_lshl_b32 s21, s17, 3
    v_lshlrev_b32 v6, 5, v1
    v_add_u32 v7, s21, v6
    ds_write_b64 v7, v[4:5]
    s_waitcnt lgkmcnt(0)
    s_barrier
    ds_read_b128 v[8:11], v6
    ds_read_b128 v[12:15], v6 offset:16
    s_waitcnt lgkmcnt(0)
    s_barrier
    v_add_f32 v4, v8, v10
    v_add_f32 v5, v12, v14
    v_add_f32 v4, v4, v5
    v_mul_f32 v4, 1048576000, v4
    v_add_f32 v9, v9, v11
    v_add_f32 v13, v13, v15
    v_add_f32 v9, v9, v13
    v_sub_f32 v8, v8, v4
    v_sub_f32 v10, v10, v4
    v_sub_f32 v12, v12, v4
    v_sub_f32 v14, v14, v4
    v_mul_f32 v11, v8, v8
    v_fma_f32 v11, v10, v10, v11
    v_fma_f32 v11, v12, v12, v11
    v_fma_f32 v11, v14, v14, v11
    v_mul_f32 v11, 1124073472, v11
    v_add_f32 v9, v9, v11
    v_mov_b32 v11, 925353388
    v_fmac_f32 v11, 989855744, v9
    v_rsq_f32 v5, v11
    s_nop 0
    v_pk_add_f32 v[32:33], v[32:33], v[4:5] op_sel_hi:[1,0] neg_lo:[0,1] neg_hi:[0,1]
    v_pk_mul_f32 v[32:33], v[32:33], v[4:5] op_sel:[0,1] op_sel_hi:[1,1]
    v_pk_add_f32 v[34:35], v[34:35], v[4:5] op_sel_hi:[1,0] neg_lo:[0,1] neg_hi:[0,1]
    v_pk_mul_f32 v[34:35], v[34:35], v[4:5] op_sel:[0,1] op_sel_hi:[1,1]
    v_pk_add_f32 v[36:37], v[36:37], v[4:5] op_sel_hi:[1,0] neg_lo:[0,1] neg_hi:[0,1]
    v_pk_mul_f32 v[36:37], v[36:37], v[4:5] op_sel:[0,1] op_sel_hi:[1,1]
    v_pk_add_f32 v[38:39], v[38:39], v[4:5] op_sel_hi:[1,0] neg_lo:[0,1] neg_hi:[0,1]
    v_pk_mul_f32 v[38:39], v[38:39], v[4:5] op_sel:[0,1] op_sel_hi:[1,1]
    v_pk_add_f32 v[40:41], v[40:41], v[4:5] op_sel_hi:[1,0] neg_lo:[0,1] neg_hi:[0,1]
    v_pk_mul_f32 v[40:41], v[40:41], v[4:5] op_sel:[0,1] op_sel_hi:[1,1]
    v_pk_add_f32 v[42:43], v[42:43], v[4:5] op_sel_hi:[1,0] neg_lo:[0,1] neg_hi:[0,1]
    v_pk_mul_f32 v[42:43], v[42:43], v[4:5] op_sel:[0,1] op_sel_hi:[1,1]
    v_pk_add_f32 v[44:45], v[44:45], v[4:5] op_sel_hi:[1,0] neg_lo:[0,1] neg_hi:[0,1]
    v_pk_mul_f32 v[44:45], v[44:45], v[4:5] op_sel:[0,1] op_sel_hi:[1,1]
    v_pk_add_f32 v[46:47], v[46:47], v[4:5] op_sel_hi:[1,0] neg_lo:[0,1] neg_hi:[0,1]
    v_pk_mul_f32 v[46:47], v[46:47], v[4:5] op_sel:[0,1] op_sel_hi:[1,1]
    v_pk_add_f32 v[48:49], v[48:49], v[4:5] op_sel_hi:[1,0] neg_lo:[0,1] neg_hi:[0,1]
    v_pk_mul_f32 v[48:49], v[48:49], v[4:5] op_sel:[0,1] op_sel_hi:[1,1]
    v_pk_add_f32 v[50:51], v[50:51], v[4:5] op_sel_hi:[1,0] neg_lo:[0,1] neg_hi:[0,1]
    v_pk_mul_f32 v[50:51], v[50:51], v[4:5] op_sel:[0,1] op_sel_hi:[1,1]
    v_pk_add_f32 v[52:53], v[52:53], v[4:5] op_sel_hi:[1,0] neg_lo:[0,1] neg_hi:[0,1]
    v_pk_mul_f32 v[52:53], v[52:53], v[4:5] op_sel:[0,1] op_sel_hi:[1,1]
    v_pk_add_f32 v[54:55], v[54:55], v[4:5] op_sel_hi:[1,0] neg_lo:[0,1] neg_hi:[0,1]
    v_pk_mul_f32 v[54:55], v[54:55], v[4:5] op_sel:[0,1] op_sel_hi:[1,1]
    v_pk_add_f32 v[56:57], v[56:57], v[4:5] op_sel_hi:[1,0] neg_lo:[0,1] neg_hi:[0,1]
    v_pk_mul_f32 v[56:57], v[56:57], v[4:5] op_sel:[0,1] op_sel_hi:[1,1]
    v_pk_add_f32 v[58:59], v[58:59], v[4:5] op_sel_hi:[1,0] neg_lo:[0,1] neg_hi:[0,1]
    v_pk_mul_f32 v[58:59], v[58:59], v[4:5] op_sel:[0,1] op_sel_hi:[1,1]
    v_pk_add_f32 v[60:61], v[60:61], v[4:5] op_sel_hi:[1,0] neg_lo:[0,1] neg_hi:[0,1]
    v_pk_mul_f32 v[60:61], v[60:61], v[4:5] op_sel:[0,1] op_sel_hi:[1,1]
    v_pk_add_f32 v[62:63], v[62:63], v[4:5] op_sel_hi:[1,0] neg_lo:[0,1] neg_hi:[0,1]
    v_pk_mul_f32 v[62:63], v[62:63], v[4:5] op_sel:[0,1] op_sel_hi:[1,1]
    v_cvt_pk_bf16_f32 v16, v32, v33
    v_cvt_pk_bf16_f32 v17, v40, v41
    v_cvt_pk_bf16_f32 v18, v34, v35
    v_cvt_pk_bf16_f32 v19, v42, v43
    v_cvt_pk_bf16_f32 v20, v36, v37
    v_cvt_pk_bf16_f32 v21, v44, v45
    v_cvt_pk_bf16_f32 v22, v38, v39
    v_cvt_pk_bf16_f32 v23, v46, v47
    v_cvt_pk_bf16_f32 v24, v48, v49
    v_cvt_pk_bf16_f32 v25, v56, v57
    v_cvt_pk_bf16_f32 v26, v50, v51
    v_cvt_pk_bf16_f32 v27, v58, v59
    v_cvt_pk_bf16_f32 v28, v52, v53
    v_cvt_pk_bf16_f32 v29, v60, v61
    v_cvt_pk_bf16_f32 v30, v54, v55
    v_cvt_pk_bf16_f32 v31, v62, v63
    v_lshlrev_b32 v3, 4, v1
    v_lshl_add_u32 v3, v2, 10, v3
    s_lshl_b32 s21, s96, 14
    s_lshl_b32 s22, s17, 12
    s_add_u32 s20, s21, s22
    buffer_store_dwordx4 v[16:19], v3, s[8:11], s20 offen offset:0 sc1
    buffer_store_dwordx4 v[20:23], v3, s[8:11], s20 offen offset:256 sc1
    buffer_store_dwordx4 v[24:27], v3, s[8:11], s20 offen offset:512 sc1
    buffer_store_dwordx4 v[28:31], v3, s[8:11], s20 offen offset:768 sc1
L_noln:
    s_waitcnt vmcnt(0)
    s_barrier
    s_mov_b32 s98, 0
    s_cmp_lg_u32 s17, 0
    s_cbranch_scc1 C_arr_skip
    s_and_b32 s96, s3, 3
    s_lshl_b32 s96, s96, 6
    s_lshl_b32 s97, s23, 2
    s_add_u32 s96, s96, s97
    s_add_u32 s96, s96, 32
    s_mov_b32 s98, 1
    s_atomic_add s98, s[88:89], s96 glc
C_arr_skip:
    s_waitcnt lgkmcnt(0)
    s_cmp_lg_u32 s98, 63
    s_cbranch_scc1 C_arr_done
    s_lshl_b32 s97, s23, 2
    s_add_u32 s96, s97, 40
    s_mov_b32 s98, 1
    s_atomic_add s98, s[88:89], s96 glc
    s_waitcnt lgkmcnt(0)
    s_cmp_lg_u32 s98, 3
    s_cbranch_scc1 C_arr_done
    v_mbcnt_lo_u32_b32 v126, -1, 0
    v_mbcnt_hi_u32_b32 v126, -1, v126
    s_mov_b32 s98, 3
    s_cmp_lg_u32 s23, 0
    s_cbranch_scc1 C_arr_tell
    v_lshlrev_b32 v125, 2, v126
    v_mov_b32 v127, 0
    buffer_atomic_add v127, v125, s[4:7], 0 offen sc0
    s_waitcnt vmcnt(0)
    v_cmp_ne_u32 vcc, 32, v127
    s_nop 0
    s_and_b32 s96, vcc_lo, 196609
    s_and_b32 s97, vcc_hi, 458755
    s_or_b32 s96, s96, s97
    s_cselect_b32 s98, 2, 1
C_arr_tell:
    v_lshlrev_b32 v126, 7, v126
    v_mov_b32 v127, s98
    s_mov_b32 s96, 65110016
    buffer_store_dword v127, v126, s[8:11], s96 offen sc1
    s_mov_b32 s96, 65118208
    buffer_store_dword v127, v126, s[8:11], s96 offen sc1
    s_mov_b32 s96, 65126400
    buffer_store_dword v127, v126, s[8:11], s96 offen sc1
    s_mov_b32 s96, 65134592
    buffer_store_dword v127, v126, s[8:11], s96 offen sc1
C_arr_done:
    v_xor_b32 v28, 0, v0
    v_lshlrev_b32 v16, 4, v28
    v_xor_b32 v28, 4, v0
    v_lshlrev_b32 v17, 4, v28
    v_xor_b32 v28, 8, v0
    v_lshlrev_b32 v18, 4, v28
    v_xor_b32 v28, 12, v0
    v_lshlrev_b32 v19, 4, v28
    v_lshrrev_b32 v28, 2, v0
    v_and_b32 v29, 3, v28
    v_lshlrev_b32 v29, 2, v29
    v_and_b32 v30, 3, v0
    v_add_u32 v29, v29, v30
    s_lshl_b32 s21, s17, 4
    v_add_u32 v29, s21, v29
    v_lshlrev_b32 v28, 10, v28
    v_lshl_add_u32 v20, v29, 4, v28
    v_add_u32 v21, 0x10000, v20
    v_lshrrev_b32 v28, 3, v0
    v_mul_u32_u24 v28, 3584, v28
    v_and_b32 v29, 7, v0
    v_bfe_u32 v30, v0, 4, 1
    v_lshlrev_b32 v30, 1, v30
    v_xor_b32 v29, v29, v30
    v_lshl_add_u32 v22, v29, 4, v28
    v_xor_b32 v29, 4, v29
    v_lshl_add_u32 v23, v29, 4, v28
    v_lshrrev_b32 v28, 4, v0
    v_lshlrev_b32 v28, 3, v28
    v_bfe_u32 v29, v0, 2, 2
    v_add_u32 v28, v28, v29
    v_lshlrev_b32 v28, 7, v28
    v_bfe_u32 v29, v0, 3, 2
    v_lshlrev_b32 v29, 1, v29
    v_bfe_u32 v30, v0, 1, 1
    s_lshl_b32 s21, s17, 1
    v_add_u32 v30, s21, v30
    v_xor_b32 v29, v29, v30
    v_lshl_add_u32 v28, v29, 4, v28
    v_and_b32 v29, 1, v0
    v_lshl_add_u32 v24, v29, 3, v28
    v_add_u32 v25, 0x10000, v24
    s_lshl_b32 s96, s3, 7
    s_add_u32 s96, s96, 65110016
    s_lshl_b32 s97, s23, 1
    s_mov_b32 s98, 0
C_go:
    buffer_load_dword v127, off, s[8:11], s96 sc1
    s_add_u32 s98, s98, 1
    s_cmp_gt_u32 s98, 400000
    s_cbranch_scc1 L_fail
    s_waitcnt vmcnt(0)
    v_readfirstlane_b32 s99, v127
    s_nop 0
    s_cmp_eq_u32 s99, s97
    s_cbranch_scc0 C_go_got
    s_branch C_go
C_go_got:
    s_cmp_eq_u32 s99, 2
    s_cbranch_scc1 L_redo
C_go_on:
    s_cmp_ge_u32 s19, 4
    s_cbranch_scc1 L_exit
    s_mov_b32 s40, 1
    v_mov_b32 v1, 0
    s_mov_b32 s37, 0
C_w0:
    buffer_load_dword v15, v1, s[8:11], s35 offen offset:0 sc1
    s_add_u32 s37, s37, 1
    s_cmp_gt_u32 s37, 400000
    s_cbranch_scc1 L_fail
    s_waitcnt vmcnt(0)
    v_cmp_gt_u32 vcc, s40, v15
    s_nop 0
    s_cbranch_vccz C_w0_ok
    s_branch C_w0
C_w0_ok:
C_load:
    s_mov_b32 s12, s74
    s_mov_b32 s13, s75
    s_mov_b32 s14, 4194304
    s_mov_b32 s15, 0x00020000
    s_lshl_b32 s21, s17, 13
    s_lshl_b32 s22, s16, 17
    s_add_u32 s22, s21, s22
    s_add_u32 s20, s22, 0
    s_add_u32 m0, s21, 0
    s_nop 0
    buffer_load_dwordx4 v16, s[12:15], s20 offen offset:0 nt lds
    buffer_load_dwordx4 v17, s[12:15], s20 offen offset:1024 nt lds
    buffer_load_dwordx4 v18, s[12:15], s20 offen offset:2048 nt lds
    buffer_load_dwordx4 v19, s[12:15], s20 offen offset:3072 nt lds
    s_lshl_b32 s21, s17, 13
    s_lshl_b32 s22, s16, 17
    s_add_u32 s22, s21, s22
    s_add_u32 s20, s22, 4096
    s_add_u32 m0, s21, 4096
    s_nop 0
    buffer_load_dwordx4 v16, s[12:15], s20 offen offset:0 nt lds
    buffer_load_dwordx4 v17, s[12:15], s20 offen offset:1024 nt lds
    buffer_load_dwordx4 v18, s[12:15], s20 offen offset:2048 nt lds
    buffer_load_dwordx4 v19, s[12:15], s20 offen offset:3072 nt lds
    s_waitcnt vmcnt(0)
    s_barrier
    s_mov_b32 s12, s74
    s_mov_b32 s13, s75
    s_mov_b32 s14, 4194304
    s_mov_b32 s15, 0x00020000
    s_lshl_b32 s21, s17, 13
    s_lshl_b32 s22, s16, 17
    s_add_u32 s22, s21, s22
    s_add_u32 s20, s22, 32768
    s_add_u32 m0, s21, 32768
    s_nop 0
    buffer_load_dwordx4 v16, s[12:15], s20 offen offset:0 nt lds
    buffer_load_dwordx4 v17, s[12:15], s20 offen offset:1024 nt lds
    buffer_load_dwordx4 v18, s[12:15], s20 offen offset:2048 nt lds
    buffer_load_dwordx4 v19, s[12:15], s20 offen offset:3072 nt lds
    s_lshl_b32 s21, s17, 13
    s_lshl_b32 s22, s16, 17
    s_add_u32 s22, s21, s22
    s_add_u32 s20, s22, 36864
    s_add_u32 m0, s21, 36864
    s_nop 0
    buffer_load_dwordx4 v16, s[12:15], s20 offen offset:0 nt lds
    buffer_load_dwordx4 v17, s[12:15], s20 offen offset:1024 nt lds
    buffer_load_dwordx4 v18, s[12:15], s20 offen offset:2048 nt lds
    buffer_load_dwordx4 v19, s[12:15], s20 offen offset:3072 nt lds
    v_xor_b32 v28, 0, v20
    v_xor_b32 v29, 64, v20
    v_xor_b32 v30, 128, v20
    v_xor_b32 v31, 192, v20
    ds_read_b64_tr_b16 a[0:1], v28 offset:0
    ds_read_b64_tr_b16 a[2:3], v28 offset:16384
    ds_read_b64_tr_b16 a[16:17], v28 offset:8
    ds_read_b64_tr_b16 a[18:19], v28 offset:16392
    ds_read_b64_tr_b16 a[32:33], v29 offset:0
    ds_read_b64_tr_b16 a[34:35], v29 offset:16384
    ds_read_b64_tr_b16 a[48:49], v29 offset:8
    ds_read_b64_tr_b16 a[50:51], v29 offset:16392
    ds_read_b64_tr_b16 a[64:65], v30 offset:0
    ds_read_b64_tr_b16 a[66:67], v30 offset:16384
    ds_read_b64_tr_b16 a[80:81], v30 offset:8
    ds_read_b64_tr_b16 a[82:83], v30 offset:16392
    ds_read_b64_tr_b16 a[96:97], v31 offset:0
    ds_read_b64_tr_b16 a[98:99], v31 offset:16384
    ds_read_b64_tr_b16 a[112:113], v31 offset:8
    ds_read_b64_tr_b16 a[114:115], v31 offset:16392
    s_waitcnt lgkmcnt(0)
    s_waitcnt vmcnt(0)
    s_barrier
    s_mov_b32 s12, s74
    s_mov_b32 s13, s75
    s_mov_b32 s14, 4194304
    s_mov_b32 s15, 0x00020000
    s_lshl_b32 s21, s17, 13
    s_lshl_b32 s22, s16, 17
    s_add_u32 s22, s21, s22
    s_add_u32 s20, s22, 65536
    s_add_u32 m0, s21, 65536
    s_nop 0
    buffer_load_dwordx4 v16, s[12:15], s20 offen offset:0 nt lds
    buffer_load_dwordx4 v17, s[12:15], s20 offen offset:1024 nt lds
    buffer_load_dwordx4 v18, s[12:15], s20 offen offset:2048 nt lds
    buffer_load_dwordx4 v19, s[12:15], s20 offen offset:3072 nt lds
    s_lshl_b32 s21, s17, 13
    s_lshl_b32 s22, s16, 17
    s_add_u32 s22, s21, s22
    s_add_u32 s20, s22, 69632
    s_add_u32 m0, s21, 69632
    s_nop 0
    buffer_load_dwordx4 v16, s[12:15], s20 offen offset:0 nt lds
    buffer_load_dwordx4 v17, s[12:15], s20 offen offset:1024 nt lds
    buffer_load_dwordx4 v18, s[12:15], s20 offen offset:2048 nt lds
    buffer_load_dwordx4 v19, s[12:15], s20 offen offset:3072 nt lds
    v_xor_b32 v28, 0, v20
    v_xor_b32 v29, 64, v20
    v_xor_b32 v30, 128, v20
    v_xor_b32 v31, 192, v20
    ds_read_b64_tr_b16 a[4:5], v28 offset:32768
    ds_read_b64_tr_b16 a[6:7], v28 offset:49152
    ds_read_b64_tr_b16 a[20:21], v28 offset:32776
    ds_read_b64_tr_b16 a[22:23], v28 offset:49160
    ds_read_b64_tr_b16 a[36:37], v29 offset:32768
    ds_read_b64_tr_b16 a[38:39], v29 offset:49152
    ds_read_b64_tr_b16 a[52:53], v29 offset:32776
    ds_read_b64_tr_b16 a[54:55], v29 offset:49160
    ds_read_b64_tr_b16 a[68:69], v30 offset:32768
    ds_read_b64_tr_b16 a[70:71], v30 offset:49152
    ds_read_b64_tr_b16 a[84:85], v30 offset:32776
    ds_read_b64_tr_b16 a[86:87], v30 offset:49160
    ds_read_b64_tr_b16 a[100:101], v31 offset:32768
    ds_read_b64_tr_b16 a[102:103], v31 offset:49152
    ds_read_b64_tr_b16 a[116:117], v31 offset:32776
    ds_read_b64_tr_b16 a[118:119], v31 offset:49160
    s_waitcnt lgkmcnt(0)
    s_waitcnt vmcnt(0)
    s_barrier
    s_mov_b32 s12, s74
    s_mov_b32 s13, s75
    s_mov_b32 s14, 4194304
    s_mov_b32 s15, 0x00020000
    s_lshl_b32 s21, s17, 13
    s_lshl_b32 s22, s16, 17
    s_add_u32 s22, s21, s22
    s_add_u32 s20, s22, 98304
    s_add_u32 m0, s21, 98304
    s_nop 0
    buffer_load_dwordx4 v16, s[12:15], s20 offen offset:0 nt lds
    buffer_load_dwordx4 v17, s[12:15], s20 offen offset:1024 nt lds
    buffer_load_dwordx4 v18, s[12:15], s20 offen offset:2048 nt lds
    buffer_load_dwordx4 v19, s[12:15], s20 offen offset:3072 nt lds
    s_lshl_b32 s21, s17, 13
    s_lshl_b32 s22, s16, 17
    s_add_u32 s22, s21, s22
    s_add_u32 s20, s22, 102400
    s_add_u32 m0, s21, 102400
    s_nop 0
    buffer_load_dwordx4 v16, s[12:15], s20 offen offset:0 nt lds
    buffer_load_dwordx4 v17, s[12:15], s20 offen offset:1024 nt lds
    buffer_load_dwordx4 v18, s[12:15], s20 offen offset:2048 nt lds
    buffer_load_dwordx4 v19, s[12:15], s20 offen offset:3072 nt lds
    v_xor_b32 v28, 0, v21
    v_xor_b32 v29, 64, v21
    v_xor_b32 v30, 128, v21
    v_xor_b32 v31, 192, v21
    ds_read_b64_tr_b16 a[8:9], v28 offset:0
    ds_read_b64_tr_b16 a[10:11], v28 offset:16384
    ds_read_b64_tr_b16 a[24:25], v28 offset:8
    ds_read_b64_tr_b16 a[26:27], v28 offset:16392
    ds_read_b64_tr_b16 a[40:41], v29 offset:0
    ds_read_b64_tr_b16 a[42:43], v29 offset:16384
    ds_read_b64_tr_b16 a[56:57], v29 offset:8
    ds_read_b64_tr_b16 a[58:59], v29 offset:16392
    ds_read_b64_tr_b16 a[72:73], v30 offset:0
    ds_read_b64_tr_b16 a[74:75], v30 offset:16384
    ds_read_b64_tr_b16 a[88:89], v30 offset:8
    ds_read_b64_tr_b16 a[90:91], v30 offset:16392
    ds_read_b64_tr_b16 a[104:105], v31 offset:0
    ds_read_b64_tr_b16 a[106:107], v31 offset:16384
    ds_read_b64_tr_b16 a[120:121], v31 offset:8
    ds_read_b64_tr_b16 a[122:123], v31 offset:16392
    s_waitcnt lgkmcnt(0)
    s_waitcnt vmcnt(0)
    s_barrier
    s_mov_b32 s12, s80
    s_mov_b32 s13, s81
    s_mov_b32 s14, 1835008
    s_mov_b32 s15, 0x00020000
    s_mul_i32 s21, s17, 229376
    s_lshl_b32 s22, s16, 7
    s_add_u32 s22, s21, s22
    s_lshl_b32 s21, s17, 13
    s_add_u32 s20, s22, 0
    s_add_u32 m0, s21, 0
    s_nop 0
    buffer_load_dwordx4 v22, s[12:15], s20 offen nt lds
    s_add_u32 s20, s22, 28672
    s_add_u32 m0, s21, 1024
    s_nop 0
    buffer_load_dwordx4 v23, s[12:15], s20 offen nt lds
    s_add_u32 s20, s22, 57344
    s_add_u32 m0, s21, 2048
    s_nop 0
    buffer_load_dwordx4 v22, s[12:15], s20 offen nt lds
    s_add_u32 s20, s22, 86016
    s_add_u32 m0, s21, 3072
    s_nop 0
    buffer_load_dwordx4 v23, s[12:15], s20 offen nt lds
    s_add_u32 s20, s22, 114688
    s_add_u32 m0, s21, 4096
    s_nop 0
    buffer_load_dwordx4 v22, s[12:15], s20 offen nt lds
    s_add_u32 s20, s22, 143360
    s_add_u32 m0, s21, 5120
    s_nop 0
    buffer_load_dwordx4 v23, s[12:15], s20 offen nt lds
    s_add_u32 s20, s22, 172032
    s_add_u32 m0, s21, 6144
    s_nop 0
    buffer_load_dwordx4 v22, s[12:15], s20 offen nt lds
    s_add_u32 s20, s22, 200704
    s_add_u32 m0, s21, 7168
    s_nop 0
    buffer_load_dwordx4 v23, s[12:15], s20 offen nt lds
    v_xor_b32 v28, 0, v21
    v_xor_b32 v29, 64, v21
    v_xor_b32 v30, 128, v21
    v_xor_b32 v31, 192, v21
    ds_read_b64_tr_b16 a[12:13], v28 offset:32768
    ds_read_b64_tr_b16 a[14:15], v28 offset:49152
    ds_read_b64_tr_b16 a[28:29], v28 offset:32776
    ds_read_b64_tr_b16 a[30:31], v28 offset:49160
    ds_read_b64_tr_b16 a[44:45], v29 offset:32768
    ds_read_b64_tr_b16 a[46:47], v29 offset:49152
    ds_read_b64_tr_b16 a[60:61], v29 offset:32776
    ds_read_b64_tr_b16 a[62:63], v29 offset:49160
    ds_read_b64_tr_b16 a[76:77], v30 offset:32768
    ds_read_b64_tr_b16 a[78:79], v30 offset:49152
    ds_read_b64_tr_b16 a[92:93], v30 offset:32776
    ds_read_b64_tr_b16 a[94:95], v30 offset:49160
    ds_read_b64_tr_b16 a[108:109], v31 offset:32768
    ds_read_b64_tr_b16 a[110:111], v31 offset:49152
    ds_read_b64_tr_b16 a[124:125], v31 offset:32776
    ds_read_b64_tr_b16 a[126:127], v31 offset:49160
    s_waitcnt lgkmcnt(0)
    s_waitcnt vmcnt(0)
    s_barrier
    s_mov_b32 s12, s80
    s_mov_b32 s13, s81
    s_mov_b32 s14, 1835008
    s_mov_b32 s15, 0x00020000
    s_mul_i32 s21, s17, 229376
    s_lshl_b32 s22, s16, 7
    s_add_u32 s22, s21, s22
    s_lshl_b32 s21, s17, 13
    s_add_u32 s20, s22, 917504
    s_add_u32 m0, s21, 32768
    s_nop 0
    buffer_load_dwordx4 v22, s[12:15], s20 offen nt lds
    s_add_u32 s20, s22, 946176
    s_add_u32 m0, s21, 33792
    s_nop 0
    buffer_load_dwordx4 v23, s[12:15], s20 offen nt lds
    s_add_u32 s20, s22, 974848
    s_add_u32 m0, s21, 34816
    s_nop 0
    buffer_load_dwordx4 v22, s[12:15], s20 offen nt lds
    s_add_u32 s20, s22, 1003520
    s_add_u32 m0, s21, 35840
    s_nop 0
    buffer_load_dwordx4 v23, s[12:15], s20 offen nt lds
    s_add_u32 s20, s22, 1032192
    s_add_u32 m0, s21, 36864
    s_nop 0
    buffer_load_dwordx4 v22, s[12:15], s20 offen nt lds
    s_add_u32 s20, s22, 1060864
    s_add_u32 m0, s21, 37888
    s_nop 0
    buffer_load_dwordx4 v23, s[12:15], s20 offen nt lds
    s_add_u32 s20, s22, 1089536
    s_add_u32 m0, s21, 38912
    s_nop 0
    buffer_load_dwordx4 v22, s[12:15], s20 offen nt lds
    s_add_u32 s20, s22, 1118208
    s_add_u32 m0, s21, 39936
    s_nop 0
    buffer_load_dwordx4 v23, s[12:15], s20 offen nt lds
    ds_read_b64_tr_b16 a[128:129], v24 offset:0
    ds_read_b64_tr_b16 a[130:131], v24 offset:512
    ds_read_b64_tr_b16 a[132:133], v24 offset:4096
    ds_read_b64_tr_b16 a[134:135], v24 offset:4608
    ds_read_b64_tr_b16 a[136:137], v24 offset:8192
    ds_read_b64_tr_b16 a[138:139], v24 offset:8704
    ds_read_b64_tr_b16 a[140:141], v24 offset:12288
    ds_read_b64_tr_b16 a[142:143], v24 offset:12800
    ds_read_b64_tr_b16 a[144:145], v24 offset:16384
    ds_read_b64_tr_b16 a[146:147], v24 offset:16896
    ds_read_b64_tr_b16 a[148:149], v24 offset:20480
    ds_read_b64_tr_b16 a[150:151], v24 offset:20992
    ds_read_b64_tr_b16 a[152:153], v24 offset:24576
    ds_read_b64_tr_b16 a[154:155], v24 offset:25088
    ds_read_b64_tr_b16 a[156:157], v24 offset:28672
    ds_read_b64_tr_b16 a[158:159], v24 offset:29184
    s_waitcnt lgkmcnt(0)
    s_waitcnt vmcnt(0)
    s_barrier
    s_mov_b32 s12, s82
    s_mov_b32 s13, s83
    s_mov_b32 s14, 1835008
    s_mov_b32 s15, 0x00020000
    s_mul_i32 s21, s17, 229376
    s_lshl_b32 s22, s16, 7
    s_add_u32 s22, s21, s22
    s_lshl_b32 s21, s17, 13
    s_add_u32 s20, s22, 0
    s_add_u32 m0, s21, 65536
    s_nop 0
    buffer_load_dwordx4 v22, s[12:15], s20 offen nt lds
    s_add_u32 s20, s22, 28672
    s_add_u32 m0, s21, 66560
    s_nop 0
    buffer_load_dwordx4 v23, s[12:15], s20 offen nt lds
    s_add_u32 s20, s22, 57344
    s_add_u32 m0, s21, 67584
    s_nop 0
    buffer_load_dwordx4 v22, s[12:15], s20 offen nt lds
    s_add_u32 s20, s22, 86016
    s_add_u32 m0, s21, 68608
    s_nop 0
    buffer_load_dwordx4 v23, s[12:15], s20 offen nt lds
    s_add_u32 s20, s22, 114688
    s_add_u32 m0, s21, 69632
    s_nop 0
    buffer_load_dwordx4 v22, s[12:15], s20 offen nt lds
    s_add_u32 s20, s22, 143360
    s_add_u32 m0, s21, 70656
    s_nop 0
    buffer_load_dwordx4 v23, s[12:15], s20 offen nt lds
    s_add_u32 s20, s22, 172032
    s_add_u32 m0, s21, 71680
    s_nop 0
    buffer_load_dwordx4 v22, s[12:15], s20 offen nt lds
    s_add_u32 s20, s22, 200704
    s_add_u32 m0, s21, 72704
    s_nop 0
    buffer_load_dwordx4 v23, s[12:15], s20 offen nt lds
    ds_read_b64_tr_b16 a[160:161], v24 offset:32768
    ds_read_b64_tr_b16 a[162:163], v24 offset:33280
    ds_read_b64_tr_b16 a[164:165], v24 offset:36864
    ds_read_b64_tr_b16 a[166:167], v24 offset:37376
    ds_read_b64_tr_b16 a[168:169], v24 offset:40960
    ds_read_b64_tr_b16 a[170:171], v24 offset:41472
    ds_read_b64_tr_b16 a[172:173], v24 offset:45056
    ds_read_b64_tr_b16 a[174:175], v24 offset:45568
    ds_read_b64_tr_b16 a[176:177], v24 offset:49152
    ds_read_b64_tr_b16 a[178:179], v24 offset:49664
    ds_read_b64_tr_b16 a[180:181], v24 offset:53248
    ds_read_b64_tr_b16 a[182:183], v24 offset:53760
    ds_read_b64_tr_b16 a[184:185], v24 offset:57344
    ds_read_b64_tr_b16 a[186:187], v24 offset:57856
    ds_read_b64_tr_b16 a[188:189], v24 offset:61440
    ds_read_b64_tr_b16 a[190:191], v24 offset:61952
    s_waitcnt lgkmcnt(0)
    s_waitcnt vmcnt(0)
    s_barrier
    s_mov_b32 s12, s82
    s_mov_b32 s13, s83
    s_mov_b32 s14, 1835008
    s_mov_b32 s15, 0x00020000
    s_mul_i32 s21, s17, 229376
    s_lshl_b32 s22, s16, 7
    s_add_u32 s22, s21, s22
    s_lshl_b32 s21, s17, 13
    s_add_u32 s20, s22, 917504
    s_add_u32 m0, s21, 98304
    s_nop 0
    buffer_load_dwordx4 v22, s[12:15], s20 offen nt lds
    s_add_u32 s20, s22, 946176
    s_add_u32 m0, s21, 99328
    s_nop 0
    buffer_load_dwordx4 v23, s[12:15], s20 offen nt lds
    s_add_u32 s20, s22, 974848
    s_add_u32 m0, s21, 100352
    s_nop 0
    buffer_load_dwordx4 v22, s[12:15], s20 offen nt lds
    s_add_u32 s20, s22, 1003520
    s_add_u32 m0, s21, 101376
    s_nop 0
    buffer_load_dwordx4 v23, s[12:15], s20 offen nt lds
    s_add_u32 s20, s22, 1032192
    s_add_u32 m0, s21, 102400
    s_nop 0
    buffer_load_dwordx4 v22, s[12:15], s20 offen nt lds
    s_add_u32 s20, s22, 1060864
    s_add_u32 m0, s21, 103424
    s_nop 0
    buffer_load_dwordx4 v23, s[12:15], s20 offen nt lds
    s_add_u32 s20, s22, 1089536
    s_add_u32 m0, s21, 104448
    s_nop 0
    buffer_load_dwordx4 v22, s[12:15], s20 offen nt lds
    s_add_u32 s20, s22, 1118208
    s_add_u32 m0, s21, 105472
    s_nop 0
    buffer_load_dwordx4 v23, s[12:15], s20 offen nt lds
    ds_read_b64_tr_b16 a[192:193], v25 offset:0
    ds_read_b64_tr_b16 a[194:195], v25 offset:512
    ds_read_b64_tr_b16 a[196:197], v25 offset:4096
    ds_read_b64_tr_b16 a[198:199], v25 offset:4608
    ds_read_b64_tr_b16 a[200:201], v25 offset:8192
    ds_read_b64_tr_b16 a[202:203], v25 offset:8704
    ds_read_b64_tr_b16 a[204:205], v25 offset:12288
    ds_read_b64_tr_b16 a[206:207], v25 offset:12800
    ds_read_b64_tr_b16 a[208:209], v25 offset:16384
    ds_read_b64_tr_b16 a[210:211], v25 offset:16896
    ds_read_b64_tr_b16 a[212:213], v25 offset:20480
    ds_read_b64_tr_b16 a[214:215], v25 offset:20992
    ds_read_b64_tr_b16 a[216:217], v25 offset:24576
    ds_read_b64_tr_b16 a[218:219], v25 offset:25088
    ds_read_b64_tr_b16 a[220:221], v25 offset:28672
    ds_read_b64_tr_b16 a[222:223], v25 offset:29184
    s_waitcnt lgkmcnt(0)
    s_waitcnt vmcnt(0)
    s_barrier
    s_mov_b32 s12, s84
    s_mov_b32 s13, s85
    s_mov_b32 s14, 1835008
    s_mov_b32 s15, 0x00020000
    s_lshl_b32 s21, s17, 13
    s_lshl_b32 s22, s16, 16
    s_add_u32 s22, s21, s22
    s_add_u32 s20, s22, 0
    s_add_u32 m0, s21, 0
    s_nop 0
    buffer_load_dwordx4 v16, s[12:15], s20 offen offset:0 nt lds
    buffer_load_dwordx4 v17, s[12:15], s20 offen offset:1024 nt lds
    buffer_load_dwordx4 v18, s[12:15], s20 offen offset:2048 nt lds
    buffer_load_dwordx4 v19, s[12:15], s20 offen offset:3072 nt lds
    s_lshl_b32 s21, s17, 13
    s_lshl_b32 s22, s16, 16
    s_add_u32 s22, s21, s22
    s_add_u32 s20, s22, 4096
    s_add_u32 m0, s21, 4096
    s_nop 0
    buffer_load_dwordx4 v16, s[12:15], s20 offen offset:0 nt lds
    buffer_load_dwordx4 v17, s[12:15], s20 offen offset:1024 nt lds
    buffer_load_dwordx4 v18, s[12:15], s20 offen offset:2048 nt lds
    buffer_load_dwordx4 v19, s[12:15], s20 offen offset:3072 nt lds
    ds_read_b64_tr_b16 a[224:225], v25 offset:32768
    ds_read_b64_tr_b16 a[226:227], v25 offset:33280
    ds_read_b64_tr_b16 a[228:229], v25 offset:36864
    ds_read_b64_tr_b16 a[230:231], v25 offset:37376
    ds_read_b64_tr_b16 a[232:233], v25 offset:40960
    ds_read_b64_tr_b16 a[234:235], v25 offset:41472
    ds_read_b64_tr_b16 a[236:237], v25 offset:45056
    ds_read_b64_tr_b16 a[238:239], v25 offset:45568
    ds_read_b64_tr_b16 a[240:241], v25 offset:49152
    ds_read_b64_tr_b16 a[242:243], v25 offset:49664
    ds_read_b64_tr_b16 a[244:245], v25 offset:53248
    ds_read_b64_tr_b16 a[246:247], v25 offset:53760
    ds_read_b64_tr_b16 a[248:249], v25 offset:57344
    ds_read_b64_tr_b16 a[250:251], v25 offset:57856
    ds_read_b64_tr_b16 a[252:253], v25 offset:61440
    ds_read_b64_tr_b16 a[254:255], v25 offset:61952
    s_waitcnt lgkmcnt(0)
    s_waitcnt vmcnt(0)
    s_barrier
    s_mov_b32 s12, s84
    s_mov_b32 s13, s85
    s_mov_b32 s14, 1835008
    s_mov_b32 s15, 0x00020000
    s_lshl_b32 s21, s17, 13
    s_lshl_b32 s22, s16, 16
    s_add_u32 s22, s21, s22
    s_add_u32 s20, s22, 32768
    s_add_u32 m0, s21, 32768
    s_nop 0
    buffer_load_dwordx4 v16, s[12:15], s20 offen offset:0 nt lds
    buffer_load_dwordx4 v17, s[12:15], s20 offen offset:1024 nt lds
    buffer_load_dwordx4 v18, s[12:15], s20 offen offset:2048 nt lds
    buffer_load_dwordx4 v19, s[12:15], s20 offen offset:3072 nt lds
    s_lshl_b32 s21, s17, 13
    s_lshl_b32 s22, s16, 16
    s_add_u32 s22, s21, s22
    s_add_u32 s20, s22, 36864
    s_add_u32 m0, s21, 36864
    s_nop 0
    buffer_load_dwordx4 v16, s[12:15], s20 offen offset:0 nt lds
    buffer_load_dwordx4 v17, s[12:15], s20 offen offset:1024 nt lds
    buffer_load_dwordx4 v18, s[12:15], s20 offen offset:2048 nt lds
    buffer_load_dwordx4 v19, s[12:15], s20 offen offset:3072 nt lds
    v_xor_b32 v28, 0, v20
    v_xor_b32 v29, 64, v20
    v_xor_b32 v30, 128, v20
    v_xor_b32 v31, 192, v20
    ds_read_b64_tr_b16 v[192:193], v28 offset:0
    ds_read_b64_tr_b16 v[194:195], v28 offset:16384
    ds_read_b64_tr_b16 v[200:201], v28 offset:8
    ds_read_b64_tr_b16 v[202:203], v28 offset:16392
    ds_read_b64_tr_b16 v[208:209], v29 offset:0
    ds_read_b64_tr_b16 v[210:211], v29 offset:16384
    ds_read_b64_tr_b16 v[216:217], v29 offset:8
    ds_read_b64_tr_b16 v[218:219], v29 offset:16392
    ds_read_b64_tr_b16 v[224:225], v30 offset:0
    ds_read_b64_tr_b16 v[226:227], v30 offset:16384
    ds_read_b64_tr_b16 v[232:233], v30 offset:8
    ds_read_b64_tr_b16 v[234:235], v30 offset:16392
    ds_read_b64_tr_b16 v[240:241], v31 offset:0
    ds_read_b64_tr_b16 v[242:243], v31 offset:16384
    ds_read_b64_tr_b16 v[248:249], v31 offset:8
    ds_read_b64_tr_b16 v[250:251], v31 offset:16392
    s_waitcnt lgkmcnt(0)
    s_waitcnt vmcnt(0)
    s_barrier
    v_xor_b32 v28, 0, v20
    v_xor_b32 v29, 64, v20
    v_xor_b32 v30, 128, v20
    v_xor_b32 v31, 192, v20
    ds_read_b64_tr_b16 v[196:197], v28 offset:32768
    ds_read_b64_tr_b16 v[198:199], v28 offset:49152
    ds_read_b64_tr_b16 v[204:205], v28 offset:32776
    ds_read_b64_tr_b16 v[206:207], v28 offset:49160
    ds_read_b64_tr_b16 v[212:213], v29 offset:32768
    ds_read_b64_tr_b16 v[214:215], v29 offset:49152
    ds_read_b64_tr_b16 v[220:221], v29 offset:32776
    ds_read_b64_tr_b16 v[222:223], v29 offset:49160
    ds_read_b64_tr_b16 v[228:229], v30 offset:32768
    ds_read_b64_tr_b16 v[230:231], v30 offset:49152
    ds_read_b64_tr_b16 v[236:237], v30 offset:32776
    ds_read_b64_tr_b16 v[238:239], v30 offset:49160
    ds_read_b64_tr_b16 v[244:245], v31 offset:32768
    ds_read_b64_tr_b16 v[246:247], v31 offset:49152
    ds_read_b64_tr_b16 v[252:253], v31 offset:32776
    ds_read_b64_tr_b16 v[254:255], v31 offset:49160
    s_waitcnt lgkmcnt(0)
    s_barrier
    s_waitcnt lgkmcnt(0)
    v_mov_b32 v32, v0
    v_and_b32 v36, 15, v32
    v_lshrrev_b32 v37, 4, v32
    v_lshlrev_b32 v0, 4, v32
    v_bfe_u32 v33, v32, 2, 1
    v_lshlrev_b32 v33, 12, v33
    v_lshl_add_u32 v33, v37, 8, v33
    v_bfe_u32 v34, v32, 3, 1
    v_lshl_add_u32 v33, v34, 6, v33
    v_and_b32 v34, 3, v32
    v_lshl_add_u32 v1, v34, 4, v33
    v_add_u32 v1, 65536, v1
    v_lshrrev_b32 v33, 3, v32
    v_mul_u32_u24 v33, 32896, v33
    v_and_b32 v34, 7, v32
    v_lshl_add_u32 v2, v34, 4, v33
    v_lshlrev_b32 v33, 10, v37
    v_lshl_add_u32 v3, v36, 4, v33
    v_mov_b32 v35, 2147483392
    v_cmp_gt_u32 vcc, 32, v32
    v_lshlrev_b32 v33, 4, v36
    v_lshl_add_u32 v33, v37, 3, v33
    v_cndmask_b32 v4, v35, v33, vcc
    s_bfe_u32 s21, s16, 196609
    v_and_b32 v33, 7, v32
    v_xor_b32 v33, s21, v33
    v_lshlrev_b32 v33, 4, v33
    v_bfe_u32 v34, v32, 3, 1
    v_lshl_add_u32 v33, v34, 11, v33
    v_lshl_add_u32 v33, v37, 3, v33
    v_cndmask_b32 v5, v35, v33, vcc
    v_lshrrev_b32 v33, 1, v36
    v_xor_b32 v33, v33, v37
    v_lshlrev_b32 v33, 4, v33
    v_lshl_add_u32 v6, v36, 7, v33
    v_xor_b32 v7, 64, v6
    s_lshl_b32 s21, s17, 12
    v_and_b32 v33, 3, v32
    v_lshlrev_b32 v33, 4, v33
    v_lshrrev_b32 v34, 2, v32
    v_add_u32 v33, v33, v34
    v_lshlrev_b32 v33, 4, v33
    v_add_u32 v8, s21, v33
    s_lshr_b32 s22, s17, 1
    s_lshl_b32 s22, s22, 11
    s_add_u32 s21, s21, s22
    s_add_u32 s21, s21, 8
    v_add_u32 v9, s21, v0
    v_and_b32 v33, 31, v32
    v_lshlrev_b32 v10, 2, v33
    v_cmp_eq_u32 vcc, 0, v32
    s_nop 1
    v_cndmask_b32 v11, v35, v32, vcc
    v_and_b32 v33, 3, v32
    v_lshlrev_b32 v12, 2, v33
    s_and_b32 s21, s17, 1
    s_lshr_b32 s22, s17, 1
    s_lshl_b32 s41, s21, 3
    s_lshl_b32 s42, s22, 10
    s_add_u32 s41, s41, s42
    v_add_u32 v13, s41, v0
    s_lshl_b32 s41, s21, 12
    s_lshl_b32 s42, s22, 11
    s_add_u32 s41, s41, s42
    v_add_u32 v14, s41, v0
    s_lshl_b32 s21, s21, 4
    v_add_u32 v33, s21, v36
    v_and_b32 v34, 1, v37
    v_lshlrev_b32 v34, 4, v34
    v_sub_u32 v33, v33, v34
    v_lshrrev_b32 v34, 1, v37
    v_lshlrev_b32 v34, 2, v34
    v_sub_u32 v33, v33, v34
    v_mov_b32 v34, 0xff800000
    v_cmp_gt_i32 vcc, 0, v33
    s_nop 1
    v_cndmask_b32 v16, 0, v34, vcc
    v_cmp_gt_i32 vcc, 1, v33
    s_nop 1
    v_cndmask_b32 v17, 0, v34, vcc
    v_cmp_gt_i32 vcc, 2, v33
    s_nop 1
    v_cndmask_b32 v18, 0, v34, vcc
    v_cmp_gt_i32 vcc, 3, v33
    s_nop 1
    v_cndmask_b32 v19, 0, v34, vcc
    v_cmp_gt_i32 vcc, 8, v33
    s_nop 1
    v_cndmask_b32 v20, 0, v34, vcc
    v_cmp_gt_i32 vcc, 9, v33
    s_nop 1
    v_cndmask_b32 v21, 0, v34, vcc
    v_cmp_gt_i32 vcc, 10, v33
    s_nop 1
    v_cndmask_b32 v22, 0, v34, vcc
    v_cmp_gt_i32 vcc, 11, v33
    s_nop 1
    v_cndmask_b32 v23, 0, v34, vcc
    v_cmp_lt_u32 vcc, 1, v37
    s_nop 1
    v_cndmask_b32 v24, 0, v34, vcc
    v_and_b32 v33, 1, v36
    v_lshlrev_b32 v33, 4, v33
    v_mov_b32 v34, 0x3f80
    v_lshlrev_b32 v35, v33, v34
    v_lshrrev_b32 v33, 1, v36
    v_cmp_eq_u32 vcc, 0, v33
    s_nop 1
    v_cndmask_b32 v28, 0, v35, vcc
    v_cmp_eq_u32 vcc, 1, v33
    s_nop 1
    v_cndmask_b32 v29, 0, v35, vcc
    v_cmp_eq_u32 vcc, 2, v33
    s_nop 1
    v_cndmask_b32 v30, 0, v35, vcc
    v_cmp_eq_u32 vcc, 3, v33
    s_nop 1
    v_cndmask_b32 v31, 0, v35, vcc
    v_lshrrev_b32 v80, 4, v0
    v_and_b32 v81, 15, v80
    v_lshrrev_b32 v80, 4, v80
    s_mul_i32 s41, s17, 8704
    s_add_u32 s41, s41, 98304
    v_mul_u32_u24 v82, 272, v81
    v_lshl_add_u32 v82, v80, 4, v82
    v_add_u32 v82, s41, v82
    v_lshrrev_b32 v80, 7, v0
    v_and_b32 v81, 0x70, v0
    v_mul_u32_u24 v83, 272, v80
    v_add3_u32 v83, s41, v83, v81
    s_and_b32 s41, s17, 1
    s_lshl_b32 s41, s41, 12
    s_add_u32 s41, s41, 81920
    v_add_u32 v85, s41, v0
    s_lshr_b32 s41, s17, 1
    s_lshl_b32 s41, s41, 12
    s_add_u32 s41, s41, 73728
    v_add_u32 v86, s41, v0
    s_lshl_b32 s41, s17, 4
    v_lshrrev_b32 v87, 5, v0
    v_add_u32 v87, s41, v87
    v_mov_b32 v88, 0
    v_mov_b32 v90, v0
    s_mov_b32 s76, 0
    s_mov_b32 s78, 0
    s_mov_b32 s77, -1
    s_cmp_lg_u32 s23, 0
    s_cbranch_scc1 C_first_s
C_first:
    s_mov_b32 s43, 0
    s_add_u32 s41, s24, 0
    s_lshr_b32 s40, s41, 1
    s_add_u32 s40, s40, 1
    s_max_u32 s40, s40, 2
    s_and_b32 s41, s41, 1
    s_lshl_b32 s41, s41, 12
    s_add_u32 s42, s41, s34
    s_mov_b32 s37, 0
C_wp0:
    buffer_load_dword v15, v12, s[8:11], s42 offen offset:0 sc1
    s_add_u32 s37, s37, 1
    s_cmp_gt_u32 s37, 400000
    s_cbranch_scc1 L_fail
    s_waitcnt vmcnt(0)
    v_cmp_gt_u32 vcc, s40, v15
    s_nop 0
    s_cbranch_vccz C_wp0_ok
    s_branch C_wp0
C_wp0_ok:
    s_mul_i32 s41, s17, 6144
    s_add_u32 s53, s26, s41
    s_cmp_lt_u32 s24, 64
    s_cselect_b32 s53, s53, 0x40000000
    s_add_u32 s54, s53, 3072
    s_mul_i32 s41, s17, 6144
    s_add_u32 m0, s41, 65536
    s_nop 0
    buffer_load_dwordx4 v0, s[8:11], s53 offen sc1 lds
    buffer_load_dwordx4 v0, s[8:11], s53 offen offset:1024 sc1 lds
    buffer_load_dwordx4 v0, s[8:11], s53 offen offset:2048 sc1 lds
    s_mul_i32 s41, s17, 6144
    s_add_u32 m0, s41, 68608
    s_nop 0
    buffer_load_dwordx4 v0, s[8:11], s54 offen sc1 lds
    buffer_load_dwordx4 v0, s[8:11], s54 offen offset:1024 sc1 lds
    buffer_load_dwordx4 v0, s[8:11], s54 offen offset:2048 sc1 lds
    s_waitcnt vmcnt(0)
C_loop:
    s_add_u32 s25, s25, 1
    s_waitcnt vmcnt(2)
    s_barrier
    buffer_load_dwordx2 v[26:27], v4, s[44:47], s36 offen
    buffer_load_dword v25, v12, s[8:11], s35 offen sc1
    s_cmp_lt_u32 s24, 28
    s_cselect_b32 s63, 4, 6
    s_add_u32 s41, s24, s63
    s_lshr_b32 s40, s41, 1
    s_add_u32 s40, s40, 1
    s_max_u32 s40, s40, 2
    s_and_b32 s41, s41, 1
    s_lshl_b32 s41, s41, 12
    s_add_u32 s42, s41, s34
    buffer_load_dword v84, v12, s[8:11], s42 offen sc1
    ds_read_b128 v[32:35], v85 offset:0
    ds_read_b128 v[36:39], v85 offset:1024
    ds_read_b128 v[40:43], v85 offset:2048
    ds_read_b128 v[44:47], v85 offset:3072
    ds_read_b128 v[48:51], v1 offset:0
    ds_read_b128 v[52:55], v1 offset:1024
    ds_read_b128 v[56:59], v1 offset:2048
    ds_read_b128 v[60:63], v1 offset:3072
    ds_read_b128 v[64:67], v1 offset:128
    ds_read_b128 v[68:71], v1 offset:1152
    ds_read_b128 v[72:75], v1 offset:2176
    ds_read_b128 v[76:79], v1 offset:3200
    s_waitcnt lgkmcnt(4)
    ds_read_b128 v[160:163], v86 offset:0
    ds_read_b128 v[164:167], v86 offset:1024
    ds_read_b128 v[168:171], v86 offset:2048
    ds_read_b128 v[172:175], v86 offset:3072
    v_mfma_f32_16x16x32_bf16 v[120:123], v[48:51], v[32:35], 0
    v_mfma_f32_16x16x32_bf16 v[120:123], v[52:55], v[36:39], v[120:123]
    v_mfma_f32_16x16x32_bf16 v[120:123], v[56:59], v[40:43], v[120:123]
    v_mfma_f32_16x16x32_bf16 v[120:123], v[60:63], v[44:47], v[120:123]
    s_waitcnt lgkmcnt(4)
    v_mfma_f32_16x16x32_bf16 v[124:127], v[64:67], v[32:35], 0
    v_mfma_f32_16x16x32_bf16 v[124:127], v[68:71], v[36:39], v[124:127]
    v_mfma_f32_16x16x32_bf16 v[124:127], v[72:75], v[40:43], v[124:127]
    v_mfma_f32_16x16x32_bf16 v[124:127], v[76:79], v[44:47], v[124:127]
    s_waitcnt lgkmcnt(0)
    v_swap_b32 v161, v162
    v_swap_b32 v165, v166
    v_swap_b32 v162, v164
    v_swap_b32 v163, v165
    v_swap_b32 v169, v170
    v_swap_b32 v173, v174
    v_swap_b32 v170, v172
    v_swap_b32 v171, v173
    v_fma_f32 v120, v120, s38, v16
    v_fma_f32 v121, v121, s38, v17
    v_fma_f32 v122, v122, s38, v18
    v_fma_f32 v123, v123, s38, v19
    v_fma_f32 v124, v124, s38, v20
    v_fma_f32 v125, v125, s38, v21
    v_fma_f32 v126, v126, s38, v22
    v_fma_f32 v127, v127, s38, v23
    v_max3_f32 v156, v120, v121, v122
    v_max3_f32 v157, v123, v124, v125
    v_max3_f32 v156, v156, v126, v127
    v_max_f32 v156, v156, v157
    s_cmp_lg_u32 s43, 0
    s_cbranch_scc1 C_have
    s_cmp_lt_u32 s24, 56
    s_cbranch_scc1 C_byflag
    s_mov_b32 s37, 0
C_poll:
    s_lshl_b32 s41, s17, 12
    s_add_u32 m0, s41, 0
    s_nop 0
    buffer_load_dwordx4 v0, s[8:11], s27 offen offset:0 sc1 lds
    buffer_load_dwordx4 v0, s[8:11], s27 offen offset:1024 sc1 lds
    buffer_load_dwordx4 v0, s[8:11], s27 offen offset:2048 sc1 lds
    buffer_load_dwordx4 v0, s[8:11], s27 offen offset:3072 sc1 lds
    s_add_u32 s37, s37, 1
    s_cmp_gt_u32 s37, 400000
    s_cbranch_scc1 L_fail
    s_waitcnt vmcnt(0)
    ds_read_b64_tr_b16 v[96:97], v8 offset:0
    ds_read_b64_tr_b16 v[98:99], v8 offset:1024
    ds_read_b64_tr_b16 v[100:101], v8 offset:2048
    ds_read_b64_tr_b16 v[102:103], v8 offset:3072
    ds_read_b64 v[104:105], v9 offset:0
    ds_read_b64 v[106:107], v9 offset:1024
    s_waitcnt lgkmcnt(5)
    v_pk_max_u16 v15, v96, v97
    s_waitcnt lgkmcnt(4)
    v_pk_max_u16 v158, v98, v99
    v_pk_max_u16 v15, v15, v158
    s_waitcnt lgkmcnt(3)
    v_pk_max_u16 v158, v100, v101
    v_pk_max_u16 v15, v15, v158
    s_waitcnt lgkmcnt(2)
    v_pk_max_u16 v158, v102, v103
    v_pk_max_u16 v15, v15, v158
    s_waitcnt lgkmcnt(1)
    v_pk_max_u16 v158, v104, v105
    v_pk_max_u16 v15, v15, v158
    s_waitcnt lgkmcnt(0)
    v_pk_max_u16 v158, v106, v107
    v_pk_max_u16 v15, v15, v158
    v_lshlrev_b32 v158, 16, v15
    v_max_u32 v15, v15, v158
    v_cmp_le_u32 vcc, 0xffff0000, v15
    s_nop 0
    s_cbranch_vccnz C_poll
    s_branch C_have3
C_byflag:
    s_add_u32 s40, s24, 1
    s_mov_b32 s37, 0
C_wr:
    buffer_load_dword v15, v12, s[8:11], s35 offen offset:0 sc1
    s_add_u32 s37, s37, 1
    s_cmp_gt_u32 s37, 400000
    s_cbranch_scc1 L_fail
    s_waitcnt vmcnt(0)
    v_cmp_gt_u32 vcc, s40, v15
    s_nop 0
    s_cbranch_vccz C_wr_ok
    s_branch C_wr
C_wr_ok:
    s_lshl_b32 s41, s17, 12
    s_add_u32 m0, s41, 0
    s_nop 0
    buffer_load_dwordx4 v0, s[8:11], s27 offen offset:0 sc1 lds
    buffer_load_dwordx4 v0, s[8:11], s27 offen offset:1024 sc1 lds
    buffer_load_dwordx4 v0, s[8:11], s27 offen offset:2048 sc1 lds
    buffer_load_dwordx4 v0, s[8:11], s27 offen offset:3072 sc1 lds
    s_waitcnt vmcnt(0)
    s_branch C_have2
C_have:
C_have2:
    ds_read_b64_tr_b16 v[96:97], v8 offset:0
    ds_read_b64_tr_b16 v[98:99], v8 offset:1024
    ds_read_b64_tr_b16 v[100:101], v8 offset:2048
    ds_read_b64_tr_b16 v[102:103], v8 offset:3072
    ds_read_b64 v[104:105], v9 offset:0
    ds_read_b64 v[106:107], v9 offset:1024
C_have3:
    s_waitcnt lgkmcnt(5)
    v_mfma_f32_16x16x16_bf16 v[128:131], v[96:97], v[32:33], 0
    v_mfma_f32_16x16x16_bf16 v[112:115], v[96:97], v[34:35], 0
    s_waitcnt lgkmcnt(4)
    v_mfma_f32_16x16x16_bf16 v[128:131], v[98:99], v[36:37], v[128:131]
    v_mfma_f32_16x16x16_bf16 v[112:115], v[98:99], v[38:39], v[112:115]
    s_waitcnt lgkmcnt(3)
    v_mfma_f32_16x16x16_bf16 v[128:131], v[100:101], v[40:41], v[128:131]
    v_mfma_f32_16x16x16_bf16 v[112:115], v[100:101], v[42:43], v[112:115]
    s_waitcnt lgkmcnt(2)
    v_mfma_f32_16x16x16_bf16 v[128:131], v[102:103], v[44:45], v[128:131]
    v_mfma_f32_16x16x16_bf16 v[112:115], v[102:103], v[46:47], v[112:115]
    v_mov_b64 v[136:137], 0
    v_mov_b64 v[138:139], 0
    s_nop 5
    v_add_f32 v128, v128, v114
    v_add_f32 v129, v129, v115
    v_mul_f32 v128, s38, v128
    v_mul_f32 v129, s38, v129
    v_max3_f32 v156, v156, v128, v129
    v_mov_b32 v157, v156
    s_nop 1
    v_permlane16_swap_b32 v156, v157
    v_max_f32 v156, v156, v157
    v_mov_b32 v157, v156
    s_nop 1
    v_permlane32_swap_b32 v156, v157
    v_max_f32 v156, v156, v157
    v_pk_add_f32 v[120:121], v[120:121], v[156:157] op_sel_hi:[1,0] neg_lo:[0,1] neg_hi:[0,1]
    v_pk_add_f32 v[122:123], v[122:123], v[156:157] op_sel_hi:[1,0] neg_lo:[0,1] neg_hi:[0,1]
    v_pk_add_f32 v[124:125], v[124:125], v[156:157] op_sel_hi:[1,0] neg_lo:[0,1] neg_hi:[0,1]
    v_pk_add_f32 v[126:127], v[126:127], v[156:157] op_sel_hi:[1,0] neg_lo:[0,1] neg_hi:[0,1]
    v_pk_add_f32 v[128:129], v[128:129], v[156:157] op_sel_hi:[1,0] neg_lo:[0,1] neg_hi:[0,1]
    v_exp_f32 v120, v120
    v_exp_f32 v121, v121
    v_exp_f32 v122, v122
    v_exp_f32 v123, v123
    v_exp_f32 v124, v124
    v_exp_f32 v125, v125
    v_exp_f32 v126, v126
    v_exp_f32 v127, v127
    v_exp_f32 v128, v128
    v_exp_f32 v129, v129
    v_cvt_pk_bf16_f32 v132, v120, v121
    v_cvt_pk_bf16_f32 v133, v122, v123
    v_cvt_pk_bf16_f32 v134, v124, v125
    v_cvt_pk_bf16_f32 v135, v126, v127
    v_cvt_pk_bf16_f32 v136, v128, v129
    v_mov_b32 v139, v136
    s_waitcnt lgkmcnt(0)
    v_mfma_f32_16x16x32_bf16 v[140:143], v[160:163], v[132:135], 0
    v_add_f32 v120, v120, v125
    v_add_f32 v121, v121, v126
    v_mfma_f32_16x16x32_bf16 v[144:147], v[164:167], v[132:135], 0
    v_add_f32 v122, v122, v127
    v_add_f32 v123, v123, v128
    v_mfma_f32_16x16x32_bf16 v[148:151], v[168:171], v[132:135], 0
    v_add_f32 v124, v124, v129
    v_add_f32 v120, v120, v121
    v_mfma_f32_16x16x32_bf16 v[152:155], v[172:175], v[132:135], 0
    v_add_f32 v122, v122, v123
    v_add_f32 v120, v120, v124
    v_mfma_f32_16x16x16_bf16 v[140:143], v[104:105], v[136:137], v[140:143]
    v_add_f32 v120, v120, v122
    v_mfma_f32_16x16x16_bf16 v[144:147], v[104:105], v[138:139], v[144:147]
    v_mfma_f32_16x16x16_bf16 v[148:151], v[106:107], v[136:137], v[148:151]
    v_mfma_f32_16x16x16_bf16 v[152:155], v[106:107], v[138:139], v[152:155]
    v_mov_b32 v156, v120
    s_nop 1
    v_permlane16_swap_b32 v120, v156
    v_add_f32 v120, v120, v156
    v_mov_b32 v156, v120
    s_nop 1
    v_permlane32_swap_b32 v120, v156
    v_add_f32 v120, v120, v156
    v_rcp_f32 v156, v120
    s_nop 0
    v_pk_mul_f32 v[140:141], v[140:141], v[156:157] op_sel_hi:[1,0]
    v_pk_mul_f32 v[142:143], v[142:143], v[156:157] op_sel_hi:[1,0]
    v_pk_mul_f32 v[144:145], v[144:145], v[156:157] op_sel_hi:[1,0]
    v_pk_mul_f32 v[146:147], v[146:147], v[156:157] op_sel_hi:[1,0]
    v_pk_mul_f32 v[148:149], v[148:149], v[156:157] op_sel_hi:[1,0]
    v_pk_mul_f32 v[150:151], v[150:151], v[156:157] op_sel_hi:[1,0]
    v_pk_mul_f32 v[152:153], v[152:153], v[156:157] op_sel_hi:[1,0]
    v_pk_mul_f32 v[154:155], v[154:155], v[156:157] op_sel_hi:[1,0]
    v_cvt_pk_bf16_f32 v140, v140, v141
    v_cvt_pk_bf16_f32 v141, v142, v143
    v_cvt_pk_bf16_f32 v142, v144, v145
    v_cvt_pk_bf16_f32 v143, v146, v147
    v_cvt_pk_bf16_f32 v144, v148, v149
    v_cvt_pk_bf16_f32 v145, v150, v151
    v_cvt_pk_bf16_f32 v146, v152, v153
    v_cvt_pk_bf16_f32 v147, v154, v155
    buffer_load_dword v89, v10, s[8:11], s33 offen offset:1536 sc1
    ds_write_b128 v14, v[140:143] offset:16384
    ds_write_b128 v14, v[144:147] offset:17408
    s_waitcnt lgkmcnt(0)
    s_barrier
    ds_read_b128 v[96:99], v0 offset:16384
    ds_read_b128 v[100:103], v0 offset:17408
    ds_read_b128 v[104:107], v0 offset:18432
    ds_read_b128 v[108:111], v0 offset:19456
    ds_read_b128 v[112:115], v0 offset:20480
    ds_read_b128 v[116:119], v0 offset:21504
    ds_read_b128 v[120:123], v0 offset:22528
    ds_read_b128 v[124:127], v0 offset:23552
    s_sub_u32 s40, s25, 1
    s_waitcnt vmcnt(0)
    v_cmp_gt_u32 vcc, s40, v89
    s_nop 0
    s_cbranch_vccz C_w4_ok
    s_mov_b32 s37, 0
C_w4:
    buffer_load_dword v15, v10, s[8:11], s33 offen offset:1536 sc1
    s_add_u32 s37, s37, 1
    s_cmp_gt_u32 s37, 400000
    s_cbranch_scc1 L_fail
    s_waitcnt vmcnt(0)
    v_cmp_gt_u32 vcc, s40, v15
    s_nop 0
    s_cbranch_vccz C_w4_ok
    s_branch C_w4
C_w4_ok:
    s_waitcnt lgkmcnt(4)
    s_add_u32 s56, s28, 0
    s_add_u32 s57, s28, 263168
    s_add_u32 s58, s28, 526336
    s_add_u32 s59, s28, 789504
    v_mfma_f32_16x16x32_bf16 v[128:131], a[0:3], v[96:99], 0
    v_mfma_f32_16x16x32_bf16 v[132:135], a[16:19], v[96:99], 0
    v_mfma_f32_16x16x32_bf16 v[128:131], a[4:7], v[100:103], v[128:131]
    v_mfma_f32_16x16x32_bf16 v[132:135], a[20:23], v[100:103], v[132:135]
    v_mfma_f32_16x16x32_bf16 v[128:131], a[8:11], v[104:107], v[128:131]
    v_mfma_f32_16x16x32_bf16 v[132:135], a[24:27], v[104:107], v[132:135]
    v_mfma_f32_16x16x32_bf16 v[128:131], a[12:15], v[108:111], v[128:131]
    v_mfma_f32_16x16x32_bf16 v[132:135], a[28:31], v[108:111], v[132:135]
    v_mfma_f32_16x16x32_bf16 v[136:139], a[32:35], v[96:99], 0
    s_nop 1
    v_mfma_f32_16x16x32_bf16 v[140:143], a[48:51], v[96:99], 0
    s_nop 1
    v_mfma_f32_16x16x32_bf16 v[136:139], a[36:39], v[100:103], v[136:139]
    v_cvt_pk_bf16_f32 v128, v128, v129
    v_cvt_pk_bf16_f32 v129, v130, v131
    v_mfma_f32_16x16x32_bf16 v[140:143], a[52:55], v[100:103], v[140:143]
    v_cvt_pk_bf16_f32 v130, v132, v133
    v_cvt_pk_bf16_f32 v131, v134, v135
    v_mfma_f32_16x16x32_bf16 v[136:139], a[40:43], v[104:107], v[136:139]
    ds_write_b128 v82, v[128:131] offset:0
    v_mfma_f32_16x16x32_bf16 v[140:143], a[56:59], v[104:107], v[140:143]
    v_mfma_f32_16x16x32_bf16 v[136:139], a[44:47], v[108:111], v[136:139]
    v_mfma_f32_16x16x32_bf16 v[140:143], a[60:63], v[108:111], v[140:143]
    v_mfma_f32_16x16x32_bf16 v[144:147], a[64:67], v[96:99], 0
    s_nop 1
    v_mfma_f32_16x16x32_bf16 v[148:151], a[80:83], v[96:99], 0
    s_nop 1
    v_mfma_f32_16x16x32_bf16 v[144:147], a[68:71], v[100:103], v[144:147]
    v_cvt_pk_bf16_f32 v136, v136, v137
    v_cvt_pk_bf16_f32 v137, v138, v139
    v_mfma_f32_16x16x32_bf16 v[148:151], a[84:87], v[100:103], v[148:151]
    v_cvt_pk_bf16_f32 v138, v140, v141
    v_cvt_pk_bf16_f32 v139, v142, v143
    v_mfma_f32_16x16x32_bf16 v[144:147], a[72:75], v[104:107], v[144:147]
    ds_write_b128 v82, v[136:139] offset:64
    v_mfma_f32_16x16x32_bf16 v[148:151], a[88:91], v[104:107], v[148:151]
    ds_read_b128 v[48:51], v83 offset:0
    v_mfma_f32_16x16x32_bf16 v[144:147], a[76:79], v[108:111], v[144:147]
    ds_read_b128 v[52:55], v83 offset:2176
    s_nop 0
    v_mfma_f32_16x16x32_bf16 v[148:151], a[92:95], v[108:111], v[148:151]
    s_nop 1
    v_mfma_f32_16x16x32_bf16 v[152:155], a[96:99], v[96:99], 0
    s_nop 1
    v_mfma_f32_16x16x32_bf16 v[156:159], a[112:115], v[96:99], 0
    s_nop 1
    v_mfma_f32_16x16x32_bf16 v[152:155], a[100:103], v[100:103], v[152:155]
    s_waitcnt lgkmcnt(1)
    buffer_store_dwordx4 v[48:51], v2, s[8:11], s56 offen offset:0
    v_mfma_f32_16x16x32_bf16 v[156:159], a[116:119], v[100:103], v[156:159]
    s_waitcnt lgkmcnt(0)
    buffer_store_dwordx4 v[52:55], v2, s[8:11], s57 offen offset:0
    v_cvt_pk_bf16_f32 v144, v144, v145
    v_mfma_f32_16x16x32_bf16 v[152:155], a[104:107], v[104:107], v[152:155]
    v_cvt_pk_bf16_f32 v145, v146, v147
    v_cvt_pk_bf16_f32 v146, v148, v149
    v_mfma_f32_16x16x32_bf16 v[156:159], a[120:123], v[104:107], v[156:159]
    v_cvt_pk_bf16_f32 v147, v150, v151
    v_mfma_f32_16x16x32_bf16 v[152:155], a[108:111], v[108:111], v[152:155]
    ds_write_b128 v82, v[144:147] offset:128
    v_mfma_f32_16x16x32_bf16 v[156:159], a[124:127], v[108:111], v[156:159]
    s_waitcnt lgkmcnt(5)
    v_mfma_f32_16x16x32_bf16 v[160:163], a[0:3], v[112:115], 0
    s_nop 1
    v_mfma_f32_16x16x32_bf16 v[164:167], a[16:19], v[112:115], 0
    s_nop 1
    v_mfma_f32_16x16x32_bf16 v[160:163], a[4:7], v[116:119], v[160:163]
    v_cvt_pk_bf16_f32 v152, v152, v153
    v_cvt_pk_bf16_f32 v153, v154, v155
    v_mfma_f32_16x16x32_bf16 v[164:167], a[20:23], v[116:119], v[164:167]
    v_cvt_pk_bf16_f32 v154, v156, v157
    v_cvt_pk_bf16_f32 v155, v158, v159
    v_mfma_f32_16x16x32_bf16 v[160:163], a[8:11], v[120:123], v[160:163]
    ds_write_b128 v82, v[152:155] offset:192
    v_mfma_f32_16x16x32_bf16 v[164:167], a[24:27], v[120:123], v[164:167]
    ds_read_b128 v[56:59], v83 offset:128
    v_mfma_f32_16x16x32_bf16 v[160:163], a[12:15], v[124:127], v[160:163]
    ds_read_b128 v[60:63], v83 offset:2304
    s_nop 0
    v_mfma_f32_16x16x32_bf16 v[164:167], a[28:31], v[124:127], v[164:167]
    s_nop 1
    v_mfma_f32_16x16x32_bf16 v[168:171], a[32:35], v[112:115], 0
    s_nop 1
    v_mfma_f32_16x16x32_bf16 v[172:175], a[48:51], v[112:115], 0
    s_nop 1
    v_mfma_f32_16x16x32_bf16 v[168:171], a[36:39], v[116:119], v[168:171]
    s_waitcnt lgkmcnt(1)
    buffer_store_dwordx4 v[56:59], v2, s[8:11], s56 offen offset:128
    v_mfma_f32_16x16x32_bf16 v[172:175], a[52:55], v[116:119], v[172:175]
    s_waitcnt lgkmcnt(0)
    buffer_store_dwordx4 v[60:63], v2, s[8:11], s57 offen offset:128
    v_cvt_pk_bf16_f32 v160, v160, v161
    v_mfma_f32_16x16x32_bf16 v[168:171], a[40:43], v[120:123], v[168:171]
    v_cvt_pk_bf16_f32 v161, v162, v163
    v_cvt_pk_bf16_f32 v162, v164, v165
    v_mfma_f32_16x16x32_bf16 v[172:175], a[56:59], v[120:123], v[172:175]
    v_cvt_pk_bf16_f32 v163, v166, v167
    v_mfma_f32_16x16x32_bf16 v[168:171], a[44:47], v[124:127], v[168:171]
    ds_write_b128 v82, v[160:163] offset:4352
    v_mfma_f32_16x16x32_bf16 v[172:175], a[60:63], v[124:127], v[172:175]
    v_mfma_f32_16x16x32_bf16 v[176:179], a[64:67], v[112:115], 0
    s_nop 1
    v_mfma_f32_16x16x32_bf16 v[180:183], a[80:83], v[112:115], 0
    s_nop 1
    v_mfma_f32_16x16x32_bf16 v[176:179], a[68:71], v[116:119], v[176:179]
    v_cvt_pk_bf16_f32 v168, v168, v169
    v_cvt_pk_bf16_f32 v169, v170, v171
    v_mfma_f32_16x16x32_bf16 v[180:183], a[84:87], v[116:119], v[180:183]
    v_cvt_pk_bf16_f32 v170, v172, v173
    v_cvt_pk_bf16_f32 v171, v174, v175
    v_mfma_f32_16x16x32_bf16 v[176:179], a[72:75], v[120:123], v[176:179]
    ds_write_b128 v82, v[168:171] offset:4416
    v_mfma_f32_16x16x32_bf16 v[180:183], a[88:91], v[120:123], v[180:183]
    ds_read_b128 v[64:67], v83 offset:4352
    v_mfma_f32_16x16x32_bf16 v[176:179], a[76:79], v[124:127], v[176:179]
    ds_read_b128 v[68:71], v83 offset:6528
    s_nop 0
    v_mfma_f32_16x16x32_bf16 v[180:183], a[92:95], v[124:127], v[180:183]
    s_nop 1
    v_mfma_f32_16x16x32_bf16 v[184:187], a[96:99], v[112:115], 0
    s_nop 1
    v_mfma_f32_16x16x32_bf16 v[188:191], a[112:115], v[112:115], 0
    s_nop 1
    v_mfma_f32_16x16x32_bf16 v[184:187], a[100:103], v[116:119], v[184:187]
    s_waitcnt lgkmcnt(1)
    buffer_store_dwordx4 v[64:67], v2, s[8:11], s58 offen offset:0
    v_mfma_f32_16x16x32_bf16 v[188:191], a[116:119], v[116:119], v[188:191]
    s_waitcnt lgkmcnt(0)
    buffer_store_dwordx4 v[68:71], v2, s[8:11], s59 offen offset:0
    v_cvt_pk_bf16_f32 v176, v176, v177
    v_mfma_f32_16x16x32_bf16 v[184:187], a[104:107], v[120:123], v[184:187]
    v_cvt_pk_bf16_f32 v177, v178, v179
    v_cvt_pk_bf16_f32 v178, v180, v181
    v_mfma_f32_16x16x32_bf16 v[188:191], a[120:123], v[120:123], v[188:191]
    v_cvt_pk_bf16_f32 v179, v182, v183
    v_mfma_f32_16x16x32_bf16 v[184:187], a[108:111], v[124:127], v[184:187]
    ds_write_b128 v82, v[176:179] offset:4480
    v_mfma_f32_16x16x32_bf16 v[188:191], a[124:127], v[124:127], v[188:191]
    s_nop 5
    v_cvt_pk_bf16_f32 v184, v184, v185
    v_cvt_pk_bf16_f32 v185, v186, v187
    v_cvt_pk_bf16_f32 v186, v188, v189
    v_cvt_pk_bf16_f32 v187, v190, v191
    ds_write_b128 v82, v[184:187] offset:4544
    ds_read_b128 v[72:75], v83 offset:4480
    ds_read_b128 v[76:79], v83 offset:6656
    s_waitcnt lgkmcnt(1)
    buffer_store_dwordx4 v[72:75], v2, s[8:11], s58 offen offset:128
    s_waitcnt lgkmcnt(0)
    buffer_store_dwordx4 v[76:79], v2, s[8:11], s59 offen offset:128
    s_waitcnt vmcnt(0)
    v_mov_b32 v15, s25
    buffer_store_dword v15, v11, s[8:11], s32 offen offset:0
    s_mov_b32 s37, 0
C_w1:
    buffer_load_dword v15, v10, s[8:11], s33 offen offset:0 sc1
    s_add_u32 s37, s37, 1
    s_cmp_gt_u32 s37, 400000
    s_cbranch_scc1 L_fail
    s_waitcnt vmcnt(0)
    v_cmp_gt_u32 vcc, s25, v15
    s_nop 0
    s_cbranch_vccz C_w1_ok
    s_branch C_w1
C_w1_ok:
    buffer_load_dwordx4 v[96:99], v3, s[8:11], s29 offen sc1
    s_add_u32 s41, s29, 4096
    buffer_load_dwordx4 v[100:103], v3, s[8:11], s41 offen sc1
    s_add_u32 s41, s29, 8192
    buffer_load_dwordx4 v[104:107], v3, s[8:11], s41 offen sc1
    s_add_u32 s41, s29, 12288
    buffer_load_dwordx4 v[108:111], v3, s[8:11], s41 offen sc1
    s_add_u32 s41, s29, 16384
    buffer_load_dwordx4 v[112:115], v3, s[8:11], s41 offen sc1
    s_add_u32 s41, s29, 20480
    buffer_load_dwordx4 v[116:119], v3, s[8:11], s41 offen sc1
    s_add_u32 s41, s29, 24576
    buffer_load_dwordx4 v[120:123], v3, s[8:11], s41 offen sc1
    s_add_u32 s41, s29, 28672
    buffer_load_dwordx4 v[124:127], v3, s[8:11], s41 offen sc1
    s_waitcnt vmcnt(7)
    v_mfma_f32_16x16x32_bf16 v[128:131], v[28:31], v[96:99], 0
    s_waitcnt vmcnt(6)
    v_mfma_f32_16x16x32_bf16 v[128:131], v[28:31], v[100:103], v[128:131]
    s_waitcnt vmcnt(5)
    v_mfma_f32_16x16x32_bf16 v[128:131], v[28:31], v[104:107], v[128:131]
    s_waitcnt vmcnt(4)
    v_mfma_f32_16x16x32_bf16 v[128:131], v[28:31], v[108:111], v[128:131]
    s_waitcnt vmcnt(3)
    v_mfma_f32_16x16x32_bf16 v[128:131], v[28:31], v[112:115], v[128:131]
    s_waitcnt vmcnt(2)
    v_mfma_f32_16x16x32_bf16 v[128:131], v[28:31], v[116:119], v[128:131]
    s_waitcnt vmcnt(1)
    v_mfma_f32_16x16x32_bf16 v[128:131], v[28:31], v[120:123], v[128:131]
    s_waitcnt vmcnt(0)
    v_mfma_f32_16x16x32_bf16 v[128:131], v[28:31], v[124:127], v[128:131]
    v_lshlrev_b32 v132, 16, v26
    v_and_b32 v133, 0xffff0000, v26
    v_lshlrev_b32 v134, 16, v27
    v_and_b32 v135, 0xffff0000, v27
    s_nop 3
    v_cvt_pk_bf16_f32 v128, v128, v129
    v_cvt_pk_bf16_f32 v130, v130, v131
    v_and_b32 v129, 0xffff0000, v128
    v_and_b32 v131, 0xffff0000, v130
    v_lshlrev_b32 v128, 16, v128
    v_lshlrev_b32 v130, 16, v130
    v_pk_add_f32 v[132:133], v[132:133], v[128:129]
    v_pk_add_f32 v[134:135], v[134:135], v[130:131]
    v_cvt_pk_bf16_f32 v26, v132, v133
    v_cvt_pk_bf16_f32 v27, v134, v135
    v_lshlrev_b32 v132, 16, v26
    v_and_b32 v133, 0xffff0000, v26
    v_lshlrev_b32 v134, 16, v27
    v_and_b32 v135, 0xffff0000, v27
    v_pk_mul_f32 v[140:141], v[132:133], v[132:133]
    v_pk_add_f32 v[136:137], v[132:133], v[134:135]
    v_pk_fma_f32 v[140:141], v[134:135], v[134:135], v[140:141]
    v_add_f32 v136, v136, v137
    v_add_f32 v137, v140, v141
    s_nop 0
    v_add_f32_dpp v136, v136, v136 row_ror:8 row_mask:0xf bank_mask:0xf
    v_add_f32_dpp v137, v137, v137 row_ror:8 row_mask:0xf bank_mask:0xf
    s_nop 0
    v_add_f32_dpp v136, v136, v136 row_ror:4 row_mask:0xf bank_mask:0xf
    v_add_f32_dpp v137, v137, v137 row_ror:4 row_mask:0xf bank_mask:0xf
    s_nop 0
    v_add_f32_dpp v136, v136, v136 row_ror:2 row_mask:0xf bank_mask:0xf
    v_add_f32_dpp v137, v137, v137 row_ror:2 row_mask:0xf bank_mask:0xf
    s_nop 0
    v_add_f32_dpp v136, v136, v136 row_ror:1 row_mask:0xf bank_mask:0xf
    v_add_f32_dpp v137, v137, v137 row_ror:1 row_mask:0xf bank_mask:0xf
    s_mov_b64 exec, 0x10001
    ds_write_b64 v87, v[136:137] offset:28672
    s_mov_b64 exec, -1
    s_waitcnt lgkmcnt(0)
    s_barrier
    ds_read_b128 v[144:147], v88 offset:28672
    ds_read_b128 v[148:151], v88 offset:28688
    ds_read_b128 v[152:155], v88 offset:28704
    ds_read_b128 v[156:159], v88 offset:28720
    s_waitcnt lgkmcnt(2)
    v_pk_add_f32 v[144:145], v[144:145], v[146:147]
    v_pk_add_f32 v[148:149], v[148:149], v[150:151]
    s_waitcnt lgkmcnt(0)
    v_pk_add_f32 v[152:153], v[152:153], v[154:155]
    v_pk_add_f32 v[156:157], v[156:157], v[158:159]
    v_pk_add_f32 v[144:145], v[144:145], v[148:149]
    v_pk_add_f32 v[152:153], v[152:153], v[156:157]
    v_pk_add_f32 v[144:145], v[144:145], v[152:153]
    v_mul_f32 v136, 989855744, v144
    v_mov_b32 v146, 925353388
    v_fmac_f32 v146, 989855744, v145
    v_fma_f32 v146, -v136, v136, v146
    v_max_f32 v146, 925353388, v146
    v_rsq_f32 v137, v146
    s_nop 0
    v_pk_add_f32 v[132:133], v[132:133], v[136:137] op_sel_hi:[1,0] neg_lo:[0,1] neg_hi:[0,1]
    v_pk_mul_f32 v[132:133], v[132:133], v[136:137] op_sel:[0,1] op_sel_hi:[1,1]
    v_pk_add_f32 v[134:135], v[134:135], v[136:137] op_sel_hi:[1,0] neg_lo:[0,1] neg_hi:[0,1]
    v_pk_mul_f32 v[134:135], v[134:135], v[136:137] op_sel:[0,1] op_sel_hi:[1,1]
    v_cvt_pk_bf16_f32 v140, v132, v133
    v_cvt_pk_bf16_f32 v141, v134, v135
    buffer_store_dwordx2 v[140:141], v5, s[8:11], s30 offen
    s_waitcnt vmcnt(0)
    v_mov_b32 v15, s25
    buffer_store_dword v15, v11, s[8:11], s32 offen offset:512
C_noln:
    s_cmp_ge_u32 s16, 28
    s_cbranch_scc1 C_noffn
    s_mov_b32 s37, 0
C_w2:
    buffer_load_dword v15, v10, s[8:11], s33 offen offset:512 sc1
    s_add_u32 s37, s37, 1
    s_cmp_gt_u32 s37, 400000
    s_cbranch_scc1 L_fail
    s_waitcnt vmcnt(0)
    v_cmp_gt_u32 vcc, s25, v15
    s_nop 0
    s_cbranch_vccz C_w2_ok
    s_branch C_w2
C_w2_ok:
    s_lshl_b32 s42, s17, 12
    s_add_u32 m0, s42, 32768
    s_add_u32 s41, s31, 0
    buffer_load_dwordx4 v0, s[8:11], s41 offen offset:0 sc1 lds
    buffer_load_dwordx4 v0, s[8:11], s41 offen offset:1024 sc1 lds
    buffer_load_dwordx4 v0, s[8:11], s41 offen offset:2048 sc1 lds
    buffer_load_dwordx4 v0, s[8:11], s41 offen offset:3072 sc1 lds
    s_add_u32 m0, s42, 49152
    s_add_u32 s41, s31, 16384
    buffer_load_dwordx4 v0, s[8:11], s41 offen offset:0 sc1 lds
    buffer_load_dwordx4 v0, s[8:11], s41 offen offset:1024 sc1 lds
    buffer_load_dwordx4 v0, s[8:11], s41 offen offset:2048 sc1 lds
    buffer_load_dwordx4 v0, s[8:11], s41 offen offset:3072 sc1 lds
    s_add_u32 s24, s24, s63
    s_mul_i32 s41, s63, 786432
    s_add_u32 s26, s26, s41
    s_mul_i32 s41, s63, 131072
    s_add_u32 s27, s27, s41
    s_add_u32 s41, s24, 0
    s_lshr_b32 s40, s41, 1
    s_add_u32 s40, s40, 1
    s_max_u32 s40, s40, 2
    s_and_b32 s41, s41, 1
    s_lshl_b32 s41, s41, 12
    s_add_u32 s42, s41, s34
    s_cmp_lt_u32 s24, 64
    s_cselect_b32 s40, s40, 0
    v_cmp_gt_u32 vcc, s40, v84
    s_nop 0
    s_cbranch_vccz C_la_ok
    s_mov_b32 s37, 0
C_la:
    buffer_load_dword v15, v12, s[8:11], s42 offen offset:0 sc1
    s_add_u32 s37, s37, 1
    s_cmp_gt_u32 s37, 400000
    s_cbranch_scc1 L_fail
    s_waitcnt vmcnt(0)
    v_cmp_gt_u32 vcc, s40, v15
    s_nop 0
    s_cbranch_vccz C_la_ok
    s_branch C_la
C_la_ok:
    v_cmp_ge_u32 vcc, s24, v25
    s_mul_i32 s41, s17, 6144
    s_add_u32 s53, s26, s41
    s_cmp_lt_u32 s24, 64
    s_cselect_b32 s53, s53, 0x40000000
    s_add_u32 s54, s53, 3072
    s_cmp_eq_u64 vcc, 0
    s_cselect_b32 s43, 1, 0
    s_cselect_b32 s55, s27, 0x40000000
    s_waitcnt vmcnt(0)
    s_barrier
    ds_read_b128 v[128:131], v6 offset:32768
    ds_read_b128 v[132:135], v6 offset:49152
    ds_read_b128 v[136:139], v7 offset:32768
    ds_read_b128 v[140:143], v7 offset:49152
    s_waitcnt lgkmcnt(2)
    v_mfma_f32_16x16x32_bf16 v[152:155], a[128:131], v[128:131], 0
    ds_read_b128 v[144:147], v6 offset:34816
    v_mfma_f32_16x16x32_bf16 v[156:159], a[128:131], v[132:135], 0
    ds_read_b128 v[148:151], v6 offset:51200
    v_mfma_f32_16x16x32_bf16 v[160:163], a[192:195], v[128:131], 0
    s_mul_i32 s41, s17, 6144
    s_add_u32 m0, s41, 65536
    s_nop 0
    buffer_load_dwordx4 v0, s[8:11], s53 offen sc1 lds
    v_mfma_f32_16x16x32_bf16 v[164:167], a[192:195], v[132:135], 0
    s_waitcnt lgkmcnt(2)
    v_mfma_f32_16x16x32_bf16 v[152:155], a[132:135], v[136:139], v[152:155]
    ds_read_b128 v[128:131], v7 offset:34816
    v_mfma_f32_16x16x32_bf16 v[156:159], a[132:135], v[140:143], v[156:159]
    ds_read_b128 v[132:135], v7 offset:51200
    v_mfma_f32_16x16x32_bf16 v[160:163], a[196:199], v[136:139], v[160:163]
    buffer_load_dwordx4 v0, s[8:11], s53 offen offset:1024 sc1 lds
    v_mfma_f32_16x16x32_bf16 v[164:167], a[196:199], v[140:143], v[164:167]
    s_waitcnt lgkmcnt(2)
    v_mfma_f32_16x16x32_bf16 v[152:155], a[136:139], v[144:147], v[152:155]
    ds_read_b128 v[136:139], v6 offset:36864
    v_mfma_f32_16x16x32_bf16 v[156:159], a[136:139], v[148:151], v[156:159]
    ds_read_b128 v[140:143], v6 offset:53248
    v_mfma_f32_16x16x32_bf16 v[160:163], a[200:203], v[144:147], v[160:163]
    buffer_load_dwordx4 v0, s[8:11], s53 offen offset:2048 sc1 lds
    v_mfma_f32_16x16x32_bf16 v[164:167], a[200:203], v[148:151], v[164:167]
    s_waitcnt lgkmcnt(2)
    v_mfma_f32_16x16x32_bf16 v[152:155], a[140:143], v[128:131], v[152:155]
    ds_read_b128 v[144:147], v7 offset:36864
    v_mfma_f32_16x16x32_bf16 v[156:159], a[140:143], v[132:135], v[156:159]
    ds_read_b128 v[148:151], v7 offset:53248
    v_mfma_f32_16x16x32_bf16 v[160:163], a[204:207], v[128:131], v[160:163]
    s_mul_i32 s41, s17, 6144
    s_add_u32 m0, s41, 68608
    s_nop 0
    buffer_load_dwordx4 v0, s[8:11], s54 offen sc1 lds
    v_mfma_f32_16x16x32_bf16 v[164:167], a[204:207], v[132:135], v[164:167]
    s_waitcnt lgkmcnt(2)
    v_mfma_f32_16x16x32_bf16 v[152:155], a[144:147], v[136:139], v[152:155]
    ds_read_b128 v[128:131], v6 offset:38912
    v_mfma_f32_16x16x32_bf16 v[156:159], a[144:147], v[140:143], v[156:159]
    ds_read_b128 v[132:135], v6 offset:55296
    v_mfma_f32_16x16x32_bf16 v[160:163], a[208:211], v[136:139], v[160:163]
    buffer_load_dwordx4 v0, s[8:11], s54 offen offset:1024 sc1 lds
    v_mfma_f32_16x16x32_bf16 v[164:167], a[208:211], v[140:143], v[164:167]
    s_waitcnt lgkmcnt(2)
    v_mfma_f32_16x16x32_bf16 v[152:155], a[148:151], v[144:147], v[152:155]
    ds_read_b128 v[136:139], v7 offset:38912
    v_mfma_f32_16x16x32_bf16 v[156:159], a[148:151], v[148:151], v[156:159]
    ds_read_b128 v[140:143], v7 offset:55296
    v_mfma_f32_16x16x32_bf16 v[160:163], a[212:215], v[144:147], v[160:163]
    buffer_load_dwordx4 v0, s[8:11], s54 offen offset:2048 sc1 lds
    v_mfma_f32_16x16x32_bf16 v[164:167], a[212:215], v[148:151], v[164:167]
    s_waitcnt lgkmcnt(2)
    v_mfma_f32_16x16x32_bf16 v[152:155], a[152:155], v[128:131], v[152:155]
    ds_read_b128 v[144:147], v6 offset:40960
    v_mfma_f32_16x16x32_bf16 v[156:159], a[152:155], v[132:135], v[156:159]
    ds_read_b128 v[148:151], v6 offset:57344
    v_mfma_f32_16x16x32_bf16 v[160:163], a[216:219], v[128:131], v[160:163]
    s_lshl_b32 s41, s17, 12
    s_add_u32 m0, s41, 0
    s_nop 0
    buffer_load_dwordx4 v0, s[8:11], s55 offen offset:0 sc1 lds
    v_mfma_f32_16x16x32_bf16 v[164:167], a[216:219], v[132:135], v[164:167]
    s_waitcnt lgkmcnt(2)
    v_mfma_f32_16x16x32_bf16 v[152:155], a[156:159], v[136:139], v[152:155]
    ds_read_b128 v[128:131], v7 offset:40960
    v_mfma_f32_16x16x32_bf16 v[156:159], a[156:159], v[140:143], v[156:159]
    ds_read_b128 v[132:135], v7 offset:57344
    v_mfma_f32_16x16x32_bf16 v[160:163], a[220:223], v[136:139], v[160:163]
    buffer_load_dwordx4 v0, s[8:11], s55 offen offset:1024 sc1 lds
    v_mfma_f32_16x16x32_bf16 v[164:167], a[220:223], v[140:143], v[164:167]
    s_waitcnt lgkmcnt(2)
    v_mfma_f32_16x16x32_bf16 v[152:155], a[160:163], v[144:147], v[152:155]
    ds_read_b128 v[136:139], v6 offset:43008
    v_mfma_f32_16x16x32_bf16 v[156:159], a[160:163], v[148:151], v[156:159]
    ds_read_b128 v[140:143], v6 offset:59392
    v_mfma_f32_16x16x32_bf16 v[160:163], a[224:227], v[144:147], v[160:163]
    buffer_load_dwordx4 v0, s[8:11], s55 offen offset:2048 sc1 lds
    v_mfma_f32_16x16x32_bf16 v[164:167], a[224:227], v[148:151], v[164:167]
    s_waitcnt lgkmcnt(2)
    v_mfma_f32_16x16x32_bf16 v[152:155], a[164:167], v[128:131], v[152:155]
    ds_read_b128 v[144:147], v7 offset:43008
    v_mfma_f32_16x16x32_bf16 v[156:159], a[164:167], v[132:135], v[156:159]
    ds_read_b128 v[148:151], v7 offset:59392
    v_mfma_f32_16x16x32_bf16 v[160:163], a[228:231], v[128:131], v[160:163]
    buffer_load_dwordx4 v0, s[8:11], s55 offen offset:3072 sc1 lds
    v_mfma_f32_16x16x32_bf16 v[164:167], a[228:231], v[132:135], v[164:167]
    s_waitcnt lgkmcnt(2)
    v_mfma_f32_16x16x32_bf16 v[152:155], a[168:171], v[136:139], v[152:155]
    ds_read_b128 v[128:131], v6 offset:45056
    v_mfma_f32_16x16x32_bf16 v[156:159], a[168:171], v[140:143], v[156:159]
    ds_read_b128 v[132:135], v6 offset:61440
    v_mfma_f32_16x16x32_bf16 v[160:163], a[232:235], v[136:139], v[160:163]
    v_mfma_f32_16x16x32_bf16 v[164:167], a[232:235], v[140:143], v[164:167]
    s_waitcnt lgkmcnt(2)
    v_mfma_f32_16x16x32_bf16 v[152:155], a[172:175], v[144:147], v[152:155]
    ds_read_b128 v[136:139], v7 offset:45056
    v_mfma_f32_16x16x32_bf16 v[156:159], a[172:175], v[148:151], v[156:159]
    ds_read_b128 v[140:143], v7 offset:61440
    v_mfma_f32_16x16x32_bf16 v[160:163], a[236:239], v[144:147], v[160:163]
    v_mfma_f32_16x16x32_bf16 v[164:167], a[236:239], v[148:151], v[164:167]
    s_waitcnt lgkmcnt(2)
    v_mfma_f32_16x16x32_bf16 v[152:155], a[176:179], v[128:131], v[152:155]
    ds_read_b128 v[144:147], v6 offset:47104
    v_mfma_f32_16x16x32_bf16 v[156:159], a[176:179], v[132:135], v[156:159]
    ds_read_b128 v[148:151], v6 offset:63488
    v_mfma_f32_16x16x32_bf16 v[160:163], a[240:243], v[128:131], v[160:163]
    v_mfma_f32_16x16x32_bf16 v[164:167], a[240:243], v[132:135], v[164:167]
    s_waitcnt lgkmcnt(2)
    v_mfma_f32_16x16x32_bf16 v[152:155], a[180:183], v[136:139], v[152:155]
    ds_read_b128 v[128:131], v7 offset:47104
    v_mfma_f32_16x16x32_bf16 v[156:159], a[180:183], v[140:143], v[156:159]
    ds_read_b128 v[132:135], v7 offset:63488
    v_mfma_f32_16x16x32_bf16 v[160:163], a[244:247], v[136:139], v[160:163]
    v_mfma_f32_16x16x32_bf16 v[164:167], a[244:247], v[140:143], v[164:167]
    s_waitcnt lgkmcnt(2)
    v_mfma_f32_16x16x32_bf16 v[152:155], a[184:187], v[144:147], v[152:155]
    v_mfma_f32_16x16x32_bf16 v[156:159], a[184:187], v[148:151], v[156:159]
    v_mfma_f32_16x16x32_bf16 v[160:163], a[248:251], v[144:147], v[160:163]
    v_mfma_f32_16x16x32_bf16 v[164:167], a[248:251], v[148:151], v[164:167]
    s_waitcnt lgkmcnt(0)
    v_mfma_f32_16x16x32_bf16 v[152:155], a[188:191], v[128:131], v[152:155]
    v_mfma_f32_16x16x32_bf16 v[156:159], a[188:191], v[132:135], v[156:159]
    v_mfma_f32_16x16x32_bf16 v[160:163], a[252:255], v[128:131], v[160:163]
    v_mfma_f32_16x16x32_bf16 v[164:167], a[252:255], v[132:135], v[164:167]
    s_mov_b32 s60, 3184710632
    s_mov_b32 s61, 3184710632
    v_mov_b32 v128, 3222493025
    v_mov_b32 v130, 1.0
    s_nop 0
    v_pk_mul_f32 v[168:169], v[152:153], v[152:153]
    v_pk_mul_f32 v[170:171], v[154:155], v[154:155]
    v_pk_mul_f32 v[172:173], v[156:157], v[156:157]
    v_pk_mul_f32 v[174:175], v[158:159], v[158:159]
    v_pk_fma_f32 v[168:169], v[168:169], s[60:61], v[128:129] op_sel_hi:[1,1,0]
    v_pk_fma_f32 v[170:171], v[170:171], s[60:61], v[128:129] op_sel_hi:[1,1,0]
    v_pk_fma_f32 v[172:173], v[172:173], s[60:61], v[128:129] op_sel_hi:[1,1,0]
    v_pk_fma_f32 v[174:175], v[174:175], s[60:61], v[128:129] op_sel_hi:[1,1,0]
    v_pk_mul_f32 v[168:169], v[168:169], v[152:153]
    v_pk_mul_f32 v[170:171], v[170:171], v[154:155]
    v_pk_mul_f32 v[172:173], v[172:173], v[156:157]
    v_pk_mul_f32 v[174:175], v[174:175], v[158:159]
    v_exp_f32 v168, v168
    v_exp_f32 v169, v169
    v_exp_f32 v170, v170
    v_exp_f32 v171, v171
    v_exp_f32 v172, v172
    v_exp_f32 v173, v173
    v_exp_f32 v174, v174
    v_exp_f32 v175, v175
    v_pk_add_f32 v[168:169], v[168:169], v[130:131] op_sel_hi:[1,0]
    v_pk_add_f32 v[170:171], v[170:171], v[130:131] op_sel_hi:[1,0]
    v_pk_add_f32 v[172:173], v[172:173], v[130:131] op_sel_hi:[1,0]
    v_pk_add_f32 v[174:175], v[174:175], v[130:131] op_sel_hi:[1,0]
    v_rcp_f32 v168, v168
    v_rcp_f32 v169, v169
    v_rcp_f32 v170, v170
    v_rcp_f32 v171, v171
    v_rcp_f32 v172, v172
    v_rcp_f32 v173, v173
    v_rcp_f32 v174, v174
    v_rcp_f32 v175, v175
    v_pk_mul_f32 v[152:153], v[152:153], v[160:161]
    v_pk_mul_f32 v[154:155], v[154:155], v[162:163]
    v_pk_mul_f32 v[156:157], v[156:157], v[164:165]
    v_pk_mul_f32 v[158:159], v[158:159], v[166:167]
    v_pk_mul_f32 v[168:169], v[168:169], v[152:153]
    v_pk_mul_f32 v[170:171], v[170:171], v[154:155]
    v_pk_mul_f32 v[172:173], v[172:173], v[156:157]
    v_pk_mul_f32 v[174:175], v[174:175], v[158:159]
    v_cvt_pk_bf16_f32 v168, v168, v169
    v_cvt_pk_bf16_f32 v169, v170, v171
    v_cvt_pk_bf16_f32 v170, v172, v173
    v_cvt_pk_bf16_f32 v171, v174, v175
    ds_write_b64 v13, v[168:169] offset:24576
    ds_write_b64 v13, v[170:171] offset:26624
    s_waitcnt lgkmcnt(0)
    s_barrier
    ds_read_b128 v[96:99], v0 offset:24576
    ds_read_b128 v[100:103], v0 offset:25600
    ds_read_b128 v[104:107], v0 offset:26624
    ds_read_b128 v[108:111], v0 offset:27648
    s_add_u32 s40, s28, 0
    s_waitcnt lgkmcnt(2)
    s_add_u32 s56, s40, 0
    s_add_u32 s57, s40, 263168
    s_add_u32 s58, s40, 526336
    s_add_u32 s59, s40, 789504
    v_mfma_f32_16x16x32_bf16 v[128:131], v[192:195], v[96:99], 0
    v_mfma_f32_16x16x32_bf16 v[132:135], v[200:203], v[96:99], 0
    v_mfma_f32_16x16x32_bf16 v[128:131], v[196:199], v[100:103], v[128:131]
    v_mfma_f32_16x16x32_bf16 v[132:135], v[204:207], v[100:103], v[132:135]
    v_mfma_f32_16x16x32_bf16 v[136:139], v[208:211], v[96:99], 0
    s_nop 1
    v_mfma_f32_16x16x32_bf16 v[140:143], v[216:219], v[96:99], 0
    s_nop 1
    v_mfma_f32_16x16x32_bf16 v[136:139], v[212:215], v[100:103], v[136:139]
    v_cvt_pk_bf16_f32 v128, v128, v129
    v_cvt_pk_bf16_f32 v129, v130, v131
    v_mfma_f32_16x16x32_bf16 v[140:143], v[220:223], v[100:103], v[140:143]
    v_cvt_pk_bf16_f32 v130, v132, v133
    v_cvt_pk_bf16_f32 v131, v134, v135
    v_mfma_f32_16x16x32_bf16 v[144:147], v[224:227], v[96:99], 0
    ds_write_b128 v82, v[128:131] offset:0
    s_nop 0
    v_mfma_f32_16x16x32_bf16 v[148:151], v[232:235], v[96:99], 0
    s_nop 1
    v_mfma_f32_16x16x32_bf16 v[144:147], v[228:231], v[100:103], v[144:147]
    v_cvt_pk_bf16_f32 v136, v136, v137
    v_cvt_pk_bf16_f32 v137, v138, v139
    v_mfma_f32_16x16x32_bf16 v[148:151], v[236:239], v[100:103], v[148:151]
    v_cvt_pk_bf16_f32 v138, v140, v141
    v_cvt_pk_bf16_f32 v139, v142, v143
    v_mfma_f32_16x16x32_bf16 v[152:155], v[240:243], v[96:99], 0
    ds_write_b128 v82, v[136:139] offset:64
    v_mfma_f32_16x16x32_bf16 v[156:159], v[248:251], v[96:99], 0
    ds_read_b128 v[48:51], v83 offset:0
    v_mfma_f32_16x16x32_bf16 v[152:155], v[244:247], v[100:103], v[152:155]
    ds_read_b128 v[52:55], v83 offset:2176
    s_nop 0
    v_mfma_f32_16x16x32_bf16 v[156:159], v[252:255], v[100:103], v[156:159]
    s_nop 1
    s_waitcnt lgkmcnt(4)
    v_mfma_f32_16x16x32_bf16 v[160:163], v[192:195], v[104:107], 0
    s_nop 1
    v_mfma_f32_16x16x32_bf16 v[164:167], v[200:203], v[104:107], 0
    s_nop 1
    v_mfma_f32_16x16x32_bf16 v[160:163], v[196:199], v[108:111], v[160:163]
    s_waitcnt lgkmcnt(1)
    buffer_store_dwordx4 v[48:51], v2, s[8:11], s56 offen offset:0
    v_mfma_f32_16x16x32_bf16 v[164:167], v[204:207], v[108:111], v[164:167]
    s_waitcnt lgkmcnt(0)
    buffer_store_dwordx4 v[52:55], v2, s[8:11], s57 offen offset:0
    v_cvt_pk_bf16_f32 v144, v144, v145
    v_mfma_f32_16x16x32_bf16 v[168:171], v[208:211], v[104:107], 0
    v_cvt_pk_bf16_f32 v145, v146, v147
    v_cvt_pk_bf16_f32 v146, v148, v149
    v_mfma_f32_16x16x32_bf16 v[172:175], v[216:219], v[104:107], 0
    v_cvt_pk_bf16_f32 v147, v150, v151
    v_mfma_f32_16x16x32_bf16 v[168:171], v[212:215], v[108:111], v[168:171]
    ds_write_b128 v82, v[144:147] offset:128
    v_cvt_pk_bf16_f32 v152, v152, v153
    v_mfma_f32_16x16x32_bf16 v[172:175], v[220:223], v[108:111], v[172:175]
    v_cvt_pk_bf16_f32 v153, v154, v155
    v_cvt_pk_bf16_f32 v154, v156, v157
    v_mfma_f32_16x16x32_bf16 v[176:179], v[224:227], v[104:107], 0
    v_cvt_pk_bf16_f32 v155, v158, v159
    v_mfma_f32_16x16x32_bf16 v[180:183], v[232:235], v[104:107], 0
    ds_write_b128 v82, v[152:155] offset:192
    v_mfma_f32_16x16x32_bf16 v[176:179], v[228:231], v[108:111], v[176:179]
    ds_read_b128 v[56:59], v83 offset:128
    v_mfma_f32_16x16x32_bf16 v[180:183], v[236:239], v[108:111], v[180:183]
    ds_read_b128 v[60:63], v83 offset:2304
    v_mfma_f32_16x16x32_bf16 v[184:187], v[240:243], v[104:107], 0
    s_waitcnt lgkmcnt(1)
    buffer_store_dwordx4 v[56:59], v2, s[8:11], s56 offen offset:128
    v_mfma_f32_16x16x32_bf16 v[188:191], v[248:251], v[104:107], 0
    s_waitcnt lgkmcnt(0)
    buffer_store_dwordx4 v[60:63], v2, s[8:11], s57 offen offset:128
    v_cvt_pk_bf16_f32 v160, v160, v161
    v_mfma_f32_16x16x32_bf16 v[184:187], v[244:247], v[108:111], v[184:187]
    v_cvt_pk_bf16_f32 v161, v162, v163
    v_cvt_pk_bf16_f32 v162, v164, v165
    v_mfma_f32_16x16x32_bf16 v[188:191], v[252:255], v[108:111], v[188:191]
    v_cvt_pk_bf16_f32 v163, v166, v167
    ds_write_b128 v82, v[160:163] offset:4352
    v_cvt_pk_bf16_f32 v168, v168, v169
    v_cvt_pk_bf16_f32 v169, v170, v171
    v_cvt_pk_bf16_f32 v170, v172, v173
    v_cvt_pk_bf16_f32 v171, v174, v175
    ds_write_b128 v82, v[168:171] offset:4416
    ds_read_b128 v[64:67], v83 offset:4352
    ds_read_b128 v[68:71], v83 offset:6528
    s_waitcnt lgkmcnt(1)
    buffer_store_dwordx4 v[64:67], v2, s[8:11], s58 offen offset:0
    s_waitcnt lgkmcnt(0)
    buffer_store_dwordx4 v[68:71], v2, s[8:11], s59 offen offset:0
    v_cvt_pk_bf16_f32 v176, v176, v177
    v_cvt_pk_bf16_f32 v177, v178, v179
    v_cvt_pk_bf16_f32 v178, v180, v181
    v_cvt_pk_bf16_f32 v179, v182, v183
    ds_write_b128 v82, v[176:179] offset:4480
    v_cvt_pk_bf16_f32 v184, v184, v185
    v_cvt_pk_bf16_f32 v185, v186, v187
    v_cvt_pk_bf16_f32 v186, v188, v189
    v_cvt_pk_bf16_f32 v187, v190, v191
    ds_write_b128 v82, v[184:187] offset:4544
    ds_read_b128 v[72:75], v83 offset:4480
    ds_read_b128 v[76:79], v83 offset:6656
    s_waitcnt lgkmcnt(1)
    buffer_store_dwordx4 v[72:75], v2, s[8:11], s58 offen offset:128
    s_waitcnt lgkmcnt(0)
    buffer_store_dwordx4 v[76:79], v2, s[8:11], s59 offen offset:128
    s_waitcnt vmcnt(0)
    v_mov_b32 v15, s25
    buffer_store_dword v15, v11, s[8:11], s32 offen offset:1024
    s_branch C_join
C_noffn:
    s_waitcnt vmcnt(0)
    s_add_u32 s24, s24, s63
    s_mul_i32 s41, s63, 786432
    s_add_u32 s26, s26, s41
    s_mul_i32 s41, s63, 131072
    s_add_u32 s27, s27, s41
    s_add_u32 s41, s24, 0
    s_lshr_b32 s40, s41, 1
    s_add_u32 s40, s40, 1
    s_max_u32 s40, s40, 2
    s_and_b32 s41, s41, 1
    s_lshl_b32 s41, s41, 12
    s_add_u32 s42, s41, s34
    s_cmp_lt_u32 s24, 64
    s_cselect_b32 s40, s40, 0
    v_cmp_gt_u32 vcc, s40, v84
    s_nop 0
    s_cbranch_vccz C_lb_ok
    s_mov_b32 s37, 0
C_lb:
    buffer_load_dword v15, v12, s[8:11], s42 offen offset:0 sc1
    s_add_u32 s37, s37, 1
    s_cmp_gt_u32 s37, 400000
    s_cbranch_scc1 L_fail
    s_waitcnt vmcnt(0)
    v_cmp_gt_u32 vcc, s40, v15
    s_nop 0
    s_cbranch_vccz C_lb_ok
    s_branch C_lb
C_lb_ok:
    v_cmp_ge_u32 vcc, s24, v25
    s_mul_i32 s41, s17, 6144
    s_add_u32 s53, s26, s41
    s_cmp_lt_u32 s24, 64
    s_cselect_b32 s53, s53, 0x40000000
    s_add_u32 s54, s53, 3072
    s_cmp_eq_u64 vcc, 0
    s_cselect_b32 s43, 1, 0
    s_cselect_b32 s55, s27, 0x40000000
    s_mul_i32 s41, s17, 6144
    s_add_u32 m0, s41, 65536
    s_nop 0
    buffer_load_dwordx4 v0, s[8:11], s53 offen sc1 lds
    buffer_load_dwordx4 v0, s[8:11], s53 offen offset:1024 sc1 lds
    buffer_load_dwordx4 v0, s[8:11], s53 offen offset:2048 sc1 lds
    s_mul_i32 s41, s17, 6144
    s_add_u32 m0, s41, 68608
    s_nop 0
    buffer_load_dwordx4 v0, s[8:11], s54 offen sc1 lds
    buffer_load_dwordx4 v0, s[8:11], s54 offen offset:1024 sc1 lds
    buffer_load_dwordx4 v0, s[8:11], s54 offen offset:2048 sc1 lds
    s_lshl_b32 s41, s17, 12
    s_add_u32 m0, s41, 0
    s_nop 0
    buffer_load_dwordx4 v0, s[8:11], s55 offen offset:0 sc1 lds
    buffer_load_dwordx4 v0, s[8:11], s55 offen offset:1024 sc1 lds
    buffer_load_dwordx4 v0, s[8:11], s55 offen offset:2048 sc1 lds
    buffer_load_dwordx4 v0, s[8:11], s55 offen offset:3072 sc1 lds
C_join:
    s_mov_b32 s37, 0
C_w3:
    buffer_load_dword v15, v10, s[8:11], s33 offen offset:1024 sc1
    s_add_u32 s37, s37, 1
    s_cmp_gt_u32 s37, 400000
    s_cbranch_scc1 L_fail
    s_waitcnt vmcnt(0)
    v_cmp_gt_u32 vcc, s25, v15
    s_nop 0
    s_and_b32 vcc_lo, vcc_lo, 0x0fffffff
    s_mov_b32 vcc_hi, 0
    s_cmp_eq_u32 vcc_lo, 0
    s_cbranch_scc1 C_w3_ok
    s_branch C_w3
C_w3_ok:
    s_add_u32 s40, s29, 0
    buffer_load_dwordx4 v[96:99], v3, s[8:11], s40 offen sc1
    s_add_u32 s41, s40, 4096
    buffer_load_dwordx4 v[100:103], v3, s[8:11], s41 offen sc1
    s_add_u32 s41, s40, 8192
    buffer_load_dwordx4 v[104:107], v3, s[8:11], s41 offen sc1
    s_add_u32 s41, s40, 12288
    buffer_load_dwordx4 v[108:111], v3, s[8:11], s41 offen sc1
    s_add_u32 s41, s40, 16384
    buffer_load_dwordx4 v[112:115], v3, s[8:11], s41 offen sc1
    s_add_u32 s41, s40, 20480
    buffer_load_dwordx4 v[116:119], v3, s[8:11], s41 offen sc1
    s_add_u32 s41, s40, 24576
    buffer_load_dwordx4 v[120:123], v3, s[8:11], s41 offen sc1
    s_waitcnt vmcnt(6)
    v_mfma_f32_16x16x32_bf16 v[128:131], v[28:31], v[96:99], 0
    s_waitcnt vmcnt(5)
    v_mfma_f32_16x16x32_bf16 v[128:131], v[28:31], v[100:103], v[128:131]
    s_waitcnt vmcnt(4)
    v_mfma_f32_16x16x32_bf16 v[128:131], v[28:31], v[104:107], v[128:131]
    s_waitcnt vmcnt(3)
    v_mfma_f32_16x16x32_bf16 v[128:131], v[28:31], v[108:111], v[128:131]
    s_waitcnt vmcnt(2)
    v_mfma_f32_16x16x32_bf16 v[128:131], v[28:31], v[112:115], v[128:131]
    s_waitcnt vmcnt(1)
    v_mfma_f32_16x16x32_bf16 v[128:131], v[28:31], v[116:119], v[128:131]
    s_waitcnt vmcnt(0)
    v_mfma_f32_16x16x32_bf16 v[128:131], v[28:31], v[120:123], v[128:131]
    v_mov_b32 v15, s25
    buffer_store_dword v15, v11, s[8:11], s32 offen offset:1536
    v_lshlrev_b32 v132, 16, v26
    v_and_b32 v133, 0xffff0000, v26
    v_lshlrev_b32 v134, 16, v27
    v_and_b32 v135, 0xffff0000, v27
    s_nop 1
    v_cvt_pk_bf16_f32 v128, v128, v129
    v_cvt_pk_bf16_f32 v130, v130, v131
    v_and_b32 v129, 0xffff0000, v128
    v_and_b32 v131, 0xffff0000, v130
    v_lshlrev_b32 v128, 16, v128
    v_lshlrev_b32 v130, 16, v130
    v_pk_add_f32 v[132:133], v[132:133], v[128:129]
    v_pk_add_f32 v[134:135], v[134:135], v[130:131]
    v_cvt_pk_bf16_f32 v136, v132, v133
    v_cvt_pk_bf16_f32 v137, v134, v135
    buffer_store_dwordx2 v[136:137], v4, s[48:51], s36 offen nt
    s_lshl_b32 s41, s63, 15
    s_add_u32 s36, s36, s41
    s_cmp_lt_u32 s24, 64
    s_cbranch_scc1 C_loop
    s_branch L_exit
L_P:
    s_sub_u32 s19, s18, 1
    v_lshrrev_b32 v28, 4, v0
    v_and_b32 v29, 15, v0
    v_and_b32 v30, 1, v28
    v_lshlrev_b32 v30, 1, v30
    v_xor_b32 v29, v29, v30
    v_lshlrev_b32 v28, 13, v28
    v_xor_b32 v30, 0, v29
    v_lshl_add_u32 v30, v30, 4, v28
    v_add_u32 v16, 0, v30
    v_xor_b32 v30, 4, v29
    v_lshl_add_u32 v30, v30, 4, v28
    v_add_u32 v17, 31744, v30
    v_xor_b32 v30, 8, v29
    v_lshl_add_u32 v30, v30, 4, v28
    v_add_u32 v18, 63488, v30
    v_xor_b32 v30, 12, v29
    v_lshl_add_u32 v30, v30, 4, v28
    v_add_u32 v19, 95232, v30
    v_lshrrev_b32 v28, 5, v0
    v_lshlrev_b32 v28, 4, v28
    v_bfe_u32 v29, v0, 4, 1
    v_lshl_add_u32 v28, v29, 2, v28
    v_bfe_u32 v30, v0, 2, 1
    v_add_u32 v28, v28, v30
    v_bfe_u32 v31, v0, 3, 1
    v_lshl_add_u32 v28, v31, 3, v28
    v_lshl_add_u32 v30, v29, 1, v30
    v_lshl_add_u32 v30, v31, 2, v30
    v_lshlrev_b32 v30, 1, v30
    v_bfe_u32 v29, v0, 1, 1
    s_lshl_b32 s21, s17, 2
    v_add_u32 v29, s21, v29
    v_xor_b32 v29, v29, v30
    v_lshlrev_b32 v28, 8, v28
    v_and_b32 v31, 1, v0
    v_lshl_add_u32 v28, v31, 3, v28
    v_lshl_add_u32 v20, v29, 4, v28
    v_xor_b32 v21, 32, v20
    v_add_u32 v22, 0x10000, v20
    v_add_u32 v23, 0x10000, v21
    s_mov_b32 s12, s70
    s_mov_b32 s13, s71
    s_mov_b32 s14, 4194304
    s_mov_b32 s15, 0x00020000
    s_lshl_b32 s21, s17, 18
    s_lshl_b32 s22, s16, 8
    s_add_u32 s21, s21, s22
    s_add_u32 s20, s21, 0
    s_lshl_b32 s21, s17, 13
    s_add_u32 m0, s21, 0
    s_nop 0
    buffer_load_dwordx4 v16, s[12:15], s20 offen offset:0  lds
    buffer_load_dwordx4 v17, s[12:15], s20 offen offset:1024  lds
    buffer_load_dwordx4 v18, s[12:15], s20 offen offset:2048  lds
    buffer_load_dwordx4 v19, s[12:15], s20 offen offset:3072  lds
    s_lshl_b32 s21, s17, 18
    s_lshl_b32 s22, s16, 8
    s_add_u32 s21, s21, s22
    s_add_u32 s20, s21, 131072
    s_lshl_b32 s21, s17, 13
    s_add_u32 m0, s21, 4096
    s_nop 0
    buffer_load_dwordx4 v16, s[12:15], s20 offen offset:0  lds
    buffer_load_dwordx4 v17, s[12:15], s20 offen offset:1024  lds
    buffer_load_dwordx4 v18, s[12:15], s20 offen offset:2048  lds
    buffer_load_dwordx4 v19, s[12:15], s20 offen offset:3072  lds
    s_mov_b32 s12, s70
    s_mov_b32 s13, s71
    s_mov_b32 s14, 4194304
    s_mov_b32 s15, 0x00020000
    s_lshl_b32 s21, s17, 18
    s_lshl_b32 s22, s16, 8
    s_add_u32 s21, s21, s22
    s_add_u32 s20, s21, 1048576
    s_lshl_b32 s21, s17, 13
    s_add_u32 m0, s21, 32768
    s_nop 0
    buffer_load_dwordx4 v16, s[12:15], s20 offen offset:0  lds
    buffer_load_dwordx4 v17, s[12:15], s20 offen offset:1024  lds
    buffer_load_dwordx4 v18, s[12:15], s20 offen offset:2048  lds
    buffer_load_dwordx4 v19, s[12:15], s20 offen offset:3072  lds
    s_lshl_b32 s21, s17, 18
    s_lshl_b32 s22, s16, 8
    s_add_u32 s21, s21, s22
    s_add_u32 s20, s21, 1179648
    s_lshl_b32 s21, s17, 13
    s_add_u32 m0, s21, 36864
    s_nop 0
    buffer_load_dwordx4 v16, s[12:15], s20 offen offset:0  lds
    buffer_load_dwordx4 v17, s[12:15], s20 offen offset:1024  lds
    buffer_load_dwordx4 v18, s[12:15], s20 offen offset:2048  lds
    buffer_load_dwordx4 v19, s[12:15], s20 offen offset:3072  lds
    v_lshrrev_b32 v3, 5, v0
    v_lshlrev_b32 v3, 10, v3
    v_bfe_u32 v4, v0, 4, 1
    v_lshl_add_u32 v3, v4, 9, v3
    v_and_b32 v4, 15, v0
    v_lshl_add_u32 v1, v4, 4, v3
    v_cmp_eq_u32 vcc, 0, v0
    v_mov_b32 v3, 2147483392
    s_nop 0
    v_cndmask_b32 v2, v3, v0, vcc
    v_lshlrev_b32 v0, 4, v0
    s_lshl_b32 s21, s19, 15
    s_lshl_b32 s22, s17, 13
    s_add_u32 s25, s21, s22
    s_mov_b32 s28, s22
    s_mul_i32 s21, s19, 786432
    s_mul_i32 s22, s16, 24576
    s_add_u32 s21, s21, s22
    s_lshl_b32 s22, s17, 10
    s_add_u32 s21, s21, s22
    s_add_u32 s26, s21, 2097152
    s_lshl_b32 s21, s19, 5
    s_add_u32 s21, s21, s16
    s_lshl_b32 s21, s21, 7
    s_lshl_b32 s22, s17, 2
    s_add_u32 s21, s21, s22
    s_add_u32 s29, s21, 65077248
    s_mov_b32 s27, 0
    s_mov_b32 s30, 0
    s_lshl_b32 s21, s16, 7
    s_add_u32 s31, s21, 65085440
    s_waitcnt vmcnt(16)
    s_barrier
    s_mov_b32 s98, 0
    s_cmp_lg_u32 s17, 0
    s_cbranch_scc1 P_arr_skip
    s_and_b32 s96, s3, 3
    s_lshl_b32 s96, s96, 6
    s_lshl_b32 s97, s23, 2
    s_add_u32 s96, s96, s97
    s_add_u32 s96, s96, 32
    s_mov_b32 s98, 1
    s_atomic_add s98, s[88:89], s96 glc
P_arr_skip:
    s_waitcnt lgkmcnt(0)
    s_cmp_lg_u32 s98, 63
    s_cbranch_scc1 P_arr_done
    s_lshl_b32 s97, s23, 2
    s_add_u32 s96, s97, 40
    s_mov_b32 s98, 1
    s_atomic_add s98, s[88:89], s96 glc
    s_waitcnt lgkmcnt(0)
    s_cmp_lg_u32 s98, 3
    s_cbranch_scc1 P_arr_done
    v_mbcnt_lo_u32_b32 v126, -1, 0
    v_mbcnt_hi_u32_b32 v126, -1, v126
    s_mov_b32 s98, 3
    s_cmp_lg_u32 s23, 0
    s_cbranch_scc1 P_arr_tell
    v_lshlrev_b32 v125, 2, v126
    v_mov_b32 v127, 0
    buffer_atomic_add v127, v125, s[4:7], 0 offen sc0
    s_waitcnt vmcnt(0)
    v_cmp_ne_u32 vcc, 32, v127
    s_nop 0
    s_and_b32 s96, vcc_lo, 196609
    s_and_b32 s97, vcc_hi, 458755
    s_or_b32 s96, s96, s97
    s_cselect_b32 s98, 2, 1
P_arr_tell:
    v_lshlrev_b32 v126, 7, v126
    v_mov_b32 v127, s98
    s_mov_b32 s96, 65110016
    buffer_store_dword v127, v126, s[8:11], s96 offen sc1
    s_mov_b32 s96, 65118208
    buffer_store_dword v127, v126, s[8:11], s96 offen sc1
    s_mov_b32 s96, 65126400
    buffer_store_dword v127, v126, s[8:11], s96 offen sc1
    s_mov_b32 s96, 65134592
    buffer_store_dword v127, v126, s[8:11], s96 offen sc1
P_arr_done:
    s_waitcnt vmcnt(8)
    s_barrier
    s_mov_b32 s12, s70
    s_mov_b32 s13, s71
    s_mov_b32 s14, 4194304
    s_mov_b32 s15, 0x00020000
    s_lshl_b32 s21, s17, 18
    s_lshl_b32 s22, s16, 8
    s_add_u32 s21, s21, s22
    s_add_u32 s20, s21, 2097152
    s_lshl_b32 s21, s17, 13
    s_add_u32 m0, s21, 65536
    s_nop 0
    buffer_load_dwordx4 v16, s[12:15], s20 offen offset:0  lds
    buffer_load_dwordx4 v17, s[12:15], s20 offen offset:1024  lds
    buffer_load_dwordx4 v18, s[12:15], s20 offen offset:2048  lds
    buffer_load_dwordx4 v19, s[12:15], s20 offen offset:3072  lds
    s_lshl_b32 s21, s17, 18
    s_lshl_b32 s22, s16, 8
    s_add_u32 s21, s21, s22
    s_add_u32 s20, s21, 2228224
    s_lshl_b32 s21, s17, 13
    s_add_u32 m0, s21, 69632
    s_nop 0
    buffer_load_dwordx4 v16, s[12:15], s20 offen offset:0  lds
    buffer_load_dwordx4 v17, s[12:15], s20 offen offset:1024  lds
    buffer_load_dwordx4 v18, s[12:15], s20 offen offset:2048  lds
    buffer_load_dwordx4 v19, s[12:15], s20 offen offset:3072  lds
    ds_read_b64_tr_b16 a[128:129], v20 offset:0
    ds_read_b64_tr_b16 a[130:131], v20 offset:512
    ds_read_b64_tr_b16 a[132:133], v20 offset:8192
    ds_read_b64_tr_b16 a[134:135], v20 offset:8704
    ds_read_b64_tr_b16 a[136:137], v21 offset:0
    ds_read_b64_tr_b16 a[138:139], v21 offset:512
    ds_read_b64_tr_b16 a[140:141], v21 offset:8192
    ds_read_b64_tr_b16 a[142:143], v21 offset:8704
    ds_read_b64_tr_b16 a[144:145], v20 offset:16384
    ds_read_b64_tr_b16 a[146:147], v20 offset:16896
    ds_read_b64_tr_b16 a[148:149], v20 offset:24576
    ds_read_b64_tr_b16 a[150:151], v20 offset:25088
    ds_read_b64_tr_b16 a[152:153], v21 offset:16384
    ds_read_b64_tr_b16 a[154:155], v21 offset:16896
    ds_read_b64_tr_b16 a[156:157], v21 offset:24576
    ds_read_b64_tr_b16 a[158:159], v21 offset:25088
    s_waitcnt lgkmcnt(0)
    s_waitcnt vmcnt(8)
    s_barrier
    s_mov_b32 s12, s70
    s_mov_b32 s13, s71
    s_mov_b32 s14, 4194304
    s_mov_b32 s15, 0x00020000
    s_lshl_b32 s21, s17, 18
    s_lshl_b32 s22, s16, 8
    s_add_u32 s21, s21, s22
    s_add_u32 s20, s21, 3145728
    s_lshl_b32 s21, s17, 13
    s_add_u32 m0, s21, 98304
    s_nop 0
    buffer_load_dwordx4 v16, s[12:15], s20 offen offset:0  lds
    buffer_load_dwordx4 v17, s[12:15], s20 offen offset:1024  lds
    buffer_load_dwordx4 v18, s[12:15], s20 offen offset:2048  lds
    buffer_load_dwordx4 v19, s[12:15], s20 offen offset:3072  lds
    s_lshl_b32 s21, s17, 18
    s_lshl_b32 s22, s16, 8
    s_add_u32 s21, s21, s22
    s_add_u32 s20, s21, 3276800
    s_lshl_b32 s21, s17, 13
    s_add_u32 m0, s21, 102400
    s_nop 0
    buffer_load_dwordx4 v16, s[12:15], s20 offen offset:0  lds
    buffer_load_dwordx4 v17, s[12:15], s20 offen offset:1024  lds
    buffer_load_dwordx4 v18, s[12:15], s20 offen offset:2048  lds
    buffer_load_dwordx4 v19, s[12:15], s20 offen offset:3072  lds
    ds_read_b64_tr_b16 a[160:161], v20 offset:32768
    ds_read_b64_tr_b16 a[162:163], v20 offset:33280
    ds_read_b64_tr_b16 a[164:165], v20 offset:40960
    ds_read_b64_tr_b16 a[166:167], v20 offset:41472
    ds_read_b64_tr_b16 a[168:169], v21 offset:32768
    ds_read_b64_tr_b16 a[170:171], v21 offset:33280
    ds_read_b64_tr_b16 a[172:173], v21 offset:40960
    ds_read_b64_tr_b16 a[174:175], v21 offset:41472
    ds_read_b64_tr_b16 a[176:177], v20 offset:49152
    ds_read_b64_tr_b16 a[178:179], v20 offset:49664
    ds_read_b64_tr_b16 a[180:181], v20 offset:57344
    ds_read_b64_tr_b16 a[182:183], v20 offset:57856
    ds_read_b64_tr_b16 a[184:185], v21 offset:49152
    ds_read_b64_tr_b16 a[186:187], v21 offset:49664
    ds_read_b64_tr_b16 a[188:189], v21 offset:57344
    ds_read_b64_tr_b16 a[190:191], v21 offset:57856
    s_waitcnt lgkmcnt(0)
    s_waitcnt vmcnt(8)
    s_barrier
    s_mov_b32 s12, s72
    s_mov_b32 s13, s73
    s_mov_b32 s14, 4194304
    s_mov_b32 s15, 0x00020000
    s_lshl_b32 s21, s17, 18
    s_lshl_b32 s22, s16, 8
    s_add_u32 s21, s21, s22
    s_add_u32 s20, s21, 0
    s_lshl_b32 s21, s17, 13
    s_add_u32 m0, s21, 0
    s_nop 0
    buffer_load_dwordx4 v16, s[12:15], s20 offen offset:0  lds
    buffer_load_dwordx4 v17, s[12:15], s20 offen offset:1024  lds
    buffer_load_dwordx4 v18, s[12:15], s20 offen offset:2048  lds
    buffer_load_dwordx4 v19, s[12:15], s20 offen offset:3072  lds
    s_lshl_b32 s21, s17, 18
    s_lshl_b32 s22, s16, 8
    s_add_u32 s21, s21, s22
    s_add_u32 s20, s21, 131072
    s_lshl_b32 s21, s17, 13
    s_add_u32 m0, s21, 4096
    s_nop 0
    buffer_load_dwordx4 v16, s[12:15], s20 offen offset:0  lds
    buffer_load_dwordx4 v17, s[12:15], s20 offen offset:1024  lds
    buffer_load_dwordx4 v18, s[12:15], s20 offen offset:2048  lds
    buffer_load_dwordx4 v19, s[12:15], s20 offen offset:3072  lds
    ds_read_b64_tr_b16 a[192:193], v22 offset:0
    ds_read_b64_tr_b16 a[194:195], v22 offset:512
    ds_read_b64_tr_b16 a[196:197], v22 offset:8192
    ds_read_b64_tr_b16 a[198:199], v22 offset:8704
    ds_read_b64_tr_b16 a[200:201], v23 offset:0
    ds_read_b64_tr_b16 a[202:203], v23 offset:512
    ds_read_b64_tr_b16 a[204:205], v23 offset:8192
    ds_read_b64_tr_b16 a[206:207], v23 offset:8704
    ds_read_b64_tr_b16 a[208:209], v22 offset:16384
    ds_read_b64_tr_b16 a[210:211], v22 offset:16896
    ds_read_b64_tr_b16 a[212:213], v22 offset:24576
    ds_read_b64_tr_b16 a[214:215], v22 offset:25088
    ds_read_b64_tr_b16 a[216:217], v23 offset:16384
    ds_read_b64_tr_b16 a[218:219], v23 offset:16896
    ds_read_b64_tr_b16 a[220:221], v23 offset:24576
    ds_read_b64_tr_b16 a[222:223], v23 offset:25088
    s_waitcnt lgkmcnt(0)
    s_waitcnt vmcnt(8)
    s_barrier
    s_mov_b32 s12, s72
    s_mov_b32 s13, s73
    s_mov_b32 s14, 4194304
    s_mov_b32 s15, 0x00020000
    s_lshl_b32 s21, s17, 18
    s_lshl_b32 s22, s16, 8
    s_add_u32 s21, s21, s22
    s_add_u32 s20, s21, 1048576
    s_lshl_b32 s21, s17, 13
    s_add_u32 m0, s21, 32768
    s_nop 0
    buffer_load_dwordx4 v16, s[12:15], s20 offen offset:0  lds
    buffer_load_dwordx4 v17, s[12:15], s20 offen offset:1024  lds
    buffer_load_dwordx4 v18, s[12:15], s20 offen offset:2048  lds
    buffer_load_dwordx4 v19, s[12:15], s20 offen offset:3072  lds
    s_lshl_b32 s21, s17, 18
    s_lshl_b32 s22, s16, 8
    s_add_u32 s21, s21, s22
    s_add_u32 s20, s21, 1179648
    s_lshl_b32 s21, s17, 13
    s_add_u32 m0, s21, 36864
    s_nop 0
    buffer_load_dwordx4 v16, s[12:15], s20 offen offset:0  lds
    buffer_load_dwordx4 v17, s[12:15], s20 offen offset:1024  lds
    buffer_load_dwordx4 v18, s[12:15], s20 offen offset:2048  lds
    buffer_load_dwordx4 v19, s[12:15], s20 offen offset:3072  lds
    ds_read_b64_tr_b16 a[224:225], v22 offset:32768
    ds_read_b64_tr_b16 a[226:227], v22 offset:33280
    ds_read_b64_tr_b16 a[228:229], v22 offset:40960
    ds_read_b64_tr_b16 a[230:231], v22 offset:41472
    ds_read_b64_tr_b16 a[232:233], v23 offset:32768
    ds_read_b64_tr_b16 a[234:235], v23 offset:33280
    ds_read_b64_tr_b16 a[236:237], v23 offset:40960
    ds_read_b64_tr_b16 a[238:239], v23 offset:41472
    ds_read_b64_tr_b16 a[240:241], v22 offset:49152
    ds_read_b64_tr_b16 a[242:243], v22 offset:49664
    ds_read_b64_tr_b16 a[244:245], v22 offset:57344
    ds_read_b64_tr_b16 a[246:247], v22 offset:57856
    ds_read_b64_tr_b16 a[248:249], v23 offset:49152
    ds_read_b64_tr_b16 a[250:251], v23 offset:49664
    ds_read_b64_tr_b16 a[252:253], v23 offset:57344
    ds_read_b64_tr_b16 a[254:255], v23 offset:57856
    s_waitcnt lgkmcnt(0)
    s_waitcnt vmcnt(8)
    s_barrier
    s_mov_b32 s12, s72
    s_mov_b32 s13, s73
    s_mov_b32 s14, 4194304
    s_mov_b32 s15, 0x00020000
    s_lshl_b32 s21, s17, 18
    s_lshl_b32 s22, s16, 8
    s_add_u32 s21, s21, s22
    s_add_u32 s20, s21, 2097152
    s_lshl_b32 s21, s17, 13
    s_add_u32 m0, s21, 65536
    s_nop 0
    buffer_load_dwordx4 v16, s[12:15], s20 offen offset:0  lds
    buffer_load_dwordx4 v17, s[12:15], s20 offen offset:1024  lds
    buffer_load_dwordx4 v18, s[12:15], s20 offen offset:2048  lds
    buffer_load_dwordx4 v19, s[12:15], s20 offen offset:3072  lds
    s_lshl_b32 s21, s17, 18
    s_lshl_b32 s22, s16, 8
    s_add_u32 s21, s21, s22
    s_add_u32 s20, s21, 2228224
    s_lshl_b32 s21, s17, 13
    s_add_u32 m0, s21, 69632
    s_nop 0
    buffer_load_dwordx4 v16, s[12:15], s20 offen offset:0  lds
    buffer_load_dwordx4 v17, s[12:15], s20 offen offset:1024  lds
    buffer_load_dwordx4 v18, s[12:15], s20 offen offset:2048  lds
    buffer_load_dwordx4 v19, s[12:15], s20 offen offset:3072  lds
    ds_read_b64_tr_b16 v[128:129], v20 offset:0
    ds_read_b64_tr_b16 v[130:131], v20 offset:512
    ds_read_b64_tr_b16 v[132:133], v20 offset:8192
    ds_read_b64_tr_b16 v[134:135], v20 offset:8704
    ds_read_b64_tr_b16 v[136:137], v21 offset:0
    ds_read_b64_tr_b16 v[138:139], v21 offset:512
    ds_read_b64_tr_b16 v[140:141], v21 offset:8192
    ds_read_b64_tr_b16 v[142:143], v21 offset:8704
    ds_read_b64_tr_b16 v[144:145], v20 offset:16384
    ds_read_b64_tr_b16 v[146:147], v20 offset:16896
    ds_read_b64_tr_b16 v[148:149], v20 offset:24576
    ds_read_b64_tr_b16 v[150:151], v20 offset:25088
    ds_read_b64_tr_b16 v[152:153], v21 offset:16384
    ds_read_b64_tr_b16 v[154:155], v21 offset:16896
    ds_read_b64_tr_b16 v[156:157], v21 offset:24576
    ds_read_b64_tr_b16 v[158:159], v21 offset:25088
    s_waitcnt lgkmcnt(0)
    s_waitcnt vmcnt(8)
    s_barrier
    s_mov_b32 s12, s72
    s_mov_b32 s13, s73
    s_mov_b32 s14, 4194304
    s_mov_b32 s15, 0x00020000
    s_lshl_b32 s21, s17, 18
    s_lshl_b32 s22, s16, 8
    s_add_u32 s21, s21, s22
    s_add_u32 s20, s21, 3145728
    s_lshl_b32 s21, s17, 13
    s_add_u32 m0, s21, 98304
    s_nop 0
    buffer_load_dwordx4 v16, s[12:15], s20 offen offset:0  lds
    buffer_load_dwordx4 v17, s[12:15], s20 offen offset:1024  lds
    buffer_load_dwordx4 v18, s[12:15], s20 offen offset:2048  lds
    buffer_load_dwordx4 v19, s[12:15], s20 offen offset:3072  lds
    s_lshl_b32 s21, s17, 18
    s_lshl_b32 s22, s16, 8
    s_add_u32 s21, s21, s22
    s_add_u32 s20, s21, 3276800
    s_lshl_b32 s21, s17, 13
    s_add_u32 m0, s21, 102400
    s_nop 0
    buffer_load_dwordx4 v16, s[12:15], s20 offen offset:0  lds
    buffer_load_dwordx4 v17, s[12:15], s20 offen offset:1024  lds
    buffer_load_dwordx4 v18, s[12:15], s20 offen offset:2048  lds
    buffer_load_dwordx4 v19, s[12:15], s20 offen offset:3072  lds
    ds_read_b64_tr_b16 v[160:161], v20 offset:32768
    ds_read_b64_tr_b16 v[162:163], v20 offset:33280
    ds_read_b64_tr_b16 v[164:165], v20 offset:40960
    ds_read_b64_tr_b16 v[166:167], v20 offset:41472
    ds_read_b64_tr_b16 v[168:169], v21 offset:32768
    ds_read_b64_tr_b16 v[170:171], v21 offset:33280
    ds_read_b64_tr_b16 v[172:173], v21 offset:40960
    ds_read_b64_tr_b16 v[174:175], v21 offset:41472
    ds_read_b64_tr_b16 v[176:177], v20 offset:49152
    ds_read_b64_tr_b16 v[178:179], v20 offset:49664
    ds_read_b64_tr_b16 v[180:181], v20 offset:57344
    ds_read_b64_tr_b16 v[182:183], v20 offset:57856
    ds_read_b64_tr_b16 v[184:185], v21 offset:49152
    ds_read_b64_tr_b16 v[186:187], v21 offset:49664
    ds_read_b64_tr_b16 v[188:189], v21 offset:57344
    ds_read_b64_tr_b16 v[190:191], v21 offset:57856
    s_waitcnt lgkmcnt(0)
    s_waitcnt vmcnt(8)
    s_barrier
    s_lshl_b32 s96, s3, 7
    s_add_u32 s96, s96, 65110016
    s_lshl_b32 s97, s23, 1
    s_mov_b32 s98, 0
P_go:
    s_mov_b32 s99, 0
    s_atomic_add s99, s[90:91], s96 glc
    s_add_u32 s98, s98, 1
    s_cmp_gt_u32 s98, 400000
    s_cbranch_scc1 L_fail
    s_waitcnt lgkmcnt(0)
    s_cmp_eq_u32 s99, s97
    s_cbranch_scc1 P_go
    s_cmp_eq_u32 s99, 2
    s_cbranch_scc1 L_redo
    v_add_u32 v4, 131072, v0
    s_add_u32 m0, s28, 131072
    s_add_u32 s20, s25, 0
    buffer_load_dwordx4 v0, s[8:11], s20 offen offset:0 sc1 lds
    buffer_load_dwordx4 v0, s[8:11], s20 offen offset:1024 sc1 lds
    buffer_load_dwordx4 v0, s[8:11], s20 offen offset:2048 sc1 lds
    buffer_load_dwordx4 v0, s[8:11], s20 offen offset:3072 sc1 lds
    s_add_u32 m0, s28, 135168
    s_add_u32 s20, s25, 4096
    buffer_load_dwordx4 v0, s[8:11], s20 offen offset:0 sc1 lds
    buffer_load_dwordx4 v0, s[8:11], s20 offen offset:1024 sc1 lds
    buffer_load_dwordx4 v0, s[8:11], s20 offen offset:2048 sc1 lds
    buffer_load_dwordx4 v0, s[8:11], s20 offen offset:3072 sc1 lds
    s_add_u32 s25, s25, 65536
    s_mov_b32 s12, s68
    s_mov_b32 s13, s69
    s_mov_b32 s14, 4194304
    s_mov_b32 s15, 0x00020000
    s_lshl_b32 s21, s17, 18
    s_lshl_b32 s22, s16, 8
    s_add_u32 s21, s21, s22
    s_add_u32 s20, s21, 0
    s_lshl_b32 s21, s17, 13
    s_add_u32 m0, s21, 0
    s_nop 0
    buffer_load_dwordx4 v16, s[12:15], s20 offen offset:0  lds
    buffer_load_dwordx4 v17, s[12:15], s20 offen offset:1024  lds
    buffer_load_dwordx4 v18, s[12:15], s20 offen offset:2048  lds
    buffer_load_dwordx4 v19, s[12:15], s20 offen offset:3072  lds
    s_lshl_b32 s21, s17, 18
    s_lshl_b32 s22, s16, 8
    s_add_u32 s21, s21, s22
    s_add_u32 s20, s21, 131072
    s_lshl_b32 s21, s17, 13
    s_add_u32 m0, s21, 4096
    s_nop 0
    buffer_load_dwordx4 v16, s[12:15], s20 offen offset:0  lds
    buffer_load_dwordx4 v17, s[12:15], s20 offen offset:1024  lds
    buffer_load_dwordx4 v18, s[12:15], s20 offen offset:2048  lds
    buffer_load_dwordx4 v19, s[12:15], s20 offen offset:3072  lds
    ds_read_b64_tr_b16 v[192:193], v22 offset:0
    ds_read_b64_tr_b16 v[194:195], v22 offset:512
    ds_read_b64_tr_b16 v[196:197], v22 offset:8192
    ds_read_b64_tr_b16 v[198:199], v22 offset:8704
    ds_read_b64_tr_b16 v[200:201], v23 offset:0
    ds_read_b64_tr_b16 v[202:203], v23 offset:512
    ds_read_b64_tr_b16 v[204:205], v23 offset:8192
    ds_read_b64_tr_b16 v[206:207], v23 offset:8704
    ds_read_b64_tr_b16 v[208:209], v22 offset:16384
    ds_read_b64_tr_b16 v[210:211], v22 offset:16896
    ds_read_b64_tr_b16 v[212:213], v22 offset:24576
    ds_read_b64_tr_b16 v[214:215], v22 offset:25088
    ds_read_b64_tr_b16 v[216:217], v23 offset:16384
    ds_read_b64_tr_b16 v[218:219], v23 offset:16896
    ds_read_b64_tr_b16 v[220:221], v23 offset:24576
    ds_read_b64_tr_b16 v[222:223], v23 offset:25088
    s_waitcnt lgkmcnt(0)
    s_waitcnt vmcnt(16)
    s_barrier
    s_mov_b32 s12, s68
    s_mov_b32 s13, s69
    s_mov_b32 s14, 4194304
    s_mov_b32 s15, 0x00020000
    s_lshl_b32 s21, s17, 18
    s_lshl_b32 s22, s16, 8
    s_add_u32 s21, s21, s22
    s_add_u32 s20, s21, 1048576
    s_lshl_b32 s21, s17, 13
    s_add_u32 m0, s21, 32768
    s_nop 0
    buffer_load_dwordx4 v16, s[12:15], s20 offen offset:0  lds
    buffer_load_dwordx4 v17, s[12:15], s20 offen offset:1024  lds
    buffer_load_dwordx4 v18, s[12:15], s20 offen offset:2048  lds
    buffer_load_dwordx4 v19, s[12:15], s20 offen offset:3072  lds
    s_lshl_b32 s21, s17, 18
    s_lshl_b32 s22, s16, 8
    s_add_u32 s21, s21, s22
    s_add_u32 s20, s21, 1179648
    s_lshl_b32 s21, s17, 13
    s_add_u32 m0, s21, 36864
    s_nop 0
    buffer_load_dwordx4 v16, s[12:15], s20 offen offset:0  lds
    buffer_load_dwordx4 v17, s[12:15], s20 offen offset:1024  lds
    buffer_load_dwordx4 v18, s[12:15], s20 offen offset:2048  lds
    buffer_load_dwordx4 v19, s[12:15], s20 offen offset:3072  lds
    ds_read_b64_tr_b16 v[224:225], v22 offset:32768
    ds_read_b64_tr_b16 v[226:227], v22 offset:33280
    ds_read_b64_tr_b16 v[228:229], v22 offset:40960
    ds_read_b64_tr_b16 v[230:231], v22 offset:41472
    ds_read_b64_tr_b16 v[232:233], v23 offset:32768
    ds_read_b64_tr_b16 v[234:235], v23 offset:33280
    ds_read_b64_tr_b16 v[236:237], v23 offset:40960
    ds_read_b64_tr_b16 v[238:239], v23 offset:41472
    ds_read_b64_tr_b16 v[240:241], v22 offset:49152
    ds_read_b64_tr_b16 v[242:243], v22 offset:49664
    ds_read_b64_tr_b16 v[244:245], v22 offset:57344
    ds_read_b64_tr_b16 v[246:247], v22 offset:57856
    ds_read_b64_tr_b16 v[248:249], v23 offset:49152
    ds_read_b64_tr_b16 v[250:251], v23 offset:49664
    ds_read_b64_tr_b16 v[252:253], v23 offset:57344
    ds_read_b64_tr_b16 v[254:255], v23 offset:57856
    s_waitcnt lgkmcnt(0)
    s_waitcnt vmcnt(16)
    s_barrier
    ds_read_b128 v[32:35], v4 offset:0
    ds_read_b128 v[36:39], v4 offset:16384
    s_waitcnt lgkmcnt(0)
    v_mfma_f32_16x16x32_bf16 v[80:83], a[128:131], v[32:35], 0
    ds_read_b128 v[40:43], v4 offset:1024
    v_mfma_f32_16x16x32_bf16 v[88:91], a[128:131], v[36:39], 0
    ds_read_b128 v[44:47], v4 offset:17408
    v_mfma_f32_16x16x32_bf16 v[84:87], a[136:139], v[32:35], 0
    v_mfma_f32_16x16x32_bf16 v[92:95], a[136:139], v[36:39], 0
    v_mfma_f32_16x16x32_bf16 v[96:99], v[32:35], v[128:131], 0
    v_mfma_f32_16x16x32_bf16 v[104:107], v[36:39], v[128:131], 0
    v_mfma_f32_16x16x32_bf16 v[100:103], v[32:35], v[136:139], 0
    v_mfma_f32_16x16x32_bf16 v[108:111], v[36:39], v[136:139], 0
    s_waitcnt lgkmcnt(0)
    v_mfma_f32_16x16x32_bf16 v[80:83], a[132:135], v[40:43], v[80:83]
    ds_read_b128 v[32:35], v4 offset:2048
    v_mfma_f32_16x16x32_bf16 v[88:91], a[132:135], v[44:47], v[88:91]
    ds_read_b128 v[36:39], v4 offset:18432
    v_mfma_f32_16x16x32_bf16 v[84:87], a[140:143], v[40:43], v[84:87]
    v_mfma_f32_16x16x32_bf16 v[92:95], a[140:143], v[44:47], v[92:95]
    v_mfma_f32_16x16x32_bf16 v[96:99], v[40:43], v[132:135], v[96:99]
    v_mfma_f32_16x16x32_bf16 v[104:107], v[44:47], v[132:135], v[104:107]
    v_mfma_f32_16x16x32_bf16 v[100:103], v[40:43], v[140:143], v[100:103]
    v_mfma_f32_16x16x32_bf16 v[108:111], v[44:47], v[140:143], v[108:111]
    s_waitcnt lgkmcnt(0)
    v_mfma_f32_16x16x32_bf16 v[80:83], a[144:147], v[32:35], v[80:83]
    ds_read_b128 v[40:43], v4 offset:3072
    v_mfma_f32_16x16x32_bf16 v[88:91], a[144:147], v[36:39], v[88:91]
    ds_read_b128 v[44:47], v4 offset:19456
    v_mfma_f32_16x16x32_bf16 v[84:87], a[152:155], v[32:35], v[84:87]
    v_mfma_f32_16x16x32_bf16 v[92:95], a[152:155], v[36:39], v[92:95]
    v_mfma_f32_16x16x32_bf16 v[96:99], v[32:35], v[144:147], v[96:99]
    v_mfma_f32_16x16x32_bf16 v[104:107], v[36:39], v[144:147], v[104:107]
    v_mfma_f32_16x16x32_bf16 v[100:103], v[32:35], v[152:155], v[100:103]
    v_mfma_f32_16x16x32_bf16 v[108:111], v[36:39], v[152:155], v[108:111]
    s_waitcnt lgkmcnt(0)
    v_mfma_f32_16x16x32_bf16 v[80:83], a[148:151], v[40:43], v[80:83]
    ds_read_b128 v[32:35], v4 offset:4096
    v_mfma_f32_16x16x32_bf16 v[88:91], a[148:151], v[44:47], v[88:91]
    ds_read_b128 v[36:39], v4 offset:20480
    v_mfma_f32_16x16x32_bf16 v[84:87], a[156:159], v[40:43], v[84:87]
    v_mfma_f32_16x16x32_bf16 v[92:95], a[156:159], v[44:47], v[92:95]
    v_mfma_f32_16x16x32_bf16 v[96:99], v[40:43], v[148:151], v[96:99]
    v_mfma_f32_16x16x32_bf16 v[104:107], v[44:47], v[148:151], v[104:107]
    v_mfma_f32_16x16x32_bf16 v[100:103], v[40:43], v[156:159], v[100:103]
    v_mfma_f32_16x16x32_bf16 v[108:111], v[44:47], v[156:159], v[108:111]
    s_waitcnt lgkmcnt(0)
    v_mfma_f32_16x16x32_bf16 v[80:83], a[160:163], v[32:35], v[80:83]
    ds_read_b128 v[40:43], v4 offset:5120
    v_mfma_f32_16x16x32_bf16 v[88:91], a[160:163], v[36:39], v[88:91]
    ds_read_b128 v[44:47], v4 offset:21504
    v_mfma_f32_16x16x32_bf16 v[84:87], a[168:171], v[32:35], v[84:87]
    v_mfma_f32_16x16x32_bf16 v[92:95], a[168:171], v[36:39], v[92:95]
    v_mfma_f32_16x16x32_bf16 v[96:99], v[32:35], v[160:163], v[96:99]
    v_mfma_f32_16x16x32_bf16 v[104:107], v[36:39], v[160:163], v[104:107]
    v_mfma_f32_16x16x32_bf16 v[100:103], v[32:35], v[168:171], v[100:103]
    v_mfma_f32_16x16x32_bf16 v[108:111], v[36:39], v[168:171], v[108:111]
    s_waitcnt lgkmcnt(0)
    v_mfma_f32_16x16x32_bf16 v[80:83], a[164:167], v[40:43], v[80:83]
    ds_read_b128 v[32:35], v4 offset:6144
    v_mfma_f32_16x16x32_bf16 v[88:91], a[164:167], v[44:47], v[88:91]
    ds_read_b128 v[36:39], v4 offset:22528
    v_mfma_f32_16x16x32_bf16 v[84:87], a[172:175], v[40:43], v[84:87]
    v_mfma_f32_16x16x32_bf16 v[92:95], a[172:175], v[44:47], v[92:95]
    v_mfma_f32_16x16x32_bf16 v[96:99], v[40:43], v[164:167], v[96:99]
    v_mfma_f32_16x16x32_bf16 v[104:107], v[44:47], v[164:167], v[104:107]
    v_mfma_f32_16x16x32_bf16 v[100:103], v[40:43], v[172:175], v[100:103]
    v_mfma_f32_16x16x32_bf16 v[108:111], v[44:47], v[172:175], v[108:111]
    s_waitcnt lgkmcnt(0)
    v_mfma_f32_16x16x32_bf16 v[80:83], a[176:179], v[32:35], v[80:83]
    ds_read_b128 v[40:43], v4 offset:7168
    v_mfma_f32_16x16x32_bf16 v[88:91], a[176:179], v[36:39], v[88:91]
    ds_read_b128 v[44:47], v4 offset:23552
    v_mfma_f32_16x16x32_bf16 v[84:87], a[184:187], v[32:35], v[84:87]
    v_mfma_f32_16x16x32_bf16 v[92:95], a[184:187], v[36:39], v[92:95]
    v_mfma_f32_16x16x32_bf16 v[96:99], v[32:35], v[176:179], v[96:99]
    v_mfma_f32_16x16x32_bf16 v[104:107], v[36:39], v[176:179], v[104:107]
    v_mfma_f32_16x16x32_bf16 v[100:103], v[32:35], v[184:187], v[100:103]
    v_mfma_f32_16x16x32_bf16 v[108:111], v[36:39], v[184:187], v[108:111]
    s_waitcnt lgkmcnt(0)
    v_mfma_f32_16x16x32_bf16 v[80:83], a[180:183], v[40:43], v[80:83]
    ds_read_b128 v[32:35], v4 offset:8192
    v_mfma_f32_16x16x32_bf16 v[88:91], a[180:183], v[44:47], v[88:91]
    ds_read_b128 v[36:39], v4 offset:24576
    v_mfma_f32_16x16x32_bf16 v[84:87], a[188:191], v[40:43], v[84:87]
    v_mfma_f32_16x16x32_bf16 v[92:95], a[188:191], v[44:47], v[92:95]
    v_mfma_f32_16x16x32_bf16 v[96:99], v[40:43], v[180:183], v[96:99]
    v_mfma_f32_16x16x32_bf16 v[104:107], v[44:47], v[180:183], v[104:107]
    v_mfma_f32_16x16x32_bf16 v[100:103], v[40:43], v[188:191], v[100:103]
    v_mfma_f32_16x16x32_bf16 v[108:111], v[44:47], v[188:191], v[108:111]
    s_waitcnt lgkmcnt(0)
    v_mfma_f32_16x16x32_bf16 v[80:83], a[192:195], v[32:35], v[80:83]
    ds_read_b128 v[40:43], v4 offset:9216
    v_mfma_f32_16x16x32_bf16 v[88:91], a[192:195], v[36:39], v[88:91]
    ds_read_b128 v[44:47], v4 offset:25600
    v_mfma_f32_16x16x32_bf16 v[84:87], a[200:203], v[32:35], v[84:87]
    v_mfma_f32_16x16x32_bf16 v[92:95], a[200:203], v[36:39], v[92:95]
    v_mfma_f32_16x16x32_bf16 v[96:99], v[32:35], v[192:195], v[96:99]
    v_mfma_f32_16x16x32_bf16 v[104:107], v[36:39], v[192:195], v[104:107]
    v_mfma_f32_16x16x32_bf16 v[100:103], v[32:35], v[200:203], v[100:103]
    v_mfma_f32_16x16x32_bf16 v[108:111], v[36:39], v[200:203], v[108:111]
    s_waitcnt lgkmcnt(0)
    v_mfma_f32_16x16x32_bf16 v[80:83], a[196:199], v[40:43], v[80:83]
    ds_read_b128 v[32:35], v4 offset:10240
    v_mfma_f32_16x16x32_bf16 v[88:91], a[196:199], v[44:47], v[88:91]
    ds_read_b128 v[36:39], v4 offset:26624
    v_mfma_f32_16x16x32_bf16 v[84:87], a[204:207], v[40:43], v[84:87]
    v_mfma_f32_16x16x32_bf16 v[92:95], a[204:207], v[44:47], v[92:95]
    v_mfma_f32_16x16x32_bf16 v[96:99], v[40:43], v[196:199], v[96:99]
    v_mfma_f32_16x16x32_bf16 v[104:107], v[44:47], v[196:199], v[104:107]
    v_mfma_f32_16x16x32_bf16 v[100:103], v[40:43], v[204:207], v[100:103]
    v_mfma_f32_16x16x32_bf16 v[108:111], v[44:47], v[204:207], v[108:111]
    s_waitcnt lgkmcnt(0)
    v_mfma_f32_16x16x32_bf16 v[80:83], a[208:211], v[32:35], v[80:83]
    ds_read_b128 v[40:43], v4 offset:11264
    v_mfma_f32_16x16x32_bf16 v[88:91], a[208:211], v[36:39], v[88:91]
    ds_read_b128 v[44:47], v4 offset:27648
    v_mfma_f32_16x16x32_bf16 v[84:87], a[216:219], v[32:35], v[84:87]
    v_mfma_f32_16x16x32_bf16 v[92:95], a[216:219], v[36:39], v[92:95]
    v_mfma_f32_16x16x32_bf16 v[96:99], v[32:35], v[208:211], v[96:99]
    v_mfma_f32_16x16x32_bf16 v[104:107], v[36:39], v[208:211], v[104:107]
    v_mfma_f32_16x16x32_bf16 v[100:103], v[32:35], v[216:219], v[100:103]
    v_mfma_f32_16x16x32_bf16 v[108:111], v[36:39], v[216:219], v[108:111]
    s_waitcnt lgkmcnt(0)
    v_mfma_f32_16x16x32_bf16 v[80:83], a[212:215], v[40:43], v[80:83]
    ds_read_b128 v[32:35], v4 offset:12288
    v_mfma_f32_16x16x32_bf16 v[88:91], a[212:215], v[44:47], v[88:91]
    ds_read_b128 v[36:39], v4 offset:28672
    v_mfma_f32_16x16x32_bf16 v[84:87], a[220:223], v[40:43], v[84:87]
    v_mfma_f32_16x16x32_bf16 v[92:95], a[220:223], v[44:47], v[92:95]
    v_mfma_f32_16x16x32_bf16 v[96:99], v[40:43], v[212:215], v[96:99]
    v_mfma_f32_16x16x32_bf16 v[104:107], v[44:47], v[212:215], v[104:107]
    v_mfma_f32_16x16x32_bf16 v[100:103], v[40:43], v[220:223], v[100:103]
    v_mfma_f32_16x16x32_bf16 v[108:111], v[44:47], v[220:223], v[108:111]
    s_waitcnt lgkmcnt(0)
    v_mfma_f32_16x16x32_bf16 v[80:83], a[224:227], v[32:35], v[80:83]
    ds_read_b128 v[40:43], v4 offset:13312
    v_mfma_f32_16x16x32_bf16 v[88:91], a[224:227], v[36:39], v[88:91]
    ds_read_b128 v[44:47], v4 offset:29696
    v_mfma_f32_16x16x32_bf16 v[84:87], a[232:235], v[32:35], v[84:87]
    v_mfma_f32_16x16x32_bf16 v[92:95], a[232:235], v[36:39], v[92:95]
    v_mfma_f32_16x16x32_bf16 v[96:99], v[32:35], v[224:227], v[96:99]
    v_mfma_f32_16x16x32_bf16 v[104:107], v[36:39], v[224:227], v[104:107]
    v_mfma_f32_16x16x32_bf16 v[100:103], v[32:35], v[232:235], v[100:103]
    v_mfma_f32_16x16x32_bf16 v[108:111], v[36:39], v[232:235], v[108:111]
    s_waitcnt lgkmcnt(0)
    v_mfma_f32_16x16x32_bf16 v[80:83], a[228:231], v[40:43], v[80:83]
    ds_read_b128 v[32:35], v4 offset:14336
    v_mfma_f32_16x16x32_bf16 v[88:91], a[228:231], v[44:47], v[88:91]
    ds_read_b128 v[36:39], v4 offset:30720
    v_mfma_f32_16x16x32_bf16 v[84:87], a[236:239], v[40:43], v[84:87]
    v_mfma_f32_16x16x32_bf16 v[92:95], a[236:239], v[44:47], v[92:95]
    v_mfma_f32_16x16x32_bf16 v[96:99], v[40:43], v[228:231], v[96:99]
    v_mfma_f32_16x16x32_bf16 v[104:107], v[44:47], v[228:231], v[104:107]
    v_mfma_f32_16x16x32_bf16 v[100:103], v[40:43], v[236:239], v[100:103]
    v_mfma_f32_16x16x32_bf16 v[108:111], v[44:47], v[236:239], v[108:111]
    s_waitcnt lgkmcnt(0)
    v_mfma_f32_16x16x32_bf16 v[80:83], a[240:243], v[32:35], v[80:83]
    ds_read_b128 v[40:43], v4 offset:15360
    v_mfma_f32_16x16x32_bf16 v[88:91], a[240:243], v[36:39], v[88:91]
    ds_read_b128 v[44:47], v4 offset:31744
    v_mfma_f32_16x16x32_bf16 v[84:87], a[248:251], v[32:35], v[84:87]
    v_mfma_f32_16x16x32_bf16 v[92:95], a[248:251], v[36:39], v[92:95]
    v_mfma_f32_16x16x32_bf16 v[96:99], v[32:35], v[240:243], v[96:99]
    v_mfma_f32_16x16x32_bf16 v[104:107], v[36:39], v[240:243], v[104:107]
    v_mfma_f32_16x16x32_bf16 v[100:103], v[32:35], v[248:251], v[100:103]
    v_mfma_f32_16x16x32_bf16 v[108:111], v[36:39], v[248:251], v[108:111]
    s_waitcnt lgkmcnt(0)
    v_mfma_f32_16x16x32_bf16 v[80:83], a[244:247], v[40:43], v[80:83]
    v_mfma_f32_16x16x32_bf16 v[88:91], a[244:247], v[44:47], v[88:91]
    v_mfma_f32_16x16x32_bf16 v[84:87], a[252:255], v[40:43], v[84:87]
    v_mfma_f32_16x16x32_bf16 v[92:95], a[252:255], v[44:47], v[92:95]
    v_mfma_f32_16x16x32_bf16 v[96:99], v[40:43], v[244:247], v[96:99]
    v_mfma_f32_16x16x32_bf16 v[104:107], v[44:47], v[244:247], v[104:107]
    v_mfma_f32_16x16x32_bf16 v[100:103], v[40:43], v[252:255], v[100:103]
    v_mfma_f32_16x16x32_bf16 v[108:111], v[44:47], v[252:255], v[108:111]
    s_mov_b32 s32, s26
    s_add_u32 s33, s26, 4096
    s_lshl_b32 s22, s17, 10
    s_add_u32 s22, s22, s26
    s_add_u32 s34, s22, 8192
    s_add_u32 s35, s26, 16384
    s_add_u32 s36, s26, 20480
    v_cvt_pk_bf16_f32 v80, v80, v81
    v_cvt_pk_bf16_f32 v81, v82, v83
    v_cvt_pk_bf16_f32 v82, v84, v85
    v_cvt_pk_bf16_f32 v83, v86, v87
    buffer_store_dwordx4 v[80:83], v0, s[8:11], s32 offen sc1
    v_cvt_pk_bf16_f32 v88, v88, v89
    v_cvt_pk_bf16_f32 v89, v90, v91
    v_cvt_pk_bf16_f32 v90, v92, v93
    v_cvt_pk_bf16_f32 v91, v94, v95
    buffer_store_dwordx4 v[88:91], v0, s[8:11], s33 offen sc1
    v_cvt_pk_bf16_f32 v96, v96, v97
    v_cvt_pk_bf16_f32 v97, v100, v101
    v_cvt_pk_bf16_f32 v98, v98, v99
    v_cvt_pk_bf16_f32 v99, v102, v103
    buffer_store_dwordx4 v[96:99], v1, s[8:11], s34 offen offset:0 sc1
    v_cvt_pk_bf16_f32 v104, v104, v105
    v_cvt_pk_bf16_f32 v105, v108, v109
    v_cvt_pk_bf16_f32 v106, v106, v107
    v_cvt_pk_bf16_f32 v107, v110, v111
    buffer_store_dwordx4 v[104:107], v1, s[8:11], s34 offen offset:256 sc1
    s_waitcnt vmcnt(12)
    s_barrier
    s_mov_b32 s12, s68
    s_mov_b32 s13, s69
    s_mov_b32 s14, 4194304
    s_mov_b32 s15, 0x00020000
    s_lshl_b32 s21, s17, 18
    s_lshl_b32 s22, s16, 8
    s_add_u32 s21, s21, s22
    s_add_u32 s20, s21, 2097152
    s_lshl_b32 s21, s17, 13
    s_add_u32 m0, s21, 65536
    s_nop 0
    buffer_load_dwordx4 v16, s[12:15], s20 offen offset:0  lds
    buffer_load_dwordx4 v17, s[12:15], s20 offen offset:1024  lds
    buffer_load_dwordx4 v18, s[12:15], s20 offen offset:2048  lds
    buffer_load_dwordx4 v19, s[12:15], s20 offen offset:3072  lds
    s_lshl_b32 s21, s17, 18
    s_lshl_b32 s22, s16, 8
    s_add_u32 s21, s21, s22
    s_add_u32 s20, s21, 2228224
    s_lshl_b32 s21, s17, 13
    s_add_u32 m0, s21, 69632
    s_nop 0
    buffer_load_dwordx4 v16, s[12:15], s20 offen offset:0  lds
    buffer_load_dwordx4 v17, s[12:15], s20 offen offset:1024  lds
    buffer_load_dwordx4 v18, s[12:15], s20 offen offset:2048  lds
    buffer_load_dwordx4 v19, s[12:15], s20 offen offset:3072  lds
    ds_read_b64_tr_b16 a[0:1], v20 offset:0
    ds_read_b64_tr_b16 a[2:3], v20 offset:512
    ds_read_b64_tr_b16 a[4:5], v20 offset:8192
    ds_read_b64_tr_b16 a[6:7], v20 offset:8704
    ds_read_b64_tr_b16 a[8:9], v21 offset:0
    ds_read_b64_tr_b16 a[10:11], v21 offset:512
    ds_read_b64_tr_b16 a[12:13], v21 offset:8192
    ds_read_b64_tr_b16 a[14:15], v21 offset:8704
    ds_read_b64_tr_b16 a[16:17], v20 offset:16384
    ds_read_b64_tr_b16 a[18:19], v20 offset:16896
    ds_read_b64_tr_b16 a[20:21], v20 offset:24576
    ds_read_b64_tr_b16 a[22:23], v20 offset:25088
    ds_read_b64_tr_b16 a[24:25], v21 offset:16384
    ds_read_b64_tr_b16 a[26:27], v21 offset:16896
    ds_read_b64_tr_b16 a[28:29], v21 offset:24576
    ds_read_b64_tr_b16 a[30:31], v21 offset:25088
    s_waitcnt lgkmcnt(0)
    s_waitcnt vmcnt(12)
    s_barrier
    s_mov_b32 s12, s68
    s_mov_b32 s13, s69
    s_mov_b32 s14, 4194304
    s_mov_b32 s15, 0x00020000
    s_lshl_b32 s21, s17, 18
    s_lshl_b32 s22, s16, 8
    s_add_u32 s21, s21, s22
    s_add_u32 s20, s21, 3145728
    s_lshl_b32 s21, s17, 13
    s_add_u32 m0, s21, 98304
    s_nop 0
    buffer_load_dwordx4 v16, s[12:15], s20 offen offset:0  lds
    buffer_load_dwordx4 v17, s[12:15], s20 offen offset:1024  lds
    buffer_load_dwordx4 v18, s[12:15], s20 offen offset:2048  lds
    buffer_load_dwordx4 v19, s[12:15], s20 offen offset:3072  lds
    s_lshl_b32 s21, s17, 18
    s_lshl_b32 s22, s16, 8
    s_add_u32 s21, s21, s22
    s_add_u32 s20, s21, 3276800
    s_lshl_b32 s21, s17, 13
    s_add_u32 m0, s21, 102400
    s_nop 0
    buffer_load_dwordx4 v16, s[12:15], s20 offen offset:0  lds
    buffer_load_dwordx4 v17, s[12:15], s20 offen offset:1024  lds
    buffer_load_dwordx4 v18, s[12:15], s20 offen offset:2048  lds
    buffer_load_dwordx4 v19, s[12:15], s20 offen offset:3072  lds
    ds_read_b64_tr_b16 a[32:33], v20 offset:32768
    ds_read_b64_tr_b16 a[34:35], v20 offset:33280
    ds_read_b64_tr_b16 a[36:37], v20 offset:40960
    ds_read_b64_tr_b16 a[38:39], v20 offset:41472
    ds_read_b64_tr_b16 a[40:41], v21 offset:32768
    ds_read_b64_tr_b16 a[42:43], v21 offset:33280
    ds_read_b64_tr_b16 a[44:45], v21 offset:40960
    ds_read_b64_tr_b16 a[46:47], v21 offset:41472
    ds_read_b64_tr_b16 a[48:49], v20 offset:49152
    ds_read_b64_tr_b16 a[50:51], v20 offset:49664
    ds_read_b64_tr_b16 a[52:53], v20 offset:57344
    ds_read_b64_tr_b16 a[54:55], v20 offset:57856
    ds_read_b64_tr_b16 a[56:57], v21 offset:49152
    ds_read_b64_tr_b16 a[58:59], v21 offset:49664
    ds_read_b64_tr_b16 a[60:61], v21 offset:57344
    ds_read_b64_tr_b16 a[62:63], v21 offset:57856
    s_waitcnt lgkmcnt(0)
    s_waitcnt vmcnt(8)
    s_barrier
    ds_read_b64_tr_b16 a[64:65], v22 offset:0
    ds_read_b64_tr_b16 a[66:67], v22 offset:512
    ds_read_b64_tr_b16 a[68:69], v22 offset:8192
    ds_read_b64_tr_b16 a[70:71], v22 offset:8704
    ds_read_b64_tr_b16 a[72:73], v23 offset:0
    ds_read_b64_tr_b16 a[74:75], v23 offset:512
    ds_read_b64_tr_b16 a[76:77], v23 offset:8192
    ds_read_b64_tr_b16 a[78:79], v23 offset:8704
    ds_read_b64_tr_b16 a[80:81], v22 offset:16384
    ds_read_b64_tr_b16 a[82:83], v22 offset:16896
    ds_read_b64_tr_b16 a[84:85], v22 offset:24576
    ds_read_b64_tr_b16 a[86:87], v22 offset:25088
    ds_read_b64_tr_b16 a[88:89], v23 offset:16384
    ds_read_b64_tr_b16 a[90:91], v23 offset:16896
    ds_read_b64_tr_b16 a[92:93], v23 offset:24576
    ds_read_b64_tr_b16 a[94:95], v23 offset:25088
    s_waitcnt lgkmcnt(0)
    s_waitcnt vmcnt(0)
    s_barrier
    ds_read_b64_tr_b16 a[96:97], v22 offset:32768
    ds_read_b64_tr_b16 a[98:99], v22 offset:33280
    ds_read_b64_tr_b16 a[100:101], v22 offset:40960
    ds_read_b64_tr_b16 a[102:103], v22 offset:41472
    ds_read_b64_tr_b16 a[104:105], v23 offset:32768
    ds_read_b64_tr_b16 a[106:107], v23 offset:33280
    ds_read_b64_tr_b16 a[108:109], v23 offset:40960
    ds_read_b64_tr_b16 a[110:111], v23 offset:41472
    ds_read_b64_tr_b16 a[112:113], v22 offset:49152
    ds_read_b64_tr_b16 a[114:115], v22 offset:49664
    ds_read_b64_tr_b16 a[116:117], v22 offset:57344
    ds_read_b64_tr_b16 a[118:119], v22 offset:57856
    ds_read_b64_tr_b16 a[120:121], v23 offset:49152
    ds_read_b64_tr_b16 a[122:123], v23 offset:49664
    ds_read_b64_tr_b16 a[124:125], v23 offset:57344
    ds_read_b64_tr_b16 a[126:127], v23 offset:57856
    s_waitcnt lgkmcnt(0)
    s_barrier
    s_waitcnt lgkmcnt(0)
    v_mov_b32 v3, 1
    s_waitcnt vmcnt(0)
    buffer_store_dword v3, v2, s[8:11], s29 offen sc1
    s_add_u32 m0, s28, 0
    s_add_u32 s20, s25, 0
    buffer_load_dwordx4 v0, s[8:11], s20 offen offset:0 sc1 lds
    buffer_load_dwordx4 v0, s[8:11], s20 offen offset:1024 sc1 lds
    buffer_load_dwordx4 v0, s[8:11], s20 offen offset:2048 sc1 lds
    buffer_load_dwordx4 v0, s[8:11], s20 offen offset:3072 sc1 lds
    s_add_u32 m0, s28, 4096
    s_add_u32 s20, s25, 4096
    buffer_load_dwordx4 v0, s[8:11], s20 offen offset:0 sc1 lds
    buffer_load_dwordx4 v0, s[8:11], s20 offen offset:1024 sc1 lds
    buffer_load_dwordx4 v0, s[8:11], s20 offen offset:2048 sc1 lds
    buffer_load_dwordx4 v0, s[8:11], s20 offen offset:3072 sc1 lds
    s_add_u32 s25, s25, 65536
    s_xor_b32 s28, s28, 32768
    ds_read_b128 v[8:11], v4 offset:0
    ds_read_b128 v[12:15], v4 offset:16384
    s_waitcnt lgkmcnt(0)
    v_mfma_f32_16x16x32_bf16 v[112:115], a[0:3], v[8:11], 0
    ds_read_b128 v[16:19], v4 offset:1024
    v_mfma_f32_16x16x32_bf16 v[120:123], a[0:3], v[12:15], 0
    ds_read_b128 v[20:23], v4 offset:17408
    v_mfma_f32_16x16x32_bf16 v[116:119], a[8:11], v[8:11], 0
    v_mfma_f32_16x16x32_bf16 v[124:127], a[8:11], v[12:15], 0
    s_waitcnt lgkmcnt(0)
    v_mfma_f32_16x16x32_bf16 v[112:115], a[4:7], v[16:19], v[112:115]
    ds_read_b128 v[8:11], v4 offset:2048
    v_mfma_f32_16x16x32_bf16 v[120:123], a[4:7], v[20:23], v[120:123]
    ds_read_b128 v[12:15], v4 offset:18432
    v_mfma_f32_16x16x32_bf16 v[116:119], a[12:15], v[16:19], v[116:119]
    v_mfma_f32_16x16x32_bf16 v[124:127], a[12:15], v[20:23], v[124:127]
    s_waitcnt lgkmcnt(0)
    v_mfma_f32_16x16x32_bf16 v[112:115], a[16:19], v[8:11], v[112:115]
    ds_read_b128 v[16:19], v4 offset:3072
    v_mfma_f32_16x16x32_bf16 v[120:123], a[16:19], v[12:15], v[120:123]
    ds_read_b128 v[20:23], v4 offset:19456
    v_mfma_f32_16x16x32_bf16 v[116:119], a[24:27], v[8:11], v[116:119]
    v_mfma_f32_16x16x32_bf16 v[124:127], a[24:27], v[12:15], v[124:127]
    s_waitcnt lgkmcnt(0)
    v_mfma_f32_16x16x32_bf16 v[112:115], a[20:23], v[16:19], v[112:115]
    ds_read_b128 v[8:11], v4 offset:4096
    v_mfma_f32_16x16x32_bf16 v[120:123], a[20:23], v[20:23], v[120:123]
    ds_read_b128 v[12:15], v4 offset:20480
    v_mfma_f32_16x16x32_bf16 v[116:119], a[28:31], v[16:19], v[116:119]
    v_mfma_f32_16x16x32_bf16 v[124:127], a[28:31], v[20:23], v[124:127]
    s_waitcnt lgkmcnt(0)
    v_mfma_f32_16x16x32_bf16 v[112:115], a[32:35], v[8:11], v[112:115]
    ds_read_b128 v[16:19], v4 offset:5120
    v_mfma_f32_16x16x32_bf16 v[120:123], a[32:35], v[12:15], v[120:123]
    ds_read_b128 v[20:23], v4 offset:21504
    v_mfma_f32_16x16x32_bf16 v[116:119], a[40:43], v[8:11], v[116:119]
    v_mfma_f32_16x16x32_bf16 v[124:127], a[40:43], v[12:15], v[124:127]
    s_waitcnt lgkmcnt(0)
    v_mfma_f32_16x16x32_bf16 v[112:115], a[36:39], v[16:19], v[112:115]
    ds_read_b128 v[8:11], v4 offset:6144
    v_mfma_f32_16x16x32_bf16 v[120:123], a[36:39], v[20:23], v[120:123]
    ds_read_b128 v[12:15], v4 offset:22528
    v_mfma_f32_16x16x32_bf16 v[116:119], a[44:47], v[16:19], v[116:119]
    v_mfma_f32_16x16x32_bf16 v[124:127], a[44:47], v[20:23], v[124:127]
    s_waitcnt lgkmcnt(0)
    v_mfma_f32_16x16x32_bf16 v[112:115], a[48:51], v[8:11], v[112:115]
    ds_read_b128 v[16:19], v4 offset:7168
    v_mfma_f32_16x16x32_bf16 v[120:123], a[48:51], v[12:15], v[120:123]
    ds_read_b128 v[20:23], v4 offset:23552
    v_mfma_f32_16x16x32_bf16 v[116:119], a[56:59], v[8:11], v[116:119]
    v_mfma_f32_16x16x32_bf16 v[124:127], a[56:59], v[12:15], v[124:127]
    s_waitcnt lgkmcnt(0)
    v_mfma_f32_16x16x32_bf16 v[112:115], a[52:55], v[16:19], v[112:115]
    ds_read_b128 v[8:11], v4 offset:8192
    v_mfma_f32_16x16x32_bf16 v[120:123], a[52:55], v[20:23], v[120:123]
    ds_read_b128 v[12:15], v4 offset:24576
    v_mfma_f32_16x16x32_bf16 v[116:119], a[60:63], v[16:19], v[116:119]
    v_mfma_f32_16x16x32_bf16 v[124:127], a[60:63], v[20:23], v[124:127]
    s_waitcnt lgkmcnt(0)
    v_mfma_f32_16x16x32_bf16 v[112:115], a[64:67], v[8:11], v[112:115]
    ds_read_b128 v[16:19], v4 offset:9216
    v_mfma_f32_16x16x32_bf16 v[120:123], a[64:67], v[12:15], v[120:123]
    ds_read_b128 v[20:23], v4 offset:25600
    v_mfma_f32_16x16x32_bf16 v[116:119], a[72:75], v[8:11], v[116:119]
    v_mfma_f32_16x16x32_bf16 v[124:127], a[72:75], v[12:15], v[124:127]
    s_waitcnt lgkmcnt(0)
    v_mfma_f32_16x16x32_bf16 v[112:115], a[68:71], v[16:19], v[112:115]
    ds_read_b128 v[8:11], v4 offset:10240
    v_mfma_f32_16x16x32_bf16 v[120:123], a[68:71], v[20:23], v[120:123]
    ds_read_b128 v[12:15], v4 offset:26624
    v_mfma_f32_16x16x32_bf16 v[116:119], a[76:79], v[16:19], v[116:119]
    v_mfma_f32_16x16x32_bf16 v[124:127], a[76:79], v[20:23], v[124:127]
    s_waitcnt lgkmcnt(0)
    v_mfma_f32_16x16x32_bf16 v[112:115], a[80:83], v[8:11], v[112:115]
    ds_read_b128 v[16:19], v4 offset:11264
    v_mfma_f32_16x16x32_bf16 v[120:123], a[80:83], v[12:15], v[120:123]
    ds_read_b128 v[20:23], v4 offset:27648
    v_mfma_f32_16x16x32_bf16 v[116:119], a[88:91], v[8:11], v[116:119]
    v_mfma_f32_16x16x32_bf16 v[124:127], a[88:91], v[12:15], v[124:127]
    s_waitcnt lgkmcnt(0)
    v_mfma_f32_16x16x32_bf16 v[112:115], a[84:87], v[16:19], v[112:115]
    ds_read_b128 v[8:11], v4 offset:12288
    v_mfma_f32_16x16x32_bf16 v[120:123], a[84:87], v[20:23], v[120:123]
    ds_read_b128 v[12:15], v4 offset:28672
    v_mfma_f32_16x16x32_bf16 v[116:119], a[92:95], v[16:19], v[116:119]
    v_mfma_f32_16x16x32_bf16 v[124:127], a[92:95], v[20:23], v[124:127]
    s_waitcnt lgkmcnt(0)
    v_mfma_f32_16x16x32_bf16 v[112:115], a[96:99], v[8:11], v[112:115]
    ds_read_b128 v[16:19], v4 offset:13312
    v_mfma_f32_16x16x32_bf16 v[120:123], a[96:99], v[12:15], v[120:123]
    ds_read_b128 v[20:23], v4 offset:29696
    v_mfma_f32_16x16x32_bf16 v[116:119], a[104:107], v[8:11], v[116:119]
    v_mfma_f32_16x16x32_bf16 v[124:127], a[104:107], v[12:15], v[124:127]
    s_waitcnt lgkmcnt(0)
    v_mfma_f32_16x16x32_bf16 v[112:115], a[100:103], v[16:19], v[112:115]
    ds_read_b128 v[8:11], v4 offset:14336
    v_mfma_f32_16x16x32_bf16 v[120:123], a[100:103], v[20:23], v[120:123]
    ds_read_b128 v[12:15], v4 offset:30720
    v_mfma_f32_16x16x32_bf16 v[116:119], a[108:111], v[16:19], v[116:119]
    v_mfma_f32_16x16x32_bf16 v[124:127], a[108:111], v[20:23], v[124:127]
    s_waitcnt lgkmcnt(0)
    v_mfma_f32_16x16x32_bf16 v[112:115], a[112:115], v[8:11], v[112:115]
    ds_read_b128 v[16:19], v4 offset:15360
    v_mfma_f32_16x16x32_bf16 v[120:123], a[112:115], v[12:15], v[120:123]
    ds_read_b128 v[20:23], v4 offset:31744
    v_mfma_f32_16x16x32_bf16 v[116:119], a[120:123], v[8:11], v[116:119]
    v_mfma_f32_16x16x32_bf16 v[124:127], a[120:123], v[12:15], v[124:127]
    s_waitcnt lgkmcnt(0)
    v_mfma_f32_16x16x32_bf16 v[112:115], a[116:119], v[16:19], v[112:115]
    v_mfma_f32_16x16x32_bf16 v[120:123], a[116:119], v[20:23], v[120:123]
    v_mfma_f32_16x16x32_bf16 v[116:119], a[124:127], v[16:19], v[116:119]
    v_mfma_f32_16x16x32_bf16 v[124:127], a[124:127], v[20:23], v[124:127]
    s_mov_b32 s32, s26
    s_add_u32 s33, s26, 4096
    s_lshl_b32 s22, s17, 10
    s_add_u32 s22, s22, s26
    s_add_u32 s34, s22, 8192
    s_add_u32 s35, s26, 16384
    s_add_u32 s36, s26, 20480
    s_add_u32 s26, s26, 1572864
    s_add_u32 s27, s27, 1
    v_cvt_pk_bf16_f32 v112, v112, v113
    v_cvt_pk_bf16_f32 v113, v114, v115
    v_cvt_pk_bf16_f32 v114, v116, v117
    v_cvt_pk_bf16_f32 v115, v118, v119
    buffer_store_dwordx4 v[112:115], v0, s[8:11], s35 offen sc1
    v_cvt_pk_bf16_f32 v120, v120, v121
    v_cvt_pk_bf16_f32 v121, v122, v123
    v_cvt_pk_bf16_f32 v122, v124, v125
    v_cvt_pk_bf16_f32 v123, v126, v127
    buffer_store_dwordx4 v[120:123], v0, s[8:11], s36 offen sc1
    s_waitcnt vmcnt(0)
    s_waitcnt vmcnt(1)
    s_barrier
    ds_read_b128 v[8:11], v0 offset:0
    ds_read_b128 v[12:15], v0 offset:16384
    s_waitcnt lgkmcnt(0)
    v_mfma_f32_16x16x32_bf16 v[32:35], a[128:131], v[8:11], 0
    ds_read_b128 v[16:19], v0 offset:1024
    v_mfma_f32_16x16x32_bf16 v[40:43], a[128:131], v[12:15], 0
    ds_read_b128 v[20:23], v0 offset:17408
    v_mfma_f32_16x16x32_bf16 v[36:39], a[136:139], v[8:11], 0
    v_mfma_f32_16x16x32_bf16 v[44:47], a[136:139], v[12:15], 0
    v_mfma_f32_16x16x32_bf16 v[48:51], v[8:11], v[128:131], 0
    v_mfma_f32_16x16x32_bf16 v[56:59], v[12:15], v[128:131], 0
    v_mfma_f32_16x16x32_bf16 v[52:55], v[8:11], v[136:139], 0
    v_mfma_f32_16x16x32_bf16 v[60:63], v[12:15], v[136:139], 0
    v_mfma_f32_16x16x32_bf16 v[64:67], a[0:3], v[8:11], 0
    v_mfma_f32_16x16x32_bf16 v[72:75], a[0:3], v[12:15], 0
    v_mfma_f32_16x16x32_bf16 v[68:71], a[8:11], v[8:11], 0
    v_mfma_f32_16x16x32_bf16 v[76:79], a[8:11], v[12:15], 0
    s_waitcnt lgkmcnt(0)
    v_mfma_f32_16x16x32_bf16 v[32:35], a[132:135], v[16:19], v[32:35]
    ds_read_b128 v[8:11], v0 offset:2048
    v_mfma_f32_16x16x32_bf16 v[40:43], a[132:135], v[20:23], v[40:43]
    ds_read_b128 v[12:15], v0 offset:18432
    v_mfma_f32_16x16x32_bf16 v[36:39], a[140:143], v[16:19], v[36:39]
    v_mfma_f32_16x16x32_bf16 v[44:47], a[140:143], v[20:23], v[44:47]
    v_mfma_f32_16x16x32_bf16 v[48:51], v[16:19], v[132:135], v[48:51]
    v_mfma_f32_16x16x32_bf16 v[56:59], v[20:23], v[132:135], v[56:59]
    v_mfma_f32_16x16x32_bf16 v[52:55], v[16:19], v[140:143], v[52:55]
    v_mfma_f32_16x16x32_bf16 v[60:63], v[20:23], v[140:143], v[60:63]
    v_mfma_f32_16x16x32_bf16 v[64:67], a[4:7], v[16:19], v[64:67]
    v_mfma_f32_16x16x32_bf16 v[72:75], a[4:7], v[20:23], v[72:75]
    v_mfma_f32_16x16x32_bf16 v[68:71], a[12:15], v[16:19], v[68:71]
    v_mfma_f32_16x16x32_bf16 v[76:79], a[12:15], v[20:23], v[76:79]
    s_waitcnt lgkmcnt(0)
    v_mfma_f32_16x16x32_bf16 v[32:35], a[144:147], v[8:11], v[32:35]
    ds_read_b128 v[16:19], v0 offset:3072
    v_mfma_f32_16x16x32_bf16 v[40:43], a[144:147], v[12:15], v[40:43]
    ds_read_b128 v[20:23], v0 offset:19456
    v_mfma_f32_16x16x32_bf16 v[36:39], a[152:155], v[8:11], v[36:39]
    v_mfma_f32_16x16x32_bf16 v[44:47], a[152:155], v[12:15], v[44:47]
    v_mfma_f32_16x16x32_bf16 v[48:51], v[8:11], v[144:147], v[48:51]
    v_mfma_f32_16x16x32_bf16 v[56:59], v[12:15], v[144:147], v[56:59]
    v_mfma_f32_16x16x32_bf16 v[52:55], v[8:11], v[152:155], v[52:55]
    v_mfma_f32_16x16x32_bf16 v[60:63], v[12:15], v[152:155], v[60:63]
    v_mfma_f32_16x16x32_bf16 v[64:67], a[16:19], v[8:11], v[64:67]
    v_mfma_f32_16x16x32_bf16 v[72:75], a[16:19], v[12:15], v[72:75]
    v_mfma_f32_16x16x32_bf16 v[68:71], a[24:27], v[8:11], v[68:71]
    v_mfma_f32_16x16x32_bf16 v[76:79], a[24:27], v[12:15], v[76:79]
    s_waitcnt lgkmcnt(0)
    v_mfma_f32_16x16x32_bf16 v[32:35], a[148:151], v[16:19], v[32:35]
    ds_read_b128 v[8:11], v0 offset:4096
    v_mfma_f32_16x16x32_bf16 v[40:43], a[148:151], v[20:23], v[40:43]
    ds_read_b128 v[12:15], v0 offset:20480
    v_mfma_f32_16x16x32_bf16 v[36:39], a[156:159], v[16:19], v[36:39]
    v_mfma_f32_16x16x32_bf16 v[44:47], a[156:159], v[20:23], v[44:47]
    v_mfma_f32_16x16x32_bf16 v[48:51], v[16:19], v[148:151], v[48:51]
    v_mfma_f32_16x16x32_bf16 v[56:59], v[20:23], v[148:151], v[56:59]
    v_mfma_f32_16x16x32_bf16 v[52:55], v[16:19], v[156:159], v[52:55]
    v_mfma_f32_16x16x32_bf16 v[60:63], v[20:23], v[156:159], v[60:63]
    v_mfma_f32_16x16x32_bf16 v[64:67], a[20:23], v[16:19], v[64:67]
    v_mfma_f32_16x16x32_bf16 v[72:75], a[20:23], v[20:23], v[72:75]
    v_mfma_f32_16x16x32_bf16 v[68:71], a[28:31], v[16:19], v[68:71]
    v_mfma_f32_16x16x32_bf16 v[76:79], a[28:31], v[20:23], v[76:79]
    s_waitcnt lgkmcnt(0)
    v_mfma_f32_16x16x32_bf16 v[32:35], a[160:163], v[8:11], v[32:35]
    ds_read_b128 v[16:19], v0 offset:5120
    v_mfma_f32_16x16x32_bf16 v[40:43], a[160:163], v[12:15], v[40:43]
    ds_read_b128 v[20:23], v0 offset:21504
    v_mfma_f32_16x16x32_bf16 v[36:39], a[168:171], v[8:11], v[36:39]
    v_mfma_f32_16x16x32_bf16 v[44:47], a[168:171], v[12:15], v[44:47]
    v_mfma_f32_16x16x32_bf16 v[48:51], v[8:11], v[160:163], v[48:51]
    v_mfma_f32_16x16x32_bf16 v[56:59], v[12:15], v[160:163], v[56:59]
    v_mfma_f32_16x16x32_bf16 v[52:55], v[8:11], v[168:171], v[52:55]
    v_mfma_f32_16x16x32_bf16 v[60:63], v[12:15], v[168:171], v[60:63]
    v_mfma_f32_16x16x32_bf16 v[64:67], a[32:35], v[8:11], v[64:67]
    v_mfma_f32_16x16x32_bf16 v[72:75], a[32:35], v[12:15], v[72:75]
    v_mfma_f32_16x16x32_bf16 v[68:71], a[40:43], v[8:11], v[68:71]
    v_mfma_f32_16x16x32_bf16 v[76:79], a[40:43], v[12:15], v[76:79]
    s_waitcnt lgkmcnt(0)
    v_mfma_f32_16x16x32_bf16 v[32:35], a[164:167], v[16:19], v[32:35]
    ds_read_b128 v[8:11], v0 offset:6144
    v_mfma_f32_16x16x32_bf16 v[40:43], a[164:167], v[20:23], v[40:43]
    ds_read_b128 v[12:15], v0 offset:22528
    v_mfma_f32_16x16x32_bf16 v[36:39], a[172:175], v[16:19], v[36:39]
    v_mfma_f32_16x16x32_bf16 v[44:47], a[172:175], v[20:23], v[44:47]
    v_mfma_f32_16x16x32_bf16 v[48:51], v[16:19], v[164:167], v[48:51]
    v_mfma_f32_16x16x32_bf16 v[56:59], v[20:23], v[164:167], v[56:59]
    v_mfma_f32_16x16x32_bf16 v[52:55], v[16:19], v[172:175], v[52:55]
    v_mfma_f32_16x16x32_bf16 v[60:63], v[20:23], v[172:175], v[60:63]
    v_mfma_f32_16x16x32_bf16 v[64:67], a[36:39], v[16:19], v[64:67]
    v_mfma_f32_16x16x32_bf16 v[72:75], a[36:39], v[20:23], v[72:75]
    v_mfma_f32_16x16x32_bf16 v[68:71], a[44:47], v[16:19], v[68:71]
    v_mfma_f32_16x16x32_bf16 v[76:79], a[44:47], v[20:23], v[76:79]
    s_waitcnt lgkmcnt(0)
    v_mfma_f32_16x16x32_bf16 v[32:35], a[176:179], v[8:11], v[32:35]
    ds_read_b128 v[16:19], v0 offset:7168
    v_mfma_f32_16x16x32_bf16 v[40:43], a[176:179], v[12:15], v[40:43]
    ds_read_b128 v[20:23], v0 offset:23552
    v_mfma_f32_16x16x32_bf16 v[36:39], a[184:187], v[8:11], v[36:39]
    v_mfma_f32_16x16x32_bf16 v[44:47], a[184:187], v[12:15], v[44:47]
    s_add_u32 m0, s28, 0
    s_add_u32 s20, s25, 0
    buffer_load_dwordx4 v0, s[8:11], s20 offen offset:0 sc1 lds
    v_mfma_f32_16x16x32_bf16 v[48:51], v[8:11], v[176:179], v[48:51]
    v_mfma_f32_16x16x32_bf16 v[56:59], v[12:15], v[176:179], v[56:59]
    v_mfma_f32_16x16x32_bf16 v[52:55], v[8:11], v[184:187], v[52:55]
    v_mfma_f32_16x16x32_bf16 v[60:63], v[12:15], v[184:187], v[60:63]
    buffer_load_dwordx4 v0, s[8:11], s20 offen offset:1024 sc1 lds
    v_mfma_f32_16x16x32_bf16 v[64:67], a[48:51], v[8:11], v[64:67]
    v_mfma_f32_16x16x32_bf16 v[72:75], a[48:51], v[12:15], v[72:75]
    v_mfma_f32_16x16x32_bf16 v[68:71], a[56:59], v[8:11], v[68:71]
    v_mfma_f32_16x16x32_bf16 v[76:79], a[56:59], v[12:15], v[76:79]
    s_waitcnt lgkmcnt(0)
    v_mfma_f32_16x16x32_bf16 v[32:35], a[180:183], v[16:19], v[32:35]
    ds_read_b128 v[8:11], v0 offset:8192
    v_mfma_f32_16x16x32_bf16 v[40:43], a[180:183], v[20:23], v[40:43]
    ds_read_b128 v[12:15], v0 offset:24576
    v_mfma_f32_16x16x32_bf16 v[36:39], a[188:191], v[16:19], v[36:39]
    v_mfma_f32_16x16x32_bf16 v[44:47], a[188:191], v[20:23], v[44:47]
    buffer_load_dwordx4 v0, s[8:11], s20 offen offset:2048 sc1 lds
    v_mfma_f32_16x16x32_bf16 v[48:51], v[16:19], v[180:183], v[48:51]
    v_mfma_f32_16x16x32_bf16 v[56:59], v[20:23], v[180:183], v[56:59]
    v_mfma_f32_16x16x32_bf16 v[52:55], v[16:19], v[188:191], v[52:55]
    v_mfma_f32_16x16x32_bf16 v[60:63], v[20:23], v[188:191], v[60:63]
    buffer_load_dwordx4 v0, s[8:11], s20 offen offset:3072 sc1 lds
    v_mfma_f32_16x16x32_bf16 v[64:67], a[52:55], v[16:19], v[64:67]
    v_mfma_f32_16x16x32_bf16 v[72:75], a[52:55], v[20:23], v[72:75]
    v_mfma_f32_16x16x32_bf16 v[68:71], a[60:63], v[16:19], v[68:71]
    v_mfma_f32_16x16x32_bf16 v[76:79], a[60:63], v[20:23], v[76:79]
    s_waitcnt lgkmcnt(0)
    v_mfma_f32_16x16x32_bf16 v[32:35], a[192:195], v[8:11], v[32:35]
    ds_read_b128 v[16:19], v0 offset:9216
    v_mfma_f32_16x16x32_bf16 v[40:43], a[192:195], v[12:15], v[40:43]
    ds_read_b128 v[20:23], v0 offset:25600
    v_mfma_f32_16x16x32_bf16 v[36:39], a[200:203], v[8:11], v[36:39]
    v_mfma_f32_16x16x32_bf16 v[44:47], a[200:203], v[12:15], v[44:47]
    s_add_u32 m0, s28, 4096
    s_add_u32 s20, s25, 4096
    buffer_load_dwordx4 v0, s[8:11], s20 offen offset:0 sc1 lds
    v_mfma_f32_16x16x32_bf16 v[48:51], v[8:11], v[192:195], v[48:51]
    v_mfma_f32_16x16x32_bf16 v[56:59], v[12:15], v[192:195], v[56:59]
    v_mfma_f32_16x16x32_bf16 v[52:55], v[8:11], v[200:203], v[52:55]
    v_mfma_f32_16x16x32_bf16 v[60:63], v[12:15], v[200:203], v[60:63]
    buffer_load_dwordx4 v0, s[8:11], s20 offen offset:1024 sc1 lds
    v_mfma_f32_16x16x32_bf16 v[64:67], a[64:67], v[8:11], v[64:67]
    v_mfma_f32_16x16x32_bf16 v[72:75], a[64:67], v[12:15], v[72:75]
    v_mfma_f32_16x16x32_bf16 v[68:71], a[72:75], v[8:11], v[68:71]
    v_mfma_f32_16x16x32_bf16 v[76:79], a[72:75], v[12:15], v[76:79]
    s_waitcnt lgkmcnt(0)
    v_mfma_f32_16x16x32_bf16 v[32:35], a[196:199], v[16:19], v[32:35]
    ds_read_b128 v[8:11], v0 offset:10240
    v_mfma_f32_16x16x32_bf16 v[40:43], a[196:199], v[20:23], v[40:43]
    ds_read_b128 v[12:15], v0 offset:26624
    v_mfma_f32_16x16x32_bf16 v[36:39], a[204:207], v[16:19], v[36:39]
    v_mfma_f32_16x16x32_bf16 v[44:47], a[204:207], v[20:23], v[44:47]
    buffer_load_dwordx4 v0, s[8:11], s20 offen offset:2048 sc1 lds
    v_mfma_f32_16x16x32_bf16 v[48:51], v[16:19], v[196:199], v[48:51]
    v_mfma_f32_16x16x32_bf16 v[56:59], v[20:23], v[196:199], v[56:59]
    v_mfma_f32_16x16x32_bf16 v[52:55], v[16:19], v[204:207], v[52:55]
    v_mfma_f32_16x16x32_bf16 v[60:63], v[20:23], v[204:207], v[60:63]
    buffer_load_dwordx4 v0, s[8:11], s20 offen offset:3072 sc1 lds
    s_add_u32 s25, s25, 65536
    s_xor_b32 s28, s28, 32768
    v_mfma_f32_16x16x32_bf16 v[64:67], a[68:71], v[16:19], v[64:67]
    v_mfma_f32_16x16x32_bf16 v[72:75], a[68:71], v[20:23], v[72:75]
    v_mfma_f32_16x16x32_bf16 v[68:71], a[76:79], v[16:19], v[68:71]
    v_mfma_f32_16x16x32_bf16 v[76:79], a[76:79], v[20:23], v[76:79]
    s_waitcnt lgkmcnt(0)
    v_mfma_f32_16x16x32_bf16 v[32:35], a[208:211], v[8:11], v[32:35]
    ds_read_b128 v[16:19], v0 offset:11264
    v_mfma_f32_16x16x32_bf16 v[40:43], a[208:211], v[12:15], v[40:43]
    ds_read_b128 v[20:23], v0 offset:27648
    v_mfma_f32_16x16x32_bf16 v[36:39], a[216:219], v[8:11], v[36:39]
    v_mfma_f32_16x16x32_bf16 v[44:47], a[216:219], v[12:15], v[44:47]
    v_mfma_f32_16x16x32_bf16 v[48:51], v[8:11], v[208:211], v[48:51]
    v_mfma_f32_16x16x32_bf16 v[56:59], v[12:15], v[208:211], v[56:59]
    v_mfma_f32_16x16x32_bf16 v[52:55], v[8:11], v[216:219], v[52:55]
    v_mfma_f32_16x16x32_bf16 v[60:63], v[12:15], v[216:219], v[60:63]
    v_mfma_f32_16x16x32_bf16 v[64:67], a[80:83], v[8:11], v[64:67]
    v_mfma_f32_16x16x32_bf16 v[72:75], a[80:83], v[12:15], v[72:75]
    v_mfma_f32_16x16x32_bf16 v[68:71], a[88:91], v[8:11], v[68:71]
    v_mfma_f32_16x16x32_bf16 v[76:79], a[88:91], v[12:15], v[76:79]
    s_waitcnt lgkmcnt(0)
    v_mfma_f32_16x16x32_bf16 v[32:35], a[212:215], v[16:19], v[32:35]
    ds_read_b128 v[8:11], v0 offset:12288
    v_mfma_f32_16x16x32_bf16 v[40:43], a[212:215], v[20:23], v[40:43]
    ds_read_b128 v[12:15], v0 offset:28672
    v_mfma_f32_16x16x32_bf16 v[36:39], a[220:223], v[16:19], v[36:39]
    v_mfma_f32_16x16x32_bf16 v[44:47], a[220:223], v[20:23], v[44:47]
    v_mfma_f32_16x16x32_bf16 v[48:51], v[16:19], v[212:215], v[48:51]
    v_mfma_f32_16x16x32_bf16 v[56:59], v[20:23], v[212:215], v[56:59]
    v_mfma_f32_16x16x32_bf16 v[52:55], v[16:19], v[220:223], v[52:55]
    v_mfma_f32_16x16x32_bf16 v[60:63], v[20:23], v[220:223], v[60:63]
    v_mfma_f32_16x16x32_bf16 v[64:67], a[84:87], v[16:19], v[64:67]
    v_mfma_f32_16x16x32_bf16 v[72:75], a[84:87], v[20:23], v[72:75]
    v_mfma_f32_16x16x32_bf16 v[68:71], a[92:95], v[16:19], v[68:71]
    v_mfma_f32_16x16x32_bf16 v[76:79], a[92:95], v[20:23], v[76:79]
    s_waitcnt lgkmcnt(0)
    v_mfma_f32_16x16x32_bf16 v[32:35], a[224:227], v[8:11], v[32:35]
    ds_read_b128 v[16:19], v0 offset:13312
    v_mfma_f32_16x16x32_bf16 v[40:43], a[224:227], v[12:15], v[40:43]
    ds_read_b128 v[20:23], v0 offset:29696
    v_mfma_f32_16x16x32_bf16 v[36:39], a[232:235], v[8:11], v[36:39]
    v_mfma_f32_16x16x32_bf16 v[44:47], a[232:235], v[12:15], v[44:47]
    v_mfma_f32_16x16x32_bf16 v[48:51], v[8:11], v[224:227], v[48:51]
    v_mfma_f32_16x16x32_bf16 v[56:59], v[12:15], v[224:227], v[56:59]
    v_mfma_f32_16x16x32_bf16 v[52:55], v[8:11], v[232:235], v[52:55]
    v_mfma_f32_16x16x32_bf16 v[60:63], v[12:15], v[232:235], v[60:63]
    v_mfma_f32_16x16x32_bf16 v[64:67], a[96:99], v[8:11], v[64:67]
    v_mfma_f32_16x16x32_bf16 v[72:75], a[96:99], v[12:15], v[72:75]
    v_mfma_f32_16x16x32_bf16 v[68:71], a[104:107], v[8:11], v[68:71]
    v_mfma_f32_16x16x32_bf16 v[76:79], a[104:107], v[12:15], v[76:79]
    s_waitcnt lgkmcnt(0)
    v_mfma_f32_16x16x32_bf16 v[32:35], a[228:231], v[16:19], v[32:35]
    ds_read_b128 v[8:11], v0 offset:14336
    v_mfma_f32_16x16x32_bf16 v[40:43], a[228:231], v[20:23], v[40:43]
    ds_read_b128 v[12:15], v0 offset:30720
    v_mfma_f32_16x16x32_bf16 v[36:39], a[236:239], v[16:19], v[36:39]
    v_mfma_f32_16x16x32_bf16 v[44:47], a[236:239], v[20:23], v[44:47]
    v_mfma_f32_16x16x32_bf16 v[48:51], v[16:19], v[228:231], v[48:51]
    v_mfma_f32_16x16x32_bf16 v[56:59], v[20:23], v[228:231], v[56:59]
    v_mfma_f32_16x16x32_bf16 v[52:55], v[16:19], v[236:239], v[52:55]
    v_mfma_f32_16x16x32_bf16 v[60:63], v[20:23], v[236:239], v[60:63]
    v_mfma_f32_16x16x32_bf16 v[64:67], a[100:103], v[16:19], v[64:67]
    v_mfma_f32_16x16x32_bf16 v[72:75], a[100:103], v[20:23], v[72:75]
    v_mfma_f32_16x16x32_bf16 v[68:71], a[108:111], v[16:19], v[68:71]
    v_mfma_f32_16x16x32_bf16 v[76:79], a[108:111], v[20:23], v[76:79]
    s_waitcnt lgkmcnt(0)
    v_mfma_f32_16x16x32_bf16 v[32:35], a[240:243], v[8:11], v[32:35]
    ds_read_b128 v[16:19], v0 offset:15360
    v_mfma_f32_16x16x32_bf16 v[40:43], a[240:243], v[12:15], v[40:43]
    ds_read_b128 v[20:23], v0 offset:31744
    v_mfma_f32_16x16x32_bf16 v[36:39], a[248:251], v[8:11], v[36:39]
    v_mfma_f32_16x16x32_bf16 v[44:47], a[248:251], v[12:15], v[44:47]
    v_mfma_f32_16x16x32_bf16 v[48:51], v[8:11], v[240:243], v[48:51]
    v_mfma_f32_16x16x32_bf16 v[56:59], v[12:15], v[240:243], v[56:59]
    v_mfma_f32_16x16x32_bf16 v[52:55], v[8:11], v[248:251], v[52:55]
    v_mfma_f32_16x16x32_bf16 v[60:63], v[12:15], v[248:251], v[60:63]
    v_mfma_f32_16x16x32_bf16 v[64:67], a[112:115], v[8:11], v[64:67]
    v_mfma_f32_16x16x32_bf16 v[72:75], a[112:115], v[12:15], v[72:75]
    v_mfma_f32_16x16x32_bf16 v[68:71], a[120:123], v[8:11], v[68:71]
    v_mfma_f32_16x16x32_bf16 v[76:79], a[120:123], v[12:15], v[76:79]
    s_waitcnt lgkmcnt(0)
    v_mfma_f32_16x16x32_bf16 v[32:35], a[244:247], v[16:19], v[32:35]
    v_mfma_f32_16x16x32_bf16 v[40:43], a[244:247], v[20:23], v[40:43]
    v_mfma_f32_16x16x32_bf16 v[36:39], a[252:255], v[16:19], v[36:39]
    v_mfma_f32_16x16x32_bf16 v[44:47], a[252:255], v[20:23], v[44:47]
    v_mfma_f32_16x16x32_bf16 v[48:51], v[16:19], v[244:247], v[48:51]
    v_mfma_f32_16x16x32_bf16 v[56:59], v[20:23], v[244:247], v[56:59]
    v_mfma_f32_16x16x32_bf16 v[52:55], v[16:19], v[252:255], v[52:55]
    v_mfma_f32_16x16x32_bf16 v[60:63], v[20:23], v[252:255], v[60:63]
    v_mfma_f32_16x16x32_bf16 v[64:67], a[116:119], v[16:19], v[64:67]
    v_mfma_f32_16x16x32_bf16 v[72:75], a[116:119], v[20:23], v[72:75]
    v_mfma_f32_16x16x32_bf16 v[68:71], a[124:127], v[16:19], v[68:71]
    v_mfma_f32_16x16x32_bf16 v[76:79], a[124:127], v[20:23], v[76:79]
    s_waitcnt vmcnt(0)
    s_mov_b32 s32, s26
    s_add_u32 s33, s26, 4096
    s_lshl_b32 s22, s17, 10
    s_add_u32 s22, s22, s26
    s_add_u32 s34, s22, 8192
    s_add_u32 s35, s26, 16384
    s_add_u32 s36, s26, 20480
    s_add_u32 s26, s26, 1572864
    s_add_u32 s27, s27, 1
    v_cvt_pk_bf16_f32 v32, v32, v33
    v_cvt_pk_bf16_f32 v33, v34, v35
    v_cvt_pk_bf16_f32 v34, v36, v37
    v_cvt_pk_bf16_f32 v35, v38, v39
    buffer_store_dwordx4 v[32:35], v0, s[8:11], s32 offen sc1
    v_cvt_pk_bf16_f32 v40, v40, v41
    v_cvt_pk_bf16_f32 v41, v42, v43
    v_cvt_pk_bf16_f32 v42, v44, v45
    v_cvt_pk_bf16_f32 v43, v46, v47
    buffer_store_dwordx4 v[40:43], v0, s[8:11], s33 offen sc1
    v_cvt_pk_bf16_f32 v48, v48, v49
    v_cvt_pk_bf16_f32 v49, v52, v53
    v_cvt_pk_bf16_f32 v50, v50, v51
    v_cvt_pk_bf16_f32 v51, v54, v55
    buffer_store_dwordx4 v[48:51], v1, s[8:11], s34 offen offset:0 sc1
    v_cvt_pk_bf16_f32 v56, v56, v57
    v_cvt_pk_bf16_f32 v57, v60, v61
    v_cvt_pk_bf16_f32 v58, v58, v59
    v_cvt_pk_bf16_f32 v59, v62, v63
    buffer_store_dwordx4 v[56:59], v1, s[8:11], s34 offen offset:256 sc1
    v_cvt_pk_bf16_f32 v64, v64, v65
    v_cvt_pk_bf16_f32 v65, v66, v67
    v_cvt_pk_bf16_f32 v66, v68, v69
    v_cvt_pk_bf16_f32 v67, v70, v71
    buffer_store_dwordx4 v[64:67], v0, s[8:11], s35 offen sc1
    v_cvt_pk_bf16_f32 v72, v72, v73
    v_cvt_pk_bf16_f32 v73, v74, v75
    v_cvt_pk_bf16_f32 v74, v76, v77
    v_cvt_pk_bf16_f32 v75, v78, v79
    buffer_store_dwordx4 v[72:75], v0, s[8:11], s36 offen sc1
    v_mov_b32 v3, s27
    s_waitcnt vmcnt(0)
    buffer_store_dword v3, v2, s[8:11], s29 offen sc1
    s_waitcnt vmcnt(1)
    s_barrier
    ds_read_b128 v[8:11], v0 offset:32768
    ds_read_b128 v[12:15], v0 offset:49152
    s_waitcnt lgkmcnt(0)
    v_mfma_f32_16x16x32_bf16 v[80:83], a[128:131], v[8:11], 0
    ds_read_b128 v[16:19], v0 offset:33792
    v_mfma_f32_16x16x32_bf16 v[88:91], a[128:131], v[12:15], 0
    ds_read_b128 v[20:23], v0 offset:50176
    v_mfma_f32_16x16x32_bf16 v[84:87], a[136:139], v[8:11], 0
    v_mfma_f32_16x16x32_bf16 v[92:95], a[136:139], v[12:15], 0
    v_mfma_f32_16x16x32_bf16 v[96:99], v[8:11], v[128:131], 0
    v_mfma_f32_16x16x32_bf16 v[104:107], v[12:15], v[128:131], 0
    v_mfma_f32_16x16x32_bf16 v[100:103], v[8:11], v[136:139], 0
    v_mfma_f32_16x16x32_bf16 v[108:111], v[12:15], v[136:139], 0
    v_mfma_f32_16x16x32_bf16 v[112:115], a[0:3], v[8:11], 0
    v_mfma_f32_16x16x32_bf16 v[120:123], a[0:3], v[12:15], 0
    v_mfma_f32_16x16x32_bf16 v[116:119], a[8:11], v[8:11], 0
    v_mfma_f32_16x16x32_bf16 v[124:127], a[8:11], v[12:15], 0
    s_waitcnt lgkmcnt(0)
    v_mfma_f32_16x16x32_bf16 v[80:83], a[132:135], v[16:19], v[80:83]
    ds_read_b128 v[8:11], v0 offset:34816
    v_mfma_f32_16x16x32_bf16 v[88:91], a[132:135], v[20:23], v[88:91]
    ds_read_b128 v[12:15], v0 offset:51200
    v_mfma_f32_16x16x32_bf16 v[84:87], a[140:143], v[16:19], v[84:87]
    v_mfma_f32_16x16x32_bf16 v[92:95], a[140:143], v[20:23], v[92:95]
    v_mfma_f32_16x16x32_bf16 v[96:99], v[16:19], v[132:135], v[96:99]
    v_mfma_f32_16x16x32_bf16 v[104:107], v[20:23], v[132:135], v[104:107]
    v_mfma_f32_16x16x32_bf16 v[100:103], v[16:19], v[140:143], v[100:103]
    v_mfma_f32_16x16x32_bf16 v[108:111], v[20:23], v[140:143], v[108:111]
    v_mfma_f32_16x16x32_bf16 v[112:115], a[4:7], v[16:19], v[112:115]
    v_mfma_f32_16x16x32_bf16 v[120:123], a[4:7], v[20:23], v[120:123]
    v_mfma_f32_16x16x32_bf16 v[116:119], a[12:15], v[16:19], v[116:119]
    v_mfma_f32_16x16x32_bf16 v[124:127], a[12:15], v[20:23], v[124:127]
    s_waitcnt lgkmcnt(0)
    v_mfma_f32_16x16x32_bf16 v[80:83], a[144:147], v[8:11], v[80:83]
    ds_read_b128 v[16:19], v0 offset:35840
    v_mfma_f32_16x16x32_bf16 v[88:91], a[144:147], v[12:15], v[88:91]
    ds_read_b128 v[20:23], v0 offset:52224
    v_mfma_f32_16x16x32_bf16 v[84:87], a[152:155], v[8:11], v[84:87]
    v_mfma_f32_16x16x32_bf16 v[92:95], a[152:155], v[12:15], v[92:95]
    v_mfma_f32_16x16x32_bf16 v[96:99], v[8:11], v[144:147], v[96:99]
    v_mfma_f32_16x16x32_bf16 v[104:107], v[12:15], v[144:147], v[104:107]
    v_mfma_f32_16x16x32_bf16 v[100:103], v[8:11], v[152:155], v[100:103]
    v_mfma_f32_16x16x32_bf16 v[108:111], v[12:15], v[152:155], v[108:111]
    v_mfma_f32_16x16x32_bf16 v[112:115], a[16:19], v[8:11], v[112:115]
    v_mfma_f32_16x16x32_bf16 v[120:123], a[16:19], v[12:15], v[120:123]
    v_mfma_f32_16x16x32_bf16 v[116:119], a[24:27], v[8:11], v[116:119]
    v_mfma_f32_16x16x32_bf16 v[124:127], a[24:27], v[12:15], v[124:127]
    s_waitcnt lgkmcnt(0)
    v_mfma_f32_16x16x32_bf16 v[80:83], a[148:151], v[16:19], v[80:83]
    ds_read_b128 v[8:11], v0 offset:36864
    v_mfma_f32_16x16x32_bf16 v[88:91], a[148:151], v[20:23], v[88:91]
    ds_read_b128 v[12:15], v0 offset:53248
    v_mfma_f32_16x16x32_bf16 v[84:87], a[156:159], v[16:19], v[84:87]
    v_mfma_f32_16x16x32_bf16 v[92:95], a[156:159], v[20:23], v[92:95]
    v_mfma_f32_16x16x32_bf16 v[96:99], v[16:19], v[148:151], v[96:99]
    v_mfma_f32_16x16x32_bf16 v[104:107], v[20:23], v[148:151], v[104:107]
    v_mfma_f32_16x16x32_bf16 v[100:103], v[16:19], v[156:159], v[100:103]
    v_mfma_f32_16x16x32_bf16 v[108:111], v[20:23], v[156:159], v[108:111]
    v_mfma_f32_16x16x32_bf16 v[112:115], a[20:23], v[16:19], v[112:115]
    v_mfma_f32_16x16x32_bf16 v[120:123], a[20:23], v[20:23], v[120:123]
    v_mfma_f32_16x16x32_bf16 v[116:119], a[28:31], v[16:19], v[116:119]
    v_mfma_f32_16x16x32_bf16 v[124:127], a[28:31], v[20:23], v[124:127]
    s_waitcnt lgkmcnt(0)
    v_mfma_f32_16x16x32_bf16 v[80:83], a[160:163], v[8:11], v[80:83]
    ds_read_b128 v[16:19], v0 offset:37888
    v_mfma_f32_16x16x32_bf16 v[88:91], a[160:163], v[12:15], v[88:91]
    ds_read_b128 v[20:23], v0 offset:54272
    v_mfma_f32_16x16x32_bf16 v[84:87], a[168:171], v[8:11], v[84:87]
    v_mfma_f32_16x16x32_bf16 v[92:95], a[168:171], v[12:15], v[92:95]
    v_mfma_f32_16x16x32_bf16 v[96:99], v[8:11], v[160:163], v[96:99]
    v_mfma_f32_16x16x32_bf16 v[104:107], v[12:15], v[160:163], v[104:107]
    v_mfma_f32_16x16x32_bf16 v[100:103], v[8:11], v[168:171], v[100:103]
    v_mfma_f32_16x16x32_bf16 v[108:111], v[12:15], v[168:171], v[108:111]
    v_mfma_f32_16x16x32_bf16 v[112:115], a[32:35], v[8:11], v[112:115]
    v_mfma_f32_16x16x32_bf16 v[120:123], a[32:35], v[12:15], v[120:123]
    v_mfma_f32_16x16x32_bf16 v[116:119], a[40:43], v[8:11], v[116:119]
    v_mfma_f32_16x16x32_bf16 v[124:127], a[40:43], v[12:15], v[124:127]
    s_waitcnt lgkmcnt(0)
    v_mfma_f32_16x16x32_bf16 v[80:83], a[164:167], v[16:19], v[80:83]
    ds_read_b128 v[8:11], v0 offset:38912
    v_mfma_f32_16x16x32_bf16 v[88:91], a[164:167], v[20:23], v[88:91]
    ds_read_b128 v[12:15], v0 offset:55296
    v_mfma_f32_16x16x32_bf16 v[84:87], a[172:175], v[16:19], v[84:87]
    v_mfma_f32_16x16x32_bf16 v[92:95], a[172:175], v[20:23], v[92:95]
    v_mfma_f32_16x16x32_bf16 v[96:99], v[16:19], v[164:167], v[96:99]
    v_mfma_f32_16x16x32_bf16 v[104:107], v[20:23], v[164:167], v[104:107]
    v_mfma_f32_16x16x32_bf16 v[100:103], v[16:19], v[172:175], v[100:103]
    v_mfma_f32_16x16x32_bf16 v[108:111], v[20:23], v[172:175], v[108:111]
    v_mfma_f32_16x16x32_bf16 v[112:115], a[36:39], v[16:19], v[112:115]
    v_mfma_f32_16x16x32_bf16 v[120:123], a[36:39], v[20:23], v[120:123]
    v_mfma_f32_16x16x32_bf16 v[116:119], a[44:47], v[16:19], v[116:119]
    v_mfma_f32_16x16x32_bf16 v[124:127], a[44:47], v[20:23], v[124:127]
    s_waitcnt lgkmcnt(0)
    v_mfma_f32_16x16x32_bf16 v[80:83], a[176:179], v[8:11], v[80:83]
    ds_read_b128 v[16:19], v0 offset:39936
    v_mfma_f32_16x16x32_bf16 v[88:91], a[176:179], v[12:15], v[88:91]
    ds_read_b128 v[20:23], v0 offset:56320
    v_mfma_f32_16x16x32_bf16 v[84:87], a[184:187], v[8:11], v[84:87]
    v_mfma_f32_16x16x32_bf16 v[92:95], a[184:187], v[12:15], v[92:95]
    s_add_u32 m0, s28, 0
    s_add_u32 s20, s25, 0
    buffer_load_dwordx4 v0, s[8:11], s20 offen offset:0 sc1 lds
    v_mfma_f32_16x16x32_bf16 v[96:99], v[8:11], v[176:179], v[96:99]
    v_mfma_f32_16x16x32_bf16 v[104:107], v[12:15], v[176:179], v[104:107]
    v_mfma_f32_16x16x32_bf16 v[100:103], v[8:11], v[184:187], v[100:103]
    v_mfma_f32_16x16x32_bf16 v[108:111], v[12:15], v[184:187], v[108:111]
    buffer_load_dwordx4 v0, s[8:11], s20 offen offset:1024 sc1 lds
    v_mfma_f32_16x16x32_bf16 v[112:115], a[48:51], v[8:11], v[112:115]
    v_mfma_f32_16x16x32_bf16 v[120:123], a[48:51], v[12:15], v[120:123]
    v_mfma_f32_16x16x32_bf16 v[116:119], a[56:59], v[8:11], v[116:119]
    v_mfma_f32_16x16x32_bf16 v[124:127], a[56:59], v[12:15], v[124:127]
    s_waitcnt lgkmcnt(0)
    v_mfma_f32_16x16x32_bf16 v[80:83], a[180:183], v[16:19], v[80:83]
    ds_read_b128 v[8:11], v0 offset:40960
    v_mfma_f32_16x16x32_bf16 v[88:91], a[180:183], v[20:23], v[88:91]
    ds_read_b128 v[12:15], v0 offset:57344
    v_mfma_f32_16x16x32_bf16 v[84:87], a[188:191], v[16:19], v[84:87]
    v_mfma_f32_16x16x32_bf16 v[92:95], a[188:191], v[20:23], v[92:95]
    buffer_load_dwordx4 v0, s[8:11], s20 offen offset:2048 sc1 lds
    v_mfma_f32_16x16x32_bf16 v[96:99], v[16:19], v[180:183], v[96:99]
    v_mfma_f32_16x16x32_bf16 v[104:107], v[20:23], v[180:183], v[104:107]
    v_mfma_f32_16x16x32_bf16 v[100:103], v[16:19], v[188:191], v[100:103]
    v_mfma_f32_16x16x32_bf16 v[108:111], v[20:23], v[188:191], v[108:111]
    buffer_load_dwordx4 v0, s[8:11], s20 offen offset:3072 sc1 lds
    v_mfma_f32_16x16x32_bf16 v[112:115], a[52:55], v[16:19], v[112:115]
    v_mfma_f32_16x16x32_bf16 v[120:123], a[52:55], v[20:23], v[120:123]
    v_mfma_f32_16x16x32_bf16 v[116:119], a[60:63], v[16:19], v[116:119]
    v_mfma_f32_16x16x32_bf16 v[124:127], a[60:63], v[20:23], v[124:127]
    s_waitcnt lgkmcnt(0)
    v_mfma_f32_16x16x32_bf16 v[80:83], a[192:195], v[8:11], v[80:83]
    ds_read_b128 v[16:19], v0 offset:41984
    v_mfma_f32_16x16x32_bf16 v[88:91], a[192:195], v[12:15], v[88:91]
    ds_read_b128 v[20:23], v0 offset:58368
    v_mfma_f32_16x16x32_bf16 v[84:87], a[200:203], v[8:11], v[84:87]
    v_mfma_f32_16x16x32_bf16 v[92:95], a[200:203], v[12:15], v[92:95]
    s_add_u32 m0, s28, 4096
    s_add_u32 s20, s25, 4096
    buffer_load_dwordx4 v0, s[8:11], s20 offen offset:0 sc1 lds
    v_mfma_f32_16x16x32_bf16 v[96:99], v[8:11], v[192:195], v[96:99]
    v_mfma_f32_16x16x32_bf16 v[104:107], v[12:15], v[192:195], v[104:107]
    v_mfma_f32_16x16x32_bf16 v[100:103], v[8:11], v[200:203], v[100:103]
    v_mfma_f32_16x16x32_bf16 v[108:111], v[12:15], v[200:203], v[108:111]
    buffer_load_dwordx4 v0, s[8:11], s20 offen offset:1024 sc1 lds
    v_mfma_f32_16x16x32_bf16 v[112:115], a[64:67], v[8:11], v[112:115]
    v_mfma_f32_16x16x32_bf16 v[120:123], a[64:67], v[12:15], v[120:123]
    v_mfma_f32_16x16x32_bf16 v[116:119], a[72:75], v[8:11], v[116:119]
    v_mfma_f32_16x16x32_bf16 v[124:127], a[72:75], v[12:15], v[124:127]
    s_waitcnt lgkmcnt(0)
    v_mfma_f32_16x16x32_bf16 v[80:83], a[196:199], v[16:19], v[80:83]
    ds_read_b128 v[8:11], v0 offset:43008
    v_mfma_f32_16x16x32_bf16 v[88:91], a[196:199], v[20:23], v[88:91]
    ds_read_b128 v[12:15], v0 offset:59392
    v_mfma_f32_16x16x32_bf16 v[84:87], a[204:207], v[16:19], v[84:87]
    v_mfma_f32_16x16x32_bf16 v[92:95], a[204:207], v[20:23], v[92:95]
    buffer_load_dwordx4 v0, s[8:11], s20 offen offset:2048 sc1 lds
    v_mfma_f32_16x16x32_bf16 v[96:99], v[16:19], v[196:199], v[96:99]
    v_mfma_f32_16x16x32_bf16 v[104:107], v[20:23], v[196:199], v[104:107]
    v_mfma_f32_16x16x32_bf16 v[100:103], v[16:19], v[204:207], v[100:103]
    v_mfma_f32_16x16x32_bf16 v[108:111], v[20:23], v[204:207], v[108:111]
    buffer_load_dwordx4 v0, s[8:11], s20 offen offset:3072 sc1 lds
    s_add_u32 s25, s25, 65536
    s_xor_b32 s28, s28, 32768
    v_mfma_f32_16x16x32_bf16 v[112:115], a[68:71], v[16:19], v[112:115]
    v_mfma_f32_16x16x32_bf16 v[120:123], a[68:71], v[20:23], v[120:123]
    v_mfma_f32_16x16x32_bf16 v[116:119], a[76:79], v[16:19], v[116:119]
    v_mfma_f32_16x16x32_bf16 v[124:127], a[76:79], v[20:23], v[124:127]
    s_waitcnt lgkmcnt(0)
    v_mfma_f32_16x16x32_bf16 v[80:83], a[208:211], v[8:11], v[80:83]
    ds_read_b128 v[16:19], v0 offset:44032
    v_mfma_f32_16x16x32_bf16 v[88:91], a[208:211], v[12:15], v[88:91]
    ds_read_b128 v[20:23], v0 offset:60416
    v_mfma_f32_16x16x32_bf16 v[84:87], a[216:219], v[8:11], v[84:87]
    v_mfma_f32_16x16x32_bf16 v[92:95], a[216:219], v[12:15], v[92:95]
    v_mfma_f32_16x16x32_bf16 v[96:99], v[8:11], v[208:211], v[96:99]
    v_mfma_f32_16x16x32_bf16 v[104:107], v[12:15], v[208:211], v[104:107]
    v_mfma_f32_16x16x32_bf16 v[100:103], v[8:11], v[216:219], v[100:103]
    v_mfma_f32_16x16x32_bf16 v[108:111], v[12:15], v[216:219], v[108:111]
    v_mfma_f32_16x16x32_bf16 v[112:115], a[80:83], v[8:11], v[112:115]
    v_mfma_f32_16x16x32_bf16 v[120:123], a[80:83], v[12:15], v[120:123]
    v_mfma_f32_16x16x32_bf16 v[116:119], a[88:91], v[8:11], v[116:119]
    v_mfma_f32_16x16x32_bf16 v[124:127], a[88:91], v[12:15], v[124:127]
    s_waitcnt lgkmcnt(0)
    v_mfma_f32_16x16x32_bf16 v[80:83], a[212:215], v[16:19], v[80:83]
    ds_read_b128 v[8:11], v0 offset:45056
    v_mfma_f32_16x16x32_bf16 v[88:91], a[212:215], v[20:23], v[88:91]
    ds_read_b128 v[12:15], v0 offset:61440
    v_mfma_f32_16x16x32_bf16 v[84:87], a[220:223], v[16:19], v[84:87]
    v_mfma_f32_16x16x32_bf16 v[92:95], a[220:223], v[20:23], v[92:95]
    v_mfma_f32_16x16x32_bf16 v[96:99], v[16:19], v[212:215], v[96:99]
    v_mfma_f32_16x16x32_bf16 v[104:107], v[20:23], v[212:215], v[104:107]
    v_mfma_f32_16x16x32_bf16 v[100:103], v[16:19], v[220:223], v[100:103]
    v_mfma_f32_16x16x32_bf16 v[108:111], v[20:23], v[220:223], v[108:111]
    v_mfma_f32_16x16x32_bf16 v[112:115], a[84:87], v[16:19], v[112:115]
    v_mfma_f32_16x16x32_bf16 v[120:123], a[84:87], v[20:23], v[120:123]
    v_mfma_f32_16x16x32_bf16 v[116:119], a[92:95], v[16:19], v[116:119]
    v_mfma_f32_16x16x32_bf16 v[124:127], a[92:95], v[20:23], v[124:127]
    s_waitcnt lgkmcnt(0)
    v_mfma_f32_16x16x32_bf16 v[80:83], a[224:227], v[8:11], v[80:83]
    ds_read_b128 v[16:19], v0 offset:46080
    v_mfma_f32_16x16x32_bf16 v[88:91], a[224:227], v[12:15], v[88:91]
    ds_read_b128 v[20:23], v0 offset:62464
    v_mfma_f32_16x16x32_bf16 v[84:87], a[232:235], v[8:11], v[84:87]
    v_mfma_f32_16x16x32_bf16 v[92:95], a[232:235], v[12:15], v[92:95]
    v_mfma_f32_16x16x32_bf16 v[96:99], v[8:11], v[224:227], v[96:99]
    v_mfma_f32_16x16x32_bf16 v[104:107], v[12:15], v[224:227], v[104:107]
    v_mfma_f32_16x16x32_bf16 v[100:103], v[8:11], v[232:235], v[100:103]
    v_mfma_f32_16x16x32_bf16 v[108:111], v[12:15], v[232:235], v[108:111]
    v_mfma_f32_16x16x32_bf16 v[112:115], a[96:99], v[8:11], v[112:115]
    v_mfma_f32_16x16x32_bf16 v[120:123], a[96:99], v[12:15], v[120:123]
    v_mfma_f32_16x16x32_bf16 v[116:119], a[104:107], v[8:11], v[116:119]
    v_mfma_f32_16x16x32_bf16 v[124:127], a[104:107], v[12:15], v[124:127]
    s_waitcnt lgkmcnt(0)
    v_mfma_f32_16x16x32_bf16 v[80:83], a[228:231], v[16:19], v[80:83]
    ds_read_b128 v[8:11], v0 offset:47104
    v_mfma_f32_16x16x32_bf16 v[88:91], a[228:231], v[20:23], v[88:91]
    ds_read_b128 v[12:15], v0 offset:63488
    v_mfma_f32_16x16x32_bf16 v[84:87], a[236:239], v[16:19], v[84:87]
    v_mfma_f32_16x16x32_bf16 v[92:95], a[236:239], v[20:23], v[92:95]
    v_mfma_f32_16x16x32_bf16 v[96:99], v[16:19], v[228:231], v[96:99]
    v_mfma_f32_16x16x32_bf16 v[104:107], v[20:23], v[228:231], v[104:107]
    v_mfma_f32_16x16x32_bf16 v[100:103], v[16:19], v[236:239], v[100:103]
    v_mfma_f32_16x16x32_bf16 v[108:111], v[20:23], v[236:239], v[108:111]
    v_mfma_f32_16x16x32_bf16 v[112:115], a[100:103], v[16:19], v[112:115]
    v_mfma_f32_16x16x32_bf16 v[120:123], a[100:103], v[20:23], v[120:123]
    v_mfma_f32_16x16x32_bf16 v[116:119], a[108:111], v[16:19], v[116:119]
    v_mfma_f32_16x16x32_bf16 v[124:127], a[108:111], v[20:23], v[124:127]
    s_waitcnt lgkmcnt(0)
    v_mfma_f32_16x16x32_bf16 v[80:83], a[240:243], v[8:11], v[80:83]
    ds_read_b128 v[16:19], v0 offset:48128
    v_mfma_f32_16x16x32_bf16 v[88:91], a[240:243], v[12:15], v[88:91]
    ds_read_b128 v[20:23], v0 offset:64512
    v_mfma_f32_16x16x32_bf16 v[84:87], a[248:251], v[8:11], v[84:87]
    v_mfma_f32_16x16x32_bf16 v[92:95], a[248:251], v[12:15], v[92:95]
    v_mfma_f32_16x16x32_bf16 v[96:99], v[8:11], v[240:243], v[96:99]
    v_mfma_f32_16x16x32_bf16 v[104:107], v[12:15], v[240:243], v[104:107]
    v_mfma_f32_16x16x32_bf16 v[100:103], v[8:11], v[248:251], v[100:103]
    v_mfma_f32_16x16x32_bf16 v[108:111], v[12:15], v[248:251], v[108:111]
    v_mfma_f32_16x16x32_bf16 v[112:115], a[112:115], v[8:11], v[112:115]
    v_mfma_f32_16x16x32_bf16 v[120:123], a[112:115], v[12:15], v[120:123]
    v_mfma_f32_16x16x32_bf16 v[116:119], a[120:123], v[8:11], v[116:119]
    v_mfma_f32_16x16x32_bf16 v[124:127], a[120:123], v[12:15], v[124:127]
    s_waitcnt lgkmcnt(0)
    v_mfma_f32_16x16x32_bf16 v[80:83], a[244:247], v[16:19], v[80:83]
    v_mfma_f32_16x16x32_bf16 v[88:91], a[244:247], v[20:23], v[88:91]
    v_mfma_f32_16x16x32_bf16 v[84:87], a[252:255], v[16:19], v[84:87]
    v_mfma_f32_16x16x32_bf16 v[92:95], a[252:255], v[20:23], v[92:95]
    v_mfma_f32_16x16x32_bf16 v[96:99], v[16:19], v[244:247], v[96:99]
    v_mfma_f32_16x16x32_bf16 v[104:107], v[20:23], v[244:247], v[104:107]
    v_mfma_f32_16x16x32_bf16 v[100:103], v[16:19], v[252:255], v[100:103]
    v_mfma_f32_16x16x32_bf16 v[108:111], v[20:23], v[252:255], v[108:111]
    v_mfma_f32_16x16x32_bf16 v[112:115], a[116:119], v[16:19], v[112:115]
    v_mfma_f32_16x16x32_bf16 v[120:123], a[116:119], v[20:23], v[120:123]
    v_mfma_f32_16x16x32_bf16 v[116:119], a[124:127], v[16:19], v[116:119]
    v_mfma_f32_16x16x32_bf16 v[124:127], a[124:127], v[20:23], v[124:127]
    s_waitcnt vmcnt(0)
P_loop:
    s_waitcnt vmcnt(1)
    s_barrier
    ds_read_b128 v[8:11], v0 offset:0
    ds_read_b128 v[12:15], v0 offset:16384
    s_mov_b32 s32, s26
    s_add_u32 s33, s26, 4096
    s_lshl_b32 s22, s17, 10
    s_add_u32 s22, s22, s26
    s_add_u32 s34, s22, 8192
    s_add_u32 s35, s26, 16384
    s_add_u32 s36, s26, 20480
    s_add_u32 s26, s26, 1572864
    s_add_u32 s27, s27, 1
    s_waitcnt lgkmcnt(0)
    v_mfma_f32_16x16x32_bf16 v[32:35], a[128:131], v[8:11], 0
    ds_read_b128 v[16:19], v0 offset:1024
    v_mfma_f32_16x16x32_bf16 v[40:43], a[128:131], v[12:15], 0
    ds_read_b128 v[20:23], v0 offset:17408
    v_mfma_f32_16x16x32_bf16 v[36:39], a[136:139], v[8:11], 0
    v_cvt_pk_bf16_f32 v80, v80, v81
    v_cvt_pk_bf16_f32 v81, v82, v83
    v_mfma_f32_16x16x32_bf16 v[44:47], a[136:139], v[12:15], 0
    v_cvt_pk_bf16_f32 v82, v84, v85
    v_cvt_pk_bf16_f32 v83, v86, v87
    v_mfma_f32_16x16x32_bf16 v[48:51], v[8:11], v[128:131], 0
    v_mfma_f32_16x16x32_bf16 v[56:59], v[12:15], v[128:131], 0
    buffer_store_dwordx4 v[80:83], v0, s[8:11], s32 offen sc1
    v_mfma_f32_16x16x32_bf16 v[52:55], v[8:11], v[136:139], 0
    v_mfma_f32_16x16x32_bf16 v[60:63], v[12:15], v[136:139], 0
    v_mfma_f32_16x16x32_bf16 v[64:67], a[0:3], v[8:11], 0
    v_mfma_f32_16x16x32_bf16 v[72:75], a[0:3], v[12:15], 0
    v_mfma_f32_16x16x32_bf16 v[68:71], a[8:11], v[8:11], 0
    v_mfma_f32_16x16x32_bf16 v[76:79], a[8:11], v[12:15], 0
    s_waitcnt lgkmcnt(0)
    v_mfma_f32_16x16x32_bf16 v[32:35], a[132:135], v[16:19], v[32:35]
    ds_read_b128 v[8:11], v0 offset:2048
    v_mfma_f32_16x16x32_bf16 v[40:43], a[132:135], v[20:23], v[40:43]
    ds_read_b128 v[12:15], v0 offset:18432
    v_mfma_f32_16x16x32_bf16 v[36:39], a[140:143], v[16:19], v[36:39]
    v_cvt_pk_bf16_f32 v88, v88, v89
    v_cvt_pk_bf16_f32 v89, v90, v91
    v_mfma_f32_16x16x32_bf16 v[44:47], a[140:143], v[20:23], v[44:47]
    v_cvt_pk_bf16_f32 v90, v92, v93
    v_cvt_pk_bf16_f32 v91, v94, v95
    v_mfma_f32_16x16x32_bf16 v[48:51], v[16:19], v[132:135], v[48:51]
    v_mfma_f32_16x16x32_bf16 v[56:59], v[20:23], v[132:135], v[56:59]
    buffer_store_dwordx4 v[88:91], v0, s[8:11], s33 offen sc1
    v_mfma_f32_16x16x32_bf16 v[52:55], v[16:19], v[140:143], v[52:55]
    v_mfma_f32_16x16x32_bf16 v[60:63], v[20:23], v[140:143], v[60:63]
    v_mfma_f32_16x16x32_bf16 v[64:67], a[4:7], v[16:19], v[64:67]
    v_mfma_f32_16x16x32_bf16 v[72:75], a[4:7], v[20:23], v[72:75]
    v_mfma_f32_16x16x32_bf16 v[68:71], a[12:15], v[16:19], v[68:71]
    v_mfma_f32_16x16x32_bf16 v[76:79], a[12:15], v[20:23], v[76:79]
    s_waitcnt lgkmcnt(0)
    v_mfma_f32_16x16x32_bf16 v[32:35], a[144:147], v[8:11], v[32:35]
    ds_read_b128 v[16:19], v0 offset:3072
    v_mfma_f32_16x16x32_bf16 v[40:43], a[144:147], v[12:15], v[40:43]
    ds_read_b128 v[20:23], v0 offset:19456
    v_mfma_f32_16x16x32_bf16 v[36:39], a[152:155], v[8:11], v[36:39]
    v_cvt_pk_bf16_f32 v96, v96, v97
    v_cvt_pk_bf16_f32 v97, v100, v101
    v_mfma_f32_16x16x32_bf16 v[44:47], a[152:155], v[12:15], v[44:47]
    v_cvt_pk_bf16_f32 v98, v98, v99
    v_cvt_pk_bf16_f32 v99, v102, v103
    v_mfma_f32_16x16x32_bf16 v[48:51], v[8:11], v[144:147], v[48:51]
    v_mfma_f32_16x16x32_bf16 v[56:59], v[12:15], v[144:147], v[56:59]
    buffer_store_dwordx4 v[96:99], v1, s[8:11], s34 offen offset:0 sc1
    v_mfma_f32_16x16x32_bf16 v[52:55], v[8:11], v[152:155], v[52:55]
    v_mfma_f32_16x16x32_bf16 v[60:63], v[12:15], v[152:155], v[60:63]
    v_mfma_f32_16x16x32_bf16 v[64:67], a[16:19], v[8:11], v[64:67]
    v_mfma_f32_16x16x32_bf16 v[72:75], a[16:19], v[12:15], v[72:75]
    v_mfma_f32_16x16x32_bf16 v[68:71], a[24:27], v[8:11], v[68:71]
    v_mfma_f32_16x16x32_bf16 v[76:79], a[24:27], v[12:15], v[76:79]
    s_waitcnt lgkmcnt(0)
    v_mfma_f32_16x16x32_bf16 v[32:35], a[148:151], v[16:19], v[32:35]
    ds_read_b128 v[8:11], v0 offset:4096
    v_mfma_f32_16x16x32_bf16 v[40:43], a[148:151], v[20:23], v[40:43]
    ds_read_b128 v[12:15], v0 offset:20480
    v_mfma_f32_16x16x32_bf16 v[36:39], a[156:159], v[16:19], v[36:39]
    v_cvt_pk_bf16_f32 v104, v104, v105
    v_cvt_pk_bf16_f32 v105, v108, v109
    v_mfma_f32_16x16x32_bf16 v[44:47], a[156:159], v[20:23], v[44:47]
    v_cvt_pk_bf16_f32 v106, v106, v107
    v_cvt_pk_bf16_f32 v107, v110, v111
    v_mfma_f32_16x16x32_bf16 v[48:51], v[16:19], v[148:151], v[48:51]
    v_mfma_f32_16x16x32_bf16 v[56:59], v[20:23], v[148:151], v[56:59]
    buffer_store_dwordx4 v[104:107], v1, s[8:11], s34 offen offset:256 sc1
    v_mfma_f32_16x16x32_bf16 v[52:55], v[16:19], v[156:159], v[52:55]
    v_mfma_f32_16x16x32_bf16 v[60:63], v[20:23], v[156:159], v[60:63]
    v_mfma_f32_16x16x32_bf16 v[64:67], a[20:23], v[16:19], v[64:67]
    v_mfma_f32_16x16x32_bf16 v[72:75], a[20:23], v[20:23], v[72:75]
    v_mfma_f32_16x16x32_bf16 v[68:71], a[28:31], v[16:19], v[68:71]
    v_mfma_f32_16x16x32_bf16 v[76:79], a[28:31], v[20:23], v[76:79]
    s_waitcnt lgkmcnt(0)
    v_mfma_f32_16x16x32_bf16 v[32:35], a[160:163], v[8:11], v[32:35]
    ds_read_b128 v[16:19], v0 offset:5120
    v_mfma_f32_16x16x32_bf16 v[40:43], a[160:163], v[12:15], v[40:43]
    ds_read_b128 v[20:23], v0 offset:21504
    v_mfma_f32_16x16x32_bf16 v[36:39], a[168:171], v[8:11], v[36:39]
    v_cvt_pk_bf16_f32 v112, v112, v113
    v_cvt_pk_bf16_f32 v113, v114, v115
    v_mfma_f32_16x16x32_bf16 v[44:47], a[168:171], v[12:15], v[44:47]
    v_cvt_pk_bf16_f32 v114, v116, v117
    v_cvt_pk_bf16_f32 v115, v118, v119
    v_mfma_f32_16x16x32_bf16 v[48:51], v[8:11], v[160:163], v[48:51]
    v_mfma_f32_16x16x32_bf16 v[56:59], v[12:15], v[160:163], v[56:59]
    buffer_store_dwordx4 v[112:115], v0, s[8:11], s35 offen sc1
    v_mfma_f32_16x16x32_bf16 v[52:55], v[8:11], v[168:171], v[52:55]
    v_mfma_f32_16x16x32_bf16 v[60:63], v[12:15], v[168:171], v[60:63]
    v_mfma_f32_16x16x32_bf16 v[64:67], a[32:35], v[8:11], v[64:67]
    v_mfma_f32_16x16x32_bf16 v[72:75], a[32:35], v[12:15], v[72:75]
    v_mfma_f32_16x16x32_bf16 v[68:71], a[40:43], v[8:11], v[68:71]
    v_mfma_f32_16x16x32_bf16 v[76:79], a[40:43], v[12:15], v[76:79]
    s_waitcnt lgkmcnt(0)
    v_mfma_f32_16x16x32_bf16 v[32:35], a[164:167], v[16:19], v[32:35]
    ds_read_b128 v[8:11], v0 offset:6144
    v_mfma_f32_16x16x32_bf16 v[40:43], a[164:167], v[20:23], v[40:43]
    ds_read_b128 v[12:15], v0 offset:22528
    v_mfma_f32_16x16x32_bf16 v[36:39], a[172:175], v[16:19], v[36:39]
    v_cvt_pk_bf16_f32 v120, v120, v121
    v_cvt_pk_bf16_f32 v121, v122, v123
    v_mfma_f32_16x16x32_bf16 v[44:47], a[172:175], v[20:23], v[44:47]
    v_cvt_pk_bf16_f32 v122, v124, v125
    v_cvt_pk_bf16_f32 v123, v126, v127
    v_mfma_f32_16x16x32_bf16 v[48:51], v[16:19], v[164:167], v[48:51]
    v_mfma_f32_16x16x32_bf16 v[56:59], v[20:23], v[164:167], v[56:59]
    buffer_store_dwordx4 v[120:123], v0, s[8:11], s36 offen sc1
    v_mfma_f32_16x16x32_bf16 v[52:55], v[16:19], v[172:175], v[52:55]
    v_mfma_f32_16x16x32_bf16 v[60:63], v[20:23], v[172:175], v[60:63]
    v_mfma_f32_16x16x32_bf16 v[64:67], a[36:39], v[16:19], v[64:67]
    v_mfma_f32_16x16x32_bf16 v[72:75], a[36:39], v[20:23], v[72:75]
    v_mfma_f32_16x16x32_bf16 v[68:71], a[44:47], v[16:19], v[68:71]
    v_mfma_f32_16x16x32_bf16 v[76:79], a[44:47], v[20:23], v[76:79]
    s_waitcnt lgkmcnt(0)
    v_mfma_f32_16x16x32_bf16 v[32:35], a[176:179], v[8:11], v[32:35]
    ds_read_b128 v[16:19], v0 offset:7168
    v_mfma_f32_16x16x32_bf16 v[40:43], a[176:179], v[12:15], v[40:43]
    ds_read_b128 v[20:23], v0 offset:23552
    v_mfma_f32_16x16x32_bf16 v[36:39], a[184:187], v[8:11], v[36:39]
    v_mfma_f32_16x16x32_bf16 v[44:47], a[184:187], v[12:15], v[44:47]
    s_add_u32 m0, s28, 0
    s_add_u32 s20, s25, 0
    buffer_load_dwordx4 v0, s[8:11], s20 offen offset:0 sc1 lds
    v_mfma_f32_16x16x32_bf16 v[48:51], v[8:11], v[176:179], v[48:51]
    v_mfma_f32_16x16x32_bf16 v[56:59], v[12:15], v[176:179], v[56:59]
    v_mfma_f32_16x16x32_bf16 v[52:55], v[8:11], v[184:187], v[52:55]
    v_mfma_f32_16x16x32_bf16 v[60:63], v[12:15], v[184:187], v[60:63]
    buffer_load_dwordx4 v0, s[8:11], s20 offen offset:1024 sc1 lds
    v_mfma_f32_16x16x32_bf16 v[64:67], a[48:51], v[8:11], v[64:67]
    v_mfma_f32_16x16x32_bf16 v[72:75], a[48:51], v[12:15], v[72:75]
    v_mfma_f32_16x16x32_bf16 v[68:71], a[56:59], v[8:11], v[68:71]
    v_mfma_f32_16x16x32_bf16 v[76:79], a[56:59], v[12:15], v[76:79]
    s_waitcnt lgkmcnt(0)
    v_mfma_f32_16x16x32_bf16 v[32:35], a[180:183], v[16:19], v[32:35]
    ds_read_b128 v[8:11], v0 offset:8192
    v_mfma_f32_16x16x32_bf16 v[40:43], a[180:183], v[20:23], v[40:43]
    ds_read_b128 v[12:15], v0 offset:24576
    v_mfma_f32_16x16x32_bf16 v[36:39], a[188:191], v[16:19], v[36:39]
    v_mfma_f32_16x16x32_bf16 v[44:47], a[188:191], v[20:23], v[44:47]
    buffer_load_dwordx4 v0, s[8:11], s20 offen offset:2048 sc1 lds
    v_mfma_f32_16x16x32_bf16 v[48:51], v[16:19], v[180:183], v[48:51]
    v_mfma_f32_16x16x32_bf16 v[56:59], v[20:23], v[180:183], v[56:59]
    v_mfma_f32_16x16x32_bf16 v[52:55], v[16:19], v[188:191], v[52:55]
    v_mfma_f32_16x16x32_bf16 v[60:63], v[20:23], v[188:191], v[60:63]
    buffer_load_dwordx4 v0, s[8:11], s20 offen offset:3072 sc1 lds
    v_mfma_f32_16x16x32_bf16 v[64:67], a[52:55], v[16:19], v[64:67]
    v_mfma_f32_16x16x32_bf16 v[72:75], a[52:55], v[20:23], v[72:75]
    v_mfma_f32_16x16x32_bf16 v[68:71], a[60:63], v[16:19], v[68:71]
    v_mfma_f32_16x16x32_bf16 v[76:79], a[60:63], v[20:23], v[76:79]
    s_waitcnt lgkmcnt(0)
    v_mfma_f32_16x16x32_bf16 v[32:35], a[192:195], v[8:11], v[32:35]
    ds_read_b128 v[16:19], v0 offset:9216
    v_mfma_f32_16x16x32_bf16 v[40:43], a[192:195], v[12:15], v[40:43]
    ds_read_b128 v[20:23], v0 offset:25600
    v_mfma_f32_16x16x32_bf16 v[36:39], a[200:203], v[8:11], v[36:39]
    v_mfma_f32_16x16x32_bf16 v[44:47], a[200:203], v[12:15], v[44:47]
    s_add_u32 m0, s28, 4096
    s_add_u32 s20, s25, 4096
    buffer_load_dwordx4 v0, s[8:11], s20 offen offset:0 sc1 lds
    v_mfma_f32_16x16x32_bf16 v[48:51], v[8:11], v[192:195], v[48:51]
    v_mfma_f32_16x16x32_bf16 v[56:59], v[12:15], v[192:195], v[56:59]
    v_mfma_f32_16x16x32_bf16 v[52:55], v[8:11], v[200:203], v[52:55]
    v_mfma_f32_16x16x32_bf16 v[60:63], v[12:15], v[200:203], v[60:63]
    buffer_load_dwordx4 v0, s[8:11], s20 offen offset:1024 sc1 lds
    v_mfma_f32_16x16x32_bf16 v[64:67], a[64:67], v[8:11], v[64:67]
    v_mfma_f32_16x16x32_bf16 v[72:75], a[64:67], v[12:15], v[72:75]
    v_mfma_f32_16x16x32_bf16 v[68:71], a[72:75], v[8:11], v[68:71]
    v_mfma_f32_16x16x32_bf16 v[76:79], a[72:75], v[12:15], v[76:79]
    s_waitcnt lgkmcnt(0)
    v_mfma_f32_16x16x32_bf16 v[32:35], a[196:199], v[16:19], v[32:35]
    ds_read_b128 v[8:11], v0 offset:10240
    v_mfma_f32_16x16x32_bf16 v[40:43], a[196:199], v[20:23], v[40:43]
    ds_read_b128 v[12:15], v0 offset:26624
    v_mfma_f32_16x16x32_bf16 v[36:39], a[204:207], v[16:19], v[36:39]
    v_mfma_f32_16x16x32_bf16 v[44:47], a[204:207], v[20:23], v[44:47]
    buffer_load_dwordx4 v0, s[8:11], s20 offen offset:2048 sc1 lds
    v_mfma_f32_16x16x32_bf16 v[48:51], v[16:19], v[196:199], v[48:51]
    v_mfma_f32_16x16x32_bf16 v[56:59], v[20:23], v[196:199], v[56:59]
    v_mfma_f32_16x16x32_bf16 v[52:55], v[16:19], v[204:207], v[52:55]
    v_mfma_f32_16x16x32_bf16 v[60:63], v[20:23], v[204:207], v[60:63]
    buffer_load_dwordx4 v0, s[8:11], s20 offen offset:3072 sc1 lds
    s_add_u32 s25, s25, 65536
    s_xor_b32 s28, s28, 32768
    v_mfma_f32_16x16x32_bf16 v[64:67], a[68:71], v[16:19], v[64:67]
    v_mfma_f32_16x16x32_bf16 v[72:75], a[68:71], v[20:23], v[72:75]
    v_mfma_f32_16x16x32_bf16 v[68:71], a[76:79], v[16:19], v[68:71]
    v_mfma_f32_16x16x32_bf16 v[76:79], a[76:79], v[20:23], v[76:79]
    s_waitcnt lgkmcnt(0)
    v_mfma_f32_16x16x32_bf16 v[32:35], a[208:211], v[8:11], v[32:35]
    ds_read_b128 v[16:19], v0 offset:11264
    v_mfma_f32_16x16x32_bf16 v[40:43], a[208:211], v[12:15], v[40:43]
    ds_read_b128 v[20:23], v0 offset:27648
    v_mfma_f32_16x16x32_bf16 v[36:39], a[216:219], v[8:11], v[36:39]
    v_mfma_f32_16x16x32_bf16 v[44:47], a[216:219], v[12:15], v[44:47]
    v_mfma_f32_16x16x32_bf16 v[48:51], v[8:11], v[208:211], v[48:51]
    v_mfma_f32_16x16x32_bf16 v[56:59], v[12:15], v[208:211], v[56:59]
    v_mfma_f32_16x16x32_bf16 v[52:55], v[8:11], v[216:219], v[52:55]
    v_mfma_f32_16x16x32_bf16 v[60:63], v[12:15], v[216:219], v[60:63]
    v_mfma_f32_16x16x32_bf16 v[64:67], a[80:83], v[8:11], v[64:67]
    v_mfma_f32_16x16x32_bf16 v[72:75], a[80:83], v[12:15], v[72:75]
    v_mfma_f32_16x16x32_bf16 v[68:71], a[88:91], v[8:11], v[68:71]
    v_mfma_f32_16x16x32_bf16 v[76:79], a[88:91], v[12:15], v[76:79]
    s_waitcnt lgkmcnt(0)
    v_mfma_f32_16x16x32_bf16 v[32:35], a[212:215], v[16:19], v[32:35]
    ds_read_b128 v[8:11], v0 offset:12288
    v_mfma_f32_16x16x32_bf16 v[40:43], a[212:215], v[20:23], v[40:43]
    ds_read_b128 v[12:15], v0 offset:28672
    v_mfma_f32_16x16x32_bf16 v[36:39], a[220:223], v[16:19], v[36:39]
    v_mfma_f32_16x16x32_bf16 v[44:47], a[220:223], v[20:23], v[44:47]
    v_mfma_f32_16x16x32_bf16 v[48:51], v[16:19], v[212:215], v[48:51]
    v_mfma_f32_16x16x32_bf16 v[56:59], v[20:23], v[212:215], v[56:59]
    v_mfma_f32_16x16x32_bf16 v[52:55], v[16:19], v[220:223], v[52:55]
    v_mfma_f32_16x16x32_bf16 v[60:63], v[20:23], v[220:223], v[60:63]
    v_mfma_f32_16x16x32_bf16 v[64:67], a[84:87], v[16:19], v[64:67]
    v_mfma_f32_16x16x32_bf16 v[72:75], a[84:87], v[20:23], v[72:75]
    v_mfma_f32_16x16x32_bf16 v[68:71], a[92:95], v[16:19], v[68:71]
    v_mfma_f32_16x16x32_bf16 v[76:79], a[92:95], v[20:23], v[76:79]
    s_waitcnt lgkmcnt(0)
    v_mfma_f32_16x16x32_bf16 v[32:35], a[224:227], v[8:11], v[32:35]
    ds_read_b128 v[16:19], v0 offset:13312
    v_mfma_f32_16x16x32_bf16 v[40:43], a[224:227], v[12:15], v[40:43]
    ds_read_b128 v[20:23], v0 offset:29696
    v_mfma_f32_16x16x32_bf16 v[36:39], a[232:235], v[8:11], v[36:39]
    v_mfma_f32_16x16x32_bf16 v[44:47], a[232:235], v[12:15], v[44:47]
    v_mfma_f32_16x16x32_bf16 v[48:51], v[8:11], v[224:227], v[48:51]
    v_mfma_f32_16x16x32_bf16 v[56:59], v[12:15], v[224:227], v[56:59]
    v_mfma_f32_16x16x32_bf16 v[52:55], v[8:11], v[232:235], v[52:55]
    v_mfma_f32_16x16x32_bf16 v[60:63], v[12:15], v[232:235], v[60:63]
    v_mfma_f32_16x16x32_bf16 v[64:67], a[96:99], v[8:11], v[64:67]
    v_mfma_f32_16x16x32_bf16 v[72:75], a[96:99], v[12:15], v[72:75]
    v_mfma_f32_16x16x32_bf16 v[68:71], a[104:107], v[8:11], v[68:71]
    v_mfma_f32_16x16x32_bf16 v[76:79], a[104:107], v[12:15], v[76:79]
    s_waitcnt lgkmcnt(0)
    v_mfma_f32_16x16x32_bf16 v[32:35], a[228:231], v[16:19], v[32:35]
    ds_read_b128 v[8:11], v0 offset:14336
    v_mfma_f32_16x16x32_bf16 v[40:43], a[228:231], v[20:23], v[40:43]
    ds_read_b128 v[12:15], v0 offset:30720
    v_mfma_f32_16x16x32_bf16 v[36:39], a[236:239], v[16:19], v[36:39]
    v_mfma_f32_16x16x32_bf16 v[44:47], a[236:239], v[20:23], v[44:47]
    v_mfma_f32_16x16x32_bf16 v[48:51], v[16:19], v[228:231], v[48:51]
    v_mfma_f32_16x16x32_bf16 v[56:59], v[20:23], v[228:231], v[56:59]
    v_mfma_f32_16x16x32_bf16 v[52:55], v[16:19], v[236:239], v[52:55]
    v_mfma_f32_16x16x32_bf16 v[60:63], v[20:23], v[236:239], v[60:63]
    v_mfma_f32_16x16x32_bf16 v[64:67], a[100:103], v[16:19], v[64:67]
    v_mfma_f32_16x16x32_bf16 v[72:75], a[100:103], v[20:23], v[72:75]
    v_mfma_f32_16x16x32_bf16 v[68:71], a[108:111], v[16:19], v[68:71]
    v_mfma_f32_16x16x32_bf16 v[76:79], a[108:111], v[20:23], v[76:79]
    s_waitcnt lgkmcnt(0)
    v_mfma_f32_16x16x32_bf16 v[32:35], a[240:243], v[8:11], v[32:35]
    ds_read_b128 v[16:19], v0 offset:15360
    v_mfma_f32_16x16x32_bf16 v[40:43], a[240:243], v[12:15], v[40:43]
    ds_read_b128 v[20:23], v0 offset:31744
    v_mfma_f32_16x16x32_bf16 v[36:39], a[248:251], v[8:11], v[36:39]
    v_mfma_f32_16x16x32_bf16 v[44:47], a[248:251], v[12:15], v[44:47]
    v_mfma_f32_16x16x32_bf16 v[48:51], v[8:11], v[240:243], v[48:51]
    v_mfma_f32_16x16x32_bf16 v[56:59], v[12:15], v[240:243], v[56:59]
    v_mfma_f32_16x16x32_bf16 v[52:55], v[8:11], v[248:251], v[52:55]
    v_mfma_f32_16x16x32_bf16 v[60:63], v[12:15], v[248:251], v[60:63]
    v_mfma_f32_16x16x32_bf16 v[64:67], a[112:115], v[8:11], v[64:67]
    v_mfma_f32_16x16x32_bf16 v[72:75], a[112:115], v[12:15], v[72:75]
    v_mfma_f32_16x16x32_bf16 v[68:71], a[120:123], v[8:11], v[68:71]
    v_mfma_f32_16x16x32_bf16 v[76:79], a[120:123], v[12:15], v[76:79]
    s_waitcnt lgkmcnt(0)
    v_mfma_f32_16x16x32_bf16 v[32:35], a[244:247], v[16:19], v[32:35]
    v_mfma_f32_16x16x32_bf16 v[40:43], a[244:247], v[20:23], v[40:43]
    v_mfma_f32_16x16x32_bf16 v[36:39], a[252:255], v[16:19], v[36:39]
    v_mfma_f32_16x16x32_bf16 v[44:47], a[252:255], v[20:23], v[44:47]
    s_waitcnt vmcnt(8)
    v_mov_b32 v3, s27
    v_mfma_f32_16x16x32_bf16 v[48:51], v[16:19], v[244:247], v[48:51]
    v_mfma_f32_16x16x32_bf16 v[56:59], v[20:23], v[244:247], v[56:59]
    buffer_store_dword v3, v2, s[8:11], s29 offen sc1
    v_mfma_f32_16x16x32_bf16 v[52:55], v[16:19], v[252:255], v[52:55]
    v_mfma_f32_16x16x32_bf16 v[60:63], v[20:23], v[252:255], v[60:63]
    v_mfma_f32_16x16x32_bf16 v[64:67], a[116:119], v[16:19], v[64:67]
    v_mfma_f32_16x16x32_bf16 v[72:75], a[116:119], v[20:23], v[72:75]
    v_mfma_f32_16x16x32_bf16 v[68:71], a[124:127], v[16:19], v[68:71]
    v_mfma_f32_16x16x32_bf16 v[76:79], a[124:127], v[20:23], v[76:79]
    s_cmp_ge_u32 s27, 31
    s_cbranch_scc1 P_done
    s_waitcnt vmcnt(1)
    s_barrier
    ds_read_b128 v[8:11], v0 offset:32768
    ds_read_b128 v[12:15], v0 offset:49152
    s_mov_b32 s32, s26
    s_add_u32 s33, s26, 4096
    s_lshl_b32 s22, s17, 10
    s_add_u32 s22, s22, s26
    s_add_u32 s34, s22, 8192
    s_add_u32 s35, s26, 16384
    s_add_u32 s36, s26, 20480
    s_add_u32 s26, s26, 1572864
    s_add_u32 s27, s27, 1
    s_waitcnt lgkmcnt(0)
    v_mfma_f32_16x16x32_bf16 v[80:83], a[128:131], v[8:11], 0
    ds_read_b128 v[16:19], v0 offset:33792
    v_mfma_f32_16x16x32_bf16 v[88:91], a[128:131], v[12:15], 0
    ds_read_b128 v[20:23], v0 offset:50176
    v_mfma_f32_16x16x32_bf16 v[84:87], a[136:139], v[8:11], 0
    v_cvt_pk_bf16_f32 v32, v32, v33
    v_cvt_pk_bf16_f32 v33, v34, v35
    v_mfma_f32_16x16x32_bf16 v[92:95], a[136:139], v[12:15], 0
    v_cvt_pk_bf16_f32 v34, v36, v37
    v_cvt_pk_bf16_f32 v35, v38, v39
    v_mfma_f32_16x16x32_bf16 v[96:99], v[8:11], v[128:131], 0
    v_mfma_f32_16x16x32_bf16 v[104:107], v[12:15], v[128:131], 0
    buffer_store_dwordx4 v[32:35], v0, s[8:11], s32 offen sc1
    v_mfma_f32_16x16x32_bf16 v[100:103], v[8:11], v[136:139], 0
    v_mfma_f32_16x16x32_bf16 v[108:111], v[12:15], v[136:139], 0
    v_mfma_f32_16x16x32_bf16 v[112:115], a[0:3], v[8:11], 0
    v_mfma_f32_16x16x32_bf16 v[120:123], a[0:3], v[12:15], 0
    v_mfma_f32_16x16x32_bf16 v[116:119], a[8:11], v[8:11], 0
    v_mfma_f32_16x16x32_bf16 v[124:127], a[8:11], v[12:15], 0
    s_waitcnt lgkmcnt(0)
    v_mfma_f32_16x16x32_bf16 v[80:83], a[132:135], v[16:19], v[80:83]
    ds_read_b128 v[8:11], v0 offset:34816
    v_mfma_f32_16x16x32_bf16 v[88:91], a[132:135], v[20:23], v[88:91]
    ds_read_b128 v[12:15], v0 offset:51200
    v_mfma_f32_16x16x32_bf16 v[84:87], a[140:143], v[16:19], v[84:87]
    v_cvt_pk_bf16_f32 v40, v40, v41
    v_cvt_pk_bf16_f32 v41, v42, v43
    v_mfma_f32_16x16x32_bf16 v[92:95], a[140:143], v[20:23], v[92:95]
    v_cvt_pk_bf16_f32 v42, v44, v45
    v_cvt_pk_bf16_f32 v43, v46, v47
    v_mfma_f32_16x16x32_bf16 v[96:99], v[16:19], v[132:135], v[96:99]
    v_mfma_f32_16x16x32_bf16 v[104:107], v[20:23], v[132:135], v[104:107]
    buffer_store_dwordx4 v[40:43], v0, s[8:11], s33 offen sc1
    v_mfma_f32_16x16x32_bf16 v[100:103], v[16:19], v[140:143], v[100:103]
    v_mfma_f32_16x16x32_bf16 v[108:111], v[20:23], v[140:143], v[108:111]
    v_mfma_f32_16x16x32_bf16 v[112:115], a[4:7], v[16:19], v[112:115]
    v_mfma_f32_16x16x32_bf16 v[120:123], a[4:7], v[20:23], v[120:123]
    v_mfma_f32_16x16x32_bf16 v[116:119], a[12:15], v[16:19], v[116:119]
    v_mfma_f32_16x16x32_bf16 v[124:127], a[12:15], v[20:23], v[124:127]
    s_waitcnt lgkmcnt(0)
    v_mfma_f32_16x16x32_bf16 v[80:83], a[144:147], v[8:11], v[80:83]
    ds_read_b128 v[16:19], v0 offset:35840
    v_mfma_f32_16x16x32_bf16 v[88:91], a[144:147], v[12:15], v[88:91]
    ds_read_b128 v[20:23], v0 offset:52224
    v_mfma_f32_16x16x32_bf16 v[84:87], a[152:155], v[8:11], v[84:87]
    v_cvt_pk_bf16_f32 v48, v48, v49
    v_cvt_pk_bf16_f32 v49, v52, v53
    v_mfma_f32_16x16x32_bf16 v[92:95], a[152:155], v[12:15], v[92:95]
    v_cvt_pk_bf16_f32 v50, v50, v51
    v_cvt_pk_bf16_f32 v51, v54, v55
    v_mfma_f32_16x16x32_bf16 v[96:99], v[8:11], v[144:147], v[96:99]
    v_mfma_f32_16x16x32_bf16 v[104:107], v[12:15], v[144:147], v[104:107]
    buffer_store_dwordx4 v[48:51], v1, s[8:11], s34 offen offset:0 sc1
    v_mfma_f32_16x16x32_bf16 v[100:103], v[8:11], v[152:155], v[100:103]
    v_mfma_f32_16x16x32_bf16 v[108:111], v[12:15], v[152:155], v[108:111]
    v_mfma_f32_16x16x32_bf16 v[112:115], a[16:19], v[8:11], v[112:115]
    v_mfma_f32_16x16x32_bf16 v[120:123], a[16:19], v[12:15], v[120:123]
    v_mfma_f32_16x16x32_bf16 v[116:119], a[24:27], v[8:11], v[116:119]
    v_mfma_f32_16x16x32_bf16 v[124:127], a[24:27], v[12:15], v[124:127]
    s_waitcnt lgkmcnt(0)
    v_mfma_f32_16x16x32_bf16 v[80:83], a[148:151], v[16:19], v[80:83]
    ds_read_b128 v[8:11], v0 offset:36864
    v_mfma_f32_16x16x32_bf16 v[88:91], a[148:151], v[20:23], v[88:91]
    ds_read_b128 v[12:15], v0 offset:53248
    v_mfma_f32_16x16x32_bf16 v[84:87], a[156:159], v[16:19], v[84:87]
    v_cvt_pk_bf16_f32 v56, v56, v57
    v_cvt_pk_bf16_f32 v57, v60, v61
    v_mfma_f32_16x16x32_bf16 v[92:95], a[156:159], v[20:23], v[92:95]
    v_cvt_pk_bf16_f32 v58, v58, v59
    v_cvt_pk_bf16_f32 v59, v62, v63
    v_mfma_f32_16x16x32_bf16 v[96:99], v[16:19], v[148:151], v[96:99]
    v_mfma_f32_16x16x32_bf16 v[104:107], v[20:23], v[148:151], v[104:107]
    buffer_store_dwordx4 v[56:59], v1, s[8:11], s34 offen offset:256 sc1
    v_mfma_f32_16x16x32_bf16 v[100:103], v[16:19], v[156:159], v[100:103]
    v_mfma_f32_16x16x32_bf16 v[108:111], v[20:23], v[156:159], v[108:111]
    v_mfma_f32_16x16x32_bf16 v[112:115], a[20:23], v[16:19], v[112:115]
    v_mfma_f32_16x16x32_bf16 v[120:123], a[20:23], v[20:23], v[120:123]
    v_mfma_f32_16x16x32_bf16 v[116:119], a[28:31], v[16:19], v[116:119]
    v_mfma_f32_16x16x32_bf16 v[124:127], a[28:31], v[20:23], v[124:127]
    s_waitcnt lgkmcnt(0)
    v_mfma_f32_16x16x32_bf16 v[80:83], a[160:163], v[8:11], v[80:83]
    ds_read_b128 v[16:19], v0 offset:37888
    v_mfma_f32_16x16x32_bf16 v[88:91], a[160:163], v[12:15], v[88:91]
    ds_read_b128 v[20:23], v0 offset:54272
    v_mfma_f32_16x16x32_bf16 v[84:87], a[168:171], v[8:11], v[84:87]
    v_cvt_pk_bf16_f32 v64, v64, v65
    v_cvt_pk_bf16_f32 v65, v66, v67
    v_mfma_f32_16x16x32_bf16 v[92:95], a[168:171], v[12:15], v[92:95]
    v_cvt_pk_bf16_f32 v66, v68, v69
    v_cvt_pk_bf16_f32 v67, v70, v71
    v_mfma_f32_16x16x32_bf16 v[96:99], v[8:11], v[160:163], v[96:99]
    v_mfma_f32_16x16x32_bf16 v[104:107], v[12:15], v[160:163], v[104:107]
    buffer_store_dwordx4 v[64:67], v0, s[8:11], s35 offen sc1
    v_mfma_f32_16x16x32_bf16 v[100:103], v[8:11], v[168:171], v[100:103]
    v_mfma_f32_16x16x32_bf16 v[108:111], v[12:15], v[168:171], v[108:111]
    v_mfma_f32_16x16x32_bf16 v[112:115], a[32:35], v[8:11], v[112:115]
    v_mfma_f32_16x16x32_bf16 v[120:123], a[32:35], v[12:15], v[120:123]
    v_mfma_f32_16x16x32_bf16 v[116:119], a[40:43], v[8:11], v[116:119]
    v_mfma_f32_16x16x32_bf16 v[124:127], a[40:43], v[12:15], v[124:127]
    s_waitcnt lgkmcnt(0)
    v_mfma_f32_16x16x32_bf16 v[80:83], a[164:167], v[16:19], v[80:83]
    ds_read_b128 v[8:11], v0 offset:38912
    v_mfma_f32_16x16x32_bf16 v[88:91], a[164:167], v[20:23], v[88:91]
    ds_read_b128 v[12:15], v0 offset:55296
    v_mfma_f32_16x16x32_bf16 v[84:87], a[172:175], v[16:19], v[84:87]
    v_cvt_pk_bf16_f32 v72, v72, v73
    v_cvt_pk_bf16_f32 v73, v74, v75
    v_mfma_f32_16x16x32_bf16 v[92:95], a[172:175], v[20:23], v[92:95]
    v_cvt_pk_bf16_f32 v74, v76, v77
    v_cvt_pk_bf16_f32 v75, v78, v79
    v_mfma_f32_16x16x32_bf16 v[96:99], v[16:19], v[164:167], v[96:99]
    v_mfma_f32_16x16x32_bf16 v[104:107], v[20:23], v[164:167], v[104:107]
    buffer_store_dwordx4 v[72:75], v0, s[8:11], s36 offen sc1
    v_mfma_f32_16x16x32_bf16 v[100:103], v[16:19], v[172:175], v[100:103]
    v_mfma_f32_16x16x32_bf16 v[108:111], v[20:23], v[172:175], v[108:111]
    v_mfma_f32_16x16x32_bf16 v[112:115], a[36:39], v[16:19], v[112:115]
    v_mfma_f32_16x16x32_bf16 v[120:123], a[36:39], v[20:23], v[120:123]
    v_mfma_f32_16x16x32_bf16 v[116:119], a[44:47], v[16:19], v[116:119]
    v_mfma_f32_16x16x32_bf16 v[124:127], a[44:47], v[20:23], v[124:127]
    s_waitcnt lgkmcnt(0)
    v_mfma_f32_16x16x32_bf16 v[80:83], a[176:179], v[8:11], v[80:83]
    ds_read_b128 v[16:19], v0 offset:39936
    v_mfma_f32_16x16x32_bf16 v[88:91], a[176:179], v[12:15], v[88:91]
    ds_read_b128 v[20:23], v0 offset:56320
    v_mfma_f32_16x16x32_bf16 v[84:87], a[184:187], v[8:11], v[84:87]
    v_mfma_f32_16x16x32_bf16 v[92:95], a[184:187], v[12:15], v[92:95]
    s_add_u32 m0, s28, 0
    s_add_u32 s20, s25, 0
    buffer_load_dwordx4 v0, s[8:11], s20 offen offset:0 sc1 lds
    v_mfma_f32_16x16x32_bf16 v[96:99], v[8:11], v[176:179], v[96:99]
    v_mfma_f32_16x16x32_bf16 v[104:107], v[12:15], v[176:179], v[104:107]
    v_mfma_f32_16x16x32_bf16 v[100:103], v[8:11], v[184:187], v[100:103]
    v_mfma_f32_16x16x32_bf16 v[108:111], v[12:15], v[184:187], v[108:111]
    buffer_load_dwordx4 v0, s[8:11], s20 offen offset:1024 sc1 lds
    v_mfma_f32_16x16x32_bf16 v[112:115], a[48:51], v[8:11], v[112:115]
    v_mfma_f32_16x16x32_bf16 v[120:123], a[48:51], v[12:15], v[120:123]
    v_mfma_f32_16x16x32_bf16 v[116:119], a[56:59], v[8:11], v[116:119]
    v_mfma_f32_16x16x32_bf16 v[124:127], a[56:59], v[12:15], v[124:127]
    s_waitcnt lgkmcnt(0)
    v_mfma_f32_16x16x32_bf16 v[80:83], a[180:183], v[16:19], v[80:83]
    ds_read_b128 v[8:11], v0 offset:40960
    v_mfma_f32_16x16x32_bf16 v[88:91], a[180:183], v[20:23], v[88:91]
    ds_read_b128 v[12:15], v0 offset:57344
    v_mfma_f32_16x16x32_bf16 v[84:87], a[188:191], v[16:19], v[84:87]
    v_mfma_f32_16x16x32_bf16 v[92:95], a[188:191], v[20:23], v[92:95]
    buffer_load_dwordx4 v0, s[8:11], s20 offen offset:2048 sc1 lds
    v_mfma_f32_16x16x32_bf16 v[96:99], v[16:19], v[180:183], v[96:99]
    v_mfma_f32_16x16x32_bf16 v[104:107], v[20:23], v[180:183], v[104:107]
    v_mfma_f32_16x16x32_bf16 v[100:103], v[16:19], v[188:191], v[100:103]
    v_mfma_f32_16x16x32_bf16 v[108:111], v[20:23], v[188:191], v[108:111]
    buffer_load_dwordx4 v0, s[8:11], s20 offen offset:3072 sc1 lds
    v_mfma_f32_16x16x32_bf16 v[112:115], a[52:55], v[16:19], v[112:115]
    v_mfma_f32_16x16x32_bf16 v[120:123], a[52:55], v[20:23], v[120:123]
    v_mfma_f32_16x16x32_bf16 v[116:119], a[60:63], v[16:19], v[116:119]
    v_mfma_f32_16x16x32_bf16 v[124:127], a[60:63], v[20:23], v[124:127]
    s_waitcnt lgkmcnt(0)
    v_mfma_f32_16x16x32_bf16 v[80:83], a[192:195], v[8:11], v[80:83]
    ds_read_b128 v[16:19], v0 offset:41984
    v_mfma_f32_16x16x32_bf16 v[88:91], a[192:195], v[12:15], v[88:91]
    ds_read_b128 v[20:23], v0 offset:58368
    v_mfma_f32_16x16x32_bf16 v[84:87], a[200:203], v[8:11], v[84:87]
    v_mfma_f32_16x16x32_bf16 v[92:95], a[200:203], v[12:15], v[92:95]
    s_add_u32 m0, s28, 4096
    s_add_u32 s20, s25, 4096
    buffer_load_dwordx4 v0, s[8:11], s20 offen offset:0 sc1 lds
    v_mfma_f32_16x16x32_bf16 v[96:99], v[8:11], v[192:195], v[96:99]
    v_mfma_f32_16x16x32_bf16 v[104:107], v[12:15], v[192:195], v[104:107]
    v_mfma_f32_16x16x32_bf16 v[100:103], v[8:11], v[200:203], v[100:103]
    v_mfma_f32_16x16x32_bf16 v[108:111], v[12:15], v[200:203], v[108:111]
    buffer_load_dwordx4 v0, s[8:11], s20 offen offset:1024 sc1 lds
    v_mfma_f32_16x16x32_bf16 v[112:115], a[64:67], v[8:11], v[112:115]
    v_mfma_f32_16x16x32_bf16 v[120:123], a[64:67], v[12:15], v[120:123]
    v_mfma_f32_16x16x32_bf16 v[116:119], a[72:75], v[8:11], v[116:119]
    v_mfma_f32_16x16x32_bf16 v[124:127], a[72:75], v[12:15], v[124:127]
    s_waitcnt lgkmcnt(0)
    v_mfma_f32_16x16x32_bf16 v[80:83], a[196:199], v[16:19], v[80:83]
    ds_read_b128 v[8:11], v0 offset:43008
    v_mfma_f32_16x16x32_bf16 v[88:91], a[196:199], v[20:23], v[88:91]
    ds_read_b128 v[12:15], v0 offset:59392
    v_mfma_f32_16x16x32_bf16 v[84:87], a[204:207], v[16:19], v[84:87]
    v_mfma_f32_16x16x32_bf16 v[92:95], a[204:207], v[20:23], v[92:95]
    buffer_load_dwordx4 v0, s[8:11], s20 offen offset:2048 sc1 lds
    v_mfma_f32_16x16x32_bf16 v[96:99], v[16:19], v[196:199], v[96:99]
    v_mfma_f32_16x16x32_bf16 v[104:107], v[20:23], v[196:199], v[104:107]
    v_mfma_f32_16x16x32_bf16 v[100:103], v[16:19], v[204:207], v[100:103]
    v_mfma_f32_16x16x32_bf16 v[108:111], v[20:23], v[204:207], v[108:111]
    buffer_load_dwordx4 v0, s[8:11], s20 offen offset:3072 sc1 lds
    s_add_u32 s25, s25, 65536
    s_xor_b32 s28, s28, 32768
    v_mfma_f32_16x16x32_bf16 v[112:115], a[68:71], v[16:19], v[112:115]
    v_mfma_f32_16x16x32_bf16 v[120:123], a[68:71], v[20:23], v[120:123]
    v_mfma_f32_16x16x32_bf16 v[116:119], a[76:79], v[16:19], v[116:119]
    v_mfma_f32_16x16x32_bf16 v[124:127], a[76:79], v[20:23], v[124:127]
    s_waitcnt lgkmcnt(0)
    v_mfma_f32_16x16x32_bf16 v[80:83], a[208:211], v[8:11], v[80:83]
    ds_read_b128 v[16:19], v0 offset:44032
    v_mfma_f32_16x16x32_bf16 v[88:91], a[208:211], v[12:15], v[88:91]
    ds_read_b128 v[20:23], v0 offset:60416
    v_mfma_f32_16x16x32_bf16 v[84:87], a[216:219], v[8:11], v[84:87]
    v_mfma_f32_16x16x32_bf16 v[92:95], a[216:219], v[12:15], v[92:95]
    v_mfma_f32_16x16x32_bf16 v[96:99], v[8:11], v[208:211], v[96:99]
    v_mfma_f32_16x16x32_bf16 v[104:107], v[12:15], v[208:211], v[104:107]
    v_mfma_f32_16x16x32_bf16 v[100:103], v[8:11], v[216:219], v[100:103]
    v_mfma_f32_16x16x32_bf16 v[108:111], v[12:15], v[216:219], v[108:111]
    v_mfma_f32_16x16x32_bf16 v[112:115], a[80:83], v[8:11], v[112:115]
    v_mfma_f32_16x16x32_bf16 v[120:123], a[80:83], v[12:15], v[120:123]
    v_mfma_f32_16x16x32_bf16 v[116:119], a[88:91], v[8:11], v[116:119]
    v_mfma_f32_16x16x32_bf16 v[124:127], a[88:91], v[12:15], v[124:127]
    s_waitcnt lgkmcnt(0)
    v_mfma_f32_16x16x32_bf16 v[80:83], a[212:215], v[16:19], v[80:83]
    ds_read_b128 v[8:11], v0 offset:45056
    v_mfma_f32_16x16x32_bf16 v[88:91], a[212:215], v[20:23], v[88:91]
    ds_read_b128 v[12:15], v0 offset:61440
    v_mfma_f32_16x16x32_bf16 v[84:87], a[220:223], v[16:19], v[84:87]
    v_mfma_f32_16x16x32_bf16 v[92:95], a[220:223], v[20:23], v[92:95]
    v_mfma_f32_16x16x32_bf16 v[96:99], v[16:19], v[212:215], v[96:99]
    v_mfma_f32_16x16x32_bf16 v[104:107], v[20:23], v[212:215], v[104:107]
    v_mfma_f32_16x16x32_bf16 v[100:103], v[16:19], v[220:223], v[100:103]
    v_mfma_f32_16x16x32_bf16 v[108:111], v[20:23], v[220:223], v[108:111]
    v_mfma_f32_16x16x32_bf16 v[112:115], a[84:87], v[16:19], v[112:115]
    v_mfma_f32_16x16x32_bf16 v[120:123], a[84:87], v[20:23], v[120:123]
    v_mfma_f32_16x16x32_bf16 v[116:119], a[92:95], v[16:19], v[116:119]
    v_mfma_f32_16x16x32_bf16 v[124:127], a[92:95], v[20:23], v[124:127]
    s_waitcnt lgkmcnt(0)
    v_mfma_f32_16x16x32_bf16 v[80:83], a[224:227], v[8:11], v[80:83]
    ds_read_b128 v[16:19], v0 offset:46080
    v_mfma_f32_16x16x32_bf16 v[88:91], a[224:227], v[12:15], v[88:91]
    ds_read_b128 v[20:23], v0 offset:62464
    v_mfma_f32_16x16x32_bf16 v[84:87], a[232:235], v[8:11], v[84:87]
    v_mfma_f32_16x16x32_bf16 v[92:95], a[232:235], v[12:15], v[92:95]
    v_mfma_f32_16x16x32_bf16 v[96:99], v[8:11], v[224:227], v[96:99]
    v_mfma_f32_16x16x32_bf16 v[104:107], v[12:15], v[224:227], v[104:107]
    v_mfma_f32_16x16x32_bf16 v[100:103], v[8:11], v[232:235], v[100:103]
    v_mfma_f32_16x16x32_bf16 v[108:111], v[12:15], v[232:235], v[108:111]
    v_mfma_f32_16x16x32_bf16 v[112:115], a[96:99], v[8:11], v[112:115]
    v_mfma_f32_16x16x32_bf16 v[120:123], a[96:99], v[12:15], v[120:123]
    v_mfma_f32_16x16x32_bf16 v[116:119], a[104:107], v[8:11], v[116:119]
    v_mfma_f32_16x16x32_bf16 v[124:127], a[104:107], v[12:15], v[124:127]
    s_waitcnt lgkmcnt(0)
    v_mfma_f32_16x16x32_bf16 v[80:83], a[228:231], v[16:19], v[80:83]
    ds_read_b128 v[8:11], v0 offset:47104
    v_mfma_f32_16x16x32_bf16 v[88:91], a[228:231], v[20:23], v[88:91]
    ds_read_b128 v[12:15], v0 offset:63488
    v_mfma_f32_16x16x32_bf16 v[84:87], a[236:239], v[16:19], v[84:87]
    v_mfma_f32_16x16x32_bf16 v[92:95], a[236:239], v[20:23], v[92:95]
    v_mfma_f32_16x16x32_bf16 v[96:99], v[16:19], v[228:231], v[96:99]
    v_mfma_f32_16x16x32_bf16 v[104:107], v[20:23], v[228:231], v[104:107]
    v_mfma_f32_16x16x32_bf16 v[100:103], v[16:19], v[236:239], v[100:103]
    v_mfma_f32_16x16x32_bf16 v[108:111], v[20:23], v[236:239], v[108:111]
    v_mfma_f32_16x16x32_bf16 v[112:115], a[100:103], v[16:19], v[112:115]
    v_mfma_f32_16x16x32_bf16 v[120:123], a[100:103], v[20:23], v[120:123]
    v_mfma_f32_16x16x32_bf16 v[116:119], a[108:111], v[16:19], v[116:119]
    v_mfma_f32_16x16x32_bf16 v[124:127], a[108:111], v[20:23], v[124:127]
    s_waitcnt lgkmcnt(0)
    v_mfma_f32_16x16x32_bf16 v[80:83], a[240:243], v[8:11], v[80:83]
    ds_read_b128 v[16:19], v0 offset:48128
    v_mfma_f32_16x16x32_bf16 v[88:91], a[240:243], v[12:15], v[88:91]
    ds_read_b128 v[20:23], v0 offset:64512
    v_mfma_f32_16x16x32_bf16 v[84:87], a[248:251], v[8:11], v[84:87]
    v_mfma_f32_16x16x32_bf16 v[92:95], a[248:251], v[12:15], v[92:95]
    v_mfma_f32_16x16x32_bf16 v[96:99], v[8:11], v[240:243], v[96:99]
    v_mfma_f32_16x16x32_bf16 v[104:107], v[12:15], v[240:243], v[104:107]
    v_mfma_f32_16x16x32_bf16 v[100:103], v[8:11], v[248:251], v[100:103]
    v_mfma_f32_16x16x32_bf16 v[108:111], v[12:15], v[248:251], v[108:111]
    v_mfma_f32_16x16x32_bf16 v[112:115], a[112:115], v[8:11], v[112:115]
    v_mfma_f32_16x16x32_bf16 v[120:123], a[112:115], v[12:15], v[120:123]
    v_mfma_f32_16x16x32_bf16 v[116:119], a[120:123], v[8:11], v[116:119]
    v_mfma_f32_16x16x32_bf16 v[124:127], a[120:123], v[12:15], v[124:127]
    s_waitcnt lgkmcnt(0)
    v_mfma_f32_16x16x32_bf16 v[80:83], a[244:247], v[16:19], v[80:83]
    v_mfma_f32_16x16x32_bf16 v[88:91], a[244:247], v[20:23], v[88:91]
    v_mfma_f32_16x16x32_bf16 v[84:87], a[252:255], v[16:19], v[84:87]
    v_mfma_f32_16x16x32_bf16 v[92:95], a[252:255], v[20:23], v[92:95]
    s_waitcnt vmcnt(8)
    v_mov_b32 v3, s27
    v_mfma_f32_16x16x32_bf16 v[96:99], v[16:19], v[244:247], v[96:99]
    v_mfma_f32_16x16x32_bf16 v[104:107], v[20:23], v[244:247], v[104:107]
    buffer_store_dword v3, v2, s[8:11], s29 offen sc1
    v_mfma_f32_16x16x32_bf16 v[100:103], v[16:19], v[252:255], v[100:103]
    v_mfma_f32_16x16x32_bf16 v[108:111], v[20:23], v[252:255], v[108:111]
    v_mfma_f32_16x16x32_bf16 v[112:115], a[116:119], v[16:19], v[112:115]
    v_mfma_f32_16x16x32_bf16 v[120:123], a[116:119], v[20:23], v[120:123]
    v_mfma_f32_16x16x32_bf16 v[116:119], a[124:127], v[16:19], v[116:119]
    v_mfma_f32_16x16x32_bf16 v[124:127], a[124:127], v[20:23], v[124:127]
    s_branch P_loop
P_done:
    s_mov_b32 s32, s26
    s_add_u32 s33, s26, 4096
    s_lshl_b32 s22, s17, 10
    s_add_u32 s22, s22, s26
    s_add_u32 s34, s22, 8192
    s_add_u32 s35, s26, 16384
    s_add_u32 s36, s26, 20480
    s_add_u32 s26, s26, 1572864
    s_add_u32 s27, s27, 1
    v_cvt_pk_bf16_f32 v32, v32, v33
    v_cvt_pk_bf16_f32 v33, v34, v35
    v_cvt_pk_bf16_f32 v34, v36, v37
    v_cvt_pk_bf16_f32 v35, v38, v39
    buffer_store_dwordx4 v[32:35], v0, s[8:11], s32 offen sc1
    v_cvt_pk_bf16_f32 v40, v40, v41
    v_cvt_pk_bf16_f32 v41, v42, v43
    v_cvt_pk_bf16_f32 v42, v44, v45
    v_cvt_pk_bf16_f32 v43, v46, v47
    buffer_store_dwordx4 v[40:43], v0, s[8:11], s33 offen sc1
    v_cvt_pk_bf16_f32 v48, v48, v49
    v_cvt_pk_bf16_f32 v49, v52, v53
    v_cvt_pk_bf16_f32 v50, v50, v51
    v_cvt_pk_bf16_f32 v51, v54, v55
    buffer_store_dwordx4 v[48:51], v1, s[8:11], s34 offen offset:0 sc1
    v_cvt_pk_bf16_f32 v56, v56, v57
    v_cvt_pk_bf16_f32 v57, v60, v61
    v_cvt_pk_bf16_f32 v58, v58, v59
    v_cvt_pk_bf16_f32 v59, v62, v63
    buffer_store_dwordx4 v[56:59], v1, s[8:11], s34 offen offset:256 sc1
    v_cvt_pk_bf16_f32 v64, v64, v65
    v_cvt_pk_bf16_f32 v65, v66, v67
    v_cvt_pk_bf16_f32 v66, v68, v69
    v_cvt_pk_bf16_f32 v67, v70, v71
    buffer_store_dwordx4 v[64:67], v0, s[8:11], s35 offen sc1
    v_cvt_pk_bf16_f32 v72, v72, v73
    v_cvt_pk_bf16_f32 v73, v74, v75
    v_cvt_pk_bf16_f32 v74, v76, v77
    v_cvt_pk_bf16_f32 v75, v78, v79
    buffer_store_dwordx4 v[72:75], v0, s[8:11], s36 offen sc1
    v_mov_b32 v3, s27
    s_waitcnt vmcnt(0)
    buffer_store_dword v3, v2, s[8:11], s29 offen sc1
    s_branch P_conv
P_conv:
    s_waitcnt vmcnt(0) lgkmcnt(0)
    s_barrier
    s_add_u32 s24, s19, 32
    s_add_u32 s19, s19, 4
    s_mov_b32 s25, 0
    s_mul_i32 s21, s24, 786432
    s_mul_i32 s22, s16, 24576
    s_add_u32 s21, s21, s22
    s_add_u32 s26, s21, 2097152
    s_mul_i32 s21, s24, 131072
    s_lshl_b32 s22, s16, 12
    s_add_u32 s21, s21, s22
    s_add_u32 s27, s21, 52559872
    s_mul_i32 s21, s19, 4194304
    s_lshl_b32 s22, s17, 8
    s_add_u32 s21, s21, s22
    s_add_u32 s21, s21, 67108864
    s_lshl_b32 s22, s16, 10
    s_add_u32 s28, s21, s22
    s_mul_i32 s22, s16, 32896
    s_add_u32 s29, s21, s22
    s_lshl_b32 s21, s19, 15
    s_lshl_b32 s22, s17, 12
    s_add_u32 s21, s21, s22
    s_add_u32 s31, s21, 92274688
    s_lshr_b32 s21, s16, 4
    s_lshl_b32 s21, s21, 14
    s_and_b32 s22, s16, 15
    s_lshl_b32 s22, s22, 7
    s_add_u32 s21, s21, s22
    s_add_u32 s30, s31, s21
    s_mul_i32 s21, s19, 2048
    s_lshl_b32 s22, s17, 7
    s_add_u32 s21, s21, s22
    s_add_u32 s33, s21, 65093632
    s_lshl_b32 s22, s16, 2
    s_add_u32 s32, s33, s22
    s_lshl_b32 s21, s16, 7
    s_add_u32 s34, s21, 65077248
    s_add_u32 s35, s21, 65085440
    s_lshl_b32 s21, s24, 5
    s_add_u32 s21, s21, s16
    s_lshl_b32 s21, s21, 10
    s_lshl_b32 s22, s17, 8
    s_add_u32 s36, s21, s22
    s_mov_b32 s38, 1040356334
    s_mov_b32 s39, 1040356334
    s_mov_b32 s44, s64
    s_mov_b32 s45, s65
    s_mov_b32 s46, 2097152
    s_mov_b32 s47, 0x00020000
    s_mov_b32 s48, s86
    s_mov_b32 s49, s87
    s_mov_b32 s50, 2097152
    s_mov_b32 s51, 0x00020000
    v_mbcnt_lo_u32_b32 v0, -1, 0
    v_mbcnt_hi_u32_b32 v0, -1, v0
    v_xor_b32 v28, 0, v0
    v_lshlrev_b32 v16, 4, v28
    v_xor_b32 v28, 4, v0
    v_lshlrev_b32 v17, 4, v28
    v_xor_b32 v28, 8, v0
    v_lshlrev_b32 v18, 4, v28
    v_xor_b32 v28, 12, v0
    v_lshlrev_b32 v19, 4, v28
    v_lshrrev_b32 v28, 2, v0
    v_and_b32 v29, 3, v28
    v_lshlrev_b32 v29, 2, v29
    v_and_b32 v30, 3, v0
    v_add_u32 v29, v29, v30
    s_lshl_b32 s21, s17, 4
    v_add_u32 v29, s21, v29
    v_lshlrev_b32 v28, 10, v28
    v_lshl_add_u32 v20, v29, 4, v28
    v_add_u32 v21, 0x10000, v20
    v_lshrrev_b32 v28, 3, v0
    v_mul_u32_u24 v28, 3584, v28
    v_and_b32 v29, 7, v0
    v_bfe_u32 v30, v0, 4, 1
    v_lshlrev_b32 v30, 1, v30
    v_xor_b32 v29, v29, v30
    v_lshl_add_u32 v22, v29, 4, v28
    v_xor_b32 v29, 4, v29
    v_lshl_add_u32 v23, v29, 4, v28
    v_lshrrev_b32 v28, 4, v0
    v_lshlrev_b32 v28, 3, v28
    v_bfe_u32 v29, v0, 2, 2
    v_add_u32 v28, v28, v29
    v_lshlrev_b32 v28, 7, v28
    v_bfe_u32 v29, v0, 3, 2
    v_lshlrev_b32 v29, 1, v29
    v_bfe_u32 v30, v0, 1, 1
    s_lshl_b32 s21, s17, 1
    v_add_u32 v30, s21, v30
    v_xor_b32 v29, v29, v30
    v_lshl_add_u32 v28, v29, 4, v28
    v_and_b32 v29, 1, v0
    v_lshl_add_u32 v24, v29, 3, v28
    v_add_u32 v25, 0x10000, v24
    s_branch C_load
L_R:
    v_lshrrev_b32 v28, 4, v0
    v_and_b32 v29, 15, v0
    v_and_b32 v30, 1, v28
    v_lshlrev_b32 v30, 1, v30
    v_xor_b32 v29, v29, v30
    v_lshlrev_b32 v28, 13, v28
    v_xor_b32 v30, 0, v29
    v_lshl_add_u32 v30, v30, 4, v28
    v_add_u32 v16, 0, v30
    v_xor_b32 v30, 4, v29
    v_lshl_add_u32 v30, v30, 4, v28
    v_add_u32 v17, 31744, v30
    v_xor_b32 v30, 8, v29
    v_lshl_add_u32 v30, v30, 4, v28
    v_add_u32 v18, 63488, v30
    v_xor_b32 v30, 12, v29
    v_lshl_add_u32 v30, v30, 4, v28
    v_add_u32 v19, 95232, v30
    v_lshrrev_b32 v28, 5, v0
    v_lshlrev_b32 v28, 4, v28
    v_bfe_u32 v29, v0, 4, 1
    v_lshl_add_u32 v28, v29, 2, v28
    v_bfe_u32 v30, v0, 2, 1
    v_add_u32 v28, v28, v30
    v_bfe_u32 v31, v0, 3, 1
    v_lshl_add_u32 v28, v31, 3, v28
    v_lshl_add_u32 v30, v29, 1, v30
    v_lshl_add_u32 v30, v31, 2, v30
    v_lshlrev_b32 v30, 1, v30
    v_bfe_u32 v29, v0, 1, 1
    s_lshl_b32 s21, s17, 2
    v_add_u32 v29, s21, v29
    v_xor_b32 v29, v29, v30
    v_lshlrev_b32 v28, 8, v28
    v_and_b32 v31, 1, v0
    v_lshl_add_u32 v28, v31, 3, v28
    v_lshl_add_u32 v20, v29, 4, v28
    v_xor_b32 v21, 32, v20
    v_add_u32 v22, 0x10000, v20
    v_add_u32 v23, 0x10000, v21
    s_mov_b32 s12, s70
    s_mov_b32 s13, s71
    s_mov_b32 s14, 4194304
    s_mov_b32 s15, 0x00020000
    s_lshl_b32 s21, s17, 18
    s_lshl_b32 s22, s16, 8
    s_add_u32 s21, s21, s22
    s_add_u32 s20, s21, 0
    s_lshl_b32 s21, s17, 13
    s_add_u32 m0, s21, 0
    s_nop 0
    buffer_load_dwordx4 v16, s[12:15], s20 offen offset:0  lds
    buffer_load_dwordx4 v17, s[12:15], s20 offen offset:1024  lds
    buffer_load_dwordx4 v18, s[12:15], s20 offen offset:2048  lds
    buffer_load_dwordx4 v19, s[12:15], s20 offen offset:3072  lds
    s_lshl_b32 s21, s17, 18
    s_lshl_b32 s22, s16, 8
    s_add_u32 s21, s21, s22
    s_add_u32 s20, s21, 131072
    s_lshl_b32 s21, s17, 13
    s_add_u32 m0, s21, 4096
    s_nop 0
    buffer_load_dwordx4 v16, s[12:15], s20 offen offset:0  lds
    buffer_load_dwordx4 v17, s[12:15], s20 offen offset:1024  lds
    buffer_load_dwordx4 v18, s[12:15], s20 offen offset:2048  lds
    buffer_load_dwordx4 v19, s[12:15], s20 offen offset:3072  lds
    s_mov_b32 s12, s70
    s_mov_b32 s13, s71
    s_mov_b32 s14, 4194304
    s_mov_b32 s15, 0x00020000
    s_lshl_b32 s21, s17, 18
    s_lshl_b32 s22, s16, 8
    s_add_u32 s21, s21, s22
    s_add_u32 s20, s21, 1048576
    s_lshl_b32 s21, s17, 13
    s_add_u32 m0, s21, 32768
    s_nop 0
    buffer_load_dwordx4 v16, s[12:15], s20 offen offset:0  lds
    buffer_load_dwordx4 v17, s[12:15], s20 offen offset:1024  lds
    buffer_load_dwordx4 v18, s[12:15], s20 offen offset:2048  lds
    buffer_load_dwordx4 v19, s[12:15], s20 offen offset:3072  lds
    s_lshl_b32 s21, s17, 18
    s_lshl_b32 s22, s16, 8
    s_add_u32 s21, s21, s22
    s_add_u32 s20, s21, 1179648
    s_lshl_b32 s21, s17, 13
    s_add_u32 m0, s21, 36864
    s_nop 0
    buffer_load_dwordx4 v16, s[12:15], s20 offen offset:0  lds
    buffer_load_dwordx4 v17, s[12:15], s20 offen offset:1024  lds
    buffer_load_dwordx4 v18, s[12:15], s20 offen offset:2048  lds
    buffer_load_dwordx4 v19, s[12:15], s20 offen offset:3072  lds
    s_mov_b32 s12, s70
    s_mov_b32 s13, s71
    s_mov_b32 s14, 4194304
    s_mov_b32 s15, 0x00020000
    s_lshl_b32 s21, s17, 18
    s_lshl_b32 s22, s16, 8
    s_add_u32 s21, s21, s22
    s_add_u32 s20, s21, 2097152
    s_lshl_b32 s21, s17, 13
    s_add_u32 m0, s21, 65536
    s_nop 0
    buffer_load_dwordx4 v16, s[12:15], s20 offen offset:0  lds
    buffer_load_dwordx4 v17, s[12:15], s20 offen offset:1024  lds
    buffer_load_dwordx4 v18, s[12:15], s20 offen offset:2048  lds
    buffer_load_dwordx4 v19, s[12:15], s20 offen offset:3072  lds
    s_lshl_b32 s21, s17, 18
    s_lshl_b32 s22, s16, 8
    s_add_u32 s21, s21, s22
    s_add_u32 s20, s21, 2228224
    s_lshl_b32 s21, s17, 13
    s_add_u32 m0, s21, 69632
    s_nop 0
    buffer_load_dwordx4 v16, s[12:15], s20 offen offset:0  lds
    buffer_load_dwordx4 v17, s[12:15], s20 offen offset:1024  lds
    buffer_load_dwordx4 v18, s[12:15], s20 offen offset:2048  lds
    buffer_load_dwordx4 v19, s[12:15], s20 offen offset:3072  lds
    s_lshr_b32 s21, s17, 1
    s_lshl_b32 s21, s21, 3
    v_xor_b32 v28, s21, v0
    v_lshlrev_b32 v24, 4, v28
    v_xor_b32 v25, 64, v24
    v_bfe_u32 v29, v0, 4, 1
    v_lshrrev_b32 v28, 5, v0
    v_lshlrev_b32 v28, 2, v28
    v_lshl_add_u32 v28, v29, 4, v28
    v_bfe_u32 v30, v0, 2, 1
    v_add_u32 v28, v28, v30
    v_lshl_add_u32 v30, v29, 1, v30
    v_lshlrev_b32 v30, 2, v30
    v_bfe_u32 v29, v0, 3, 1
    v_bfe_u32 v31, v0, 1, 1
    v_lshl_add_u32 v29, v29, 1, v31
    s_lshl_b32 s21, s17, 2
    v_add_u32 v29, s21, v29
    v_xor_b32 v29, v29, v30
    v_lshlrev_b32 v28, 10, v28
    v_and_b32 v31, 1, v0
    v_lshl_add_u32 v28, v31, 3, v28
    v_lshl_add_u32 v26, v29, 4, v28
    v_add_u32 v27, 0x10000, v26
    v_mov_b32 v15, v0
    v_lshrrev_b32 v12, 3, v15
    s_lshl_b32 s21, s17, 3
    v_add_u32 v12, s21, v12
    v_mul_u32_u24 v12, 8320, v12
    v_and_b32 v13, 7, v15
    v_lshl_add_u32 v12, v13, 3, v12
    s_lshl_b32 s21, s16, 6
    v_add_u32 v3, s21, v12
    v_lshrrev_b32 v12, 4, v15
    v_lshlrev_b32 v12, 2, v12
    v_and_b32 v13, 3, v15
    v_lshl_add_u32 v12, v13, 5, v12
    v_and_b32 v13, 12, v15
    v_cmp_eq_u32 vcc, 0, v13
    v_mov_b32 v14, 2147483392
    s_nop 0
    v_cndmask_b32 v4, v14, v12, vcc
    v_and_b32 v14, 15, v15
    v_lshlrev_b32 v14, 3, v14
    v_add_u32 v14, 155648, v14
    v_bfe_u32 v12, v15, 4, 1
    v_mul_u32_u24 v13, 1088, v12
    v_add_u32 v5, v13, v14
    v_lshrrev_b32 v13, 5, v15
    v_lshl_add_u32 v5, v13, 9, v5
    s_lshl_b32 s21, s17, 7
    v_add_u32 v14, s21, v14
    v_mul_u32_u24 v13, 1088, v13
    v_lshl_add_u32 v13, v12, 2, v13
    v_add_u32 v9, v13, v14
    v_lshrrev_b32 v13, 4, v15
    v_mul_u32_u24 v13, 1088, v13
    v_add_u32 v10, v13, v14
    v_and_b32 v12, 1, v15
    v_mul_u32_u24 v12, 1088, v12
    v_lshrrev_b32 v13, 2, v15
    v_lshl_add_u32 v12, v13, 3, v12
    v_add_u32 v6, 155648, v12
    v_and_b32 v12, 3, v15
    v_lshlrev_b32 v7, 2, v12
    v_and_b32 v12, 1, v15
    v_mul_u32_u24 v12, 0xaaaa, v12
    v_bfe_u32 v13, v15, 3, 1
    v_mul_u32_u24 v13, 0xaaaa, v13
    v_lshl_add_u32 v12, v13, 16, v12
    v_add_u32 v8, 0x44444444, v12
    s_mov_b32 s78, 0xff00ff00
    s_mov_b32 s79, 0xff00ff00
    s_mov_b32 s60, 0xcccccccc
    s_mov_b32 s61, 0xcccccccc
    v_lshlrev_b32 v0, 4, v15
    v_add_u32 v1, 0x10000, v0
    v_add_u32 v2, 0x20000, v0
    v_and_b32 v11, 15, v15
    v_and_b32 v12, 1, v11
    v_lshlrev_b32 v12, 4, v12
    v_mov_b32 v13, 0x3f80
    v_lshlrev_b32 v14, v12, v13
    v_lshrrev_b32 v11, 1, v11
    v_cmp_eq_u32 vcc, 0, v11
    s_nop 1
    v_cndmask_b32 v32, 0, v14, vcc
    v_cmp_eq_u32 vcc, 1, v11
    s_nop 1
    v_cndmask_b32 v33, 0, v14, vcc
    v_cmp_eq_u32 vcc, 2, v11
    s_nop 1
    v_cndmask_b32 v34, 0, v14, vcc
    v_cmp_eq_u32 vcc, 3, v11
    s_nop 1
    v_cndmask_b32 v35, 0, v14, vcc
    ds_write_b128 v2, v[32:35] offset:31232
    s_mov_b32 s24, 0
    s_mov_b32 s28, 62914560
    s_mov_b32 s29, 62916608
    s_mov_b32 s30, 62918656
    s_mov_b32 s31, 62920704
    s_mul_i32 s21, s16, 8320
    s_lshl_b32 s22, s17, 11
    s_add_u32 s21, s21, s22
    s_add_u32 s32, s21, 62914560
    s_lshl_b32 s21, s17, 11
    s_add_u32 s33, s21, 65011712
    s_lshr_b32 s22, s16, 2
    s_lshl_b32 s22, s22, 8
    s_add_u32 s21, s21, s22
    s_and_b32 s22, s16, 1
    s_lshl_b32 s22, s22, 4
    s_add_u32 s21, s21, s22
    s_and_b32 s22, s16, 2
    s_lshl_b32 s22, s22, 6
    s_add_u32 s21, s21, s22
    s_add_u32 s34, s21, 65019904
    s_add_u32 s35, s21, 65011712
    s_mul_i32 s21, s16, 24576
    s_lshl_b32 s22, s17, 11
    s_add_u32 s21, s21, s22
    s_add_u32 s36, s21, 2097152
    s_add_u32 s42, s21, 2105344
    s_add_u32 s43, s22, 131072
    s_lshl_b32 s21, s16, 12
    s_lshl_b32 s22, s17, 10
    s_add_u32 s21, s21, s22
    s_add_u32 s37, s21, 52428800
    s_lshl_b32 s21, s16, 7
    s_add_u32 s92, s21, 65077248
    s_add_u32 s93, s21, 65085440
    s_mov_b32 s94, 0
    s_mov_b32 s38, 0
    s_mov_b32 s40, 1040356334
    s_mov_b32 s41, 1040356334
    s_mov_b32 s45, 0xfffefffe
    s_mov_b32 s26, 0x3f803f80
    s_mov_b32 s27, 0x3f803f80
    s_waitcnt vmcnt(24)
    s_barrier
    s_mov_b32 s98, 0
    s_cmp_lg_u32 s17, 0
    s_cbranch_scc1 R_arr_skip
    s_and_b32 s96, s3, 3
    s_lshl_b32 s96, s96, 6
    s_lshl_b32 s97, s23, 2
    s_add_u32 s96, s96, s97
    s_add_u32 s96, s96, 32
    s_mov_b32 s98, 1
    s_atomic_add s98, s[88:89], s96 glc
R_arr_skip:
    s_mov_b32 s12, s66
    s_mov_b32 s13, s67
    s_mov_b32 s14, 8192
    s_mov_b32 s15, 0x00020000
    v_lshrrev_b32 v12, 4, v0
    v_bfe_u32 v13, v12, 1, 3
    v_lshlrev_b32 v13, 10, v13
    v_and_b32 v14, 1, v12
    v_lshl_add_u32 v13, v14, 4, v13
    v_lshrrev_b32 v12, 4, v12
    v_lshl_add_u32 v12, v12, 5, v13
    s_lshl_b32 s21, s17, 8
    buffer_load_dwordx4 v[64:67], v12, s[12:15], s21 offen offset:0
    buffer_load_dwordx4 v[68:71], v12, s[12:15], s21 offen offset:128
    s_waitcnt lgkmcnt(0)
    s_cmp_lg_u32 s98, 63
    s_cbranch_scc1 R_arr_done
    s_lshl_b32 s97, s23, 2
    s_add_u32 s96, s97, 40
    s_mov_b32 s98, 1
    s_atomic_add s98, s[88:89], s96 glc
    s_waitcnt lgkmcnt(0)
    s_cmp_lg_u32 s98, 3
    s_cbranch_scc1 R_arr_done
    v_mbcnt_lo_u32_b32 v126, -1, 0
    v_mbcnt_hi_u32_b32 v126, -1, v126
    s_mov_b32 s98, 3
    s_cmp_lg_u32 s23, 0
    s_cbranch_scc1 R_arr_tell
    v_lshlrev_b32 v125, 2, v126
    v_mov_b32 v127, 0
    buffer_atomic_add v127, v125, s[4:7], 0 offen sc0
    s_waitcnt vmcnt(0)
    v_cmp_ne_u32 vcc, 32, v127
    s_nop 0
    s_and_b32 s96, vcc_lo, 196609
    s_and_b32 s97, vcc_hi, 458755
    s_or_b32 s96, s96, s97
    s_cselect_b32 s98, 2, 1
R_arr_tell:
    v_lshlrev_b32 v126, 7, v126
    v_mov_b32 v127, s98
    s_mov_b32 s96, 65110016
    buffer_store_dword v127, v126, s[8:11], s96 offen sc1
    s_mov_b32 s96, 65118208
    buffer_store_dword v127, v126, s[8:11], s96 offen sc1
    s_mov_b32 s96, 65126400
    buffer_store_dword v127, v126, s[8:11], s96 offen sc1
    s_mov_b32 s96, 65134592
    buffer_store_dword v127, v126, s[8:11], s96 offen sc1
R_arr_done:
    s_waitcnt vmcnt(18)
    s_barrier
    s_mov_b32 s12, s70
    s_mov_b32 s13, s71
    s_mov_b32 s14, 4194304
    s_mov_b32 s15, 0x00020000
    s_lshl_b32 s21, s17, 18
    s_lshl_b32 s22, s16, 8
    s_add_u32 s21, s21, s22
    s_add_u32 s20, s21, 3145728
    s_lshl_b32 s21, s17, 13
    s_add_u32 m0, s21, 98304
    s_nop 0
    buffer_load_dwordx4 v16, s[12:15], s20 offen offset:0  lds
    buffer_load_dwordx4 v17, s[12:15], s20 offen offset:1024  lds
    buffer_load_dwordx4 v18, s[12:15], s20 offen offset:2048  lds
    buffer_load_dwordx4 v19, s[12:15], s20 offen offset:3072  lds
    s_lshl_b32 s21, s17, 18
    s_lshl_b32 s22, s16, 8
    s_add_u32 s21, s21, s22
    s_add_u32 s20, s21, 3276800
    s_lshl_b32 s21, s17, 13
    s_add_u32 m0, s21, 102400
    s_nop 0
    buffer_load_dwordx4 v16, s[12:15], s20 offen offset:0  lds
    buffer_load_dwordx4 v17, s[12:15], s20 offen offset:1024  lds
    buffer_load_dwordx4 v18, s[12:15], s20 offen offset:2048  lds
    buffer_load_dwordx4 v19, s[12:15], s20 offen offset:3072  lds
    ds_read_b64_tr_b16 a[128:129], v20 offset:0
    ds_read_b64_tr_b16 a[130:131], v20 offset:512
    ds_read_b64_tr_b16 a[132:133], v20 offset:8192
    ds_read_b64_tr_b16 a[134:135], v20 offset:8704
    ds_read_b64_tr_b16 a[136:137], v21 offset:0
    ds_read_b64_tr_b16 a[138:139], v21 offset:512
    ds_read_b64_tr_b16 a[140:141], v21 offset:8192
    ds_read_b64_tr_b16 a[142:143], v21 offset:8704
    ds_read_b64_tr_b16 a[144:145], v20 offset:16384
    ds_read_b64_tr_b16 a[146:147], v20 offset:16896
    ds_read_b64_tr_b16 a[148:149], v20 offset:24576
    ds_read_b64_tr_b16 a[150:151], v20 offset:25088
    ds_read_b64_tr_b16 a[152:153], v21 offset:16384
    ds_read_b64_tr_b16 a[154:155], v21 offset:16896
    ds_read_b64_tr_b16 a[156:157], v21 offset:24576
    ds_read_b64_tr_b16 a[158:159], v21 offset:25088
    s_waitcnt lgkmcnt(0)
    s_waitcnt vmcnt(18)
    s_barrier
    s_mov_b32 s12, s72
    s_mov_b32 s13, s73
    s_mov_b32 s14, 4194304
    s_mov_b32 s15, 0x00020000
    s_lshl_b32 s21, s17, 18
    s_lshl_b32 s22, s16, 8
    s_add_u32 s21, s21, s22
    s_add_u32 s20, s21, 0
    s_lshl_b32 s21, s17, 13
    s_add_u32 m0, s21, 0
    s_nop 0
    buffer_load_dwordx4 v16, s[12:15], s20 offen offset:0  lds
    buffer_load_dwordx4 v17, s[12:15], s20 offen offset:1024  lds
    buffer_load_dwordx4 v18, s[12:15], s20 offen offset:2048  lds
    buffer_load_dwordx4 v19, s[12:15], s20 offen offset:3072  lds
    s_lshl_b32 s21, s17, 18
    s_lshl_b32 s22, s16, 8
    s_add_u32 s21, s21, s22
    s_add_u32 s20, s21, 131072
    s_lshl_b32 s21, s17, 13
    s_add_u32 m0, s21, 4096
    s_nop 0
    buffer_load_dwordx4 v16, s[12:15], s20 offen offset:0  lds
    buffer_load_dwordx4 v17, s[12:15], s20 offen offset:1024  lds
    buffer_load_dwordx4 v18, s[12:15], s20 offen offset:2048  lds
    buffer_load_dwordx4 v19, s[12:15], s20 offen offset:3072  lds
    ds_read_b64_tr_b16 a[160:161], v20 offset:32768
    ds_read_b64_tr_b16 a[162:163], v20 offset:33280
    ds_read_b64_tr_b16 a[164:165], v20 offset:40960
    ds_read_b64_tr_b16 a[166:167], v20 offset:41472
    ds_read_b64_tr_b16 a[168:169], v21 offset:32768
    ds_read_b64_tr_b16 a[170:171], v21 offset:33280
    ds_read_b64_tr_b16 a[172:173], v21 offset:40960
    ds_read_b64_tr_b16 a[174:175], v21 offset:41472
    ds_read_b64_tr_b16 a[176:177], v20 offset:49152
    ds_read_b64_tr_b16 a[178:179], v20 offset:49664
    ds_read_b64_tr_b16 a[180:181], v20 offset:57344
    ds_read_b64_tr_b16 a[182:183], v20 offset:57856
    ds_read_b64_tr_b16 a[184:185], v21 offset:49152
    ds_read_b64_tr_b16 a[186:187], v21 offset:49664
    ds_read_b64_tr_b16 a[188:189], v21 offset:57344
    ds_read_b64_tr_b16 a[190:191], v21 offset:57856
    s_waitcnt lgkmcnt(0)
    s_waitcnt vmcnt(18)
    s_barrier
    s_mov_b32 s12, s72
    s_mov_b32 s13, s73
    s_mov_b32 s14, 4194304
    s_mov_b32 s15, 0x00020000
    s_lshl_b32 s21, s17, 18
    s_lshl_b32 s22, s16, 8
    s_add_u32 s21, s21, s22
    s_add_u32 s20, s21, 1048576
    s_lshl_b32 s21, s17, 13
    s_add_u32 m0, s21, 32768
    s_nop 0
    buffer_load_dwordx4 v16, s[12:15], s20 offen offset:0  lds
    buffer_load_dwordx4 v17, s[12:15], s20 offen offset:1024  lds
    buffer_load_dwordx4 v18, s[12:15], s20 offen offset:2048  lds
    buffer_load_dwordx4 v19, s[12:15], s20 offen offset:3072  lds
    s_lshl_b32 s21, s17, 18
    s_lshl_b32 s22, s16, 8
    s_add_u32 s21, s21, s22
    s_add_u32 s20, s21, 1179648
    s_lshl_b32 s21, s17, 13
    s_add_u32 m0, s21, 36864
    s_nop 0
    buffer_load_dwordx4 v16, s[12:15], s20 offen offset:0  lds
    buffer_load_dwordx4 v17, s[12:15], s20 offen offset:1024  lds
    buffer_load_dwordx4 v18, s[12:15], s20 offen offset:2048  lds
    buffer_load_dwordx4 v19, s[12:15], s20 offen offset:3072  lds
    ds_read_b64_tr_b16 a[192:193], v22 offset:0
    ds_read_b64_tr_b16 a[194:195], v22 offset:512
    ds_read_b64_tr_b16 a[196:197], v22 offset:8192
    ds_read_b64_tr_b16 a[198:199], v22 offset:8704
    ds_read_b64_tr_b16 a[200:201], v23 offset:0
    ds_read_b64_tr_b16 a[202:203], v23 offset:512
    ds_read_b64_tr_b16 a[204:205], v23 offset:8192
    ds_read_b64_tr_b16 a[206:207], v23 offset:8704
    ds_read_b64_tr_b16 a[208:209], v22 offset:16384
    ds_read_b64_tr_b16 a[210:211], v22 offset:16896
    ds_read_b64_tr_b16 a[212:213], v22 offset:24576
    ds_read_b64_tr_b16 a[214:215], v22 offset:25088
    ds_read_b64_tr_b16 a[216:217], v23 offset:16384
    ds_read_b64_tr_b16 a[218:219], v23 offset:16896
    ds_read_b64_tr_b16 a[220:221], v23 offset:24576
    ds_read_b64_tr_b16 a[222:223], v23 offset:25088
    s_waitcnt lgkmcnt(0)
    s_waitcnt vmcnt(16)
    s_barrier
    s_mov_b32 s12, s72
    s_mov_b32 s13, s73
    s_mov_b32 s14, 4194304
    s_mov_b32 s15, 0x00020000
    s_lshl_b32 s21, s17, 18
    s_lshl_b32 s22, s16, 8
    s_add_u32 s21, s21, s22
    s_add_u32 s20, s21, 2097152
    s_lshl_b32 s21, s17, 13
    s_add_u32 m0, s21, 65536
    s_nop 0
    buffer_load_dwordx4 v16, s[12:15], s20 offen offset:0  lds
    buffer_load_dwordx4 v17, s[12:15], s20 offen offset:1024  lds
    buffer_load_dwordx4 v18, s[12:15], s20 offen offset:2048  lds
    buffer_load_dwordx4 v19, s[12:15], s20 offen offset:3072  lds
    s_lshl_b32 s21, s17, 18
    s_lshl_b32 s22, s16, 8
    s_add_u32 s21, s21, s22
    s_add_u32 s20, s21, 2228224
    s_lshl_b32 s21, s17, 13
    s_add_u32 m0, s21, 69632
    s_nop 0
    buffer_load_dwordx4 v16, s[12:15], s20 offen offset:0  lds
    buffer_load_dwordx4 v17, s[12:15], s20 offen offset:1024  lds
    buffer_load_dwordx4 v18, s[12:15], s20 offen offset:2048  lds
    buffer_load_dwordx4 v19, s[12:15], s20 offen offset:3072  lds
    ds_read_b64_tr_b16 a[224:225], v22 offset:32768
    ds_read_b64_tr_b16 a[226:227], v22 offset:33280
    ds_read_b64_tr_b16 a[228:229], v22 offset:40960
    ds_read_b64_tr_b16 a[230:231], v22 offset:41472
    ds_read_b64_tr_b16 a[232:233], v23 offset:32768
    ds_read_b64_tr_b16 a[234:235], v23 offset:33280
    ds_read_b64_tr_b16 a[236:237], v23 offset:40960
    ds_read_b64_tr_b16 a[238:239], v23 offset:41472
    ds_read_b64_tr_b16 a[240:241], v22 offset:49152
    ds_read_b64_tr_b16 a[242:243], v22 offset:49664
    ds_read_b64_tr_b16 a[244:245], v22 offset:57344
    ds_read_b64_tr_b16 a[246:247], v22 offset:57856
    ds_read_b64_tr_b16 a[248:249], v23 offset:49152
    ds_read_b64_tr_b16 a[250:251], v23 offset:49664
    ds_read_b64_tr_b16 a[252:253], v23 offset:57344
    ds_read_b64_tr_b16 a[254:255], v23 offset:57856
    s_waitcnt lgkmcnt(0)
    s_waitcnt vmcnt(16)
    s_barrier
    s_mov_b32 s12, s72
    s_mov_b32 s13, s73
    s_mov_b32 s14, 4194304
    s_mov_b32 s15, 0x00020000
    s_lshl_b32 s21, s17, 18
    s_lshl_b32 s22, s16, 8
    s_add_u32 s21, s21, s22
    s_add_u32 s20, s21, 3145728
    s_lshl_b32 s21, s17, 13
    s_add_u32 m0, s21, 98304
    s_nop 0
    buffer_load_dwordx4 v16, s[12:15], s20 offen offset:0  lds
    buffer_load_dwordx4 v17, s[12:15], s20 offen offset:1024  lds
    buffer_load_dwordx4 v18, s[12:15], s20 offen offset:2048  lds
    buffer_load_dwordx4 v19, s[12:15], s20 offen offset:3072  lds
    s_lshl_b32 s21, s17, 18
    s_lshl_b32 s22, s16, 8
    s_add_u32 s21, s21, s22
    s_add_u32 s20, s21, 3276800
    s_lshl_b32 s21, s17, 13
    s_add_u32 m0, s21, 102400
    s_nop 0
    buffer_load_dwordx4 v16, s[12:15], s20 offen offset:0  lds
    buffer_load_dwordx4 v17, s[12:15], s20 offen offset:1024  lds
    buffer_load_dwordx4 v18, s[12:15], s20 offen offset:2048  lds
    buffer_load_dwordx4 v19, s[12:15], s20 offen offset:3072  lds
    ds_read_b64_tr_b16 v[128:129], v20 offset:0
    ds_read_b64_tr_b16 v[130:131], v20 offset:512
    ds_read_b64_tr_b16 v[132:133], v20 offset:8192
    ds_read_b64_tr_b16 v[134:135], v20 offset:8704
    ds_read_b64_tr_b16 v[136:137], v21 offset:0
    ds_read_b64_tr_b16 v[138:139], v21 offset:512
    ds_read_b64_tr_b16 v[140:141], v21 offset:8192
    ds_read_b64_tr_b16 v[142:143], v21 offset:8704
    ds_read_b64_tr_b16 v[144:145], v20 offset:16384
    ds_read_b64_tr_b16 v[146:147], v20 offset:16896
    ds_read_b64_tr_b16 v[148:149], v20 offset:24576
    ds_read_b64_tr_b16 v[150:151], v20 offset:25088
    ds_read_b64_tr_b16 v[152:153], v21 offset:16384
    ds_read_b64_tr_b16 v[154:155], v21 offset:16896
    ds_read_b64_tr_b16 v[156:157], v21 offset:24576
    ds_read_b64_tr_b16 v[158:159], v21 offset:25088
    s_waitcnt lgkmcnt(0)
    s_waitcnt vmcnt(16)
    s_barrier
    s_mov_b32 s12, s68
    s_mov_b32 s13, s69
    s_mov_b32 s14, 4194304
    s_mov_b32 s15, 0x00020000
    s_lshl_b32 s21, s17, 18
    s_lshl_b32 s22, s16, 8
    s_add_u32 s21, s21, s22
    s_add_u32 s20, s21, 0
    s_lshl_b32 s21, s17, 13
    s_add_u32 m0, s21, 0
    s_nop 0
    buffer_load_dwordx4 v16, s[12:15], s20 offen offset:0  lds
    buffer_load_dwordx4 v17, s[12:15], s20 offen offset:1024  lds
    buffer_load_dwordx4 v18, s[12:15], s20 offen offset:2048  lds
    buffer_load_dwordx4 v19, s[12:15], s20 offen offset:3072  lds
    s_lshl_b32 s21, s17, 18
    s_lshl_b32 s22, s16, 8
    s_add_u32 s21, s21, s22
    s_add_u32 s20, s21, 131072
    s_lshl_b32 s21, s17, 13
    s_add_u32 m0, s21, 4096
    s_nop 0
    buffer_load_dwordx4 v16, s[12:15], s20 offen offset:0  lds
    buffer_load_dwordx4 v17, s[12:15], s20 offen offset:1024  lds
    buffer_load_dwordx4 v18, s[12:15], s20 offen offset:2048  lds
    buffer_load_dwordx4 v19, s[12:15], s20 offen offset:3072  lds
    ds_read_b64_tr_b16 v[160:161], v20 offset:32768
    ds_read_b64_tr_b16 v[162:163], v20 offset:33280
    ds_read_b64_tr_b16 v[164:165], v20 offset:40960
    ds_read_b64_tr_b16 v[166:167], v20 offset:41472
    ds_read_b64_tr_b16 v[168:169], v21 offset:32768
    ds_read_b64_tr_b16 v[170:171], v21 offset:33280
    ds_read_b64_tr_b16 v[172:173], v21 offset:40960
    ds_read_b64_tr_b16 v[174:175], v21 offset:41472
    ds_read_b64_tr_b16 v[176:177], v20 offset:49152
    ds_read_b64_tr_b16 v[178:179], v20 offset:49664
    ds_read_b64_tr_b16 v[180:181], v20 offset:57344
    ds_read_b64_tr_b16 v[182:183], v20 offset:57856
    ds_read_b64_tr_b16 v[184:185], v21 offset:49152
    ds_read_b64_tr_b16 v[186:187], v21 offset:49664
    ds_read_b64_tr_b16 v[188:189], v21 offset:57344
    ds_read_b64_tr_b16 v[190:191], v21 offset:57856
    s_waitcnt lgkmcnt(0)
    s_waitcnt vmcnt(16)
    s_barrier
    s_mov_b32 s12, s68
    s_mov_b32 s13, s69
    s_mov_b32 s14, 4194304
    s_mov_b32 s15, 0x00020000
    s_lshl_b32 s21, s17, 18
    s_lshl_b32 s22, s16, 8
    s_add_u32 s21, s21, s22
    s_add_u32 s20, s21, 1048576
    s_lshl_b32 s21, s17, 13
    s_add_u32 m0, s21, 32768
    s_nop 0
    buffer_load_dwordx4 v16, s[12:15], s20 offen offset:0  lds
    buffer_load_dwordx4 v17, s[12:15], s20 offen offset:1024  lds
    buffer_load_dwordx4 v18, s[12:15], s20 offen offset:2048  lds
    buffer_load_dwordx4 v19, s[12:15], s20 offen offset:3072  lds
    s_lshl_b32 s21, s17, 18
    s_lshl_b32 s22, s16, 8
    s_add_u32 s21, s21, s22
    s_add_u32 s20, s21, 1179648
    s_lshl_b32 s21, s17, 13
    s_add_u32 m0, s21, 36864
    s_nop 0
    buffer_load_dwordx4 v16, s[12:15], s20 offen offset:0  lds
    buffer_load_dwordx4 v17, s[12:15], s20 offen offset:1024  lds
    buffer_load_dwordx4 v18, s[12:15], s20 offen offset:2048  lds
    buffer_load_dwordx4 v19, s[12:15], s20 offen offset:3072  lds
    ds_read_b64_tr_b16 v[192:193], v22 offset:0
    ds_read_b64_tr_b16 v[194:195], v22 offset:512
    ds_read_b64_tr_b16 v[196:197], v22 offset:8192
    ds_read_b64_tr_b16 v[198:199], v22 offset:8704
    ds_read_b64_tr_b16 v[200:201], v23 offset:0
    ds_read_b64_tr_b16 v[202:203], v23 offset:512
    ds_read_b64_tr_b16 v[204:205], v23 offset:8192
    ds_read_b64_tr_b16 v[206:207], v23 offset:8704
    ds_read_b64_tr_b16 v[208:209], v22 offset:16384
    ds_read_b64_tr_b16 v[210:211], v22 offset:16896
    ds_read_b64_tr_b16 v[212:213], v22 offset:24576
    ds_read_b64_tr_b16 v[214:215], v22 offset:25088
    ds_read_b64_tr_b16 v[216:217], v23 offset:16384
    ds_read_b64_tr_b16 v[218:219], v23 offset:16896
    ds_read_b64_tr_b16 v[220:221], v23 offset:24576
    ds_read_b64_tr_b16 v[222:223], v23 offset:25088
    s_waitcnt lgkmcnt(0)
    s_waitcnt vmcnt(16)
    s_barrier
    s_mov_b32 s12, s74
    s_mov_b32 s13, s75
    s_mov_b32 s14, 4194304
    s_mov_b32 s15, 0x00020000
    s_lshl_b32 s21, s17, 13
    s_lshl_b32 s22, s16, 17
    s_add_u32 s22, s21, s22
    s_add_u32 s20, s22, 0
    s_add_u32 m0, s21, 65536
    s_nop 0
    buffer_load_dwordx4 v24, s[12:15], s20 offen offset:0  lds
    buffer_load_dwordx4 v25, s[12:15], s20 offen offset:1024  lds
    buffer_load_dwordx4 v24, s[12:15], s20 offen offset:2048  lds
    buffer_load_dwordx4 v25, s[12:15], s20 offen offset:3072  lds
    s_lshl_b32 s21, s17, 13
    s_lshl_b32 s22, s16, 17
    s_add_u32 s22, s21, s22
    s_add_u32 s20, s22, 4096
    s_add_u32 m0, s21, 69632
    s_nop 0
    buffer_load_dwordx4 v24, s[12:15], s20 offen offset:0  lds
    buffer_load_dwordx4 v25, s[12:15], s20 offen offset:1024  lds
    buffer_load_dwordx4 v24, s[12:15], s20 offen offset:2048  lds
    buffer_load_dwordx4 v25, s[12:15], s20 offen offset:3072  lds
    ds_read_b64_tr_b16 v[224:225], v22 offset:32768
    ds_read_b64_tr_b16 v[226:227], v22 offset:33280
    ds_read_b64_tr_b16 v[228:229], v22 offset:40960
    ds_read_b64_tr_b16 v[230:231], v22 offset:41472
    ds_read_b64_tr_b16 v[232:233], v23 offset:32768
    ds_read_b64_tr_b16 v[234:235], v23 offset:33280
    ds_read_b64_tr_b16 v[236:237], v23 offset:40960
    ds_read_b64_tr_b16 v[238:239], v23 offset:41472
    ds_read_b64_tr_b16 v[240:241], v22 offset:49152
    ds_read_b64_tr_b16 v[242:243], v22 offset:49664
    ds_read_b64_tr_b16 v[244:245], v22 offset:57344
    ds_read_b64_tr_b16 v[246:247], v22 offset:57856
    ds_read_b64_tr_b16 v[248:249], v23 offset:49152
    ds_read_b64_tr_b16 v[250:251], v23 offset:49664
    ds_read_b64_tr_b16 v[252:253], v23 offset:57344
    ds_read_b64_tr_b16 v[254:255], v23 offset:57856
    s_waitcnt lgkmcnt(0)
    s_waitcnt vmcnt(16)
    s_barrier
    s_mov_b32 s12, s74
    s_mov_b32 s13, s75
    s_mov_b32 s14, 4194304
    s_mov_b32 s15, 0x00020000
    s_lshl_b32 s21, s17, 13
    s_lshl_b32 s22, s16, 17
    s_add_u32 s22, s21, s22
    s_add_u32 s20, s22, 32768
    s_add_u32 m0, s21, 98304
    s_nop 0
    buffer_load_dwordx4 v24, s[12:15], s20 offen offset:0  lds
    buffer_load_dwordx4 v25, s[12:15], s20 offen offset:1024  lds
    buffer_load_dwordx4 v24, s[12:15], s20 offen offset:2048  lds
    buffer_load_dwordx4 v25, s[12:15], s20 offen offset:3072  lds
    s_lshl_b32 s21, s17, 13
    s_lshl_b32 s22, s16, 17
    s_add_u32 s22, s21, s22
    s_add_u32 s20, s22, 36864
    s_add_u32 m0, s21, 102400
    s_nop 0
    buffer_load_dwordx4 v24, s[12:15], s20 offen offset:0  lds
    buffer_load_dwordx4 v25, s[12:15], s20 offen offset:1024  lds
    buffer_load_dwordx4 v24, s[12:15], s20 offen offset:2048  lds
    buffer_load_dwordx4 v25, s[12:15], s20 offen offset:3072  lds
    ds_read_b64_tr_b16 a[0:1], v20 offset:0
    ds_read_b64_tr_b16 a[2:3], v20 offset:512
    ds_read_b64_tr_b16 a[4:5], v20 offset:8192
    ds_read_b64_tr_b16 a[6:7], v20 offset:8704
    ds_read_b64_tr_b16 a[8:9], v21 offset:0
    ds_read_b64_tr_b16 a[10:11], v21 offset:512
    ds_read_b64_tr_b16 a[12:13], v21 offset:8192
    ds_read_b64_tr_b16 a[14:15], v21 offset:8704
    ds_read_b64_tr_b16 a[16:17], v20 offset:16384
    ds_read_b64_tr_b16 a[18:19], v20 offset:16896
    ds_read_b64_tr_b16 a[20:21], v20 offset:24576
    ds_read_b64_tr_b16 a[22:23], v20 offset:25088
    ds_read_b64_tr_b16 a[24:25], v21 offset:16384
    ds_read_b64_tr_b16 a[26:27], v21 offset:16896
    ds_read_b64_tr_b16 a[28:29], v21 offset:24576
    ds_read_b64_tr_b16 a[30:31], v21 offset:25088
    s_waitcnt lgkmcnt(0)
    s_waitcnt vmcnt(16)
    s_barrier
    s_mov_b32 s12, s68
    s_mov_b32 s13, s69
    s_mov_b32 s14, 4194304
    s_mov_b32 s15, 0x00020000
    s_lshl_b32 s21, s17, 18
    s_lshl_b32 s22, s16, 8
    s_add_u32 s21, s21, s22
    s_add_u32 s20, s21, 2097152
    s_lshl_b32 s21, s17, 13
    s_add_u32 m0, s21, 0
    s_nop 0
    buffer_load_dwordx4 v16, s[12:15], s20 offen offset:0  lds
    buffer_load_dwordx4 v17, s[12:15], s20 offen offset:1024  lds
    buffer_load_dwordx4 v18, s[12:15], s20 offen offset:2048  lds
    buffer_load_dwordx4 v19, s[12:15], s20 offen offset:3072  lds
    s_lshl_b32 s21, s17, 18
    s_lshl_b32 s22, s16, 8
    s_add_u32 s21, s21, s22
    s_add_u32 s20, s21, 2228224
    s_lshl_b32 s21, s17, 13
    s_add_u32 m0, s21, 4096
    s_nop 0
    buffer_load_dwordx4 v16, s[12:15], s20 offen offset:0  lds
    buffer_load_dwordx4 v17, s[12:15], s20 offen offset:1024  lds
    buffer_load_dwordx4 v18, s[12:15], s20 offen offset:2048  lds
    buffer_load_dwordx4 v19, s[12:15], s20 offen offset:3072  lds
    ds_read_b64_tr_b16 a[32:33], v20 offset:32768
    ds_read_b64_tr_b16 a[34:35], v20 offset:33280
    ds_read_b64_tr_b16 a[36:37], v20 offset:40960
    ds_read_b64_tr_b16 a[38:39], v20 offset:41472
    ds_read_b64_tr_b16 a[40:41], v21 offset:32768
    ds_read_b64_tr_b16 a[42:43], v21 offset:33280
    ds_read_b64_tr_b16 a[44:45], v21 offset:40960
    ds_read_b64_tr_b16 a[46:47], v21 offset:41472
    ds_read_b64_tr_b16 a[48:49], v20 offset:49152
    ds_read_b64_tr_b16 a[50:51], v20 offset:49664
    ds_read_b64_tr_b16 a[52:53], v20 offset:57344
    ds_read_b64_tr_b16 a[54:55], v20 offset:57856
    ds_read_b64_tr_b16 a[56:57], v21 offset:49152
    ds_read_b64_tr_b16 a[58:59], v21 offset:49664
    ds_read_b64_tr_b16 a[60:61], v21 offset:57344
    ds_read_b64_tr_b16 a[62:63], v21 offset:57856
    s_waitcnt lgkmcnt(0)
    s_waitcnt vmcnt(16)
    s_barrier
    s_mov_b32 s12, s68
    s_mov_b32 s13, s69
    s_mov_b32 s14, 4194304
    s_mov_b32 s15, 0x00020000
    s_lshl_b32 s21, s17, 18
    s_lshl_b32 s22, s16, 8
    s_add_u32 s21, s21, s22
    s_add_u32 s20, s21, 3145728
    s_lshl_b32 s21, s17, 13
    s_add_u32 m0, s21, 32768
    s_nop 0
    buffer_load_dwordx4 v16, s[12:15], s20 offen offset:0  lds
    buffer_load_dwordx4 v17, s[12:15], s20 offen offset:1024  lds
    buffer_load_dwordx4 v18, s[12:15], s20 offen offset:2048  lds
    buffer_load_dwordx4 v19, s[12:15], s20 offen offset:3072  lds
    s_lshl_b32 s21, s17, 18
    s_lshl_b32 s22, s16, 8
    s_add_u32 s21, s21, s22
    s_add_u32 s20, s21, 3276800
    s_lshl_b32 s21, s17, 13
    s_add_u32 m0, s21, 36864
    s_nop 0
    buffer_load_dwordx4 v16, s[12:15], s20 offen offset:0  lds
    buffer_load_dwordx4 v17, s[12:15], s20 offen offset:1024  lds
    buffer_load_dwordx4 v18, s[12:15], s20 offen offset:2048  lds
    buffer_load_dwordx4 v19, s[12:15], s20 offen offset:3072  lds
    ds_read_b64_tr_b16 a[64:65], v27 offset:0
    ds_read_b64_tr_b16 a[66:67], v27 offset:2048
    ds_read_b64_tr_b16 a[68:69], v27 offset:8192
    ds_read_b64_tr_b16 a[70:71], v27 offset:10240
    ds_read_b64_tr_b16 a[72:73], v27 offset:256
    ds_read_b64_tr_b16 a[74:75], v27 offset:2304
    ds_read_b64_tr_b16 a[76:77], v27 offset:8448
    ds_read_b64_tr_b16 a[78:79], v27 offset:10496
    ds_read_b64_tr_b16 a[80:81], v27 offset:512
    ds_read_b64_tr_b16 a[82:83], v27 offset:2560
    ds_read_b64_tr_b16 a[84:85], v27 offset:8704
    ds_read_b64_tr_b16 a[86:87], v27 offset:10752
    ds_read_b64_tr_b16 a[88:89], v27 offset:768
    ds_read_b64_tr_b16 a[90:91], v27 offset:2816
    ds_read_b64_tr_b16 a[92:93], v27 offset:8960
    ds_read_b64_tr_b16 a[94:95], v27 offset:11008
    s_waitcnt lgkmcnt(0)
    s_waitcnt vmcnt(16)
    s_barrier
    s_mov_b32 s12, s74
    s_mov_b32 s13, s75
    s_mov_b32 s14, 4194304
    s_mov_b32 s15, 0x00020000
    s_lshl_b32 s21, s17, 13
    s_lshl_b32 s22, s16, 17
    s_add_u32 s22, s21, s22
    s_add_u32 s20, s22, 65536
    s_add_u32 m0, s21, 65536
    s_nop 0
    buffer_load_dwordx4 v24, s[12:15], s20 offen offset:0  lds
    buffer_load_dwordx4 v25, s[12:15], s20 offen offset:1024  lds
    buffer_load_dwordx4 v24, s[12:15], s20 offen offset:2048  lds
    buffer_load_dwordx4 v25, s[12:15], s20 offen offset:3072  lds
    s_lshl_b32 s21, s17, 13
    s_lshl_b32 s22, s16, 17
    s_add_u32 s22, s21, s22
    s_add_u32 s20, s22, 69632
    s_add_u32 m0, s21, 69632
    s_nop 0
    buffer_load_dwordx4 v24, s[12:15], s20 offen offset:0  lds
    buffer_load_dwordx4 v25, s[12:15], s20 offen offset:1024  lds
    buffer_load_dwordx4 v24, s[12:15], s20 offen offset:2048  lds
    buffer_load_dwordx4 v25, s[12:15], s20 offen offset:3072  lds
    ds_read_b64_tr_b16 a[96:97], v27 offset:32768
    ds_read_b64_tr_b16 a[98:99], v27 offset:34816
    ds_read_b64_tr_b16 a[100:101], v27 offset:40960
    ds_read_b64_tr_b16 a[102:103], v27 offset:43008
    ds_read_b64_tr_b16 a[104:105], v27 offset:33024
    ds_read_b64_tr_b16 a[106:107], v27 offset:35072
    ds_read_b64_tr_b16 a[108:109], v27 offset:41216
    ds_read_b64_tr_b16 a[110:111], v27 offset:43264
    ds_read_b64_tr_b16 a[112:113], v27 offset:33280
    ds_read_b64_tr_b16 a[114:115], v27 offset:35328
    ds_read_b64_tr_b16 a[116:117], v27 offset:41472
    ds_read_b64_tr_b16 a[118:119], v27 offset:43520
    ds_read_b64_tr_b16 a[120:121], v27 offset:33536
    ds_read_b64_tr_b16 a[122:123], v27 offset:35584
    ds_read_b64_tr_b16 a[124:125], v27 offset:41728
    ds_read_b64_tr_b16 a[126:127], v27 offset:43776
    s_waitcnt lgkmcnt(0)
    s_waitcnt vmcnt(16)
    s_barrier
    s_mov_b32 s12, s74
    s_mov_b32 s13, s75
    s_mov_b32 s14, 4194304
    s_mov_b32 s15, 0x00020000
    s_lshl_b32 s21, s17, 13
    s_lshl_b32 s22, s16, 17
    s_add_u32 s22, s21, s22
    s_add_u32 s20, s22, 98304
    s_add_u32 m0, s21, 98304
    s_nop 0
    buffer_load_dwordx4 v24, s[12:15], s20 offen offset:0  lds
    buffer_load_dwordx4 v25, s[12:15], s20 offen offset:1024  lds
    buffer_load_dwordx4 v24, s[12:15], s20 offen offset:2048  lds
    buffer_load_dwordx4 v25, s[12:15], s20 offen offset:3072  lds
    s_lshl_b32 s21, s17, 13
    s_lshl_b32 s22, s16, 17
    s_add_u32 s22, s21, s22
    s_add_u32 s20, s22, 102400
    s_add_u32 m0, s21, 102400
    s_nop 0
    buffer_load_dwordx4 v24, s[12:15], s20 offen offset:0  lds
    buffer_load_dwordx4 v25, s[12:15], s20 offen offset:1024  lds
    buffer_load_dwordx4 v24, s[12:15], s20 offen offset:2048  lds
    buffer_load_dwordx4 v25, s[12:15], s20 offen offset:3072  lds
    ds_read_b64_tr_b16 v[32:33], v20 offset:0
    ds_read_b64_tr_b16 v[34:35], v20 offset:512
    ds_read_b64_tr_b16 v[36:37], v20 offset:8192
    ds_read_b64_tr_b16 v[38:39], v20 offset:8704
    ds_read_b64_tr_b16 v[40:41], v21 offset:0
    ds_read_b64_tr_b16 v[42:43], v21 offset:512
    ds_read_b64_tr_b16 v[44:45], v21 offset:8192
    ds_read_b64_tr_b16 v[46:47], v21 offset:8704
    ds_read_b64_tr_b16 v[48:49], v20 offset:16384
    ds_read_b64_tr_b16 v[50:51], v20 offset:16896
    ds_read_b64_tr_b16 v[52:53], v20 offset:24576
    ds_read_b64_tr_b16 v[54:55], v20 offset:25088
    ds_read_b64_tr_b16 v[56:57], v21 offset:16384
    ds_read_b64_tr_b16 v[58:59], v21 offset:16896
    ds_read_b64_tr_b16 v[60:61], v21 offset:24576
    ds_read_b64_tr_b16 v[62:63], v21 offset:25088
    s_waitcnt lgkmcnt(0)
    s_barrier
    s_lshl_b32 s21, s17, 13
    v_add_u32 v28, s21, v0
    ds_write_b128 v28, v[32:35] offset:0
    ds_write_b128 v28, v[36:39] offset:1024
    ds_write_b128 v28, v[40:43] offset:2048
    ds_write_b128 v28, v[44:47] offset:3072
    ds_write_b128 v28, v[48:51] offset:4096
    ds_write_b128 v28, v[52:55] offset:5120
    ds_write_b128 v28, v[56:59] offset:6144
    ds_write_b128 v28, v[60:63] offset:7168
    s_lshl_b32 s96, s3, 7
    s_add_u32 s96, s96, 65110016
    s_load_dword s77, s[90:91], s96 glc
    s_waitcnt vmcnt(16)
    s_barrier
    ds_read_b64_tr_b16 v[32:33], v20 offset:32768
    ds_read_b64_tr_b16 v[34:35], v20 offset:33280
    ds_read_b64_tr_b16 v[36:37], v20 offset:40960
    ds_read_b64_tr_b16 v[38:39], v20 offset:41472
    ds_read_b64_tr_b16 v[40:41], v21 offset:32768
    ds_read_b64_tr_b16 v[42:43], v21 offset:33280
    ds_read_b64_tr_b16 v[44:45], v21 offset:40960
    ds_read_b64_tr_b16 v[46:47], v21 offset:41472
    ds_read_b64_tr_b16 v[48:49], v20 offset:49152
    ds_read_b64_tr_b16 v[50:51], v20 offset:49664
    ds_read_b64_tr_b16 v[52:53], v20 offset:57344
    ds_read_b64_tr_b16 v[54:55], v20 offset:57856
    ds_read_b64_tr_b16 v[56:57], v21 offset:49152
    ds_read_b64_tr_b16 v[58:59], v21 offset:49664
    ds_read_b64_tr_b16 v[60:61], v21 offset:57344
    ds_read_b64_tr_b16 v[62:63], v21 offset:57856
    s_waitcnt lgkmcnt(0)
    s_barrier
    s_lshl_b32 s21, s17, 13
    v_add_u32 v28, s21, v0
    ds_write_b128 v28, v[32:35] offset:32768
    ds_write_b128 v28, v[36:39] offset:33792
    ds_write_b128 v28, v[40:43] offset:34816
    ds_write_b128 v28, v[44:47] offset:35840
    ds_write_b128 v28, v[48:51] offset:36864
    ds_write_b128 v28, v[52:55] offset:37888
    ds_write_b128 v28, v[56:59] offset:38912
    ds_write_b128 v28, v[60:63] offset:39936
    s_lshl_b32 s97, s23, 1
    s_add_u32 s97, s97, 1
    s_cmp_eq_u32 s77, s97
    s_cbranch_scc0 R_nowarm
    s_add_u32 s21, s32, 0
    buffer_load_dwordx4 v[96:99], v0, s[8:11], s21 offen offset:0 sc1
    buffer_load_dwordx4 v[100:103], v0, s[8:11], s21 offen offset:1024 sc1
    s_xor_b32 s21, s33, 0
    buffer_load_dwordx4 v[72:75], v0, s[8:11], s21 offen offset:0 sc1
    buffer_load_dwordx4 v[76:79], v0, s[8:11], s21 offen offset:1024 sc1
    s_add_u32 s21, s32, 1048576
    buffer_load_dwordx4 v[104:107], v0, s[8:11], s21 offen offset:0 sc1
    buffer_load_dwordx4 v[108:111], v0, s[8:11], s21 offen offset:1024 sc1
    s_xor_b32 s21, s33, 8192
    buffer_load_dwordx4 v[80:83], v0, s[8:11], s21 offen offset:0 sc1
    buffer_load_dwordx4 v[84:87], v0, s[8:11], s21 offen offset:1024 sc1
R_nowarm:
    s_waitcnt vmcnt(8)
    s_barrier
    ds_read_b64_tr_b16 v[32:33], v27 offset:0
    ds_read_b64_tr_b16 v[34:35], v27 offset:2048
    ds_read_b64_tr_b16 v[36:37], v27 offset:8192
    ds_read_b64_tr_b16 v[38:39], v27 offset:10240
    ds_read_b64_tr_b16 v[40:41], v27 offset:256
    ds_read_b64_tr_b16 v[42:43], v27 offset:2304
    ds_read_b64_tr_b16 v[44:45], v27 offset:8448
    ds_read_b64_tr_b16 v[46:47], v27 offset:10496
    ds_read_b64_tr_b16 v[48:49], v27 offset:512
    ds_read_b64_tr_b16 v[50:51], v27 offset:2560
    ds_read_b64_tr_b16 v[52:53], v27 offset:8704
    ds_read_b64_tr_b16 v[54:55], v27 offset:10752
    ds_read_b64_tr_b16 v[56:57], v27 offset:768
    ds_read_b64_tr_b16 v[58:59], v27 offset:2816
    ds_read_b64_tr_b16 v[60:61], v27 offset:8960
    ds_read_b64_tr_b16 v[62:63], v27 offset:11008
    s_waitcnt lgkmcnt(0)
    s_barrier
    s_lshl_b32 s21, s17, 13
    v_add_u32 v28, s21, v1
    ds_write_b128 v28, v[32:35] offset:0
    ds_write_b128 v28, v[36:39] offset:1024
    ds_write_b128 v28, v[40:43] offset:2048
    ds_write_b128 v28, v[44:47] offset:3072
    ds_write_b128 v28, v[48:51] offset:4096
    ds_write_b128 v28, v[52:55] offset:5120
    ds_write_b128 v28, v[56:59] offset:6144
    ds_write_b128 v28, v[60:63] offset:7168
    s_waitcnt vmcnt(0)
    s_barrier
    ds_read_b64_tr_b16 v[32:33], v27 offset:32768
    ds_read_b64_tr_b16 v[34:35], v27 offset:34816
    ds_read_b64_tr_b16 v[36:37], v27 offset:40960
    ds_read_b64_tr_b16 v[38:39], v27 offset:43008
    ds_read_b64_tr_b16 v[40:41], v27 offset:33024
    ds_read_b64_tr_b16 v[42:43], v27 offset:35072
    ds_read_b64_tr_b16 v[44:45], v27 offset:41216
    ds_read_b64_tr_b16 v[46:47], v27 offset:43264
    ds_read_b64_tr_b16 v[48:49], v27 offset:33280
    ds_read_b64_tr_b16 v[50:51], v27 offset:35328
    ds_read_b64_tr_b16 v[52:53], v27 offset:41472
    ds_read_b64_tr_b16 v[54:55], v27 offset:43520
    ds_read_b64_tr_b16 v[56:57], v27 offset:33536
    ds_read_b64_tr_b16 v[58:59], v27 offset:35584
    ds_read_b64_tr_b16 v[60:61], v27 offset:41728
    ds_read_b64_tr_b16 v[62:63], v27 offset:43776
    s_waitcnt lgkmcnt(0)
    s_barrier
    s_lshl_b32 s21, s17, 13
    v_add_u32 v28, s21, v1
    ds_write_b128 v28, v[32:35] offset:32768
    ds_write_b128 v28, v[36:39] offset:33792
    ds_write_b128 v28, v[40:43] offset:34816
    ds_write_b128 v28, v[44:47] offset:35840
    ds_write_b128 v28, v[48:51] offset:36864
    ds_write_b128 v28, v[52:55] offset:37888
    ds_write_b128 v28, v[56:59] offset:38912
    ds_write_b128 v28, v[60:63] offset:39936
    s_waitcnt lgkmcnt(0)
    s_lshl_b32 s96, s3, 7
    s_add_u32 s96, s96, 65110016
    s_lshl_b32 s97, s23, 1
    s_add_u32 s98, s97, 1
    s_cmp_eq_u32 s77, s98
    s_cbranch_scc1 R_go_on
    s_mov_b32 s98, 0
R_go:
    buffer_load_dword v127, off, s[8:11], s96 sc1
    s_add_u32 s98, s98, 1
    s_cmp_gt_u32 s98, 400000
    s_cbranch_scc1 L_fail
    s_waitcnt vmcnt(0)
    v_readfirstlane_b32 s99, v127
    s_nop 0
    s_cmp_eq_u32 s99, s97
    s_cbranch_scc0 R_go_got
    s_branch R_go
R_go_got:
    s_cmp_eq_u32 s99, 2
    s_cbranch_scc1 L_redo
R_go_on:
    v_bfe_u32 v12, v0, 6, 1
    v_lshl_add_u32 v12, v12, 12, v7
    s_mov_b32 s95, 1
    s_mov_b32 s39, 0
R_f0:
    buffer_load_dword v11, v12, s[8:11], s92 offen sc1
    s_add_u32 s39, s39, 1
    s_cmp_gt_u32 s39, 400000
    s_cbranch_scc1 L_fail
    s_waitcnt vmcnt(0)
    v_cmp_gt_u32 vcc, s95, v11
    s_nop 0
    s_cbranch_vccnz R_f0
    s_mov_b32 m0, s43
    s_nop 0
    buffer_load_dwordx4 v0, s[8:11], s36 offen offset:0 sc1 lds
    buffer_load_dwordx4 v0, s[8:11], s36 offen offset:1024 sc1 lds
    s_add_u32 m0, s43, 8192
    s_nop 0
    buffer_load_dwordx4 v0, s[8:11], s42 offen offset:0 sc1 lds
    buffer_load_dwordx4 v0, s[8:11], s42 offen offset:1024 sc1 lds
    s_cmp_lg_u32 s23, 0
    s_cbranch_scc1 L_ws
L_w:
    s_cmp_eq_u32 s17, 1
    s_cbranch_scc1 L_w1
    s_cmp_eq_u32 s17, 2
    s_cbranch_scc1 L_w2
    s_cmp_eq_u32 s17, 3
    s_cbranch_scc1 L_w3
L_w0:
    v_mov_b64 v[16:17], v[64:65]
    v_mov_b64 v[18:19], v[66:67]
    v_mov_b64 v[20:21], v[68:69]
    v_mov_b64 v[22:23], v[70:71]
    ds_read_b128 v[48:51], v0 offset:0
    ds_read_b128 v[52:55], v0 offset:1024
    ds_read_b128 v[56:59], v0 offset:2048
    ds_read_b128 v[60:63], v0 offset:3072
    ds_read_b128 v[64:67], v0 offset:4096
    ds_read_b128 v[68:71], v0 offset:5120
    ds_read_b128 v[72:75], v0 offset:6144
    ds_read_b128 v[76:79], v0 offset:7168
    ds_read_b128 v[80:83], v0 offset:32768
    ds_read_b128 v[84:87], v0 offset:33792
    ds_read_b128 v[88:91], v0 offset:34816
    ds_read_b128 v[92:95], v0 offset:35840
    v_mov_b64 v[96:97], 0
    v_mov_b64 v[98:99], 0
    v_mov_b64 v[100:101], 0
    v_mov_b64 v[102:103], 0
    v_mov_b64 v[104:105], 0
    v_mov_b64 v[106:107], 0
    v_mov_b64 v[108:109], 0
    v_mov_b64 v[110:111], 0
    v_mov_b64 v[112:113], 0
    v_mov_b64 v[114:115], 0
    v_mov_b64 v[116:117], 0
    v_mov_b64 v[118:119], 0
    v_mov_b32 v15, -1
    v_mov_b32 v11, 0
    s_waitcnt lgkmcnt(0)
    s_branch R0_top
.p2align 6
    s_nop 0
    s_nop 0
R0_h2a:
    s_waitcnt lgkmcnt(0)
    s_waitcnt vmcnt(3)
    v_max3_u32 v12, v16, v17, v18
    s_waitcnt vmcnt(2)
    v_max3_u32 v13, v19, v20, v21
    v_max3_u32 v12, v12, v22, v23
    v_max_u32 v12, v12, v13
    v_cmp_eq_u32 vcc, -1, v12
    v_smfmac_f32_16x16x64_bf16 v[96:99], v[16:19], a[0:7], v8
    ds_write_b128 v2, v[16:19] offset:16384
    s_cbranch_vccnz R0_h2
R0_top1:
    v_smfmac_f32_16x16x64_bf16 v[100:103], v[16:19], a[8:15], v8
    ds_write_b128 v2, v[20:23] offset:17408
    s_xor_b32 s33, s33, 8192
    v_smfmac_f32_16x16x64_bf16 v[96:99], v[20:23], a[16:23], v8
    v_add_u32 v15, 2176, v6
    v_smfmac_f32_16x16x64_bf16 v[100:103], v[20:23], a[24:31], v8
    v_cndmask_b32 v15, v6, v15, s[60:61]
    v_smfmac_f32_16x16x64_bf16 v[104:107], v[16:19], a[128:135], v8
    v_smfmac_f32_16x16x64_bf16 v[108:111], v[16:19], a[136:143], v8
    v_smfmac_f32_16x16x64_bf16 v[104:107], v[20:23], a[144:151], v8
    s_waitcnt vmcnt(0) lgkmcnt(0)
    s_barrier
    ds_read_b128 v[32:35], v2 offset:20480
    v_smfmac_f32_16x16x64_bf16 v[108:111], v[20:23], a[152:159], v8
    ds_read_b128 v[36:39], v2 offset:21504
    v_smfmac_f32_16x16x64_bf16 v[112:115], v[16:19], v[128:135], v8
    ds_read_b128 v[40:43], v2 offset:22528
    v_smfmac_f32_16x16x64_bf16 v[116:119], v[16:19], v[136:143], v8
    ds_read_b128 v[24:27], v2 offset:18432
    v_smfmac_f32_16x16x64_bf16 v[112:115], v[20:23], v[144:151], v8
    ds_read_b128 v[28:31], v2 offset:19456
    s_waitcnt lgkmcnt(4)
    v_smfmac_f32_16x16x64_bf16 v[96:99], v[32:35], v[48:55], v8
    ds_read_b128 v[44:47], v2 offset:23552
    v_smfmac_f32_16x16x64_bf16 v[100:103], v[32:35], v[56:63], v8
    ds_read_b128 v[48:51], v0 offset:36864
    s_waitcnt lgkmcnt(5)
    v_smfmac_f32_16x16x64_bf16 v[96:99], v[36:39], v[64:71], v8
    ds_read_b128 v[52:55], v0 offset:37888
    v_smfmac_f32_16x16x64_bf16 v[100:103], v[36:39], v[72:79], v8
    ds_read_b128 v[56:59], v0 offset:38912
    s_waitcnt lgkmcnt(6)
    v_smfmac_f32_16x16x64_bf16 v[96:99], v[40:43], v[80:87], v8
    ds_read_b128 v[60:63], v0 offset:39936
    v_smfmac_f32_16x16x64_bf16 v[100:103], v[40:43], v[88:95], v8
    ds_read_b128 v[64:67], v2 offset:4096
    s_waitcnt lgkmcnt(7)
    v_smfmac_f32_16x16x64_bf16 v[96:99], v[24:27], a[32:39], v8
    ds_read_b128 v[68:71], v2 offset:5120
    v_smfmac_f32_16x16x64_bf16 v[100:103], v[24:27], a[40:47], v8
    ds_read_b128 v[72:75], v2 offset:6144
    s_waitcnt lgkmcnt(8)
    v_smfmac_f32_16x16x64_bf16 v[96:99], v[28:31], a[48:55], v8
    ds_read_b128 v[76:79], v2 offset:7168
    v_smfmac_f32_16x16x64_bf16 v[100:103], v[28:31], a[56:63], v8
    s_waitcnt lgkmcnt(8)
    s_waitcnt lgkmcnt(6)
    v_smfmac_f32_16x16x64_bf16 v[96:99], v[44:47], v[48:55], v8
    ds_read_b128 v[48:51], v2 offset:0
    s_waitcnt lgkmcnt(5)
    v_smfmac_f32_16x16x64_bf16 v[100:103], v[44:47], v[56:63], v8
    ds_read_b128 v[52:55], v2 offset:1024
    v_smfmac_f32_16x16x64_bf16 v[104:107], v[32:35], a[192:199], v8
    ds_read_b128 v[56:59], v2 offset:2048
    buffer_store_dwordx4 v[120:123], v0, s[8:11], s37 offen sc1
    s_add_u32 s36, s36, 786432
    v_smfmac_f32_16x16x64_bf16 v[108:111], v[32:35], a[200:207], v8
    ds_read_b128 v[60:63], v2 offset:3072
    s_mov_b32 m0, s43
    s_add_u32 s42, s42, 786432
    v_smfmac_f32_16x16x64_bf16 v[104:107], v[36:39], a[208:215], v8
    v_add_f32 v96, v96, v97
    v_add_f32 v98, v98, v99
    v_smfmac_f32_16x16x64_bf16 v[108:111], v[36:39], a[216:223], v8
    v_add_f32 v100, v100, v101
    v_add_f32 v102, v102, v103
    v_smfmac_f32_16x16x64_bf16 v[104:107], v[40:43], a[224:231], v8
    v_cvt_pk_bf16_f32 v124, v96, v98
    v_cvt_pk_bf16_f32 v125, v100, v102
    v_smfmac_f32_16x16x64_bf16 v[108:111], v[40:43], a[232:239], v8
    ds_write2st64_b32 v9, v124, v125 offset0:0 offset1:2
    v_smfmac_f32_16x16x64_bf16 v[104:107], v[24:27], a[160:167], v8
    s_mov_b32 s94, s24
    v_smfmac_f32_16x16x64_bf16 v[108:111], v[24:27], a[168:175], v8
    buffer_load_dword v11, v7, s[8:11], s92 offen sc1
    v_smfmac_f32_16x16x64_bf16 v[104:107], v[28:31], a[176:183], v8
    v_smfmac_f32_16x16x64_bf16 v[108:111], v[28:31], a[184:191], v8
    s_add_u32 s37, s37, 131072
    s_waitcnt lgkmcnt(0)
    s_barrier
    v_smfmac_f32_16x16x64_bf16 v[104:107], v[44:47], a[240:247], v8
    ds_read_b64_tr_b16 v[80:81], v6 offset:0
    ds_read_b64_tr_b16 v[82:83], v6 offset:512
    v_smfmac_f32_16x16x64_bf16 v[108:111], v[44:47], a[248:255], v8
    ds_read_b64_tr_b16 v[84:85], v6 offset:128
    ds_read_b64_tr_b16 v[86:87], v6 offset:640
    v_smfmac_f32_16x16x64_bf16 v[116:119], v[20:23], v[152:159], v8
    ds_read_b64_tr_b16 v[88:89], v6 offset:256
    ds_read_b64_tr_b16 v[90:91], v6 offset:768
    v_smfmac_f32_16x16x64_bf16 v[112:115], v[32:35], v[192:199], v8
    ds_read_b64_tr_b16 v[92:93], v6 offset:384
    ds_read_b64_tr_b16 v[94:95], v6 offset:896
    v_add_f32 v104, v104, v105
    v_add_f32 v106, v106, v107
    v_add_f32 v108, v108, v109
    v_add_f32 v110, v110, v111
    v_cvt_pk_bf16_f32 v120, v104, v106
    v_cvt_pk_bf16_f32 v121, v108, v110
    s_waitcnt lgkmcnt(4)
    v_mfma_f32_16x16x32_bf16 v[96:99], v[48:51], v[80:83], 0
    ds_write2st64_b32 v10, v120, v121 offset0:9 offset1:11
    v_mfma_f32_16x16x32_bf16 v[100:103], v[64:67], v[80:83], 0
    v_mfma_f32_16x16x32_bf16 v[96:99], v[52:55], v[84:87], v[96:99]
    buffer_load_dwordx4 v0, s[8:11], s36 offen offset:0 sc1 lds
    v_mov_b64 v[126:127], s[26:27]
    v_mfma_f32_16x16x32_bf16 v[100:103], v[68:71], v[84:87], v[100:103]
    s_waitcnt lgkmcnt(0)
    s_barrier
    v_mfma_f32_16x16x32_bf16 v[96:99], v[56:59], v[88:91], v[96:99]
    ds_read_b64_tr_b16 v[48:49], v15 offset:2304
    ds_read_b64_tr_b16 v[50:51], v15 offset:2816
    v_mfma_f32_16x16x32_bf16 v[100:103], v[72:75], v[88:91], v[100:103]
    ds_read_b64_tr_b16 v[64:65], v15 offset:2432
    ds_read_b64_tr_b16 v[66:67], v15 offset:2944
    v_mfma_f32_16x16x32_bf16 v[96:99], v[60:63], v[92:95], v[96:99]
    ds_read_b64_tr_b16 v[52:53], v15 offset:2560
    ds_read_b64_tr_b16 v[54:55], v15 offset:3072
    v_mfma_f32_16x16x32_bf16 v[100:103], v[76:79], v[92:95], v[100:103]
    ds_read_b64_tr_b16 v[68:69], v15 offset:2688
    ds_read_b64_tr_b16 v[70:71], v15 offset:3200
    s_waitcnt lgkmcnt(6)
    v_mfma_f32_16x16x32_bf16 v[104:107], v[48:51], v[80:83], 0
    ds_read_b128 v[56:59], v2 offset:8192
    v_mov_b64 v[124:125], s[26:27]
    s_waitcnt lgkmcnt(5)
    v_mfma_f32_16x16x32_bf16 v[104:107], v[64:67], v[84:87], v[104:107]
    ds_read_b128 v[60:63], v2 offset:9216
    v_max3_f32 v12, v96, v97, v98
    s_waitcnt lgkmcnt(4)
    v_mfma_f32_16x16x32_bf16 v[104:107], v[52:55], v[88:91], v[104:107]
    buffer_load_dwordx4 v0, s[8:11], s36 offen offset:1024 sc1 lds
    v_max3_f32 v13, v99, v100, v101
    v_max3_f32 v12, v12, v102, v103
    s_waitcnt lgkmcnt(2)
    v_mfma_f32_16x16x32_bf16 v[104:107], v[68:71], v[92:95], v[104:107]
    v_max_f32 v12, v12, v13
    v_smfmac_f32_16x16x64_bf16 v[116:119], v[32:35], v[200:207], v8
    ds_read_b128 v[80:83], v1 offset:0
    s_add_u32 m0, s43, 8192
    v_smfmac_f32_16x16x64_bf16 v[112:115], v[36:39], v[208:215], v8
    ds_read_b128 v[84:87], v1 offset:1024
    s_add_u32 s24, s24, 1
    s_nop 0
    v_max3_f32 v12, v12, v104, v105
    v_mov_b32 v13, v12
    v_smfmac_f32_16x16x64_bf16 v[116:119], v[36:39], v[216:223], v8
    ds_read_b128 v[88:91], v1 offset:32768
    v_permlane32_swap_b32 v12, v13
    v_max_f32 v12, v12, v13
    v_mov_b32 v13, v12
    v_smfmac_f32_16x16x64_bf16 v[112:115], v[40:43], v[224:231], v8
    ds_read_b128 v[92:95], v1 offset:33792
    v_permlane16_swap_b32 v12, v13
    v_max_f32 v12, v12, v13
    v_mul_f32 v12, s40, v12
    v_pk_fma_f32 v[96:97], v[96:97], s[40:41], v[12:13] op_sel_hi:[1,1,0] neg_lo:[0,0,1] neg_hi:[0,0,1]
    v_pk_fma_f32 v[98:99], v[98:99], s[40:41], v[12:13] op_sel_hi:[1,1,0] neg_lo:[0,0,1] neg_hi:[0,0,1]
    v_pk_fma_f32 v[100:101], v[100:101], s[40:41], v[12:13] op_sel_hi:[1,1,0] neg_lo:[0,0,1] neg_hi:[0,0,1]
    v_pk_fma_f32 v[102:103], v[102:103], s[40:41], v[12:13] op_sel_hi:[1,1,0] neg_lo:[0,0,1] neg_hi:[0,0,1]
    v_pk_fma_f32 v[104:105], v[104:105], s[40:41], v[12:13] op_sel_hi:[1,1,0] neg_lo:[0,0,1] neg_hi:[0,0,1]
    v_smfmac_f32_16x16x64_bf16 v[116:119], v[40:43], v[232:239], v8
    ds_read_b128 v[48:51], v1 offset:2048
    v_exp_f32 v96, v96
    v_smfmac_f32_16x16x64_bf16 v[112:115], v[24:27], v[160:167], v8
    ds_read_b128 v[52:55], v1 offset:3072
    v_exp_f32 v97, v97
    v_smfmac_f32_16x16x64_bf16 v[116:119], v[24:27], v[168:175], v8
    ds_read_b128 v[64:67], v1 offset:34816
    v_exp_f32 v98, v98
    v_smfmac_f32_16x16x64_bf16 v[112:115], v[28:31], v[176:183], v8
    ds_read_b128 v[68:71], v1 offset:35840
    v_exp_f32 v99, v99
    s_waitcnt lgkmcnt(8)
    v_smfmac_f32_16x16x64_bf16 v[116:119], v[28:31], v[184:191], v8
    buffer_load_dwordx4 v0, s[8:11], s42 offen offset:0 sc1 lds
    v_exp_f32 v100, v100
    v_smfmac_f32_16x16x64_bf16 v[112:115], v[44:47], v[240:247], v8
    v_exp_f32 v101, v101
    v_smfmac_f32_16x16x64_bf16 v[116:119], v[44:47], v[248:255], v8
    buffer_load_dwordx4 v0, s[8:11], s42 offen offset:1024 sc1 lds
    v_exp_f32 v102, v102
    v_exp_f32 v103, v103
    v_mov_b64 v[12:13], 0
    v_mov_b64 v[14:15], 0
    v_cvt_pk_bf16_f32 v72, v96, v97
    v_cvt_pk_bf16_f32 v73, v98, v99
    v_cvt_pk_bf16_f32 v74, v100, v101
    v_cvt_pk_bf16_f32 v75, v102, v103
    v_exp_f32 v104, v104
    v_exp_f32 v105, v105
    v_mfma_f32_16x16x32_bf16 v[108:111], v[72:75], v[124:127], 0
    v_cvt_pk_bf16_f32 v104, v104, v105
    v_add_f32 v112, v112, v113
    v_smfmac_f32_16x16x64_bf16 v[12:15], v[72:75], v[56:63], v8 abid:1
    v_cndmask_b32 v76, v104, 0, s[78:79]
    v_cndmask_b32 v77, 0, v104, s[78:79]
    v_add_f32 v114, v114, v115
    v_add_f32 v116, v116, v117
    v_mfma_f32_16x16x16_bf16 v[108:111], v[76:77], v[124:125], v[108:111]
    v_add_f32 v118, v118, v119
    v_cvt_pk_bf16_f32 v122, v112, v114
    v_cvt_pk_bf16_f32 v123, v116, v118
    s_nop 1
    v_mfma_f32_16x16x16_bf16 v[12:15], v[76:77], v[122:123], v[12:15]
    s_nop 1
    v_rcp_f32 v108, v108
    s_nop 0
    v_rcp_f32 v109, v109
    s_nop 0
    v_rcp_f32 v110, v110
    s_nop 0
    v_rcp_f32 v111, v111
    s_nop 0
    v_pk_mul_f32 v[12:13], v[12:13], v[108:109]
    v_pk_mul_f32 v[14:15], v[14:15], v[110:111]
    v_cvt_pk_bf16_f32 v12, v12, v13
    v_cvt_pk_bf16_f32 v13, v14, v15
    ds_write_b64 v5, v[12:13] offset:0
    v_mov_b64 v[72:73], 0
    v_mov_b64 v[74:75], 0
    v_mov_b64 v[76:77], 0
    v_mov_b64 v[78:79], 0
    v_mov_b64 v[56:57], 0
    v_mov_b64 v[58:59], 0
    v_mov_b64 v[60:61], 0
    v_mov_b64 v[62:63], 0
    s_waitcnt lgkmcnt(0)
    s_barrier
    ds_read_b64_tr_b16 v[96:97], v6 offset:0
    ds_read_b64_tr_b16 v[98:99], v6 offset:512
    ds_read_b64_tr_b16 v[100:101], v6 offset:128
    ds_read_b64_tr_b16 v[102:103], v6 offset:640
    ds_read_b64_tr_b16 v[104:105], v6 offset:256
    ds_read_b64_tr_b16 v[106:107], v6 offset:768
    ds_read_b64_tr_b16 v[108:109], v6 offset:384
    ds_read_b64_tr_b16 v[110:111], v6 offset:896
    s_waitcnt lgkmcnt(6)
    v_smfmac_f32_16x16x64_bf16 v[72:75], v[96:99], a[64:71], v8 abid:1
    ds_read_b128 v[16:19], v1 offset:4096
    s_waitcnt lgkmcnt(5)
    v_smfmac_f32_16x16x64_bf16 v[72:75], v[100:103], a[96:103], v8 abid:1
    ds_read_b128 v[20:23], v1 offset:5120
    s_waitcnt lgkmcnt(4)
    v_smfmac_f32_16x16x64_bf16 v[72:75], v[104:107], v[80:87], v8 abid:1
    ds_read_b128 v[24:27], v1 offset:36864
    s_waitcnt lgkmcnt(3)
    v_smfmac_f32_16x16x64_bf16 v[72:75], v[108:111], v[88:95], v8 abid:1
    ds_read_b128 v[28:31], v1 offset:37888
    v_smfmac_f32_16x16x64_bf16 v[76:79], v[96:99], a[72:79], v8 abid:1
    ds_read_b128 v[32:35], v1 offset:6144
    s_nop 0
    v_mov_b64 v[112:113], 0
    v_smfmac_f32_16x16x64_bf16 v[76:79], v[100:103], a[104:111], v8 abid:1
    ds_read_b128 v[36:39], v1 offset:7168
    s_nop 0
    v_cvt_pk_bf16_f32 v72, v72, v73
    v_cvt_pk_bf16_f32 v73, v74, v75
    v_and_or_b32 v72, v72, -2, s38
    v_smfmac_f32_16x16x64_bf16 v[76:79], v[104:107], v[48:55], v8 abid:1
    buffer_store_dwordx2 v[72:73], v3, s[8:11], s28 offen
    v_smfmac_f32_16x16x64_bf16 v[76:79], v[108:111], v[64:71], v8 abid:1
    ds_read_b128 v[40:43], v1 offset:38912
    v_smfmac_f32_16x16x64_bf16 v[56:59], v[96:99], a[80:87], v8 abid:1
    ds_read_b128 v[44:47], v1 offset:39936
    s_nop 0
    v_mov_b64 v[114:115], 0
    v_smfmac_f32_16x16x64_bf16 v[56:59], v[100:103], a[112:119], v8 abid:1
    s_nop 0
    s_nop 0
    v_cvt_pk_bf16_f32 v76, v76, v77
    v_cvt_pk_bf16_f32 v77, v78, v79
    v_and_or_b32 v76, v76, -2, s38
    s_waitcnt lgkmcnt(4)
    v_smfmac_f32_16x16x64_bf16 v[56:59], v[104:107], v[16:23], v8 abid:1
    buffer_store_dwordx2 v[76:77], v3, s[8:11], s29 offen
    v_smfmac_f32_16x16x64_bf16 v[56:59], v[108:111], v[24:31], v8 abid:1
    v_smfmac_f32_16x16x64_bf16 v[60:63], v[96:99], a[88:95], v8 abid:1
    s_nop 1
    v_mov_b64 v[116:117], 0
    v_smfmac_f32_16x16x64_bf16 v[60:63], v[100:103], a[120:127], v8 abid:1
    s_nop 0
    s_nop 1
    v_cvt_pk_bf16_f32 v56, v56, v57
    v_cvt_pk_bf16_f32 v57, v58, v59
    v_and_or_b32 v56, v56, -2, s38
    s_waitcnt lgkmcnt(0)
    v_smfmac_f32_16x16x64_bf16 v[60:63], v[104:107], v[32:39], v8 abid:1
    buffer_store_dwordx2 v[56:57], v3, s[8:11], s30 offen
    ds_read_b128 v[32:35], v2 offset:31232
    v_smfmac_f32_16x16x64_bf16 v[60:63], v[108:111], v[40:47], v8 abid:1
    s_mov_b32 s39, 0
    v_mov_b64 v[96:97], 0
    v_mov_b64 v[98:99], 0
    s_nop 4
    v_cvt_pk_bf16_f32 v60, v60, v61
    v_cvt_pk_bf16_f32 v61, v62, v63
    v_and_or_b32 v60, v60, -2, s38
    buffer_store_dwordx2 v[60:61], v3, s[8:11], s31 offen
    v_mov_b64 v[100:101], 0
    v_mov_b64 v[102:103], 0
    v_mov_b64 v[104:105], 0
    v_mov_b64 v[106:107], 0
    v_mov_b64 v[108:109], 0
    v_mov_b64 v[110:111], 0
    v_mov_b64 v[118:119], 0
    buffer_load_dwordx4 v[24:27], v0, s[8:11], s32 offen offset:0 sc1
    buffer_load_dwordx4 v[28:31], v0, s[8:11], s32 offen offset:1024 sc1
    s_waitcnt vmcnt(3)
    buffer_load_dwordx4 v[16:19], v0, s[8:11], s32 offen offset:0 sc1
    buffer_load_dwordx4 v[20:23], v0, s[8:11], s32 offen offset:1024 sc1
    v_pk_min_u16 v120, v120, s45
    v_pk_min_u16 v121, v121, s45
    v_pk_min_u16 v122, v122, s45
    v_pk_min_u16 v123, v123, s45
    v_mov_b32 v15, -1
    s_waitcnt lgkmcnt(0)
R0_h1a:
    s_waitcnt vmcnt(3)
    v_mfma_f32_16x16x32_bf16 v[36:39], v[24:27], v[32:35], 0
    v_bitop3_b32 v12, v24, v26, s38 bitop3:0x7e
    s_waitcnt vmcnt(2)
    v_mfma_f32_16x16x32_bf16 v[36:39], v[28:31], v[32:35], v[36:39]
    v_bitop3_b32 v13, v28, v30, s38 bitop3:0x7e
    v_bitop3_b32 v12, v12, v13, 1 bitop3:0xa8
    v_cmp_ne_u32 vcc, 0, v12
    s_nop 0
    s_cbranch_vccnz R0_h1
R0_h1ok:
    s_nop 3
    v_permlane32_swap_b32 v36, v38
    v_permlane32_swap_b32 v37, v39
    v_add_f32 v36, v36, v38
    v_add_f32 v37, v37, v39
    s_nop 1
    v_permlane16_swap_b32 v36, v37
    v_add_f32 v12, v36, v37
    s_nop 1
    v_mov_b32_dpp v13, v12 row_shl:4 row_mask:0xf bank_mask:0xf
    v_cvt_pk_bf16_f32 v12, v12, v13
    v_min_u32 v12, -2, v12
    buffer_store_dword v12, v4, s[8:11], s34 offen
    s_xor_b32 s32, s32, 1048576
    s_lshr_b32 s38, s24, 1
    buffer_store_dword v15, v4, s[8:11], s35 offen
    s_xor_b32 s35, s35, 8192
    s_xor_b32 s28, s28, 1048576
    s_xor_b32 s29, s29, 1048576
    s_xor_b32 s30, s30, 1048576
    s_xor_b32 s31, s31, 1048576
    s_xor_b32 s34, s34, 8192
    s_and_b32 s38, s38, 1
    s_lshl_b32 s39, s39, 16
    ds_read_b128 v[48:51], v0 offset:0
    ds_read_b128 v[52:55], v0 offset:1024
    ds_read_b128 v[56:59], v0 offset:2048
    s_add_u32 s95, s24, 3
    s_lshr_b32 s95, s95, 1
    s_cmp_lt_u32 s24, 63
    s_cselect_b32 s95, s95, 0
    v_cmp_gt_u32 vcc, s95, v11
    s_nop 0
    s_cbranch_vccnz R0_fw
R0_fok:
    s_xor_b32 s92, s92, 4096
    s_mov_b32 s25, 0
    s_cmp_eq_u32 s24, 63
    s_cbranch_scc1 R0_last
    s_waitcnt vmcnt(0)
    buffer_load_dwordx4 v[16:19], v0, s[8:11], s33 offen sc1
    buffer_load_dwordx4 v[20:23], v0, s[8:11], s33 offen offset:1024 sc1
    ds_read_b128 v[60:63], v0 offset:3072
    ds_read_b128 v[64:67], v0 offset:4096
    ds_read_b128 v[68:71], v0 offset:5120
    ds_read_b128 v[72:75], v0 offset:6144
    ds_read_b128 v[76:79], v0 offset:7168
    ds_read_b128 v[80:83], v0 offset:32768
    ds_read_b128 v[84:87], v0 offset:33792
    ds_read_b128 v[88:91], v0 offset:34816
    ds_read_b128 v[92:95], v0 offset:35840
    s_waitcnt lgkmcnt(0)
    buffer_load_dwordx4 v[24:27], v0, s[8:11], s33 offen sc1
    buffer_load_dwordx4 v[28:31], v0, s[8:11], s33 offen offset:1024 sc1
    s_branch R0_h2a
R0_h1:
    buffer_load_dwordx4 v[24:27], v0, s[8:11], s32 offen offset:0 sc1
    buffer_load_dwordx4 v[28:31], v0, s[8:11], s32 offen offset:1024 sc1
    s_add_u32 s39, s39, 1
    s_cmp_gt_u32 s39, 60000
    s_cbranch_scc1 L_fail
    s_waitcnt vmcnt(3)
    v_mfma_f32_16x16x32_bf16 v[36:39], v[16:19], v[32:35], 0
    v_bitop3_b32 v12, v16, v18, s38 bitop3:0x7e
    s_waitcnt vmcnt(2)
    v_mfma_f32_16x16x32_bf16 v[36:39], v[20:23], v[32:35], v[36:39]
    v_bitop3_b32 v13, v20, v22, s38 bitop3:0x7e
    v_bitop3_b32 v12, v12, v13, 1 bitop3:0xa8
    v_cmp_ne_u32 vcc, 0, v12
    s_nop 0
    s_cbranch_vccz R0_h1ok
    buffer_load_dwordx4 v[16:19], v0, s[8:11], s32 offen offset:0 sc1
    buffer_load_dwordx4 v[20:23], v0, s[8:11], s32 offen offset:1024 sc1
    s_add_u32 s39, s39, 1
    s_branch R0_h1a
R0_h2:
    s_nop 5
    v_mov_b64 v[96:97], 0
    v_mov_b64 v[98:99], 0
    s_add_u32 s25, s25, 1
    s_cmp_gt_u32 s25, 60000
    s_cbranch_scc1 L_fail
    s_waitcnt vmcnt(1)
    v_max3_u32 v12, v24, v25, v26
    s_waitcnt vmcnt(0)
    v_max3_u32 v13, v27, v28, v29
    v_max3_u32 v12, v12, v30, v31
    v_max_u32 v12, v12, v13
    v_cmp_eq_u32 vcc, -1, v12
    s_nop 0
    s_cbranch_vccnz R0_h2b
    v_mov_b64 v[16:17], v[24:25]
    v_mov_b64 v[18:19], v[26:27]
    v_mov_b64 v[20:21], v[28:29]
    v_mov_b64 v[22:23], v[30:31]
    s_branch R0_top
R0_h2b:
    buffer_load_dwordx4 v[16:19], v0, s[8:11], s33 offen sc1
    buffer_load_dwordx4 v[20:23], v0, s[8:11], s33 offen offset:1024 sc1
    s_waitcnt vmcnt(1)
    buffer_load_dwordx4 v[24:27], v0, s[8:11], s33 offen sc1
    buffer_load_dwordx4 v[28:31], v0, s[8:11], s33 offen offset:1024 sc1
    s_add_u32 s25, s25, 1
    s_branch R0_h2a
R0_top:
    v_smfmac_f32_16x16x64_bf16 v[96:99], v[16:19], a[0:7], v8
    ds_write_b128 v2, v[16:19] offset:16384
    s_branch R0_top1
R0_fw:
    s_mov_b32 s39, 0
R0_fw2:
    buffer_load_dword v11, v7, s[8:11], s92 offen sc1
    s_add_u32 s39, s39, 1
    s_cmp_gt_u32 s39, 400000
    s_cbranch_scc1 L_fail
    s_waitcnt vmcnt(0)
    v_cmp_gt_u32 vcc, s95, v11
    s_nop 0
    s_cbranch_vccnz R0_fw2
    s_branch R0_fok
R0_last:
    s_waitcnt vmcnt(0)
R0_l2:
    buffer_load_dwordx4 v[16:19], v0, s[8:11], s33 offen sc1
    buffer_load_dwordx4 v[20:23], v0, s[8:11], s33 offen offset:1024 sc1
    s_add_u32 s25, s25, 1
    s_cmp_gt_u32 s25, 60000
    s_cbranch_scc1 L_fail
    s_waitcnt vmcnt(1)
    v_max3_u32 v12, v16, v17, v18
    s_waitcnt vmcnt(0)
    v_max3_u32 v13, v19, v20, v21
    v_max3_u32 v12, v12, v22, v23
    v_max_u32 v12, v12, v13
    v_cmp_eq_u32 vcc, -1, v12
    s_nop 0
    s_cbranch_vccnz R0_l2
    v_smfmac_f32_16x16x64_bf16 v[104:107], v[16:19], a[128:135], v8
    ds_write_b128 v2, v[16:19] offset:16384
    v_smfmac_f32_16x16x64_bf16 v[108:111], v[16:19], a[136:143], v8
    ds_write_b128 v2, v[20:23] offset:17408
    v_smfmac_f32_16x16x64_bf16 v[112:115], v[16:19], v[128:135], v8
    v_smfmac_f32_16x16x64_bf16 v[116:119], v[16:19], v[136:143], v8
    v_smfmac_f32_16x16x64_bf16 v[104:107], v[20:23], a[144:151], v8
    v_smfmac_f32_16x16x64_bf16 v[108:111], v[20:23], a[152:159], v8
    v_smfmac_f32_16x16x64_bf16 v[112:115], v[20:23], v[144:151], v8
    s_waitcnt lgkmcnt(0)
    s_barrier
    ds_read_b128 v[32:35], v2 offset:20480
    ds_read_b128 v[36:39], v2 offset:21504
    ds_read_b128 v[40:43], v2 offset:22528
    ds_read_b128 v[24:27], v2 offset:18432
    ds_read_b128 v[28:31], v2 offset:19456
    ds_read_b128 v[44:47], v2 offset:23552
    v_smfmac_f32_16x16x64_bf16 v[116:119], v[20:23], v[152:159], v8
    buffer_store_dwordx4 v[120:123], v0, s[8:11], s37 offen sc1
    s_add_u32 s37, s37, 131072
    s_waitcnt lgkmcnt(5)
    v_smfmac_f32_16x16x64_bf16 v[104:107], v[32:35], a[192:199], v8
    v_smfmac_f32_16x16x64_bf16 v[108:111], v[32:35], a[200:207], v8
    v_smfmac_f32_16x16x64_bf16 v[112:115], v[32:35], v[192:199], v8
    v_smfmac_f32_16x16x64_bf16 v[116:119], v[32:35], v[200:207], v8
    s_waitcnt lgkmcnt(4)
    v_smfmac_f32_16x16x64_bf16 v[104:107], v[36:39], a[208:215], v8
    v_smfmac_f32_16x16x64_bf16 v[108:111], v[36:39], a[216:223], v8
    v_smfmac_f32_16x16x64_bf16 v[112:115], v[36:39], v[208:215], v8
    v_smfmac_f32_16x16x64_bf16 v[116:119], v[36:39], v[216:223], v8
    s_waitcnt lgkmcnt(3)
    v_smfmac_f32_16x16x64_bf16 v[104:107], v[40:43], a[224:231], v8
    v_smfmac_f32_16x16x64_bf16 v[108:111], v[40:43], a[232:239], v8
    v_smfmac_f32_16x16x64_bf16 v[112:115], v[40:43], v[224:231], v8
    v_smfmac_f32_16x16x64_bf16 v[116:119], v[40:43], v[232:239], v8
    s_waitcnt lgkmcnt(2)
    v_smfmac_f32_16x16x64_bf16 v[104:107], v[24:27], a[160:167], v8
    v_smfmac_f32_16x16x64_bf16 v[108:111], v[24:27], a[168:175], v8
    v_smfmac_f32_16x16x64_bf16 v[112:115], v[24:27], v[160:167], v8
    v_smfmac_f32_16x16x64_bf16 v[116:119], v[24:27], v[168:175], v8
    s_waitcnt lgkmcnt(1)
    v_smfmac_f32_16x16x64_bf16 v[104:107], v[28:31], a[176:183], v8
    v_smfmac_f32_16x16x64_bf16 v[108:111], v[28:31], a[184:191], v8
    v_smfmac_f32_16x16x64_bf16 v[112:115], v[28:31], v[176:183], v8
    v_smfmac_f32_16x16x64_bf16 v[116:119], v[28:31], v[184:191], v8
    s_waitcnt lgkmcnt(0)
    v_smfmac_f32_16x16x64_bf16 v[104:107], v[44:47], a[240:247], v8
    v_smfmac_f32_16x16x64_bf16 v[108:111], v[44:47], a[248:255], v8
    v_smfmac_f32_16x16x64_bf16 v[112:115], v[44:47], v[240:247], v8
    v_smfmac_f32_16x16x64_bf16 v[116:119], v[44:47], v[248:255], v8
    s_nop 4
    v_add_f32 v104, v104, v105
    v_add_f32 v106, v106, v107
    v_add_f32 v108, v108, v109
    v_add_f32 v110, v110, v111
    v_cvt_pk_bf16_f32 v120, v104, v106
    v_cvt_pk_bf16_f32 v121, v108, v110
    v_add_f32 v112, v112, v113
    v_add_f32 v114, v114, v115
    v_add_f32 v116, v116, v117
    v_add_f32 v118, v118, v119
    v_cvt_pk_bf16_f32 v122, v112, v114
    v_cvt_pk_bf16_f32 v123, v116, v118
    v_pk_min_u16 v120, v120, s45
    v_pk_min_u16 v121, v121, s45
    v_pk_min_u16 v122, v122, s45
    v_pk_min_u16 v123, v123, s45
    buffer_store_dwordx4 v[120:123], v0, s[8:11], s37 offen sc1
    v_mov_b32 v15, 64
    s_waitcnt vmcnt(0)
    s_barrier
    s_branch L_exit_r
L_w1:
    v_mov_b64 v[24:25], v[64:65]
    v_mov_b64 v[26:27], v[66:67]
    v_mov_b64 v[28:29], v[68:69]
    v_mov_b64 v[30:31], v[70:71]
    ds_read_b128 v[48:51], v0 offset:8192
    ds_read_b128 v[52:55], v0 offset:9216
    ds_read_b128 v[56:59], v0 offset:10240
    ds_read_b128 v[60:63], v0 offset:11264
    ds_read_b128 v[64:67], v0 offset:12288
    ds_read_b128 v[68:71], v0 offset:13312
    ds_read_b128 v[72:75], v0 offset:14336
    ds_read_b128 v[76:79], v0 offset:15360
    ds_read_b128 v[80:83], v0 offset:40960
    ds_read_b128 v[84:87], v0 offset:41984
    ds_read_b128 v[88:91], v0 offset:43008
    ds_read_b128 v[92:95], v0 offset:44032
    v_mov_b64 v[96:97], 0
    v_mov_b64 v[98:99], 0
    v_mov_b64 v[100:101], 0
    v_mov_b64 v[102:103], 0
    v_mov_b64 v[104:105], 0
    v_mov_b64 v[106:107], 0
    v_mov_b64 v[108:109], 0
    v_mov_b64 v[110:111], 0
    v_mov_b64 v[112:113], 0
    v_mov_b64 v[114:115], 0
    v_mov_b64 v[116:117], 0
    v_mov_b64 v[118:119], 0
    v_mov_b32 v15, -1
    v_mov_b32 v11, 0
    s_waitcnt lgkmcnt(0)
    s_branch R1_top
.p2align 6
    s_nop 0
    s_nop 0
R1_h2a:
    s_waitcnt lgkmcnt(0)
    s_waitcnt vmcnt(3)
    v_max3_u32 v12, v24, v25, v26
    s_waitcnt vmcnt(2)
    v_max3_u32 v13, v27, v28, v29
    v_max3_u32 v12, v12, v30, v31
    v_max_u32 v12, v12, v13
    v_cmp_eq_u32 vcc, -1, v12
    v_smfmac_f32_16x16x64_bf16 v[96:99], v[24:27], a[32:39], v8
    ds_write_b128 v2, v[24:27] offset:18432
    s_cbranch_vccnz R1_h2
R1_top1:
    v_smfmac_f32_16x16x64_bf16 v[100:103], v[24:27], a[40:47], v8
    ds_write_b128 v2, v[28:31] offset:19456
    s_xor_b32 s33, s33, 8192
    v_smfmac_f32_16x16x64_bf16 v[96:99], v[28:31], a[48:55], v8
    v_add_u32 v15, 2176, v6
    v_smfmac_f32_16x16x64_bf16 v[100:103], v[28:31], a[56:63], v8
    v_cndmask_b32 v15, v6, v15, s[60:61]
    v_smfmac_f32_16x16x64_bf16 v[104:107], v[24:27], a[160:167], v8
    v_smfmac_f32_16x16x64_bf16 v[108:111], v[24:27], a[168:175], v8
    v_smfmac_f32_16x16x64_bf16 v[104:107], v[28:31], a[176:183], v8
    s_waitcnt vmcnt(0) lgkmcnt(0)
    s_barrier
    ds_read_b128 v[32:35], v2 offset:20480
    v_smfmac_f32_16x16x64_bf16 v[108:111], v[28:31], a[184:191], v8
    ds_read_b128 v[36:39], v2 offset:21504
    v_smfmac_f32_16x16x64_bf16 v[112:115], v[24:27], v[160:167], v8
    ds_read_b128 v[40:43], v2 offset:22528
    v_smfmac_f32_16x16x64_bf16 v[116:119], v[24:27], v[168:175], v8
    ds_read_b128 v[16:19], v2 offset:16384
    v_smfmac_f32_16x16x64_bf16 v[112:115], v[28:31], v[176:183], v8
    ds_read_b128 v[20:23], v2 offset:17408
    s_waitcnt lgkmcnt(4)
    v_smfmac_f32_16x16x64_bf16 v[96:99], v[32:35], v[48:55], v8
    ds_read_b128 v[44:47], v2 offset:23552
    v_smfmac_f32_16x16x64_bf16 v[100:103], v[32:35], v[56:63], v8
    ds_read_b128 v[48:51], v0 offset:45056
    s_waitcnt lgkmcnt(5)
    v_smfmac_f32_16x16x64_bf16 v[96:99], v[36:39], v[64:71], v8
    ds_read_b128 v[52:55], v0 offset:46080
    v_smfmac_f32_16x16x64_bf16 v[100:103], v[36:39], v[72:79], v8
    ds_read_b128 v[56:59], v0 offset:47104
    s_waitcnt lgkmcnt(6)
    v_smfmac_f32_16x16x64_bf16 v[96:99], v[40:43], v[80:87], v8
    ds_read_b128 v[60:63], v0 offset:48128
    v_smfmac_f32_16x16x64_bf16 v[100:103], v[40:43], v[88:95], v8
    ds_read_b128 v[64:67], v2 offset:4096
    s_waitcnt lgkmcnt(7)
    v_smfmac_f32_16x16x64_bf16 v[96:99], v[16:19], a[0:7], v8
    ds_read_b128 v[68:71], v2 offset:5120
    v_smfmac_f32_16x16x64_bf16 v[100:103], v[16:19], a[8:15], v8
    ds_read_b128 v[72:75], v2 offset:6144
    s_waitcnt lgkmcnt(8)
    v_smfmac_f32_16x16x64_bf16 v[96:99], v[20:23], a[16:23], v8
    ds_read_b128 v[76:79], v2 offset:7168
    v_smfmac_f32_16x16x64_bf16 v[100:103], v[20:23], a[24:31], v8
    s_waitcnt lgkmcnt(8)
    s_waitcnt lgkmcnt(6)
    v_smfmac_f32_16x16x64_bf16 v[96:99], v[44:47], v[48:55], v8
    ds_read_b128 v[48:51], v2 offset:0
    s_waitcnt lgkmcnt(5)
    v_smfmac_f32_16x16x64_bf16 v[100:103], v[44:47], v[56:63], v8
    ds_read_b128 v[52:55], v2 offset:1024
    v_smfmac_f32_16x16x64_bf16 v[104:107], v[32:35], a[192:199], v8
    ds_read_b128 v[56:59], v2 offset:2048
    s_add_u32 s36, s36, 786432
    s_mov_b32 m0, s43
    v_smfmac_f32_16x16x64_bf16 v[108:111], v[32:35], a[200:207], v8
    ds_read_b128 v[60:63], v2 offset:3072
    buffer_store_dwordx4 v[120:123], v0, s[8:11], s37 offen sc1
    s_add_u32 s42, s42, 786432
    v_smfmac_f32_16x16x64_bf16 v[104:107], v[36:39], a[208:215], v8
    v_add_f32 v96, v96, v97
    v_add_f32 v98, v98, v99
    v_smfmac_f32_16x16x64_bf16 v[108:111], v[36:39], a[216:223], v8
    v_add_f32 v100, v100, v101
    v_add_f32 v102, v102, v103
    v_smfmac_f32_16x16x64_bf16 v[104:107], v[40:43], a[224:231], v8
    v_cvt_pk_bf16_f32 v124, v96, v98
    v_cvt_pk_bf16_f32 v125, v100, v102
    v_smfmac_f32_16x16x64_bf16 v[108:111], v[40:43], a[232:239], v8
    ds_write2st64_b32 v9, v124, v125 offset0:0 offset1:2
    v_smfmac_f32_16x16x64_bf16 v[104:107], v[16:19], a[128:135], v8
    s_mov_b32 s94, s24
    v_smfmac_f32_16x16x64_bf16 v[108:111], v[16:19], a[136:143], v8
    buffer_store_dword v11, v7, s[8:11], s93 offen sc1
    v_smfmac_f32_16x16x64_bf16 v[104:107], v[20:23], a[144:151], v8
    v_smfmac_f32_16x16x64_bf16 v[108:111], v[20:23], a[152:159], v8
    s_add_u32 s37, s37, 131072
    s_waitcnt lgkmcnt(0)
    s_barrier
    v_smfmac_f32_16x16x64_bf16 v[104:107], v[44:47], a[240:247], v8
    ds_read_b64_tr_b16 v[80:81], v6 offset:0
    ds_read_b64_tr_b16 v[82:83], v6 offset:512
    v_smfmac_f32_16x16x64_bf16 v[108:111], v[44:47], a[248:255], v8
    ds_read_b64_tr_b16 v[84:85], v6 offset:128
    ds_read_b64_tr_b16 v[86:87], v6 offset:640
    v_smfmac_f32_16x16x64_bf16 v[116:119], v[28:31], v[184:191], v8
    ds_read_b64_tr_b16 v[88:89], v6 offset:256
    ds_read_b64_tr_b16 v[90:91], v6 offset:768
    v_smfmac_f32_16x16x64_bf16 v[112:115], v[32:35], v[192:199], v8
    ds_read_b64_tr_b16 v[92:93], v6 offset:384
    ds_read_b64_tr_b16 v[94:95], v6 offset:896
    v_add_f32 v104, v104, v105
    v_add_f32 v106, v106, v107
    v_add_f32 v108, v108, v109
    v_add_f32 v110, v110, v111
    v_cvt_pk_bf16_f32 v120, v104, v106
    v_cvt_pk_bf16_f32 v121, v108, v110
    s_waitcnt lgkmcnt(4)
    v_mfma_f32_16x16x32_bf16 v[96:99], v[48:51], v[80:83], 0
    ds_write2st64_b32 v10, v120, v121 offset0:9 offset1:11
    v_mfma_f32_16x16x32_bf16 v[100:103], v[64:67], v[80:83], 0
    v_mfma_f32_16x16x32_bf16 v[96:99], v[52:55], v[84:87], v[96:99]
    buffer_load_dwordx4 v0, s[8:11], s36 offen offset:0 sc1 lds
    v_mov_b64 v[126:127], s[26:27]
    v_mfma_f32_16x16x32_bf16 v[100:103], v[68:71], v[84:87], v[100:103]
    s_waitcnt lgkmcnt(0)
    s_barrier
    v_mfma_f32_16x16x32_bf16 v[96:99], v[56:59], v[88:91], v[96:99]
    ds_read_b64_tr_b16 v[48:49], v15 offset:2304
    ds_read_b64_tr_b16 v[50:51], v15 offset:2816
    v_mfma_f32_16x16x32_bf16 v[100:103], v[72:75], v[88:91], v[100:103]
    ds_read_b64_tr_b16 v[64:65], v15 offset:2432
    ds_read_b64_tr_b16 v[66:67], v15 offset:2944
    v_mfma_f32_16x16x32_bf16 v[96:99], v[60:63], v[92:95], v[96:99]
    ds_read_b64_tr_b16 v[52:53], v15 offset:2560
    ds_read_b64_tr_b16 v[54:55], v15 offset:3072
    v_mfma_f32_16x16x32_bf16 v[100:103], v[76:79], v[92:95], v[100:103]
    ds_read_b64_tr_b16 v[68:69], v15 offset:2688
    ds_read_b64_tr_b16 v[70:71], v15 offset:3200
    s_waitcnt lgkmcnt(6)
    v_mfma_f32_16x16x32_bf16 v[104:107], v[48:51], v[80:83], 0
    ds_read_b128 v[56:59], v2 offset:10240
    v_mov_b64 v[124:125], s[26:27]
    s_waitcnt lgkmcnt(5)
    v_mfma_f32_16x16x32_bf16 v[104:107], v[64:67], v[84:87], v[104:107]
    ds_read_b128 v[60:63], v2 offset:11264
    v_max3_f32 v12, v96, v97, v98
    s_waitcnt lgkmcnt(4)
    v_mfma_f32_16x16x32_bf16 v[104:107], v[52:55], v[88:91], v[104:107]
    buffer_load_dwordx4 v0, s[8:11], s36 offen offset:1024 sc1 lds
    v_max3_f32 v13, v99, v100, v101
    v_max3_f32 v12, v12, v102, v103
    s_waitcnt lgkmcnt(2)
    v_mfma_f32_16x16x32_bf16 v[104:107], v[68:71], v[92:95], v[104:107]
    v_max_f32 v12, v12, v13
    v_smfmac_f32_16x16x64_bf16 v[116:119], v[32:35], v[200:207], v8
    ds_read_b128 v[80:83], v1 offset:8192
    s_add_u32 m0, s43, 8192
    v_smfmac_f32_16x16x64_bf16 v[112:115], v[36:39], v[208:215], v8
    ds_read_b128 v[84:87], v1 offset:9216
    s_add_u32 s24, s24, 1
    s_nop 0
    v_max3_f32 v12, v12, v104, v105
    v_mov_b32 v13, v12
    v_smfmac_f32_16x16x64_bf16 v[116:119], v[36:39], v[216:223], v8
    ds_read_b128 v[88:91], v1 offset:40960
    v_permlane32_swap_b32 v12, v13
    v_max_f32 v12, v12, v13
    v_mov_b32 v13, v12
    v_smfmac_f32_16x16x64_bf16 v[112:115], v[40:43], v[224:231], v8
    ds_read_b128 v[92:95], v1 offset:41984
    v_permlane16_swap_b32 v12, v13
    v_max_f32 v12, v12, v13
    v_mul_f32 v12, s40, v12
    v_pk_fma_f32 v[96:97], v[96:97], s[40:41], v[12:13] op_sel_hi:[1,1,0] neg_lo:[0,0,1] neg_hi:[0,0,1]
    v_pk_fma_f32 v[98:99], v[98:99], s[40:41], v[12:13] op_sel_hi:[1,1,0] neg_lo:[0,0,1] neg_hi:[0,0,1]
    v_pk_fma_f32 v[100:101], v[100:101], s[40:41], v[12:13] op_sel_hi:[1,1,0] neg_lo:[0,0,1] neg_hi:[0,0,1]
    v_pk_fma_f32 v[102:103], v[102:103], s[40:41], v[12:13] op_sel_hi:[1,1,0] neg_lo:[0,0,1] neg_hi:[0,0,1]
    v_pk_fma_f32 v[104:105], v[104:105], s[40:41], v[12:13] op_sel_hi:[1,1,0] neg_lo:[0,0,1] neg_hi:[0,0,1]
    v_smfmac_f32_16x16x64_bf16 v[116:119], v[40:43], v[232:239], v8
    ds_read_b128 v[48:51], v1 offset:10240
    v_exp_f32 v96, v96
    v_smfmac_f32_16x16x64_bf16 v[112:115], v[16:19], v[128:135], v8
    ds_read_b128 v[52:55], v1 offset:11264
    v_exp_f32 v97, v97
    v_smfmac_f32_16x16x64_bf16 v[116:119], v[16:19], v[136:143], v8
    ds_read_b128 v[64:67], v1 offset:43008
    v_exp_f32 v98, v98
    s_waitcnt lgkmcnt(7)
    v_smfmac_f32_16x16x64_bf16 v[112:115], v[20:23], v[144:151], v8
    buffer_load_dwordx4 v0, s[8:11], s42 offen offset:0 sc1 lds
    v_exp_f32 v99, v99
    v_smfmac_f32_16x16x64_bf16 v[116:119], v[20:23], v[152:159], v8
    ds_read_b128 v[68:71], v1 offset:44032
    v_exp_f32 v100, v100
    v_smfmac_f32_16x16x64_bf16 v[112:115], v[44:47], v[240:247], v8
    buffer_load_dwordx4 v0, s[8:11], s42 offen offset:1024 sc1 lds
    v_exp_f32 v101, v101
    v_smfmac_f32_16x16x64_bf16 v[116:119], v[44:47], v[248:255], v8
    v_exp_f32 v102, v102
    v_exp_f32 v103, v103
    v_mov_b64 v[12:13], 0
    v_mov_b64 v[14:15], 0
    v_cvt_pk_bf16_f32 v72, v96, v97
    v_cvt_pk_bf16_f32 v73, v98, v99
    v_cvt_pk_bf16_f32 v74, v100, v101
    v_cvt_pk_bf16_f32 v75, v102, v103
    v_exp_f32 v104, v104
    v_exp_f32 v105, v105
    v_mfma_f32_16x16x32_bf16 v[108:111], v[72:75], v[124:127], 0
    v_cvt_pk_bf16_f32 v104, v104, v105
    v_add_f32 v112, v112, v113
    v_smfmac_f32_16x16x64_bf16 v[12:15], v[72:75], v[56:63], v8 abid:1
    v_cndmask_b32 v76, v104, 0, s[78:79]
    v_cndmask_b32 v77, 0, v104, s[78:79]
    v_add_f32 v114, v114, v115
    v_add_f32 v116, v116, v117
    v_mfma_f32_16x16x16_bf16 v[108:111], v[76:77], v[124:125], v[108:111]
    v_add_f32 v118, v118, v119
    v_cvt_pk_bf16_f32 v122, v112, v114
    v_cvt_pk_bf16_f32 v123, v116, v118
    s_nop 1
    v_mfma_f32_16x16x16_bf16 v[12:15], v[76:77], v[122:123], v[12:15]
    s_nop 1
    v_rcp_f32 v108, v108
    s_nop 0
    v_rcp_f32 v109, v109
    s_nop 0
    v_rcp_f32 v110, v110
    s_nop 0
    v_rcp_f32 v111, v111
    s_nop 0
    v_pk_mul_f32 v[12:13], v[12:13], v[108:109]
    v_pk_mul_f32 v[14:15], v[14:15], v[110:111]
    v_cvt_pk_bf16_f32 v12, v12, v13
    v_cvt_pk_bf16_f32 v13, v14, v15
    ds_write_b64 v5, v[12:13] offset:128
    v_mov_b64 v[72:73], 0
    v_mov_b64 v[74:75], 0
    v_mov_b64 v[76:77], 0
    v_mov_b64 v[78:79], 0
    v_mov_b64 v[56:57], 0
    v_mov_b64 v[58:59], 0
    v_mov_b64 v[60:61], 0
    v_mov_b64 v[62:63], 0
    s_waitcnt lgkmcnt(0)
    s_barrier
    ds_read_b64_tr_b16 v[96:97], v6 offset:0
    ds_read_b64_tr_b16 v[98:99], v6 offset:512
    ds_read_b64_tr_b16 v[100:101], v6 offset:128
    ds_read_b64_tr_b16 v[102:103], v6 offset:640
    ds_read_b64_tr_b16 v[104:105], v6 offset:256
    ds_read_b64_tr_b16 v[106:107], v6 offset:768
    ds_read_b64_tr_b16 v[108:109], v6 offset:384
    ds_read_b64_tr_b16 v[110:111], v6 offset:896
    s_waitcnt lgkmcnt(6)
    v_smfmac_f32_16x16x64_bf16 v[72:75], v[96:99], a[64:71], v8 abid:1
    ds_read_b128 v[16:19], v1 offset:12288
    s_waitcnt lgkmcnt(5)
    v_smfmac_f32_16x16x64_bf16 v[72:75], v[100:103], a[96:103], v8 abid:1
    ds_read_b128 v[20:23], v1 offset:13312
    s_waitcnt lgkmcnt(4)
    v_smfmac_f32_16x16x64_bf16 v[72:75], v[104:107], v[80:87], v8 abid:1
    ds_read_b128 v[24:27], v1 offset:45056
    s_waitcnt lgkmcnt(3)
    v_smfmac_f32_16x16x64_bf16 v[72:75], v[108:111], v[88:95], v8 abid:1
    ds_read_b128 v[28:31], v1 offset:46080
    v_smfmac_f32_16x16x64_bf16 v[76:79], v[96:99], a[72:79], v8 abid:1
    ds_read_b128 v[32:35], v1 offset:14336
    s_nop 0
    v_mov_b64 v[112:113], 0
    v_smfmac_f32_16x16x64_bf16 v[76:79], v[100:103], a[104:111], v8 abid:1
    ds_read_b128 v[36:39], v1 offset:15360
    s_nop 0
    v_cvt_pk_bf16_f32 v72, v72, v73
    v_cvt_pk_bf16_f32 v73, v74, v75
    v_and_or_b32 v72, v72, -2, s38
    v_smfmac_f32_16x16x64_bf16 v[76:79], v[104:107], v[48:55], v8 abid:1
    buffer_store_dwordx2 v[72:73], v3, s[8:11], s28 offen
    v_smfmac_f32_16x16x64_bf16 v[76:79], v[108:111], v[64:71], v8 abid:1
    ds_read_b128 v[40:43], v1 offset:47104
    v_smfmac_f32_16x16x64_bf16 v[56:59], v[96:99], a[80:87], v8 abid:1
    ds_read_b128 v[44:47], v1 offset:48128
    s_nop 0
    v_mov_b64 v[114:115], 0
    v_smfmac_f32_16x16x64_bf16 v[56:59], v[100:103], a[112:119], v8 abid:1
    s_nop 0
    s_nop 0
    v_cvt_pk_bf16_f32 v76, v76, v77
    v_cvt_pk_bf16_f32 v77, v78, v79
    v_and_or_b32 v76, v76, -2, s38
    s_waitcnt lgkmcnt(4)
    v_smfmac_f32_16x16x64_bf16 v[56:59], v[104:107], v[16:23], v8 abid:1
    buffer_store_dwordx2 v[76:77], v3, s[8:11], s29 offen
    v_smfmac_f32_16x16x64_bf16 v[56:59], v[108:111], v[24:31], v8 abid:1
    v_smfmac_f32_16x16x64_bf16 v[60:63], v[96:99], a[88:95], v8 abid:1
    s_nop 1
    v_mov_b64 v[116:117], 0
    v_smfmac_f32_16x16x64_bf16 v[60:63], v[100:103], a[120:127], v8 abid:1
    s_nop 0
    s_nop 1
    v_cvt_pk_bf16_f32 v56, v56, v57
    v_cvt_pk_bf16_f32 v57, v58, v59
    v_and_or_b32 v56, v56, -2, s38
    s_waitcnt lgkmcnt(0)
    v_smfmac_f32_16x16x64_bf16 v[60:63], v[104:107], v[32:39], v8 abid:1
    buffer_store_dwordx2 v[56:57], v3, s[8:11], s30 offen
    ds_read_b128 v[32:35], v2 offset:31232
    v_smfmac_f32_16x16x64_bf16 v[60:63], v[108:111], v[40:47], v8 abid:1
    s_mov_b32 s39, 0
    v_mov_b64 v[96:97], 0
    v_mov_b64 v[98:99], 0
    s_nop 4
    v_cvt_pk_bf16_f32 v60, v60, v61
    v_cvt_pk_bf16_f32 v61, v62, v63
    v_and_or_b32 v60, v60, -2, s38
    buffer_store_dwordx2 v[60:61], v3, s[8:11], s31 offen
    v_mov_b64 v[100:101], 0
    v_mov_b64 v[102:103], 0
    v_mov_b64 v[104:105], 0
    v_mov_b64 v[106:107], 0
    v_mov_b64 v[108:109], 0
    v_mov_b64 v[110:111], 0
    v_mov_b64 v[118:119], 0
    s_waitcnt vmcnt(3)
    buffer_load_dwordx4 v[24:27], v0, s[8:11], s32 offen offset:0 sc1
    buffer_load_dwordx4 v[28:31], v0, s[8:11], s32 offen offset:1024 sc1
    ds_read_b128 v[48:51], v0 offset:8192
    ds_read_b128 v[52:55], v0 offset:9216
    ds_read_b128 v[56:59], v0 offset:10240
    s_waitcnt vmcnt(3)
    buffer_load_dwordx4 v[16:19], v0, s[8:11], s32 offen offset:0 sc1
    buffer_load_dwordx4 v[20:23], v0, s[8:11], s32 offen offset:1024 sc1
    v_pk_min_u16 v120, v120, s45
    v_pk_min_u16 v121, v121, s45
    v_pk_min_u16 v122, v122, s45
    v_pk_min_u16 v123, v123, s45
    v_mov_b32 v15, -1
    s_waitcnt lgkmcnt(3)
R1_h1a:
    s_waitcnt vmcnt(3)
    v_mfma_f32_16x16x32_bf16 v[36:39], v[24:27], v[32:35], 0
    v_bitop3_b32 v12, v24, v26, s38 bitop3:0x7e
    s_waitcnt vmcnt(2)
    v_mfma_f32_16x16x32_bf16 v[36:39], v[28:31], v[32:35], v[36:39]
    v_bitop3_b32 v13, v28, v30, s38 bitop3:0x7e
    v_bitop3_b32 v12, v12, v13, 1 bitop3:0xa8
    v_cmp_ne_u32 vcc, 0, v12
    s_nop 0
    s_cbranch_vccnz R1_h1
R1_h1ok:
    s_nop 3
    v_permlane32_swap_b32 v36, v38
    v_permlane32_swap_b32 v37, v39
    v_add_f32 v36, v36, v38
    v_add_f32 v37, v37, v39
    s_nop 1
    v_permlane16_swap_b32 v36, v37
    v_add_f32 v12, v36, v37
    s_nop 1
    v_mov_b32_dpp v13, v12 row_shl:4 row_mask:0xf bank_mask:0xf
    v_cvt_pk_bf16_f32 v12, v12, v13
    v_min_u32 v12, -2, v12
    buffer_store_dword v12, v4, s[8:11], s34 offen
    s_xor_b32 s32, s32, 1048576
    s_lshr_b32 s38, s24, 1
    buffer_store_dword v15, v4, s[8:11], s35 offen
    s_xor_b32 s35, s35, 8192
    v_mov_b32 v11, s94
    s_xor_b32 s28, s28, 1048576
    s_xor_b32 s29, s29, 1048576
    s_xor_b32 s30, s30, 1048576
    s_xor_b32 s31, s31, 1048576
    s_xor_b32 s34, s34, 8192
    s_and_b32 s38, s38, 1
    s_lshl_b32 s39, s39, 16
    s_xor_b32 s92, s92, 4096
    s_mov_b32 s25, 0
    s_cmp_eq_u32 s24, 63
    s_cbranch_scc1 R1_last
    s_waitcnt vmcnt(1)
    buffer_load_dwordx4 v[24:27], v0, s[8:11], s33 offen sc1
    buffer_load_dwordx4 v[28:31], v0, s[8:11], s33 offen offset:1024 sc1
    ds_read_b128 v[60:63], v0 offset:11264
    ds_read_b128 v[64:67], v0 offset:12288
    ds_read_b128 v[68:71], v0 offset:13312
    ds_read_b128 v[72:75], v0 offset:14336
    ds_read_b128 v[76:79], v0 offset:15360
    ds_read_b128 v[80:83], v0 offset:40960
    ds_read_b128 v[84:87], v0 offset:41984
    ds_read_b128 v[88:91], v0 offset:43008
    ds_read_b128 v[92:95], v0 offset:44032
    s_waitcnt lgkmcnt(0)
    buffer_load_dwordx4 v[32:35], v0, s[8:11], s33 offen sc1
    buffer_load_dwordx4 v[36:39], v0, s[8:11], s33 offen offset:1024 sc1
    s_branch R1_h2a
R1_h1:
    buffer_load_dwordx4 v[24:27], v0, s[8:11], s32 offen offset:0 sc1
    buffer_load_dwordx4 v[28:31], v0, s[8:11], s32 offen offset:1024 sc1
    s_add_u32 s39, s39, 1
    s_cmp_gt_u32 s39, 60000
    s_cbranch_scc1 L_fail
    s_waitcnt vmcnt(3)
    v_mfma_f32_16x16x32_bf16 v[36:39], v[16:19], v[32:35], 0
    v_bitop3_b32 v12, v16, v18, s38 bitop3:0x7e
    s_waitcnt vmcnt(2)
    v_mfma_f32_16x16x32_bf16 v[36:39], v[20:23], v[32:35], v[36:39]
    v_bitop3_b32 v13, v20, v22, s38 bitop3:0x7e
    v_bitop3_b32 v12, v12, v13, 1 bitop3:0xa8
    v_cmp_ne_u32 vcc, 0, v12
    s_nop 0
    s_cbranch_vccz R1_h1ok
    buffer_load_dwordx4 v[16:19], v0, s[8:11], s32 offen offset:0 sc1
    buffer_load_dwordx4 v[20:23], v0, s[8:11], s32 offen offset:1024 sc1
    s_add_u32 s39, s39, 1
    s_branch R1_h1a
R1_h2:
    s_nop 5
    v_mov_b64 v[96:97], 0
    v_mov_b64 v[98:99], 0
    s_add_u32 s25, s25, 1
    s_cmp_gt_u32 s25, 60000
    s_cbranch_scc1 L_fail
    s_waitcnt vmcnt(1)
    v_max3_u32 v12, v32, v33, v34
    s_waitcnt vmcnt(0)
    v_max3_u32 v13, v35, v36, v37
    v_max3_u32 v12, v12, v38, v39
    v_max_u32 v12, v12, v13
    v_cmp_eq_u32 vcc, -1, v12
    s_nop 0
    s_cbranch_vccnz R1_h2b
    v_mov_b64 v[24:25], v[32:33]
    v_mov_b64 v[26:27], v[34:35]
    v_mov_b64 v[28:29], v[36:37]
    v_mov_b64 v[30:31], v[38:39]
    s_branch R1_top
R1_h2b:
    buffer_load_dwordx4 v[24:27], v0, s[8:11], s33 offen sc1
    buffer_load_dwordx4 v[28:31], v0, s[8:11], s33 offen offset:1024 sc1
    s_waitcnt vmcnt(1)
    buffer_load_dwordx4 v[32:35], v0, s[8:11], s33 offen sc1
    buffer_load_dwordx4 v[36:39], v0, s[8:11], s33 offen offset:1024 sc1
    s_add_u32 s25, s25, 1
    s_branch R1_h2a
R1_top:
    v_smfmac_f32_16x16x64_bf16 v[96:99], v[24:27], a[32:39], v8
    ds_write_b128 v2, v[24:27] offset:18432
    s_branch R1_top1
R1_last:
    s_waitcnt vmcnt(0)
R1_l2:
    buffer_load_dwordx4 v[24:27], v0, s[8:11], s33 offen sc1
    buffer_load_dwordx4 v[28:31], v0, s[8:11], s33 offen offset:1024 sc1
    s_add_u32 s25, s25, 1
    s_cmp_gt_u32 s25, 60000
    s_cbranch_scc1 L_fail
    s_waitcnt vmcnt(1)
    v_max3_u32 v12, v24, v25, v26
    s_waitcnt vmcnt(0)
    v_max3_u32 v13, v27, v28, v29
    v_max3_u32 v12, v12, v30, v31
    v_max_u32 v12, v12, v13
    v_cmp_eq_u32 vcc, -1, v12
    s_nop 0
    s_cbranch_vccnz R1_l2
    v_smfmac_f32_16x16x64_bf16 v[104:107], v[24:27], a[160:167], v8
    ds_write_b128 v2, v[24:27] offset:18432
    v_smfmac_f32_16x16x64_bf16 v[108:111], v[24:27], a[168:175], v8
    ds_write_b128 v2, v[28:31] offset:19456
    v_smfmac_f32_16x16x64_bf16 v[112:115], v[24:27], v[160:167], v8
    v_smfmac_f32_16x16x64_bf16 v[116:119], v[24:27], v[168:175], v8
    v_smfmac_f32_16x16x64_bf16 v[104:107], v[28:31], a[176:183], v8
    v_smfmac_f32_16x16x64_bf16 v[108:111], v[28:31], a[184:191], v8
    v_smfmac_f32_16x16x64_bf16 v[112:115], v[28:31], v[176:183], v8
    s_waitcnt lgkmcnt(0)
    s_barrier
    ds_read_b128 v[32:35], v2 offset:20480
    ds_read_b128 v[36:39], v2 offset:21504
    ds_read_b128 v[40:43], v2 offset:22528
    ds_read_b128 v[16:19], v2 offset:16384
    ds_read_b128 v[20:23], v2 offset:17408
    ds_read_b128 v[44:47], v2 offset:23552
    v_smfmac_f32_16x16x64_bf16 v[116:119], v[28:31], v[184:191], v8
    buffer_store_dwordx4 v[120:123], v0, s[8:11], s37 offen sc1
    s_add_u32 s37, s37, 131072
    s_waitcnt lgkmcnt(5)
    v_smfmac_f32_16x16x64_bf16 v[104:107], v[32:35], a[192:199], v8
    v_smfmac_f32_16x16x64_bf16 v[108:111], v[32:35], a[200:207], v8
    v_smfmac_f32_16x16x64_bf16 v[112:115], v[32:35], v[192:199], v8
    v_smfmac_f32_16x16x64_bf16 v[116:119], v[32:35], v[200:207], v8
    s_waitcnt lgkmcnt(4)
    v_smfmac_f32_16x16x64_bf16 v[104:107], v[36:39], a[208:215], v8
    v_smfmac_f32_16x16x64_bf16 v[108:111], v[36:39], a[216:223], v8
    v_smfmac_f32_16x16x64_bf16 v[112:115], v[36:39], v[208:215], v8
    v_smfmac_f32_16x16x64_bf16 v[116:119], v[36:39], v[216:223], v8
    s_waitcnt lgkmcnt(3)
    v_smfmac_f32_16x16x64_bf16 v[104:107], v[40:43], a[224:231], v8
    v_smfmac_f32_16x16x64_bf16 v[108:111], v[40:43], a[232:239], v8
    v_smfmac_f32_16x16x64_bf16 v[112:115], v[40:43], v[224:231], v8
    v_smfmac_f32_16x16x64_bf16 v[116:119], v[40:43], v[232:239], v8
    s_waitcnt lgkmcnt(2)
    v_smfmac_f32_16x16x64_bf16 v[104:107], v[16:19], a[128:135], v8
    v_smfmac_f32_16x16x64_bf16 v[108:111], v[16:19], a[136:143], v8
    v_smfmac_f32_16x16x64_bf16 v[112:115], v[16:19], v[128:135], v8
    v_smfmac_f32_16x16x64_bf16 v[116:119], v[16:19], v[136:143], v8
    s_waitcnt lgkmcnt(1)
    v_smfmac_f32_16x16x64_bf16 v[104:107], v[20:23], a[144:151], v8
    v_smfmac_f32_16x16x64_bf16 v[108:111], v[20:23], a[152:159], v8
    v_smfmac_f32_16x16x64_bf16 v[112:115], v[20:23], v[144:151], v8
    v_smfmac_f32_16x16x64_bf16 v[116:119], v[20:23], v[152:159], v8
    s_waitcnt lgkmcnt(0)
    v_smfmac_f32_16x16x64_bf16 v[104:107], v[44:47], a[240:247], v8
    v_smfmac_f32_16x16x64_bf16 v[108:111], v[44:47], a[248:255], v8
    v_smfmac_f32_16x16x64_bf16 v[112:115], v[44:47], v[240:247], v8
    v_smfmac_f32_16x16x64_bf16 v[116:119], v[44:47], v[248:255], v8
    s_nop 4
    v_add_f32 v104, v104, v105
    v_add_f32 v106, v106, v107
    v_add_f32 v108, v108, v109
    v_add_f32 v110, v110, v111
    v_cvt_pk_bf16_f32 v120, v104, v106
    v_cvt_pk_bf16_f32 v121, v108, v110
    v_add_f32 v112, v112, v113
    v_add_f32 v114, v114, v115
    v_add_f32 v116, v116, v117
    v_add_f32 v118, v118, v119
    v_cvt_pk_bf16_f32 v122, v112, v114
    v_cvt_pk_bf16_f32 v123, v116, v118
    v_pk_min_u16 v120, v120, s45
    v_pk_min_u16 v121, v121, s45
    v_pk_min_u16 v122, v122, s45
    v_pk_min_u16 v123, v123, s45
    buffer_store_dwordx4 v[120:123], v0, s[8:11], s37 offen sc1
    v_mov_b32 v15, 64
    s_waitcnt vmcnt(0)
    s_barrier
    buffer_store_dword v15, v7, s[8:11], s93 offen sc1
    s_branch L_exit_r
L_w2:
    v_mov_b64 v[32:33], v[64:65]
    v_mov_b64 v[34:35], v[66:67]
    v_mov_b64 v[36:37], v[68:69]
    v_mov_b64 v[38:39], v[70:71]
    ds_read_b128 v[48:51], v0 offset:16384
    ds_read_b128 v[52:55], v0 offset:17408
    ds_read_b128 v[56:59], v0 offset:18432
    ds_read_b128 v[60:63], v0 offset:19456
    ds_read_b128 v[64:67], v0 offset:20480
    ds_read_b128 v[68:71], v0 offset:21504
    ds_read_b128 v[72:75], v0 offset:22528
    ds_read_b128 v[76:79], v0 offset:23552
    ds_read_b128 v[80:83], v0 offset:49152
    ds_read_b128 v[84:87], v0 offset:50176
    ds_read_b128 v[88:91], v0 offset:51200
    ds_read_b128 v[92:95], v0 offset:52224
    v_mov_b64 v[96:97], 0
    v_mov_b64 v[98:99], 0
    v_mov_b64 v[100:101], 0
    v_mov_b64 v[102:103], 0
    v_mov_b64 v[104:105], 0
    v_mov_b64 v[106:107], 0
    v_mov_b64 v[108:109], 0
    v_mov_b64 v[110:111], 0
    v_mov_b64 v[112:113], 0
    v_mov_b64 v[114:115], 0
    v_mov_b64 v[116:117], 0
    v_mov_b64 v[118:119], 0
    v_mov_b32 v15, -1
    v_mov_b32 v11, 0
    s_waitcnt lgkmcnt(0)
    s_branch R2_top
.p2align 6
    s_nop 0
    s_nop 0
R2_h2a:
    s_waitcnt lgkmcnt(0)
    s_waitcnt vmcnt(3)
    v_max3_u32 v12, v32, v33, v34
    s_waitcnt vmcnt(2)
    v_max3_u32 v13, v35, v36, v37
    v_max3_u32 v12, v12, v38, v39
    v_max_u32 v12, v12, v13
    v_cmp_eq_u32 vcc, -1, v12
    v_smfmac_f32_16x16x64_bf16 v[96:99], v[32:35], v[48:55], v8
    ds_write_b128 v2, v[32:35] offset:20480
    s_cbranch_vccnz R2_h2
R2_top1:
    v_smfmac_f32_16x16x64_bf16 v[100:103], v[32:35], v[56:63], v8
    ds_write_b128 v2, v[36:39] offset:21504
    s_xor_b32 s33, s33, 8192
    v_smfmac_f32_16x16x64_bf16 v[96:99], v[36:39], v[64:71], v8
    v_add_u32 v15, 2176, v6
    v_smfmac_f32_16x16x64_bf16 v[100:103], v[36:39], v[72:79], v8
    v_cndmask_b32 v15, v6, v15, s[60:61]
    v_smfmac_f32_16x16x64_bf16 v[104:107], v[32:35], a[192:199], v8
    v_smfmac_f32_16x16x64_bf16 v[108:111], v[32:35], a[200:207], v8
    v_smfmac_f32_16x16x64_bf16 v[104:107], v[36:39], a[208:215], v8
    s_waitcnt vmcnt(0) lgkmcnt(0)
    s_barrier
    ds_read_b128 v[40:43], v2 offset:22528
    v_smfmac_f32_16x16x64_bf16 v[108:111], v[36:39], a[216:223], v8
    ds_read_b128 v[16:19], v2 offset:16384
    v_smfmac_f32_16x16x64_bf16 v[112:115], v[32:35], v[192:199], v8
    ds_read_b128 v[20:23], v2 offset:17408
    v_smfmac_f32_16x16x64_bf16 v[116:119], v[32:35], v[200:207], v8
    ds_read_b128 v[24:27], v2 offset:18432
    v_smfmac_f32_16x16x64_bf16 v[112:115], v[36:39], v[208:215], v8
    ds_read_b128 v[28:31], v2 offset:19456
    s_waitcnt lgkmcnt(4)
    v_smfmac_f32_16x16x64_bf16 v[96:99], v[40:43], v[80:87], v8
    ds_read_b128 v[44:47], v2 offset:23552
    v_smfmac_f32_16x16x64_bf16 v[100:103], v[40:43], v[88:95], v8
    ds_read_b128 v[48:51], v0 offset:53248
    s_waitcnt lgkmcnt(5)
    v_smfmac_f32_16x16x64_bf16 v[96:99], v[16:19], a[0:7], v8
    ds_read_b128 v[52:55], v0 offset:54272
    v_smfmac_f32_16x16x64_bf16 v[100:103], v[16:19], a[8:15], v8
    ds_read_b128 v[56:59], v0 offset:55296
    s_waitcnt lgkmcnt(6)
    v_smfmac_f32_16x16x64_bf16 v[96:99], v[20:23], a[16:23], v8
    ds_read_b128 v[60:63], v0 offset:56320
    v_smfmac_f32_16x16x64_bf16 v[100:103], v[20:23], a[24:31], v8
    ds_read_b128 v[64:67], v2 offset:4096
    s_waitcnt lgkmcnt(7)
    v_smfmac_f32_16x16x64_bf16 v[96:99], v[24:27], a[32:39], v8
    ds_read_b128 v[68:71], v2 offset:5120
    v_smfmac_f32_16x16x64_bf16 v[100:103], v[24:27], a[40:47], v8
    ds_read_b128 v[72:75], v2 offset:6144
    s_waitcnt lgkmcnt(8)
    v_smfmac_f32_16x16x64_bf16 v[96:99], v[28:31], a[48:55], v8
    ds_read_b128 v[76:79], v2 offset:7168
    v_smfmac_f32_16x16x64_bf16 v[100:103], v[28:31], a[56:63], v8
    s_waitcnt lgkmcnt(8)
    s_waitcnt lgkmcnt(6)
    v_smfmac_f32_16x16x64_bf16 v[96:99], v[44:47], v[48:55], v8
    ds_read_b128 v[48:51], v2 offset:0
    s_waitcnt lgkmcnt(5)
    v_smfmac_f32_16x16x64_bf16 v[100:103], v[44:47], v[56:63], v8
    ds_read_b128 v[52:55], v2 offset:1024
    v_smfmac_f32_16x16x64_bf16 v[104:107], v[40:43], a[224:231], v8
    ds_read_b128 v[56:59], v2 offset:2048
    buffer_store_dwordx4 v[120:123], v0, s[8:11], s37 offen sc1
    s_add_u32 s36, s36, 786432
    v_smfmac_f32_16x16x64_bf16 v[108:111], v[40:43], a[232:239], v8
    ds_read_b128 v[60:63], v2 offset:3072
    s_mov_b32 m0, s43
    s_add_u32 s42, s42, 786432
    v_smfmac_f32_16x16x64_bf16 v[104:107], v[16:19], a[128:135], v8
    v_add_f32 v96, v96, v97
    v_add_f32 v98, v98, v99
    v_smfmac_f32_16x16x64_bf16 v[108:111], v[16:19], a[136:143], v8
    v_add_f32 v100, v100, v101
    v_add_f32 v102, v102, v103
    v_smfmac_f32_16x16x64_bf16 v[104:107], v[20:23], a[144:151], v8
    v_cvt_pk_bf16_f32 v124, v96, v98
    v_cvt_pk_bf16_f32 v125, v100, v102
    v_smfmac_f32_16x16x64_bf16 v[108:111], v[20:23], a[152:159], v8
    ds_write2st64_b32 v9, v124, v125 offset0:0 offset1:2
    v_smfmac_f32_16x16x64_bf16 v[104:107], v[24:27], a[160:167], v8
    s_mov_b32 s94, s24
    v_smfmac_f32_16x16x64_bf16 v[108:111], v[24:27], a[168:175], v8
    v_smfmac_f32_16x16x64_bf16 v[104:107], v[28:31], a[176:183], v8
    v_smfmac_f32_16x16x64_bf16 v[108:111], v[28:31], a[184:191], v8
    s_add_u32 s37, s37, 131072
    s_waitcnt lgkmcnt(0)
    s_barrier
    v_smfmac_f32_16x16x64_bf16 v[104:107], v[44:47], a[240:247], v8
    ds_read_b64_tr_b16 v[80:81], v6 offset:0
    ds_read_b64_tr_b16 v[82:83], v6 offset:512
    v_smfmac_f32_16x16x64_bf16 v[108:111], v[44:47], a[248:255], v8
    ds_read_b64_tr_b16 v[84:85], v6 offset:128
    ds_read_b64_tr_b16 v[86:87], v6 offset:640
    v_smfmac_f32_16x16x64_bf16 v[116:119], v[36:39], v[216:223], v8
    ds_read_b64_tr_b16 v[88:89], v6 offset:256
    ds_read_b64_tr_b16 v[90:91], v6 offset:768
    v_smfmac_f32_16x16x64_bf16 v[112:115], v[40:43], v[224:231], v8
    ds_read_b64_tr_b16 v[92:93], v6 offset:384
    ds_read_b64_tr_b16 v[94:95], v6 offset:896
    v_add_f32 v104, v104, v105
    v_add_f32 v106, v106, v107
    v_add_f32 v108, v108, v109
    v_add_f32 v110, v110, v111
    v_cvt_pk_bf16_f32 v120, v104, v106
    v_cvt_pk_bf16_f32 v121, v108, v110
    s_waitcnt lgkmcnt(4)
    v_mfma_f32_16x16x32_bf16 v[96:99], v[48:51], v[80:83], 0
    ds_write2st64_b32 v10, v120, v121 offset0:9 offset1:11
    v_mfma_f32_16x16x32_bf16 v[100:103], v[64:67], v[80:83], 0
    v_mfma_f32_16x16x32_bf16 v[96:99], v[52:55], v[84:87], v[96:99]
    v_mov_b64 v[126:127], s[26:27]
    v_mfma_f32_16x16x32_bf16 v[100:103], v[68:71], v[84:87], v[100:103]
    buffer_load_dwordx4 v0, s[8:11], s36 offen offset:0 sc1 lds
    s_waitcnt lgkmcnt(0)
    s_barrier
    v_mfma_f32_16x16x32_bf16 v[96:99], v[56:59], v[88:91], v[96:99]
    ds_read_b64_tr_b16 v[48:49], v15 offset:2304
    ds_read_b64_tr_b16 v[50:51], v15 offset:2816
    v_mfma_f32_16x16x32_bf16 v[100:103], v[72:75], v[88:91], v[100:103]
    ds_read_b64_tr_b16 v[64:65], v15 offset:2432
    ds_read_b64_tr_b16 v[66:67], v15 offset:2944
    v_mfma_f32_16x16x32_bf16 v[96:99], v[60:63], v[92:95], v[96:99]
    ds_read_b64_tr_b16 v[52:53], v15 offset:2560
    ds_read_b64_tr_b16 v[54:55], v15 offset:3072
    v_mfma_f32_16x16x32_bf16 v[100:103], v[76:79], v[92:95], v[100:103]
    ds_read_b64_tr_b16 v[68:69], v15 offset:2688
    ds_read_b64_tr_b16 v[70:71], v15 offset:3200
    s_waitcnt lgkmcnt(6)
    v_mfma_f32_16x16x32_bf16 v[104:107], v[48:51], v[80:83], 0
    ds_read_b128 v[56:59], v2 offset:12288
    v_mov_b64 v[124:125], s[26:27]
    s_waitcnt lgkmcnt(5)
    v_mfma_f32_16x16x32_bf16 v[104:107], v[64:67], v[84:87], v[104:107]
    ds_read_b128 v[60:63], v2 offset:13312
    v_max3_f32 v12, v96, v97, v98
    s_waitcnt lgkmcnt(4)
    v_mfma_f32_16x16x32_bf16 v[104:107], v[52:55], v[88:91], v[104:107]
    v_max3_f32 v13, v99, v100, v101
    v_max3_f32 v12, v12, v102, v103
    s_waitcnt lgkmcnt(2)
    v_mfma_f32_16x16x32_bf16 v[104:107], v[68:71], v[92:95], v[104:107]
    buffer_load_dwordx4 v0, s[8:11], s36 offen offset:1024 sc1 lds
    v_max_f32 v12, v12, v13
    v_smfmac_f32_16x16x64_bf16 v[116:119], v[40:43], v[232:239], v8
    ds_read_b128 v[80:83], v1 offset:16384
    s_add_u32 m0, s43, 8192
    v_smfmac_f32_16x16x64_bf16 v[112:115], v[16:19], v[128:135], v8
    ds_read_b128 v[84:87], v1 offset:17408
    s_add_u32 s24, s24, 1
    v_max3_f32 v12, v12, v104, v105
    v_mov_b32 v13, v12
    v_smfmac_f32_16x16x64_bf16 v[116:119], v[16:19], v[136:143], v8
    ds_read_b128 v[88:91], v1 offset:49152
    v_permlane32_swap_b32 v12, v13
    v_max_f32 v12, v12, v13
    v_mov_b32 v13, v12
    v_smfmac_f32_16x16x64_bf16 v[112:115], v[20:23], v[144:151], v8
    ds_read_b128 v[92:95], v1 offset:50176
    v_permlane16_swap_b32 v12, v13
    v_max_f32 v12, v12, v13
    v_mul_f32 v12, s40, v12
    v_pk_fma_f32 v[96:97], v[96:97], s[40:41], v[12:13] op_sel_hi:[1,1,0] neg_lo:[0,0,1] neg_hi:[0,0,1]
    v_pk_fma_f32 v[98:99], v[98:99], s[40:41], v[12:13] op_sel_hi:[1,1,0] neg_lo:[0,0,1] neg_hi:[0,0,1]
    v_pk_fma_f32 v[100:101], v[100:101], s[40:41], v[12:13] op_sel_hi:[1,1,0] neg_lo:[0,0,1] neg_hi:[0,0,1]
    v_pk_fma_f32 v[102:103], v[102:103], s[40:41], v[12:13] op_sel_hi:[1,1,0] neg_lo:[0,0,1] neg_hi:[0,0,1]
    v_pk_fma_f32 v[104:105], v[104:105], s[40:41], v[12:13] op_sel_hi:[1,1,0] neg_lo:[0,0,1] neg_hi:[0,0,1]
    v_smfmac_f32_16x16x64_bf16 v[116:119], v[20:23], v[152:159], v8
    ds_read_b128 v[48:51], v1 offset:18432
    v_exp_f32 v96, v96
    v_smfmac_f32_16x16x64_bf16 v[112:115], v[24:27], v[160:167], v8
    ds_read_b128 v[52:55], v1 offset:19456
    v_exp_f32 v97, v97
    v_smfmac_f32_16x16x64_bf16 v[116:119], v[24:27], v[168:175], v8
    ds_read_b128 v[64:67], v1 offset:51200
    v_exp_f32 v98, v98
    v_smfmac_f32_16x16x64_bf16 v[112:115], v[28:31], v[176:183], v8
    ds_read_b128 v[68:71], v1 offset:52224
    v_exp_f32 v99, v99
    s_waitcnt lgkmcnt(8)
    v_smfmac_f32_16x16x64_bf16 v[116:119], v[28:31], v[184:191], v8
    buffer_load_dwordx4 v0, s[8:11], s42 offen offset:0 sc1 lds
    v_exp_f32 v100, v100
    v_smfmac_f32_16x16x64_bf16 v[112:115], v[44:47], v[240:247], v8
    v_exp_f32 v101, v101
    v_smfmac_f32_16x16x64_bf16 v[116:119], v[44:47], v[248:255], v8
    buffer_load_dwordx4 v0, s[8:11], s42 offen offset:1024 sc1 lds
    v_exp_f32 v102, v102
    v_exp_f32 v103, v103
    v_mov_b64 v[12:13], 0
    v_mov_b64 v[14:15], 0
    v_cvt_pk_bf16_f32 v72, v96, v97
    v_cvt_pk_bf16_f32 v73, v98, v99
    v_cvt_pk_bf16_f32 v74, v100, v101
    v_cvt_pk_bf16_f32 v75, v102, v103
    v_exp_f32 v104, v104
    v_exp_f32 v105, v105
    v_mfma_f32_16x16x32_bf16 v[108:111], v[72:75], v[124:127], 0
    v_cvt_pk_bf16_f32 v104, v104, v105
    v_add_f32 v112, v112, v113
    v_smfmac_f32_16x16x64_bf16 v[12:15], v[72:75], v[56:63], v8 abid:1
    v_cndmask_b32 v76, v104, 0, s[78:79]
    v_cndmask_b32 v77, 0, v104, s[78:79]
    v_add_f32 v114, v114, v115
    v_add_f32 v116, v116, v117
    v_mfma_f32_16x16x16_bf16 v[108:111], v[76:77], v[124:125], v[108:111]
    v_add_f32 v118, v118, v119
    v_cvt_pk_bf16_f32 v122, v112, v114
    v_cvt_pk_bf16_f32 v123, v116, v118
    s_nop 1
    v_mfma_f32_16x16x16_bf16 v[12:15], v[76:77], v[122:123], v[12:15]
    s_nop 1
    v_rcp_f32 v108, v108
    s_nop 0
    v_rcp_f32 v109, v109
    s_nop 0
    v_rcp_f32 v110, v110
    s_nop 0
    v_rcp_f32 v111, v111
    s_nop 0
    v_pk_mul_f32 v[12:13], v[12:13], v[108:109]
    v_pk_mul_f32 v[14:15], v[14:15], v[110:111]
    v_cvt_pk_bf16_f32 v12, v12, v13
    v_cvt_pk_bf16_f32 v13, v14, v15
    ds_write_b64 v5, v[12:13] offset:256
    v_mov_b64 v[72:73], 0
    v_mov_b64 v[74:75], 0
    v_mov_b64 v[76:77], 0
    v_mov_b64 v[78:79], 0
    v_mov_b64 v[56:57], 0
    v_mov_b64 v[58:59], 0
    v_mov_b64 v[60:61], 0
    v_mov_b64 v[62:63], 0
    s_waitcnt lgkmcnt(0)
    s_barrier
    ds_read_b64_tr_b16 v[96:97], v6 offset:0
    ds_read_b64_tr_b16 v[98:99], v6 offset:512
    ds_read_b64_tr_b16 v[100:101], v6 offset:128
    ds_read_b64_tr_b16 v[102:103], v6 offset:640
    ds_read_b64_tr_b16 v[104:105], v6 offset:256
    ds_read_b64_tr_b16 v[106:107], v6 offset:768
    ds_read_b64_tr_b16 v[108:109], v6 offset:384
    ds_read_b64_tr_b16 v[110:111], v6 offset:896
    s_waitcnt lgkmcnt(6)
    v_smfmac_f32_16x16x64_bf16 v[72:75], v[96:99], a[64:71], v8 abid:1
    ds_read_b128 v[16:19], v1 offset:20480
    s_waitcnt lgkmcnt(5)
    v_smfmac_f32_16x16x64_bf16 v[72:75], v[100:103], a[96:103], v8 abid:1
    ds_read_b128 v[20:23], v1 offset:21504
    s_waitcnt lgkmcnt(4)
    v_smfmac_f32_16x16x64_bf16 v[72:75], v[104:107], v[80:87], v8 abid:1
    ds_read_b128 v[24:27], v1 offset:53248
    s_waitcnt lgkmcnt(3)
    v_smfmac_f32_16x16x64_bf16 v[72:75], v[108:111], v[88:95], v8 abid:1
    ds_read_b128 v[28:31], v1 offset:54272
    v_smfmac_f32_16x16x64_bf16 v[76:79], v[96:99], a[72:79], v8 abid:1
    ds_read_b128 v[32:35], v1 offset:22528
    s_nop 0
    v_mov_b64 v[112:113], 0
    v_smfmac_f32_16x16x64_bf16 v[76:79], v[100:103], a[104:111], v8 abid:1
    ds_read_b128 v[36:39], v1 offset:23552
    s_nop 0
    v_cvt_pk_bf16_f32 v72, v72, v73
    v_cvt_pk_bf16_f32 v73, v74, v75
    v_and_or_b32 v72, v72, -2, s38
    v_smfmac_f32_16x16x64_bf16 v[76:79], v[104:107], v[48:55], v8 abid:1
    buffer_store_dwordx2 v[72:73], v3, s[8:11], s28 offen
    v_smfmac_f32_16x16x64_bf16 v[76:79], v[108:111], v[64:71], v8 abid:1
    ds_read_b128 v[40:43], v1 offset:55296
    v_smfmac_f32_16x16x64_bf16 v[56:59], v[96:99], a[80:87], v8 abid:1
    ds_read_b128 v[44:47], v1 offset:56320
    s_nop 0
    v_mov_b64 v[114:115], 0
    v_smfmac_f32_16x16x64_bf16 v[56:59], v[100:103], a[112:119], v8 abid:1
    s_nop 0
    s_nop 0
    v_cvt_pk_bf16_f32 v76, v76, v77
    v_cvt_pk_bf16_f32 v77, v78, v79
    v_and_or_b32 v76, v76, -2, s38
    s_waitcnt lgkmcnt(4)
    v_smfmac_f32_16x16x64_bf16 v[56:59], v[104:107], v[16:23], v8 abid:1
    buffer_store_dwordx2 v[76:77], v3, s[8:11], s29 offen
    v_smfmac_f32_16x16x64_bf16 v[56:59], v[108:111], v[24:31], v8 abid:1
    v_smfmac_f32_16x16x64_bf16 v[60:63], v[96:99], a[88:95], v8 abid:1
    s_nop 1
    v_mov_b64 v[116:117], 0
    v_smfmac_f32_16x16x64_bf16 v[60:63], v[100:103], a[120:127], v8 abid:1
    s_nop 0
    s_nop 1
    v_cvt_pk_bf16_f32 v56, v56, v57
    v_cvt_pk_bf16_f32 v57, v58, v59
    v_and_or_b32 v56, v56, -2, s38
    s_waitcnt lgkmcnt(0)
    v_smfmac_f32_16x16x64_bf16 v[60:63], v[104:107], v[32:39], v8 abid:1
    buffer_store_dwordx2 v[56:57], v3, s[8:11], s30 offen
    ds_read_b128 v[32:35], v2 offset:31232
    v_smfmac_f32_16x16x64_bf16 v[60:63], v[108:111], v[40:47], v8 abid:1
    s_mov_b32 s39, 0
    v_mov_b64 v[96:97], 0
    v_mov_b64 v[98:99], 0
    s_nop 4
    v_cvt_pk_bf16_f32 v60, v60, v61
    v_cvt_pk_bf16_f32 v61, v62, v63
    v_and_or_b32 v60, v60, -2, s38
    buffer_store_dwordx2 v[60:61], v3, s[8:11], s31 offen
    v_mov_b64 v[100:101], 0
    v_mov_b64 v[102:103], 0
    v_mov_b64 v[104:105], 0
    v_mov_b64 v[106:107], 0
    v_mov_b64 v[108:109], 0
    v_mov_b64 v[110:111], 0
    v_mov_b64 v[118:119], 0
    ds_read_b128 v[48:51], v0 offset:16384
    ds_read_b128 v[52:55], v0 offset:17408
    ds_read_b128 v[56:59], v0 offset:18432
    s_waitcnt vmcnt(2)
    buffer_load_dwordx4 v[24:27], v0, s[8:11], s32 offen offset:0 sc1
    buffer_load_dwordx4 v[28:31], v0, s[8:11], s32 offen offset:1024 sc1
    s_waitcnt vmcnt(2)
    ds_read_b128 v[60:63], v0 offset:19456
    ds_read_b128 v[64:67], v0 offset:20480
    buffer_load_dwordx4 v[16:19], v0, s[8:11], s32 offen offset:0 sc1
    buffer_load_dwordx4 v[20:23], v0, s[8:11], s32 offen offset:1024 sc1
    v_pk_min_u16 v120, v120, s45
    v_pk_min_u16 v121, v121, s45
    v_pk_min_u16 v122, v122, s45
    v_pk_min_u16 v123, v123, s45
    v_mov_b32 v15, -1
    s_waitcnt lgkmcnt(5)
R2_h1a:
    s_waitcnt vmcnt(3)
    v_mfma_f32_16x16x32_bf16 v[36:39], v[24:27], v[32:35], 0
    v_bitop3_b32 v12, v24, v26, s38 bitop3:0x7e
    s_waitcnt vmcnt(2)
    v_mfma_f32_16x16x32_bf16 v[36:39], v[28:31], v[32:35], v[36:39]
    v_bitop3_b32 v13, v28, v30, s38 bitop3:0x7e
    v_bitop3_b32 v12, v12, v13, 1 bitop3:0xa8
    v_cmp_ne_u32 vcc, 0, v12
    s_nop 0
    s_cbranch_vccnz R2_h1
R2_h1ok:
    s_nop 3
    v_permlane32_swap_b32 v36, v38
    v_permlane32_swap_b32 v37, v39
    v_add_f32 v36, v36, v38
    v_add_f32 v37, v37, v39
    s_nop 1
    v_permlane16_swap_b32 v36, v37
    v_add_f32 v12, v36, v37
    s_nop 1
    v_mov_b32_dpp v13, v12 row_shl:4 row_mask:0xf bank_mask:0xf
    v_cvt_pk_bf16_f32 v12, v12, v13
    v_min_u32 v12, -2, v12
    buffer_store_dword v12, v4, s[8:11], s34 offen
    s_xor_b32 s32, s32, 1048576
    s_lshr_b32 s38, s24, 1
    buffer_store_dword v15, v4, s[8:11], s35 offen
    s_xor_b32 s35, s35, 8192
    s_xor_b32 s28, s28, 1048576
    s_xor_b32 s29, s29, 1048576
    s_xor_b32 s30, s30, 1048576
    s_xor_b32 s31, s31, 1048576
    s_xor_b32 s34, s34, 8192
    s_and_b32 s38, s38, 1
    s_lshl_b32 s39, s39, 16
    s_xor_b32 s92, s92, 4096
    s_mov_b32 s25, 0
    s_cmp_eq_u32 s24, 63
    s_cbranch_scc1 R2_last
    s_waitcnt vmcnt(1)
    buffer_load_dwordx4 v[32:35], v0, s[8:11], s33 offen sc1
    buffer_load_dwordx4 v[36:39], v0, s[8:11], s33 offen offset:1024 sc1
    ds_read_b128 v[68:71], v0 offset:21504
    ds_read_b128 v[72:75], v0 offset:22528
    ds_read_b128 v[76:79], v0 offset:23552
    ds_read_b128 v[80:83], v0 offset:49152
    ds_read_b128 v[84:87], v0 offset:50176
    ds_read_b128 v[88:91], v0 offset:51200
    ds_read_b128 v[92:95], v0 offset:52224
    s_waitcnt lgkmcnt(0)
    buffer_load_dwordx4 v[40:43], v0, s[8:11], s33 offen sc1
    buffer_load_dwordx4 v[44:47], v0, s[8:11], s33 offen offset:1024 sc1
    s_branch R2_h2a
R2_h1:
    buffer_load_dwordx4 v[24:27], v0, s[8:11], s32 offen offset:0 sc1
    buffer_load_dwordx4 v[28:31], v0, s[8:11], s32 offen offset:1024 sc1
    s_add_u32 s39, s39, 1
    s_cmp_gt_u32 s39, 60000
    s_cbranch_scc1 L_fail
    s_waitcnt vmcnt(3)
    v_mfma_f32_16x16x32_bf16 v[36:39], v[16:19], v[32:35], 0
    v_bitop3_b32 v12, v16, v18, s38 bitop3:0x7e
    s_waitcnt vmcnt(2)
    v_mfma_f32_16x16x32_bf16 v[36:39], v[20:23], v[32:35], v[36:39]
    v_bitop3_b32 v13, v20, v22, s38 bitop3:0x7e
    v_bitop3_b32 v12, v12, v13, 1 bitop3:0xa8
    v_cmp_ne_u32 vcc, 0, v12
    s_nop 0
    s_cbranch_vccz R2_h1ok
    buffer_load_dwordx4 v[16:19], v0, s[8:11], s32 offen offset:0 sc1
    buffer_load_dwordx4 v[20:23], v0, s[8:11], s32 offen offset:1024 sc1
    s_add_u32 s39, s39, 1
    s_branch R2_h1a
R2_h2:
    s_nop 5
    v_mov_b64 v[96:97], 0
    v_mov_b64 v[98:99], 0
    s_add_u32 s25, s25, 1
    s_cmp_gt_u32 s25, 60000
    s_cbranch_scc1 L_fail
    s_waitcnt vmcnt(1)
    v_max3_u32 v12, v40, v41, v42
    s_waitcnt vmcnt(0)
    v_max3_u32 v13, v43, v44, v45
    v_max3_u32 v12, v12, v46, v47
    v_max_u32 v12, v12, v13
    v_cmp_eq_u32 vcc, -1, v12
    s_nop 0
    s_cbranch_vccnz R2_h2b
    v_mov_b64 v[32:33], v[40:41]
    v_mov_b64 v[34:35], v[42:43]
    v_mov_b64 v[36:37], v[44:45]
    v_mov_b64 v[38:39], v[46:47]
    s_branch R2_top
R2_h2b:
    buffer_load_dwordx4 v[32:35], v0, s[8:11], s33 offen sc1
    buffer_load_dwordx4 v[36:39], v0, s[8:11], s33 offen offset:1024 sc1
    s_waitcnt vmcnt(1)
    buffer_load_dwordx4 v[40:43], v0, s[8:11], s33 offen sc1
    buffer_load_dwordx4 v[44:47], v0, s[8:11], s33 offen offset:1024 sc1
    s_add_u32 s25, s25, 1
    s_branch R2_h2a
R2_top:
    v_smfmac_f32_16x16x64_bf16 v[96:99], v[32:35], v[48:55], v8
    ds_write_b128 v2, v[32:35] offset:20480
    s_branch R2_top1
R2_last:
    s_waitcnt vmcnt(0)
R2_l2:
    buffer_load_dwordx4 v[32:35], v0, s[8:11], s33 offen sc1
    buffer_load_dwordx4 v[36:39], v0, s[8:11], s33 offen offset:1024 sc1
    s_add_u32 s25, s25, 1
    s_cmp_gt_u32 s25, 60000
    s_cbranch_scc1 L_fail
    s_waitcnt vmcnt(1)
    v_max3_u32 v12, v32, v33, v34
    s_waitcnt vmcnt(0)
    v_max3_u32 v13, v35, v36, v37
    v_max3_u32 v12, v12, v38, v39
    v_max_u32 v12, v12, v13
    v_cmp_eq_u32 vcc, -1, v12
    s_nop 0
    s_cbranch_vccnz R2_l2
    v_smfmac_f32_16x16x64_bf16 v[104:107], v[32:35], a[192:199], v8
    ds_write_b128 v2, v[32:35] offset:20480
    v_smfmac_f32_16x16x64_bf16 v[108:111], v[32:35], a[200:207], v8
    ds_write_b128 v2, v[36:39] offset:21504
    v_smfmac_f32_16x16x64_bf16 v[112:115], v[32:35], v[192:199], v8
    v_smfmac_f32_16x16x64_bf16 v[116:119], v[32:35], v[200:207], v8
    v_smfmac_f32_16x16x64_bf16 v[104:107], v[36:39], a[208:215], v8
    v_smfmac_f32_16x16x64_bf16 v[108:111], v[36:39], a[216:223], v8
    v_smfmac_f32_16x16x64_bf16 v[112:115], v[36:39], v[208:215], v8
    s_waitcnt lgkmcnt(0)
    s_barrier
    ds_read_b128 v[40:43], v2 offset:22528
    ds_read_b128 v[16:19], v2 offset:16384
    ds_read_b128 v[20:23], v2 offset:17408
    ds_read_b128 v[24:27], v2 offset:18432
    ds_read_b128 v[28:31], v2 offset:19456
    ds_read_b128 v[44:47], v2 offset:23552
    v_smfmac_f32_16x16x64_bf16 v[116:119], v[36:39], v[216:223], v8
    buffer_store_dwordx4 v[120:123], v0, s[8:11], s37 offen sc1
    s_add_u32 s37, s37, 131072
    s_waitcnt lgkmcnt(5)
    v_smfmac_f32_16x16x64_bf16 v[104:107], v[40:43], a[224:231], v8
    v_smfmac_f32_16x16x64_bf16 v[108:111], v[40:43], a[232:239], v8
    v_smfmac_f32_16x16x64_bf16 v[112:115], v[40:43], v[224:231], v8
    v_smfmac_f32_16x16x64_bf16 v[116:119], v[40:43], v[232:239], v8
    s_waitcnt lgkmcnt(4)
    v_smfmac_f32_16x16x64_bf16 v[104:107], v[16:19], a[128:135], v8
    v_smfmac_f32_16x16x64_bf16 v[108:111], v[16:19], a[136:143], v8
    v_smfmac_f32_16x16x64_bf16 v[112:115], v[16:19], v[128:135], v8
    v_smfmac_f32_16x16x64_bf16 v[116:119], v[16:19], v[136:143], v8
    s_waitcnt lgkmcnt(3)
    v_smfmac_f32_16x16x64_bf16 v[104:107], v[20:23], a[144:151], v8
    v_smfmac_f32_16x16x64_bf16 v[108:111], v[20:23], a[152:159], v8
    v_smfmac_f32_16x16x64_bf16 v[112:115], v[20:23], v[144:151], v8
    v_smfmac_f32_16x16x64_bf16 v[116:119], v[20:23], v[152:159], v8
    s_waitcnt lgkmcnt(2)
    v_smfmac_f32_16x16x64_bf16 v[104:107], v[24:27], a[160:167], v8
    v_smfmac_f32_16x16x64_bf16 v[108:111], v[24:27], a[168:175], v8
    v_smfmac_f32_16x16x64_bf16 v[112:115], v[24:27], v[160:167], v8
    v_smfmac_f32_16x16x64_bf16 v[116:119], v[24:27], v[168:175], v8
    s_waitcnt lgkmcnt(1)
    v_smfmac_f32_16x16x64_bf16 v[104:107], v[28:31], a[176:183], v8
    v_smfmac_f32_16x16x64_bf16 v[108:111], v[28:31], a[184:191], v8
    v_smfmac_f32_16x16x64_bf16 v[112:115], v[28:31], v[176:183], v8
    v_smfmac_f32_16x16x64_bf16 v[116:119], v[28:31], v[184:191], v8
    s_waitcnt lgkmcnt(0)
    v_smfmac_f32_16x16x64_bf16 v[104:107], v[44:47], a[240:247], v8
    v_smfmac_f32_16x16x64_bf16 v[108:111], v[44:47], a[248:255], v8
    v_smfmac_f32_16x16x64_bf16 v[112:115], v[44:47], v[240:247], v8
    v_smfmac_f32_16x16x64_bf16 v[116:119], v[44:47], v[248:255], v8
    s_nop 4
    v_add_f32 v104, v104, v105
    v_add_f32 v106, v106, v107
    v_add_f32 v108, v108, v109
    v_add_f32 v110, v110, v111
    v_cvt_pk_bf16_f32 v120, v104, v106
    v_cvt_pk_bf16_f32 v121, v108, v110
    v_add_f32 v112, v112, v113
    v_add_f32 v114, v114, v115
    v_add_f32 v116, v116, v117
    v_add_f32 v118, v118, v119
    v_cvt_pk_bf16_f32 v122, v112, v114
    v_cvt_pk_bf16_f32 v123, v116, v118
    v_pk_min_u16 v120, v120, s45
    v_pk_min_u16 v121, v121, s45
    v_pk_min_u16 v122, v122, s45
    v_pk_min_u16 v123, v123, s45
    buffer_store_dwordx4 v[120:123], v0, s[8:11], s37 offen sc1
    v_mov_b32 v15, 64
    s_waitcnt vmcnt(0)
    s_barrier
    s_branch L_exit_r
L_w3:
    v_mov_b64 v[40:41], v[64:65]
    v_mov_b64 v[42:43], v[66:67]
    v_mov_b64 v[44:45], v[68:69]
    v_mov_b64 v[46:47], v[70:71]
    ds_read_b128 v[48:51], v0 offset:57344
    ds_read_b128 v[52:55], v0 offset:58368
    ds_read_b128 v[56:59], v0 offset:59392
    ds_read_b128 v[60:63], v0 offset:60416
    ds_read_b128 v[64:67], v0 offset:61440
    ds_read_b128 v[68:71], v0 offset:62464
    ds_read_b128 v[72:75], v0 offset:63488
    ds_read_b128 v[76:79], v0 offset:64512
    ds_read_b128 v[80:83], v0 offset:24576
    ds_read_b128 v[84:87], v0 offset:25600
    ds_read_b128 v[88:91], v0 offset:26624
    ds_read_b128 v[92:95], v0 offset:27648
    v_mov_b64 v[96:97], 0
    v_mov_b64 v[98:99], 0
    v_mov_b64 v[100:101], 0
    v_mov_b64 v[102:103], 0
    v_mov_b64 v[104:105], 0
    v_mov_b64 v[106:107], 0
    v_mov_b64 v[108:109], 0
    v_mov_b64 v[110:111], 0
    v_mov_b64 v[112:113], 0
    v_mov_b64 v[114:115], 0
    v_mov_b64 v[116:117], 0
    v_mov_b64 v[118:119], 0
    v_mov_b32 v15, -1
    v_mov_b32 v11, 0
    s_waitcnt lgkmcnt(0)
    s_branch R3_top
.p2align 6
    s_nop 0
    s_nop 0
R3_h2a:
    s_waitcnt lgkmcnt(0)
    s_waitcnt vmcnt(3)
    v_max3_u32 v12, v40, v41, v42
    s_waitcnt vmcnt(2)
    v_max3_u32 v13, v43, v44, v45
    v_max3_u32 v12, v12, v46, v47
    v_max_u32 v12, v12, v13
    v_cmp_eq_u32 vcc, -1, v12
    v_smfmac_f32_16x16x64_bf16 v[96:99], v[40:43], v[48:55], v8
    ds_write_b128 v2, v[40:43] offset:22528
    s_cbranch_vccnz R3_h2
R3_top1:
    v_smfmac_f32_16x16x64_bf16 v[100:103], v[40:43], v[56:63], v8
    ds_write_b128 v2, v[44:47] offset:23552
    s_xor_b32 s33, s33, 8192
    v_smfmac_f32_16x16x64_bf16 v[96:99], v[44:47], v[64:71], v8
    v_add_u32 v15, 2176, v6
    v_smfmac_f32_16x16x64_bf16 v[100:103], v[44:47], v[72:79], v8
    v_cndmask_b32 v15, v6, v15, s[60:61]
    v_smfmac_f32_16x16x64_bf16 v[104:107], v[40:43], a[224:231], v8
    v_smfmac_f32_16x16x64_bf16 v[108:111], v[40:43], a[232:239], v8
    v_smfmac_f32_16x16x64_bf16 v[104:107], v[44:47], a[240:247], v8
    s_waitcnt vmcnt(0) lgkmcnt(0)
    s_barrier
    ds_read_b128 v[32:35], v2 offset:20480
    v_smfmac_f32_16x16x64_bf16 v[108:111], v[44:47], a[248:255], v8
    ds_read_b128 v[16:19], v2 offset:16384
    v_smfmac_f32_16x16x64_bf16 v[112:115], v[40:43], v[224:231], v8
    ds_read_b128 v[20:23], v2 offset:17408
    v_smfmac_f32_16x16x64_bf16 v[116:119], v[40:43], v[232:239], v8
    ds_read_b128 v[24:27], v2 offset:18432
    v_smfmac_f32_16x16x64_bf16 v[112:115], v[44:47], v[240:247], v8
    ds_read_b128 v[28:31], v2 offset:19456
    s_waitcnt lgkmcnt(4)
    v_smfmac_f32_16x16x64_bf16 v[96:99], v[32:35], v[80:87], v8
    ds_read_b128 v[36:39], v2 offset:21504
    v_smfmac_f32_16x16x64_bf16 v[100:103], v[32:35], v[88:95], v8
    ds_read_b128 v[48:51], v0 offset:28672
    s_waitcnt lgkmcnt(5)
    v_smfmac_f32_16x16x64_bf16 v[96:99], v[16:19], a[0:7], v8
    ds_read_b128 v[52:55], v0 offset:29696
    v_smfmac_f32_16x16x64_bf16 v[100:103], v[16:19], a[8:15], v8
    ds_read_b128 v[56:59], v0 offset:30720
    s_waitcnt lgkmcnt(6)
    v_smfmac_f32_16x16x64_bf16 v[96:99], v[20:23], a[16:23], v8
    ds_read_b128 v[60:63], v0 offset:31744
    v_smfmac_f32_16x16x64_bf16 v[100:103], v[20:23], a[24:31], v8
    ds_read_b128 v[64:67], v2 offset:4096
    s_waitcnt lgkmcnt(7)
    v_smfmac_f32_16x16x64_bf16 v[96:99], v[24:27], a[32:39], v8
    ds_read_b128 v[68:71], v2 offset:5120
    v_smfmac_f32_16x16x64_bf16 v[100:103], v[24:27], a[40:47], v8
    ds_read_b128 v[72:75], v2 offset:6144
    s_waitcnt lgkmcnt(8)
    v_smfmac_f32_16x16x64_bf16 v[96:99], v[28:31], a[48:55], v8
    ds_read_b128 v[76:79], v2 offset:7168
    v_smfmac_f32_16x16x64_bf16 v[100:103], v[28:31], a[56:63], v8
    s_waitcnt lgkmcnt(8)
    s_waitcnt lgkmcnt(6)
    v_smfmac_f32_16x16x64_bf16 v[96:99], v[36:39], v[48:55], v8
    ds_read_b128 v[48:51], v2 offset:0
    s_waitcnt lgkmcnt(5)
    v_smfmac_f32_16x16x64_bf16 v[100:103], v[36:39], v[56:63], v8
    ds_read_b128 v[52:55], v2 offset:1024
    v_smfmac_f32_16x16x64_bf16 v[104:107], v[32:35], a[192:199], v8
    ds_read_b128 v[56:59], v2 offset:2048
    s_add_u32 s36, s36, 786432
    s_mov_b32 m0, s43
    v_smfmac_f32_16x16x64_bf16 v[108:111], v[32:35], a[200:207], v8
    ds_read_b128 v[60:63], v2 offset:3072
    buffer_store_dwordx4 v[120:123], v0, s[8:11], s37 offen sc1
    s_add_u32 s42, s42, 786432
    v_smfmac_f32_16x16x64_bf16 v[104:107], v[16:19], a[128:135], v8
    v_add_f32 v96, v96, v97
    v_add_f32 v98, v98, v99
    v_smfmac_f32_16x16x64_bf16 v[108:111], v[16:19], a[136:143], v8
    v_add_f32 v100, v100, v101
    v_add_f32 v102, v102, v103
    v_smfmac_f32_16x16x64_bf16 v[104:107], v[20:23], a[144:151], v8
    v_cvt_pk_bf16_f32 v124, v96, v98
    v_cvt_pk_bf16_f32 v125, v100, v102
    v_smfmac_f32_16x16x64_bf16 v[108:111], v[20:23], a[152:159], v8
    ds_write2st64_b32 v9, v124, v125 offset0:0 offset1:2
    v_smfmac_f32_16x16x64_bf16 v[104:107], v[24:27], a[160:167], v8
    s_mov_b32 s94, s24
    v_smfmac_f32_16x16x64_bf16 v[108:111], v[24:27], a[168:175], v8
    v_smfmac_f32_16x16x64_bf16 v[104:107], v[28:31], a[176:183], v8
    v_smfmac_f32_16x16x64_bf16 v[108:111], v[28:31], a[184:191], v8
    s_add_u32 s37, s37, 131072
    s_waitcnt lgkmcnt(0)
    s_barrier
    v_smfmac_f32_16x16x64_bf16 v[104:107], v[36:39], a[208:215], v8
    ds_read_b64_tr_b16 v[80:81], v6 offset:0
    ds_read_b64_tr_b16 v[82:83], v6 offset:512
    v_smfmac_f32_16x16x64_bf16 v[108:111], v[36:39], a[216:223], v8
    ds_read_b64_tr_b16 v[84:85], v6 offset:128
    ds_read_b64_tr_b16 v[86:87], v6 offset:640
    v_smfmac_f32_16x16x64_bf16 v[116:119], v[44:47], v[248:255], v8
    ds_read_b64_tr_b16 v[88:89], v6 offset:256
    ds_read_b64_tr_b16 v[90:91], v6 offset:768
    v_smfmac_f32_16x16x64_bf16 v[112:115], v[32:35], v[192:199], v8
    ds_read_b64_tr_b16 v[92:93], v6 offset:384
    ds_read_b64_tr_b16 v[94:95], v6 offset:896
    v_add_f32 v104, v104, v105
    v_add_f32 v106, v106, v107
    v_add_f32 v108, v108, v109
    v_add_f32 v110, v110, v111
    v_cvt_pk_bf16_f32 v120, v104, v106
    v_cvt_pk_bf16_f32 v121, v108, v110
    s_waitcnt lgkmcnt(4)
    v_mfma_f32_16x16x32_bf16 v[96:99], v[48:51], v[80:83], 0
    ds_write2st64_b32 v10, v120, v121 offset0:9 offset1:11
    v_mfma_f32_16x16x32_bf16 v[100:103], v[64:67], v[80:83], 0
    v_mfma_f32_16x16x32_bf16 v[96:99], v[52:55], v[84:87], v[96:99]
    v_mov_b64 v[126:127], s[26:27]
    v_mfma_f32_16x16x32_bf16 v[100:103], v[68:71], v[84:87], v[100:103]
    buffer_load_dwordx4 v0, s[8:11], s36 offen offset:0 sc1 lds
    s_waitcnt lgkmcnt(0)
    s_barrier
    v_mfma_f32_16x16x32_bf16 v[96:99], v[56:59], v[88:91], v[96:99]
    ds_read_b64_tr_b16 v[48:49], v15 offset:2304
    ds_read_b64_tr_b16 v[50:51], v15 offset:2816
    v_mfma_f32_16x16x32_bf16 v[100:103], v[72:75], v[88:91], v[100:103]
    ds_read_b64_tr_b16 v[64:65], v15 offset:2432
    ds_read_b64_tr_b16 v[66:67], v15 offset:2944
    v_mfma_f32_16x16x32_bf16 v[96:99], v[60:63], v[92:95], v[96:99]
    ds_read_b64_tr_b16 v[52:53], v15 offset:2560
    ds_read_b64_tr_b16 v[54:55], v15 offset:3072
    v_mfma_f32_16x16x32_bf16 v[100:103], v[76:79], v[92:95], v[100:103]
    ds_read_b64_tr_b16 v[68:69], v15 offset:2688
    ds_read_b64_tr_b16 v[70:71], v15 offset:3200
    s_waitcnt lgkmcnt(6)
    v_mfma_f32_16x16x32_bf16 v[104:107], v[48:51], v[80:83], 0
    ds_read_b128 v[56:59], v2 offset:14336
    v_mov_b64 v[124:125], s[26:27]
    s_waitcnt lgkmcnt(5)
    v_mfma_f32_16x16x32_bf16 v[104:107], v[64:67], v[84:87], v[104:107]
    ds_read_b128 v[60:63], v2 offset:15360
    v_max3_f32 v12, v96, v97, v98
    s_waitcnt lgkmcnt(4)
    v_mfma_f32_16x16x32_bf16 v[104:107], v[52:55], v[88:91], v[104:107]
    v_max3_f32 v13, v99, v100, v101
    v_max3_f32 v12, v12, v102, v103
    s_waitcnt lgkmcnt(2)
    v_mfma_f32_16x16x32_bf16 v[104:107], v[68:71], v[92:95], v[104:107]
    buffer_load_dwordx4 v0, s[8:11], s36 offen offset:1024 sc1 lds
    v_max_f32 v12, v12, v13
    v_smfmac_f32_16x16x64_bf16 v[116:119], v[32:35], v[200:207], v8
    ds_read_b128 v[80:83], v1 offset:24576
    s_add_u32 m0, s43, 8192
    v_smfmac_f32_16x16x64_bf16 v[112:115], v[16:19], v[128:135], v8
    ds_read_b128 v[84:87], v1 offset:25600
    s_add_u32 s24, s24, 1
    v_max3_f32 v12, v12, v104, v105
    v_mov_b32 v13, v12
    v_smfmac_f32_16x16x64_bf16 v[116:119], v[16:19], v[136:143], v8
    ds_read_b128 v[88:91], v1 offset:57344
    v_permlane32_swap_b32 v12, v13
    v_max_f32 v12, v12, v13
    v_mov_b32 v13, v12
    v_smfmac_f32_16x16x64_bf16 v[112:115], v[20:23], v[144:151], v8
    ds_read_b128 v[92:95], v1 offset:58368
    v_permlane16_swap_b32 v12, v13
    v_max_f32 v12, v12, v13
    v_mul_f32 v12, s40, v12
    v_pk_fma_f32 v[96:97], v[96:97], s[40:41], v[12:13] op_sel_hi:[1,1,0] neg_lo:[0,0,1] neg_hi:[0,0,1]
    v_pk_fma_f32 v[98:99], v[98:99], s[40:41], v[12:13] op_sel_hi:[1,1,0] neg_lo:[0,0,1] neg_hi:[0,0,1]
    v_pk_fma_f32 v[100:101], v[100:101], s[40:41], v[12:13] op_sel_hi:[1,1,0] neg_lo:[0,0,1] neg_hi:[0,0,1]
    v_pk_fma_f32 v[102:103], v[102:103], s[40:41], v[12:13] op_sel_hi:[1,1,0] neg_lo:[0,0,1] neg_hi:[0,0,1]
    v_pk_fma_f32 v[104:105], v[104:105], s[40:41], v[12:13] op_sel_hi:[1,1,0] neg_lo:[0,0,1] neg_hi:[0,0,1]
    v_smfmac_f32_16x16x64_bf16 v[116:119], v[20:23], v[152:159], v8
    ds_read_b128 v[48:51], v1 offset:26624
    v_exp_f32 v96, v96
    v_smfmac_f32_16x16x64_bf16 v[112:115], v[24:27], v[160:167], v8
    ds_read_b128 v[52:55], v1 offset:27648
    v_exp_f32 v97, v97
    v_smfmac_f32_16x16x64_bf16 v[116:119], v[24:27], v[168:175], v8
    ds_read_b128 v[64:67], v1 offset:59392
    v_exp_f32 v98, v98
    s_waitcnt lgkmcnt(7)
    v_smfmac_f32_16x16x64_bf16 v[112:115], v[28:31], v[176:183], v8
    buffer_load_dwordx4 v0, s[8:11], s42 offen offset:0 sc1 lds
    v_exp_f32 v99, v99
    v_smfmac_f32_16x16x64_bf16 v[116:119], v[28:31], v[184:191], v8
    ds_read_b128 v[68:71], v1 offset:60416
    v_exp_f32 v100, v100
    v_smfmac_f32_16x16x64_bf16 v[112:115], v[36:39], v[208:215], v8
    buffer_load_dwordx4 v0, s[8:11], s42 offen offset:1024 sc1 lds
    v_exp_f32 v101, v101
    v_smfmac_f32_16x16x64_bf16 v[116:119], v[36:39], v[216:223], v8
    v_exp_f32 v102, v102
    v_exp_f32 v103, v103
    v_mov_b64 v[12:13], 0
    v_mov_b64 v[14:15], 0
    v_cvt_pk_bf16_f32 v72, v96, v97
    v_cvt_pk_bf16_f32 v73, v98, v99
    v_cvt_pk_bf16_f32 v74, v100, v101
    v_cvt_pk_bf16_f32 v75, v102, v103
    v_exp_f32 v104, v104
    v_exp_f32 v105, v105
    v_mfma_f32_16x16x32_bf16 v[108:111], v[72:75], v[124:127], 0
    v_cvt_pk_bf16_f32 v104, v104, v105
    v_add_f32 v112, v112, v113
    v_smfmac_f32_16x16x64_bf16 v[12:15], v[72:75], v[56:63], v8 abid:1
    v_cndmask_b32 v76, v104, 0, s[78:79]
    v_cndmask_b32 v77, 0, v104, s[78:79]
    v_add_f32 v114, v114, v115
    v_add_f32 v116, v116, v117
    v_mfma_f32_16x16x16_bf16 v[108:111], v[76:77], v[124:125], v[108:111]
    v_add_f32 v118, v118, v119
    v_cvt_pk_bf16_f32 v122, v112, v114
    v_cvt_pk_bf16_f32 v123, v116, v118
    s_nop 1
    v_mfma_f32_16x16x16_bf16 v[12:15], v[76:77], v[122:123], v[12:15]
    s_nop 1
    v_rcp_f32 v108, v108
    s_nop 0
    v_rcp_f32 v109, v109
    s_nop 0
    v_rcp_f32 v110, v110
    s_nop 0
    v_rcp_f32 v111, v111
    s_nop 0
    v_pk_mul_f32 v[12:13], v[12:13], v[108:109]
    v_pk_mul_f32 v[14:15], v[14:15], v[110:111]
    v_cvt_pk_bf16_f32 v12, v12, v13
    v_cvt_pk_bf16_f32 v13, v14, v15
    ds_write_b64 v5, v[12:13] offset:384
    v_mov_b64 v[72:73], 0
    v_mov_b64 v[74:75], 0
    v_mov_b64 v[76:77], 0
    v_mov_b64 v[78:79], 0
    v_mov_b64 v[56:57], 0
    v_mov_b64 v[58:59], 0
    v_mov_b64 v[60:61], 0
    v_mov_b64 v[62:63], 0
    s_waitcnt lgkmcnt(0)
    s_barrier
    ds_read_b64_tr_b16 v[96:97], v6 offset:0
    ds_read_b64_tr_b16 v[98:99], v6 offset:512
    ds_read_b64_tr_b16 v[100:101], v6 offset:128
    ds_read_b64_tr_b16 v[102:103], v6 offset:640
    ds_read_b64_tr_b16 v[104:105], v6 offset:256
    ds_read_b64_tr_b16 v[106:107], v6 offset:768
    ds_read_b64_tr_b16 v[108:109], v6 offset:384
    ds_read_b64_tr_b16 v[110:111], v6 offset:896
    s_waitcnt lgkmcnt(6)
    v_smfmac_f32_16x16x64_bf16 v[72:75], v[96:99], a[64:71], v8 abid:1
    ds_read_b128 v[16:19], v1 offset:28672
    s_waitcnt lgkmcnt(5)
    v_smfmac_f32_16x16x64_bf16 v[72:75], v[100:103], a[96:103], v8 abid:1
    ds_read_b128 v[20:23], v1 offset:29696
    s_waitcnt lgkmcnt(4)
    v_smfmac_f32_16x16x64_bf16 v[72:75], v[104:107], v[80:87], v8 abid:1
    ds_read_b128 v[24:27], v1 offset:61440
    s_waitcnt lgkmcnt(3)
    v_smfmac_f32_16x16x64_bf16 v[72:75], v[108:111], v[88:95], v8 abid:1
    ds_read_b128 v[28:31], v1 offset:62464
    v_smfmac_f32_16x16x64_bf16 v[76:79], v[96:99], a[72:79], v8 abid:1
    ds_read_b128 v[32:35], v1 offset:30720
    s_nop 0
    v_mov_b64 v[112:113], 0
    v_smfmac_f32_16x16x64_bf16 v[76:79], v[100:103], a[104:111], v8 abid:1
    ds_read_b128 v[36:39], v1 offset:31744
    s_nop 0
    v_cvt_pk_bf16_f32 v72, v72, v73
    v_cvt_pk_bf16_f32 v73, v74, v75
    v_and_or_b32 v72, v72, -2, s38
    v_smfmac_f32_16x16x64_bf16 v[76:79], v[104:107], v[48:55], v8 abid:1
    buffer_store_dwordx2 v[72:73], v3, s[8:11], s28 offen
    v_smfmac_f32_16x16x64_bf16 v[76:79], v[108:111], v[64:71], v8 abid:1
    ds_read_b128 v[40:43], v1 offset:63488
    v_smfmac_f32_16x16x64_bf16 v[56:59], v[96:99], a[80:87], v8 abid:1
    ds_read_b128 v[44:47], v1 offset:64512
    s_nop 0
    v_mov_b64 v[114:115], 0
    v_smfmac_f32_16x16x64_bf16 v[56:59], v[100:103], a[112:119], v8 abid:1
    s_nop 0
    s_nop 0
    v_cvt_pk_bf16_f32 v76, v76, v77
    v_cvt_pk_bf16_f32 v77, v78, v79
    v_and_or_b32 v76, v76, -2, s38
    s_waitcnt lgkmcnt(4)
    v_smfmac_f32_16x16x64_bf16 v[56:59], v[104:107], v[16:23], v8 abid:1
    buffer_store_dwordx2 v[76:77], v3, s[8:11], s29 offen
    v_smfmac_f32_16x16x64_bf16 v[56:59], v[108:111], v[24:31], v8 abid:1
    v_smfmac_f32_16x16x64_bf16 v[60:63], v[96:99], a[88:95], v8 abid:1
    s_nop 1
    v_mov_b64 v[116:117], 0
    v_smfmac_f32_16x16x64_bf16 v[60:63], v[100:103], a[120:127], v8 abid:1
    s_nop 0
    s_nop 1
    v_cvt_pk_bf16_f32 v56, v56, v57
    v_cvt_pk_bf16_f32 v57, v58, v59
    v_and_or_b32 v56, v56, -2, s38
    s_waitcnt lgkmcnt(0)
    v_smfmac_f32_16x16x64_bf16 v[60:63], v[104:107], v[32:39], v8 abid:1
    buffer_store_dwordx2 v[56:57], v3, s[8:11], s30 offen
    ds_read_b128 v[32:35], v2 offset:31232
    v_smfmac_f32_16x16x64_bf16 v[60:63], v[108:111], v[40:47], v8 abid:1
    s_mov_b32 s39, 0
    v_mov_b64 v[96:97], 0
    v_mov_b64 v[98:99], 0
    s_nop 4
    v_cvt_pk_bf16_f32 v60, v60, v61
    v_cvt_pk_bf16_f32 v61, v62, v63
    v_and_or_b32 v60, v60, -2, s38
    buffer_store_dwordx2 v[60:61], v3, s[8:11], s31 offen
    v_mov_b64 v[100:101], 0
    v_mov_b64 v[102:103], 0
    v_mov_b64 v[104:105], 0
    v_mov_b64 v[106:107], 0
    v_mov_b64 v[108:109], 0
    v_mov_b64 v[110:111], 0
    v_mov_b64 v[118:119], 0
    s_waitcnt vmcnt(2)
    buffer_load_dwordx4 v[24:27], v0, s[8:11], s32 offen offset:0 sc1
    buffer_load_dwordx4 v[28:31], v0, s[8:11], s32 offen offset:1024 sc1
    ds_read_b128 v[48:51], v0 offset:57344
    ds_read_b128 v[52:55], v0 offset:58368
    ds_read_b128 v[56:59], v0 offset:59392
    s_waitcnt vmcnt(2)
    ds_read_b128 v[60:63], v0 offset:60416
    ds_read_b128 v[64:67], v0 offset:61440
    ds_read_b128 v[68:71], v0 offset:62464
    ds_read_b128 v[72:75], v0 offset:63488
    buffer_load_dwordx4 v[16:19], v0, s[8:11], s32 offen offset:0 sc1
    buffer_load_dwordx4 v[20:23], v0, s[8:11], s32 offen offset:1024 sc1
    v_pk_min_u16 v120, v120, s45
    v_pk_min_u16 v121, v121, s45
    v_pk_min_u16 v122, v122, s45
    v_pk_min_u16 v123, v123, s45
    v_mov_b32 v15, -1
    s_waitcnt lgkmcnt(7)
R3_h1a:
    s_waitcnt vmcnt(3)
    v_mfma_f32_16x16x32_bf16 v[36:39], v[24:27], v[32:35], 0
    v_bitop3_b32 v12, v24, v26, s38 bitop3:0x7e
    s_waitcnt vmcnt(2)
    v_mfma_f32_16x16x32_bf16 v[36:39], v[28:31], v[32:35], v[36:39]
    v_bitop3_b32 v13, v28, v30, s38 bitop3:0x7e
    v_bitop3_b32 v12, v12, v13, 1 bitop3:0xa8
    v_cmp_ne_u32 vcc, 0, v12
    s_nop 0
    s_cbranch_vccnz R3_h1
R3_h1ok:
    s_nop 3
    v_permlane32_swap_b32 v36, v38
    v_permlane32_swap_b32 v37, v39
    v_add_f32 v36, v36, v38
    v_add_f32 v37, v37, v39
    s_nop 1
    v_permlane16_swap_b32 v36, v37
    v_add_f32 v12, v36, v37
    s_nop 1
    v_mov_b32_dpp v13, v12 row_shl:4 row_mask:0xf bank_mask:0xf
    v_cvt_pk_bf16_f32 v12, v12, v13
    v_min_u32 v12, -2, v12
    buffer_store_dword v12, v4, s[8:11], s34 offen
    s_xor_b32 s32, s32, 1048576
    s_lshr_b32 s38, s24, 1
    buffer_store_dword v15, v4, s[8:11], s35 offen
    s_xor_b32 s35, s35, 8192
    s_xor_b32 s28, s28, 1048576
    s_xor_b32 s29, s29, 1048576
    s_xor_b32 s30, s30, 1048576
    s_xor_b32 s31, s31, 1048576
    s_xor_b32 s34, s34, 8192
    s_and_b32 s38, s38, 1
    s_lshl_b32 s39, s39, 16
    s_xor_b32 s92, s92, 4096
    s_mov_b32 s25, 0
    s_cmp_eq_u32 s24, 63
    s_cbranch_scc1 R3_last
    s_waitcnt vmcnt(1)
    buffer_load_dwordx4 v[40:43], v0, s[8:11], s33 offen sc1
    buffer_load_dwordx4 v[44:47], v0, s[8:11], s33 offen offset:1024 sc1
    ds_read_b128 v[76:79], v0 offset:64512
    ds_read_b128 v[80:83], v0 offset:24576
    ds_read_b128 v[84:87], v0 offset:25600
    ds_read_b128 v[88:91], v0 offset:26624
    ds_read_b128 v[92:95], v0 offset:27648
    s_waitcnt vmcnt(2)
    s_waitcnt lgkmcnt(0)
    buffer_load_dwordx4 v[16:19], v0, s[8:11], s33 offen sc1
    buffer_load_dwordx4 v[20:23], v0, s[8:11], s33 offen offset:1024 sc1
    s_branch R3_h2a
R3_h1:
    buffer_load_dwordx4 v[24:27], v0, s[8:11], s32 offen offset:0 sc1
    buffer_load_dwordx4 v[28:31], v0, s[8:11], s32 offen offset:1024 sc1
    s_add_u32 s39, s39, 1
    s_cmp_gt_u32 s39, 60000
    s_cbranch_scc1 L_fail
    s_waitcnt vmcnt(3)
    v_mfma_f32_16x16x32_bf16 v[36:39], v[16:19], v[32:35], 0
    v_bitop3_b32 v12, v16, v18, s38 bitop3:0x7e
    s_waitcnt vmcnt(2)
    v_mfma_f32_16x16x32_bf16 v[36:39], v[20:23], v[32:35], v[36:39]
    v_bitop3_b32 v13, v20, v22, s38 bitop3:0x7e
    v_bitop3_b32 v12, v12, v13, 1 bitop3:0xa8
    v_cmp_ne_u32 vcc, 0, v12
    s_nop 0
    s_cbranch_vccz R3_h1ok
    buffer_load_dwordx4 v[16:19], v0, s[8:11], s32 offen offset:0 sc1
    buffer_load_dwordx4 v[20:23], v0, s[8:11], s32 offen offset:1024 sc1
    s_add_u32 s39, s39, 1
    s_branch R3_h1a
R3_h2:
    s_nop 5
    v_mov_b64 v[96:97], 0
    v_mov_b64 v[98:99], 0
    s_add_u32 s25, s25, 1
    s_cmp_gt_u32 s25, 60000
    s_cbranch_scc1 L_fail
    s_waitcnt vmcnt(1)
    v_max3_u32 v12, v16, v17, v18
    s_waitcnt vmcnt(0)
    v_max3_u32 v13, v19, v20, v21
    v_max3_u32 v12, v12, v22, v23
    v_max_u32 v12, v12, v13
    v_cmp_eq_u32 vcc, -1, v12
    s_nop 0
    s_cbranch_vccnz R3_h2b
    v_mov_b64 v[40:41], v[16:17]
    v_mov_b64 v[42:43], v[18:19]
    v_mov_b64 v[44:45], v[20:21]
    v_mov_b64 v[46:47], v[22:23]
    s_branch R3_top
R3_h2b:
    buffer_load_dwordx4 v[40:43], v0, s[8:11], s33 offen sc1
    buffer_load_dwordx4 v[44:47], v0, s[8:11], s33 offen offset:1024 sc1
    s_waitcnt vmcnt(1)
    buffer_load_dwordx4 v[16:19], v0, s[8:11], s33 offen sc1
    buffer_load_dwordx4 v[20:23], v0, s[8:11], s33 offen offset:1024 sc1
    s_add_u32 s25, s25, 1
    s_branch R3_h2a
R3_top:
    v_smfmac_f32_16x16x64_bf16 v[96:99], v[40:43], v[48:55], v8
    ds_write_b128 v2, v[40:43] offset:22528
    s_branch R3_top1
R3_last:
    s_waitcnt vmcnt(0)
R3_l2:
    buffer_load_dwordx4 v[40:43], v0, s[8:11], s33 offen sc1
    buffer_load_dwordx4 v[44:47], v0, s[8:11], s33 offen offset:1024 sc1
    s_add_u32 s25, s25, 1
    s_cmp_gt_u32 s25, 60000
    s_cbranch_scc1 L_fail
    s_waitcnt vmcnt(1)
    v_max3_u32 v12, v40, v41, v42
    s_waitcnt vmcnt(0)
    v_max3_u32 v13, v43, v44, v45
    v_max3_u32 v12, v12, v46, v47
    v_max_u32 v12, v12, v13
    v_cmp_eq_u32 vcc, -1, v12
    s_nop 0
    s_cbranch_vccnz R3_l2
    v_smfmac_f32_16x16x64_bf16 v[104:107], v[40:43], a[224:231], v8
    ds_write_b128 v2, v[40:43] offset:22528
    v_smfmac_f32_16x16x64_bf16 v[108:111], v[40:43], a[232:239], v8
    ds_write_b128 v2, v[44:47] offset:23552
    v_smfmac_f32_16x16x64_bf16 v[112:115], v[40:43], v[224:231], v8
    v_smfmac_f32_16x16x64_bf16 v[116:119], v[40:43], v[232:239], v8
    v_smfmac_f32_16x16x64_bf16 v[104:107], v[44:47], a[240:247], v8
    v_smfmac_f32_16x16x64_bf16 v[108:111], v[44:47], a[248:255], v8
    v_smfmac_f32_16x16x64_bf16 v[112:115], v[44:47], v[240:247], v8
    s_waitcnt lgkmcnt(0)
    s_barrier
    ds_read_b128 v[32:35], v2 offset:20480
    ds_read_b128 v[16:19], v2 offset:16384
    ds_read_b128 v[20:23], v2 offset:17408
    ds_read_b128 v[24:27], v2 offset:18432
    ds_read_b128 v[28:31], v2 offset:19456
    ds_read_b128 v[36:39], v2 offset:21504
    v_smfmac_f32_16x16x64_bf16 v[116:119], v[44:47], v[248:255], v8
    buffer_store_dwordx4 v[120:123], v0, s[8:11], s37 offen sc1
    s_add_u32 s37, s37, 131072
    s_waitcnt lgkmcnt(5)
    v_smfmac_f32_16x16x64_bf16 v[104:107], v[32:35], a[192:199], v8
    v_smfmac_f32_16x16x64_bf16 v[108:111], v[32:35], a[200:207], v8
    v_smfmac_f32_16x16x64_bf16 v[112:115], v[32:35], v[192:199], v8
    v_smfmac_f32_16x16x64_bf16 v[116:119], v[32:35], v[200:207], v8
    s_waitcnt lgkmcnt(4)
    v_smfmac_f32_16x16x64_bf16 v[104:107], v[16:19], a[128:135], v8
    v_smfmac_f32_16x16x64_bf16 v[108:111], v[16:19], a[136:143], v8
    v_smfmac_f32_16x16x64_bf16 v[112:115], v[16:19], v[128:135], v8
    v_smfmac_f32_16x16x64_bf16 v[116:119], v[16:19], v[136:143], v8
    s_waitcnt lgkmcnt(3)
    v_smfmac_f32_16x16x64_bf16 v[104:107], v[20:23], a[144:151], v8
    v_smfmac_f32_16x16x64_bf16 v[108:111], v[20:23], a[152:159], v8
    v_smfmac_f32_16x16x64_bf16 v[112:115], v[20:23], v[144:151], v8
    v_smfmac_f32_16x16x64_bf16 v[116:119], v[20:23], v[152:159], v8
    s_waitcnt lgkmcnt(2)
    v_smfmac_f32_16x16x64_bf16 v[104:107], v[24:27], a[160:167], v8
    v_smfmac_f32_16x16x64_bf16 v[108:111], v[24:27], a[168:175], v8
    v_smfmac_f32_16x16x64_bf16 v[112:115], v[24:27], v[160:167], v8
    v_smfmac_f32_16x16x64_bf16 v[116:119], v[24:27], v[168:175], v8
    s_waitcnt lgkmcnt(1)
    v_smfmac_f32_16x16x64_bf16 v[104:107], v[28:31], a[176:183], v8
    v_smfmac_f32_16x16x64_bf16 v[108:111], v[28:31], a[184:191], v8
    v_smfmac_f32_16x16x64_bf16 v[112:115], v[28:31], v[176:183], v8
    v_smfmac_f32_16x16x64_bf16 v[116:119], v[28:31], v[184:191], v8
    s_waitcnt lgkmcnt(0)
    v_smfmac_f32_16x16x64_bf16 v[104:107], v[36:39], a[208:215], v8
    v_smfmac_f32_16x16x64_bf16 v[108:111], v[36:39], a[216:223], v8
    v_smfmac_f32_16x16x64_bf16 v[112:115], v[36:39], v[208:215], v8
    v_smfmac_f32_16x16x64_bf16 v[116:119], v[36:39], v[216:223], v8
    s_nop 4
    v_add_f32 v104, v104, v105
    v_add_f32 v106, v106, v107
    v_add_f32 v108, v108, v109
    v_add_f32 v110, v110, v111
    v_cvt_pk_bf16_f32 v120, v104, v106
    v_cvt_pk_bf16_f32 v121, v108, v110
    v_add_f32 v112, v112, v113
    v_add_f32 v114, v114, v115
    v_add_f32 v116, v116, v117
    v_add_f32 v118, v118, v119
    v_cvt_pk_bf16_f32 v122, v112, v114
    v_cvt_pk_bf16_f32 v123, v116, v118
    v_pk_min_u16 v120, v120, s45
    v_pk_min_u16 v121, v121, s45
    v_pk_min_u16 v122, v122, s45
    v_pk_min_u16 v123, v123, s45
    buffer_store_dwordx4 v[120:123], v0, s[8:11], s37 offen sc1
    v_mov_b32 v15, 64
    s_waitcnt vmcnt(0)
    s_barrier
    s_branch L_exit_r
L_exit_r:
    s_branch L_exit
L_none:
    s_waitcnt vmcnt(0)
    s_barrier
    s_mov_b32 s98, 0
    s_cmp_lg_u32 s17, 0
    s_cbranch_scc1 N_arr_skip
    s_and_b32 s96, s3, 3
    s_lshl_b32 s96, s96, 6
    s_lshl_b32 s97, s23, 2
    s_add_u32 s96, s96, s97
    s_add_u32 s96, s96, 32
    s_mov_b32 s98, 1
    s_atomic_add s98, s[88:89], s96 glc
N_arr_skip:
    s_waitcnt lgkmcnt(0)
    s_cmp_lg_u32 s98, 63
    s_cbranch_scc1 N_arr_done
    s_lshl_b32 s97, s23, 2
    s_add_u32 s96, s97, 40
    s_mov_b32 s98, 1
    s_atomic_add s98, s[88:89], s96 glc
    s_waitcnt lgkmcnt(0)
    s_cmp_lg_u32 s98, 3
    s_cbranch_scc1 N_arr_done
    v_mbcnt_lo_u32_b32 v126, -1, 0
    v_mbcnt_hi_u32_b32 v126, -1, v126
    s_mov_b32 s98, 3
    s_cmp_lg_u32 s23, 0
    s_cbranch_scc1 N_arr_tell
    v_lshlrev_b32 v125, 2, v126
    v_mov_b32 v127, 0
    buffer_atomic_add v127, v125, s[4:7], 0 offen sc0
    s_waitcnt vmcnt(0)
    v_cmp_ne_u32 vcc, 32, v127
    s_nop 0
    s_and_b32 s96, vcc_lo, 196609
    s_and_b32 s97, vcc_hi, 458755
    s_or_b32 s96, s96, s97
    s_cselect_b32 s98, 2, 1
N_arr_tell:
    v_lshlrev_b32 v126, 7, v126
    v_mov_b32 v127, s98
    s_mov_b32 s96, 65110016
    buffer_store_dword v127, v126, s[8:11], s96 offen sc1
    s_mov_b32 s96, 65118208
    buffer_store_dword v127, v126, s[8:11], s96 offen sc1
    s_mov_b32 s96, 65126400
    buffer_store_dword v127, v126, s[8:11], s96 offen sc1
    s_mov_b32 s96, 65134592
    buffer_store_dword v127, v126, s[8:11], s96 offen sc1
N_arr_done:
    s_lshl_b32 s96, s3, 7
    s_add_u32 s96, s96, 65110016
    s_lshl_b32 s97, s23, 1
    s_mov_b32 s98, 0
N_go:
    buffer_load_dword v127, off, s[8:11], s96 sc1
    s_add_u32 s98, s98, 1
    s_cmp_gt_u32 s98, 400000
    s_cbranch_scc1 L_fail
    s_waitcnt vmcnt(0)
    v_readfirstlane_b32 s99, v127
    s_nop 0
    s_cmp_eq_u32 s99, s97
    s_cbranch_scc0 N_go_got
    s_branch N_go
N_go_got:
    s_cmp_eq_u32 s99, 2
    s_cbranch_scc1 L_redo
N_go_on:
    s_branch L_fail
L_redo:
    s_waitcnt vmcnt(0) lgkmcnt(0)
    s_barrier
    s_mov_b32 s23, 1
    s_lshr_b32 s18, s3, 5
    s_and_b32 s16, s3, 31
    s_branch L_role
L_fail:
    v_mov_b32 v126, 56
    v_mov_b32 v127, 1
    buffer_atomic_add v127, v126, s[4:7], 0 offen
L_exit:
    s_waitcnt vmcnt(0) lgkmcnt(0)
L_end:
    s_endpgm
L_fast_end:
C_first_s:
    s_mov_b32 s43, 0
    s_add_u32 s41, s24, 0
    s_lshr_b32 s40, s41, 1
    s_add_u32 s40, s40, 1
    s_max_u32 s40, s40, 2
    s_and_b32 s41, s41, 1
    s_lshl_b32 s41, s41, 12
    s_add_u32 s42, s41, s34
    s_mov_b32 s37, 0
C_wp0_s:
    buffer_load_dword v15, v12, s[8:11], s42 offen offset:0 sc1
    s_add_u32 s37, s37, 1
    s_cmp_gt_u32 s37, 400000
    s_cbranch_scc1 L_fail
    s_waitcnt vmcnt(0)
    v_cmp_gt_u32 vcc, s40, v15
    s_nop 0
    s_cbranch_vccz C_wp0_s_ok
    s_branch C_wp0_s
C_wp0_s_ok:
    s_mul_i32 s41, s17, 6144
    s_add_u32 s53, s26, s41
    s_cmp_lt_u32 s24, 64
    s_cselect_b32 s53, s53, 0x40000000
    s_add_u32 s54, s53, 3072
    s_mul_i32 s41, s17, 6144
    s_add_u32 m0, s41, 65536
    s_nop 0
    buffer_load_dwordx4 v0, s[8:11], s53 offen sc1 lds
    buffer_load_dwordx4 v0, s[8:11], s53 offen offset:1024 sc1 lds
    buffer_load_dwordx4 v0, s[8:11], s53 offen offset:2048 sc1 lds
    s_mul_i32 s41, s17, 6144
    s_add_u32 m0, s41, 68608
    s_nop 0
    buffer_load_dwordx4 v0, s[8:11], s54 offen sc1 lds
    buffer_load_dwordx4 v0, s[8:11], s54 offen offset:1024 sc1 lds
    buffer_load_dwordx4 v0, s[8:11], s54 offen offset:2048 sc1 lds
    s_waitcnt vmcnt(0)
C_loop_s:
    s_add_u32 s25, s25, 1
    s_waitcnt vmcnt(2)
    s_barrier
    buffer_load_dwordx2 v[26:27], v4, s[44:47], s36 offen
    buffer_load_dword v25, v12, s[8:11], s35 offen sc1
    s_cmp_lt_u32 s24, 28
    s_cselect_b32 s63, 4, 6
    s_add_u32 s41, s24, s63
    s_lshr_b32 s40, s41, 1
    s_add_u32 s40, s40, 1
    s_max_u32 s40, s40, 2
    s_and_b32 s41, s41, 1
    s_lshl_b32 s41, s41, 12
    s_add_u32 s42, s41, s34
    buffer_load_dword v84, v12, s[8:11], s42 offen sc1
    ds_read_b128 v[32:35], v85 offset:0
    ds_read_b128 v[36:39], v85 offset:1024
    ds_read_b128 v[40:43], v85 offset:2048
    ds_read_b128 v[44:47], v85 offset:3072
    ds_read_b128 v[48:51], v1 offset:0
    ds_read_b128 v[52:55], v1 offset:1024
    ds_read_b128 v[56:59], v1 offset:2048
    ds_read_b128 v[60:63], v1 offset:3072
    ds_read_b128 v[64:67], v1 offset:128
    ds_read_b128 v[68:71], v1 offset:1152
    ds_read_b128 v[72:75], v1 offset:2176
    ds_read_b128 v[76:79], v1 offset:3200
    s_waitcnt lgkmcnt(4)
    ds_read_b128 v[160:163], v86 offset:0
    ds_read_b128 v[164:167], v86 offset:1024
    ds_read_b128 v[168:171], v86 offset:2048
    ds_read_b128 v[172:175], v86 offset:3072
    v_mfma_f32_16x16x32_bf16 v[120:123], v[48:51], v[32:35], 0
    v_mfma_f32_16x16x32_bf16 v[120:123], v[52:55], v[36:39], v[120:123]
    v_mfma_f32_16x16x32_bf16 v[120:123], v[56:59], v[40:43], v[120:123]
    v_mfma_f32_16x16x32_bf16 v[120:123], v[60:63], v[44:47], v[120:123]
    s_waitcnt lgkmcnt(4)
    v_mfma_f32_16x16x32_bf16 v[124:127], v[64:67], v[32:35], 0
    v_mfma_f32_16x16x32_bf16 v[124:127], v[68:71], v[36:39], v[124:127]
    v_mfma_f32_16x16x32_bf16 v[124:127], v[72:75], v[40:43], v[124:127]
    v_mfma_f32_16x16x32_bf16 v[124:127], v[76:79], v[44:47], v[124:127]
    s_waitcnt lgkmcnt(0)
    v_swap_b32 v161, v162
    v_swap_b32 v165, v166
    v_swap_b32 v162, v164
    v_swap_b32 v163, v165
    v_swap_b32 v169, v170
    v_swap_b32 v173, v174
    v_swap_b32 v170, v172
    v_swap_b32 v171, v173
    v_fma_f32 v120, v120, s38, v16
    v_fma_f32 v121, v121, s38, v17
    v_fma_f32 v122, v122, s38, v18
    v_fma_f32 v123, v123, s38, v19
    v_fma_f32 v124, v124, s38, v20
    v_fma_f32 v125, v125, s38, v21
    v_fma_f32 v126, v126, s38, v22
    v_fma_f32 v127, v127, s38, v23
    v_max3_f32 v156, v120, v121, v122
    v_max3_f32 v157, v123, v124, v125
    v_max3_f32 v156, v156, v126, v127
    v_max_f32 v156, v156, v157
    s_cmp_lg_u32 s43, 0
    s_cbranch_scc1 C_have_s
    s_cmp_lt_u32 s24, 56
    s_cbranch_scc1 C_byflag_s
    s_mov_b32 s37, 0
C_poll_s:
    s_lshl_b32 s41, s17, 12
    s_add_u32 m0, s41, 0
    s_nop 0
    buffer_load_dwordx4 v0, s[8:11], s27 offen offset:0 sc1 lds
    buffer_load_dwordx4 v0, s[8:11], s27 offen offset:1024 sc1 lds
    buffer_load_dwordx4 v0, s[8:11], s27 offen offset:2048 sc1 lds
    buffer_load_dwordx4 v0, s[8:11], s27 offen offset:3072 sc1 lds
    s_add_u32 s37, s37, 1
    s_cmp_gt_u32 s37, 400000
    s_cbranch_scc1 L_fail
    s_waitcnt vmcnt(0)
    ds_read_b64_tr_b16 v[96:97], v8 offset:0
    ds_read_b64_tr_b16 v[98:99], v8 offset:1024
    ds_read_b64_tr_b16 v[100:101], v8 offset:2048
    ds_read_b64_tr_b16 v[102:103], v8 offset:3072
    ds_read_b64 v[104:105], v9 offset:0
    ds_read_b64 v[106:107], v9 offset:1024
    s_waitcnt lgkmcnt(5)
    v_pk_max_u16 v15, v96, v97
    s_waitcnt lgkmcnt(4)
    v_pk_max_u16 v158, v98, v99
    v_pk_max_u16 v15, v15, v158
    s_waitcnt lgkmcnt(3)
    v_pk_max_u16 v158, v100, v101
    v_pk_max_u16 v15, v15, v158
    s_waitcnt lgkmcnt(2)
    v_pk_max_u16 v158, v102, v103
    v_pk_max_u16 v15, v15, v158
    s_waitcnt lgkmcnt(1)
    v_pk_max_u16 v158, v104, v105
    v_pk_max_u16 v15, v15, v158
    s_waitcnt lgkmcnt(0)
    v_pk_max_u16 v158, v106, v107
    v_pk_max_u16 v15, v15, v158
    v_lshlrev_b32 v158, 16, v15
    v_max_u32 v15, v15, v158
    v_cmp_le_u32 vcc, 0xffff0000, v15
    s_nop 0
    s_cbranch_vccnz C_poll_s
    s_branch C_have3_s
C_byflag_s:
    s_add_u32 s40, s24, 1
    s_mov_b32 s37, 0
C_wr_s:
    buffer_load_dword v15, v12, s[8:11], s35 offen offset:0 sc1
    s_add_u32 s37, s37, 1
    s_cmp_gt_u32 s37, 400000
    s_cbranch_scc1 L_fail
    s_waitcnt vmcnt(0)
    v_cmp_gt_u32 vcc, s40, v15
    s_nop 0
    s_cbranch_vccz C_wr_s_ok
    s_branch C_wr_s
C_wr_s_ok:
    s_lshl_b32 s41, s17, 12
    s_add_u32 m0, s41, 0
    s_nop 0
    buffer_load_dwordx4 v0, s[8:11], s27 offen offset:0 sc1 lds
    buffer_load_dwordx4 v0, s[8:11], s27 offen offset:1024 sc1 lds
    buffer_load_dwordx4 v0, s[8:11], s27 offen offset:2048 sc1 lds
    buffer_load_dwordx4 v0, s[8:11], s27 offen offset:3072 sc1 lds
    s_waitcnt vmcnt(0)
    s_branch C_have2_s
C_have_s:
C_have2_s:
    ds_read_b64_tr_b16 v[96:97], v8 offset:0
    ds_read_b64_tr_b16 v[98:99], v8 offset:1024
    ds_read_b64_tr_b16 v[100:101], v8 offset:2048
    ds_read_b64_tr_b16 v[102:103], v8 offset:3072
    ds_read_b64 v[104:105], v9 offset:0
    ds_read_b64 v[106:107], v9 offset:1024
C_have3_s:
    s_waitcnt lgkmcnt(5)
    v_mfma_f32_16x16x16_bf16 v[128:131], v[96:97], v[32:33], 0
    v_mfma_f32_16x16x16_bf16 v[112:115], v[96:97], v[34:35], 0
    s_waitcnt lgkmcnt(4)
    v_mfma_f32_16x16x16_bf16 v[128:131], v[98:99], v[36:37], v[128:131]
    v_mfma_f32_16x16x16_bf16 v[112:115], v[98:99], v[38:39], v[112:115]
    s_waitcnt lgkmcnt(3)
    v_mfma_f32_16x16x16_bf16 v[128:131], v[100:101], v[40:41], v[128:131]
    v_mfma_f32_16x16x16_bf16 v[112:115], v[100:101], v[42:43], v[112:115]
    s_waitcnt lgkmcnt(2)
    v_mfma_f32_16x16x16_bf16 v[128:131], v[102:103], v[44:45], v[128:131]
    v_mfma_f32_16x16x16_bf16 v[112:115], v[102:103], v[46:47], v[112:115]
    v_mov_b64 v[136:137], 0
    v_mov_b64 v[138:139], 0
    s_nop 5
    v_add_f32 v128, v128, v114
    v_add_f32 v129, v129, v115
    v_mul_f32 v128, s38, v128
    v_mul_f32 v129, s38, v129
    v_max3_f32 v156, v156, v128, v129
    v_mov_b32 v157, v156
    s_nop 1
    v_permlane16_swap_b32 v156, v157
    v_max_f32 v156, v156, v157
    v_mov_b32 v157, v156
    s_nop 1
    v_permlane32_swap_b32 v156, v157
    v_max_f32 v156, v156, v157
    v_pk_add_f32 v[120:121], v[120:121], v[156:157] op_sel_hi:[1,0] neg_lo:[0,1] neg_hi:[0,1]
    v_pk_add_f32 v[122:123], v[122:123], v[156:157] op_sel_hi:[1,0] neg_lo:[0,1] neg_hi:[0,1]
    v_pk_add_f32 v[124:125], v[124:125], v[156:157] op_sel_hi:[1,0] neg_lo:[0,1] neg_hi:[0,1]
    v_pk_add_f32 v[126:127], v[126:127], v[156:157] op_sel_hi:[1,0] neg_lo:[0,1] neg_hi:[0,1]
    v_pk_add_f32 v[128:129], v[128:129], v[156:157] op_sel_hi:[1,0] neg_lo:[0,1] neg_hi:[0,1]
    v_exp_f32 v120, v120
    v_exp_f32 v121, v121
    v_exp_f32 v122, v122
    v_exp_f32 v123, v123
    v_exp_f32 v124, v124
    v_exp_f32 v125, v125
    v_exp_f32 v126, v126
    v_exp_f32 v127, v127
    v_exp_f32 v128, v128
    v_exp_f32 v129, v129
    v_cvt_pk_bf16_f32 v132, v120, v121
    v_cvt_pk_bf16_f32 v133, v122, v123
    v_cvt_pk_bf16_f32 v134, v124, v125
    v_cvt_pk_bf16_f32 v135, v126, v127
    v_cvt_pk_bf16_f32 v136, v128, v129
    v_mov_b32 v139, v136
    s_waitcnt lgkmcnt(0)
    v_mfma_f32_16x16x32_bf16 v[140:143], v[160:163], v[132:135], 0
    v_add_f32 v120, v120, v125
    v_add_f32 v121, v121, v126
    v_mfma_f32_16x16x32_bf16 v[144:147], v[164:167], v[132:135], 0
    v_add_f32 v122, v122, v127
    v_add_f32 v123, v123, v128
    v_mfma_f32_16x16x32_bf16 v[148:151], v[168:171], v[132:135], 0
    v_add_f32 v124, v124, v129
    v_add_f32 v120, v120, v121
    v_mfma_f32_16x16x32_bf16 v[152:155], v[172:175], v[132:135], 0
    v_add_f32 v122, v122, v123
    v_add_f32 v120, v120, v124
    v_mfma_f32_16x16x16_bf16 v[140:143], v[104:105], v[136:137], v[140:143]
    v_add_f32 v120, v120, v122
    v_mfma_f32_16x16x16_bf16 v[144:147], v[104:105], v[138:139], v[144:147]
    v_mfma_f32_16x16x16_bf16 v[148:151], v[106:107], v[136:137], v[148:151]
    v_mfma_f32_16x16x16_bf16 v[152:155], v[106:107], v[138:139], v[152:155]
    v_mov_b32 v156, v120
    s_nop 1
    v_permlane16_swap_b32 v120, v156
    v_add_f32 v120, v120, v156
    v_mov_b32 v156, v120
    s_nop 1
    v_permlane32_swap_b32 v120, v156
    v_add_f32 v120, v120, v156
    v_rcp_f32 v156, v120
    s_nop 0
    v_pk_mul_f32 v[140:141], v[140:141], v[156:157] op_sel_hi:[1,0]
    v_pk_mul_f32 v[142:143], v[142:143], v[156:157] op_sel_hi:[1,0]
    v_pk_mul_f32 v[144:145], v[144:145], v[156:157] op_sel_hi:[1,0]
    v_pk_mul_f32 v[146:147], v[146:147], v[156:157] op_sel_hi:[1,0]
    v_pk_mul_f32 v[148:149], v[148:149], v[156:157] op_sel_hi:[1,0]
    v_pk_mul_f32 v[150:151], v[150:151], v[156:157] op_sel_hi:[1,0]
    v_pk_mul_f32 v[152:153], v[152:153], v[156:157] op_sel_hi:[1,0]
    v_pk_mul_f32 v[154:155], v[154:155], v[156:157] op_sel_hi:[1,0]
    v_cvt_pk_bf16_f32 v140, v140, v141
    v_cvt_pk_bf16_f32 v141, v142, v143
    v_cvt_pk_bf16_f32 v142, v144, v145
    v_cvt_pk_bf16_f32 v143, v146, v147
    v_cvt_pk_bf16_f32 v144, v148, v149
    v_cvt_pk_bf16_f32 v145, v150, v151
    v_cvt_pk_bf16_f32 v146, v152, v153
    v_cvt_pk_bf16_f32 v147, v154, v155
    buffer_load_dword v89, v10, s[8:11], s33 offen offset:1536 sc1
    ds_write_b128 v14, v[140:143] offset:16384
    ds_write_b128 v14, v[144:147] offset:17408
    s_waitcnt lgkmcnt(0)
    s_barrier
    ds_read_b128 v[96:99], v0 offset:16384
    ds_read_b128 v[100:103], v0 offset:17408
    ds_read_b128 v[104:107], v0 offset:18432
    ds_read_b128 v[108:111], v0 offset:19456
    ds_read_b128 v[112:115], v0 offset:20480
    ds_read_b128 v[116:119], v0 offset:21504
    ds_read_b128 v[120:123], v0 offset:22528
    ds_read_b128 v[124:127], v0 offset:23552
    s_sub_u32 s40, s25, 1
    s_waitcnt vmcnt(0)
    v_cmp_gt_u32 vcc, s40, v89
    s_nop 0
    s_cbranch_vccz C_w4_s_ok
    s_mov_b32 s37, 0
C_w4_s:
    buffer_load_dword v15, v10, s[8:11], s33 offen offset:1536 sc1
    s_add_u32 s37, s37, 1
    s_cmp_gt_u32 s37, 400000
    s_cbranch_scc1 L_fail
    s_waitcnt vmcnt(0)
    v_cmp_gt_u32 vcc, s40, v15
    s_nop 0
    s_cbranch_vccz C_w4_s_ok
    s_branch C_w4_s
C_w4_s_ok:
    s_waitcnt lgkmcnt(4)
    s_add_u32 s56, s28, 0
    s_add_u32 s57, s28, 263168
    s_add_u32 s58, s28, 526336
    s_add_u32 s59, s28, 789504
    v_mfma_f32_16x16x32_bf16 v[128:131], a[0:3], v[96:99], 0
    v_mfma_f32_16x16x32_bf16 v[132:135], a[16:19], v[96:99], 0
    v_mfma_f32_16x16x32_bf16 v[128:131], a[4:7], v[100:103], v[128:131]
    v_mfma_f32_16x16x32_bf16 v[132:135], a[20:23], v[100:103], v[132:135]
    v_mfma_f32_16x16x32_bf16 v[128:131], a[8:11], v[104:107], v[128:131]
    v_mfma_f32_16x16x32_bf16 v[132:135], a[24:27], v[104:107], v[132:135]
    v_mfma_f32_16x16x32_bf16 v[128:131], a[12:15], v[108:111], v[128:131]
    v_mfma_f32_16x16x32_bf16 v[132:135], a[28:31], v[108:111], v[132:135]
    v_mfma_f32_16x16x32_bf16 v[136:139], a[32:35], v[96:99], 0
    s_nop 1
    v_mfma_f32_16x16x32_bf16 v[140:143], a[48:51], v[96:99], 0
    s_nop 1
    v_mfma_f32_16x16x32_bf16 v[136:139], a[36:39], v[100:103], v[136:139]
    v_cvt_pk_bf16_f32 v128, v128, v129
    v_cvt_pk_bf16_f32 v129, v130, v131
    v_mfma_f32_16x16x32_bf16 v[140:143], a[52:55], v[100:103], v[140:143]
    v_cvt_pk_bf16_f32 v130, v132, v133
    v_cvt_pk_bf16_f32 v131, v134, v135
    v_mfma_f32_16x16x32_bf16 v[136:139], a[40:43], v[104:107], v[136:139]
    ds_write_b128 v82, v[128:131] offset:0
    v_mfma_f32_16x16x32_bf16 v[140:143], a[56:59], v[104:107], v[140:143]
    v_mfma_f32_16x16x32_bf16 v[136:139], a[44:47], v[108:111], v[136:139]
    v_mfma_f32_16x16x32_bf16 v[140:143], a[60:63], v[108:111], v[140:143]
    v_mfma_f32_16x16x32_bf16 v[144:147], a[64:67], v[96:99], 0
    s_nop 1
    v_mfma_f32_16x16x32_bf16 v[148:151], a[80:83], v[96:99], 0
    s_nop 1
    v_mfma_f32_16x16x32_bf16 v[144:147], a[68:71], v[100:103], v[144:147]
    v_cvt_pk_bf16_f32 v136, v136, v137
    v_cvt_pk_bf16_f32 v137, v138, v139
    v_mfma_f32_16x16x32_bf16 v[148:151], a[84:87], v[100:103], v[148:151]
    v_cvt_pk_bf16_f32 v138, v140, v141
    v_cvt_pk_bf16_f32 v139, v142, v143
    v_mfma_f32_16x16x32_bf16 v[144:147], a[72:75], v[104:107], v[144:147]
    ds_write_b128 v82, v[136:139] offset:64
    v_mfma_f32_16x16x32_bf16 v[148:151], a[88:91], v[104:107], v[148:151]
    ds_read_b128 v[48:51], v83 offset:0
    v_mfma_f32_16x16x32_bf16 v[144:147], a[76:79], v[108:111], v[144:147]
    ds_read_b128 v[52:55], v83 offset:2176
    s_nop 0
    v_mfma_f32_16x16x32_bf16 v[148:151], a[92:95], v[108:111], v[148:151]
    s_nop 1
    v_mfma_f32_16x16x32_bf16 v[152:155], a[96:99], v[96:99], 0
    s_nop 1
    v_mfma_f32_16x16x32_bf16 v[156:159], a[112:115], v[96:99], 0
    s_nop 1
    v_mfma_f32_16x16x32_bf16 v[152:155], a[100:103], v[100:103], v[152:155]
    s_waitcnt lgkmcnt(1)
    buffer_store_dwordx4 v[48:51], v2, s[8:11], s56 offen offset:0 sc1
    v_mfma_f32_16x16x32_bf16 v[156:159], a[116:119], v[100:103], v[156:159]
    s_waitcnt lgkmcnt(0)
    buffer_store_dwordx4 v[52:55], v2, s[8:11], s57 offen offset:0 sc1
    v_cvt_pk_bf16_f32 v144, v144, v145
    v_mfma_f32_16x16x32_bf16 v[152:155], a[104:107], v[104:107], v[152:155]
    v_cvt_pk_bf16_f32 v145, v146, v147
    v_cvt_pk_bf16_f32 v146, v148, v149
    v_mfma_f32_16x16x32_bf16 v[156:159], a[120:123], v[104:107], v[156:159]
    v_cvt_pk_bf16_f32 v147, v150, v151
    v_mfma_f32_16x16x32_bf16 v[152:155], a[108:111], v[108:111], v[152:155]
    ds_write_b128 v82, v[144:147] offset:128
    v_mfma_f32_16x16x32_bf16 v[156:159], a[124:127], v[108:111], v[156:159]
    s_waitcnt lgkmcnt(5)
    v_mfma_f32_16x16x32_bf16 v[160:163], a[0:3], v[112:115], 0
    s_nop 1
    v_mfma_f32_16x16x32_bf16 v[164:167], a[16:19], v[112:115], 0
    s_nop 1
    v_mfma_f32_16x16x32_bf16 v[160:163], a[4:7], v[116:119], v[160:163]
    v_cvt_pk_bf16_f32 v152, v152, v153
    v_cvt_pk_bf16_f32 v153, v154, v155
    v_mfma_f32_16x16x32_bf16 v[164:167], a[20:23], v[116:119], v[164:167]
    v_cvt_pk_bf16_f32 v154, v156, v157
    v_cvt_pk_bf16_f32 v155, v158, v159
    v_mfma_f32_16x16x32_bf16 v[160:163], a[8:11], v[120:123], v[160:163]
    ds_write_b128 v82, v[152:155] offset:192
    v_mfma_f32_16x16x32_bf16 v[164:167], a[24:27], v[120:123], v[164:167]
    ds_read_b128 v[56:59], v83 offset:128
    v_mfma_f32_16x16x32_bf16 v[160:163], a[12:15], v[124:127], v[160:163]
    ds_read_b128 v[60:63], v83 offset:2304
    s_nop 0
    v_mfma_f32_16x16x32_bf16 v[164:167], a[28:31], v[124:127], v[164:167]
    s_nop 1
    v_mfma_f32_16x16x32_bf16 v[168:171], a[32:35], v[112:115], 0
    s_nop 1
    v_mfma_f32_16x16x32_bf16 v[172:175], a[48:51], v[112:115], 0
    s_nop 1
    v_mfma_f32_16x16x32_bf16 v[168:171], a[36:39], v[116:119], v[168:171]
    s_waitcnt lgkmcnt(1)
    buffer_store_dwordx4 v[56:59], v2, s[8:11], s56 offen offset:128 sc1
    v_mfma_f32_16x16x32_bf16 v[172:175], a[52:55], v[116:119], v[172:175]
    s_waitcnt lgkmcnt(0)
    buffer_store_dwordx4 v[60:63], v2, s[8:11], s57 offen offset:128 sc1
    v_cvt_pk_bf16_f32 v160, v160, v161
    v_mfma_f32_16x16x32_bf16 v[168:171], a[40:43], v[120:123], v[168:171]
    v_cvt_pk_bf16_f32 v161, v162, v163
    v_cvt_pk_bf16_f32 v162, v164, v165
    v_mfma_f32_16x16x32_bf16 v[172:175], a[56:59], v[120:123], v[172:175]
    v_cvt_pk_bf16_f32 v163, v166, v167
    v_mfma_f32_16x16x32_bf16 v[168:171], a[44:47], v[124:127], v[168:171]
    ds_write_b128 v82, v[160:163] offset:4352
    v_mfma_f32_16x16x32_bf16 v[172:175], a[60:63], v[124:127], v[172:175]
    v_mfma_f32_16x16x32_bf16 v[176:179], a[64:67], v[112:115], 0
    s_nop 1
    v_mfma_f32_16x16x32_bf16 v[180:183], a[80:83], v[112:115], 0
    s_nop 1
    v_mfma_f32_16x16x32_bf16 v[176:179], a[68:71], v[116:119], v[176:179]
    v_cvt_pk_bf16_f32 v168, v168, v169
    v_cvt_pk_bf16_f32 v169, v170, v171
    v_mfma_f32_16x16x32_bf16 v[180:183], a[84:87], v[116:119], v[180:183]
    v_cvt_pk_bf16_f32 v170, v172, v173
    v_cvt_pk_bf16_f32 v171, v174, v175
    v_mfma_f32_16x16x32_bf16 v[176:179], a[72:75], v[120:123], v[176:179]
    ds_write_b128 v82, v[168:171] offset:4416
    v_mfma_f32_16x16x32_bf16 v[180:183], a[88:91], v[120:123], v[180:183]
    ds_read_b128 v[64:67], v83 offset:4352
    v_mfma_f32_16x16x32_bf16 v[176:179], a[76:79], v[124:127], v[176:179]
    ds_read_b128 v[68:71], v83 offset:6528
    s_nop 0
    v_mfma_f32_16x16x32_bf16 v[180:183], a[92:95], v[124:127], v[180:183]
    s_nop 1
    v_mfma_f32_16x16x32_bf16 v[184:187], a[96:99], v[112:115], 0
    s_nop 1
    v_mfma_f32_16x16x32_bf16 v[188:191], a[112:115], v[112:115], 0
    s_nop 1
    v_mfma_f32_16x16x32_bf16 v[184:187], a[100:103], v[116:119], v[184:187]
    s_waitcnt lgkmcnt(1)
    buffer_store_dwordx4 v[64:67], v2, s[8:11], s58 offen offset:0 sc1
    v_mfma_f32_16x16x32_bf16 v[188:191], a[116:119], v[116:119], v[188:191]
    s_waitcnt lgkmcnt(0)
    buffer_store_dwordx4 v[68:71], v2, s[8:11], s59 offen offset:0 sc1
    v_cvt_pk_bf16_f32 v176, v176, v177
    v_mfma_f32_16x16x32_bf16 v[184:187], a[104:107], v[120:123], v[184:187]
    v_cvt_pk_bf16_f32 v177, v178, v179
    v_cvt_pk_bf16_f32 v178, v180, v181
    v_mfma_f32_16x16x32_bf16 v[188:191], a[120:123], v[120:123], v[188:191]
    v_cvt_pk_bf16_f32 v179, v182, v183
    v_mfma_f32_16x16x32_bf16 v[184:187], a[108:111], v[124:127], v[184:187]
    ds_write_b128 v82, v[176:179] offset:4480
    v_mfma_f32_16x16x32_bf16 v[188:191], a[124:127], v[124:127], v[188:191]
    s_nop 5
    v_cvt_pk_bf16_f32 v184, v184, v185
    v_cvt_pk_bf16_f32 v185, v186, v187
    v_cvt_pk_bf16_f32 v186, v188, v189
    v_cvt_pk_bf16_f32 v187, v190, v191
    ds_write_b128 v82, v[184:187] offset:4544
    ds_read_b128 v[72:75], v83 offset:4480
    ds_read_b128 v[76:79], v83 offset:6656
    s_waitcnt lgkmcnt(1)
    buffer_store_dwordx4 v[72:75], v2, s[8:11], s58 offen offset:128 sc1
    s_waitcnt lgkmcnt(0)
    buffer_store_dwordx4 v[76:79], v2, s[8:11], s59 offen offset:128 sc1
    s_waitcnt vmcnt(0)
    v_mov_b32 v15, s25
    buffer_store_dword v15, v11, s[8:11], s32 offen offset:0 sc1
    s_mov_b32 s37, 0
C_w1_s:
    buffer_load_dword v15, v10, s[8:11], s33 offen offset:0 sc1
    s_add_u32 s37, s37, 1
    s_cmp_gt_u32 s37, 400000
    s_cbranch_scc1 L_fail
    s_waitcnt vmcnt(0)
    v_cmp_gt_u32 vcc, s25, v15
    s_nop 0
    s_cbranch_vccz C_w1_s_ok
    s_branch C_w1_s
C_w1_s_ok:
    buffer_load_dwordx4 v[96:99], v3, s[8:11], s29 offen sc1
    s_add_u32 s41, s29, 4096
    buffer_load_dwordx4 v[100:103], v3, s[8:11], s41 offen sc1
    s_add_u32 s41, s29, 8192
    buffer_load_dwordx4 v[104:107], v3, s[8:11], s41 offen sc1
    s_add_u32 s41, s29, 12288
    buffer_load_dwordx4 v[108:111], v3, s[8:11], s41 offen sc1
    s_add_u32 s41, s29, 16384
    buffer_load_dwordx4 v[112:115], v3, s[8:11], s41 offen sc1
    s_add_u32 s41, s29, 20480
    buffer_load_dwordx4 v[116:119], v3, s[8:11], s41 offen sc1
    s_add_u32 s41, s29, 24576
    buffer_load_dwordx4 v[120:123], v3, s[8:11], s41 offen sc1
    s_add_u32 s41, s29, 28672
    buffer_load_dwordx4 v[124:127], v3, s[8:11], s41 offen sc1
    s_waitcnt vmcnt(7)
    v_mfma_f32_16x16x32_bf16 v[128:131], v[28:31], v[96:99], 0
    s_waitcnt vmcnt(6)
    v_mfma_f32_16x16x32_bf16 v[128:131], v[28:31], v[100:103], v[128:131]
    s_waitcnt vmcnt(5)
    v_mfma_f32_16x16x32_bf16 v[128:131], v[28:31], v[104:107], v[128:131]
    s_waitcnt vmcnt(4)
    v_mfma_f32_16x16x32_bf16 v[128:131], v[28:31], v[108:111], v[128:131]
    s_waitcnt vmcnt(3)
    v_mfma_f32_16x16x32_bf16 v[128:131], v[28:31], v[112:115], v[128:131]
    s_waitcnt vmcnt(2)
    v_mfma_f32_16x16x32_bf16 v[128:131], v[28:31], v[116:119], v[128:131]
    s_waitcnt vmcnt(1)
    v_mfma_f32_16x16x32_bf16 v[128:131], v[28:31], v[120:123], v[128:131]
    s_waitcnt vmcnt(0)
    v_mfma_f32_16x16x32_bf16 v[128:131], v[28:31], v[124:127], v[128:131]
    v_lshlrev_b32 v132, 16, v26
    v_and_b32 v133, 0xffff0000, v26
    v_lshlrev_b32 v134, 16, v27
    v_and_b32 v135, 0xffff0000, v27
    s_nop 3
    v_cvt_pk_bf16_f32 v128, v128, v129
    v_cvt_pk_bf16_f32 v130, v130, v131
    v_and_b32 v129, 0xffff0000, v128
    v_and_b32 v131, 0xffff0000, v130
    v_lshlrev_b32 v128, 16, v128
    v_lshlrev_b32 v130, 16, v130
    v_pk_add_f32 v[132:133], v[132:133], v[128:129]
    v_pk_add_f32 v[134:135], v[134:135], v[130:131]
    v_cvt_pk_bf16_f32 v26, v132, v133
    v_cvt_pk_bf16_f32 v27, v134, v135
    v_lshlrev_b32 v132, 16, v26
    v_and_b32 v133, 0xffff0000, v26
    v_lshlrev_b32 v134, 16, v27
    v_and_b32 v135, 0xffff0000, v27
    v_pk_mul_f32 v[140:141], v[132:133], v[132:133]
    v_pk_add_f32 v[136:137], v[132:133], v[134:135]
    v_pk_fma_f32 v[140:141], v[134:135], v[134:135], v[140:141]
    v_add_f32 v136, v136, v137
    v_add_f32 v137, v140, v141
    s_nop 0
    v_add_f32_dpp v136, v136, v136 row_ror:8 row_mask:0xf bank_mask:0xf
    v_add_f32_dpp v137, v137, v137 row_ror:8 row_mask:0xf bank_mask:0xf
    s_nop 0
    v_add_f32_dpp v136, v136, v136 row_ror:4 row_mask:0xf bank_mask:0xf
    v_add_f32_dpp v137, v137, v137 row_ror:4 row_mask:0xf bank_mask:0xf
    s_nop 0
    v_add_f32_dpp v136, v136, v136 row_ror:2 row_mask:0xf bank_mask:0xf
    v_add_f32_dpp v137, v137, v137 row_ror:2 row_mask:0xf bank_mask:0xf
    s_nop 0
    v_add_f32_dpp v136, v136, v136 row_ror:1 row_mask:0xf bank_mask:0xf
    v_add_f32_dpp v137, v137, v137 row_ror:1 row_mask:0xf bank_mask:0xf
    s_mov_b64 exec, 0x10001
    ds_write_b64 v87, v[136:137] offset:28672
    s_mov_b64 exec, -1
    s_waitcnt lgkmcnt(0)
    s_barrier
    ds_read_b128 v[144:147], v88 offset:28672
    ds_read_b128 v[148:151], v88 offset:28688
    ds_read_b128 v[152:155], v88 offset:28704
    ds_read_b128 v[156:159], v88 offset:28720
    s_waitcnt lgkmcnt(2)
    v_pk_add_f32 v[144:145], v[144:145], v[146:147]
    v_pk_add_f32 v[148:149], v[148:149], v[150:151]
    s_waitcnt lgkmcnt(0)
    v_pk_add_f32 v[152:153], v[152:153], v[154:155]
    v_pk_add_f32 v[156:157], v[156:157], v[158:159]
    v_pk_add_f32 v[144:145], v[144:145], v[148:149]
    v_pk_add_f32 v[152:153], v[152:153], v[156:157]
    v_pk_add_f32 v[144:145], v[144:145], v[152:153]
    v_mul_f32 v136, 989855744, v144
    v_mov_b32 v146, 925353388
    v_fmac_f32 v146, 989855744, v145
    v_fma_f32 v146, -v136, v136, v146
    v_max_f32 v146, 925353388, v146
    v_rsq_f32 v137, v146
    s_nop 0
    v_pk_add_f32 v[132:133], v[132:133], v[136:137] op_sel_hi:[1,0] neg_lo:[0,1] neg_hi:[0,1]
    v_pk_mul_f32 v[132:133], v[132:133], v[136:137] op_sel:[0,1] op_sel_hi:[1,1]
    v_pk_add_f32 v[134:135], v[134:135], v[136:137] op_sel_hi:[1,0] neg_lo:[0,1] neg_hi:[0,1]
    v_pk_mul_f32 v[134:135], v[134:135], v[136:137] op_sel:[0,1] op_sel_hi:[1,1]
    v_cvt_pk_bf16_f32 v140, v132, v133
    v_cvt_pk_bf16_f32 v141, v134, v135
    buffer_store_dwordx2 v[140:141], v5, s[8:11], s30 offen sc1
    s_waitcnt vmcnt(0)
    v_mov_b32 v15, s25
    buffer_store_dword v15, v11, s[8:11], s32 offen offset:512 sc1
C_noln_s:
    s_cmp_ge_u32 s16, 28
    s_cbranch_scc1 C_noffn_s
    s_mov_b32 s37, 0
C_w2_s:
    buffer_load_dword v15, v10, s[8:11], s33 offen offset:512 sc1
    s_add_u32 s37, s37, 1
    s_cmp_gt_u32 s37, 400000
    s_cbranch_scc1 L_fail
    s_waitcnt vmcnt(0)
    v_cmp_gt_u32 vcc, s25, v15
    s_nop 0
    s_cbranch_vccz C_w2_s_ok
    s_branch C_w2_s
C_w2_s_ok:
    s_lshl_b32 s42, s17, 12
    s_add_u32 m0, s42, 32768
    s_add_u32 s41, s31, 0
    buffer_load_dwordx4 v0, s[8:11], s41 offen offset:0 sc1 lds
    buffer_load_dwordx4 v0, s[8:11], s41 offen offset:1024 sc1 lds
    buffer_load_dwordx4 v0, s[8:11], s41 offen offset:2048 sc1 lds
    buffer_load_dwordx4 v0, s[8:11], s41 offen offset:3072 sc1 lds
    s_add_u32 m0, s42, 49152
    s_add_u32 s41, s31, 16384
    buffer_load_dwordx4 v0, s[8:11], s41 offen offset:0 sc1 lds
    buffer_load_dwordx4 v0, s[8:11], s41 offen offset:1024 sc1 lds
    buffer_load_dwordx4 v0, s[8:11], s41 offen offset:2048 sc1 lds
    buffer_load_dwordx4 v0, s[8:11], s41 offen offset:3072 sc1 lds
    s_add_u32 s24, s24, s63
    s_mul_i32 s41, s63, 786432
    s_add_u32 s26, s26, s41
    s_mul_i32 s41, s63, 131072
    s_add_u32 s27, s27, s41
    s_add_u32 s41, s24, 0
    s_lshr_b32 s40, s41, 1
    s_add_u32 s40, s40, 1
    s_max_u32 s40, s40, 2
    s_and_b32 s41, s41, 1
    s_lshl_b32 s41, s41, 12
    s_add_u32 s42, s41, s34
    s_cmp_lt_u32 s24, 64
    s_cselect_b32 s40, s40, 0
    v_cmp_gt_u32 vcc, s40, v84
    s_nop 0
    s_cbranch_vccz C_la_s_ok
    s_mov_b32 s37, 0
C_la_s:
    buffer_load_dword v15, v12, s[8:11], s42 offen offset:0 sc1
    s_add_u32 s37, s37, 1
    s_cmp_gt_u32 s37, 400000
    s_cbranch_scc1 L_fail
    s_waitcnt vmcnt(0)
    v_cmp_gt_u32 vcc, s40, v15
    s_nop 0
    s_cbranch_vccz C_la_s_ok
    s_branch C_la_s
C_la_s_ok:
    v_cmp_ge_u32 vcc, s24, v25
    s_mul_i32 s41, s17, 6144
    s_add_u32 s53, s26, s41
    s_cmp_lt_u32 s24, 64
    s_cselect_b32 s53, s53, 0x40000000
    s_add_u32 s54, s53, 3072
    s_cmp_eq_u64 vcc, 0
    s_cselect_b32 s43, 1, 0
    s_cselect_b32 s55, s27, 0x40000000
    s_waitcnt vmcnt(0)
    s_barrier
    ds_read_b128 v[128:131], v6 offset:32768
    ds_read_b128 v[132:135], v6 offset:49152
    ds_read_b128 v[136:139], v7 offset:32768
    ds_read_b128 v[140:143], v7 offset:49152
    s_waitcnt lgkmcnt(2)
    v_mfma_f32_16x16x32_bf16 v[152:155], a[128:131], v[128:131], 0
    ds_read_b128 v[144:147], v6 offset:34816
    v_mfma_f32_16x16x32_bf16 v[156:159], a[128:131], v[132:135], 0
    ds_read_b128 v[148:151], v6 offset:51200
    v_mfma_f32_16x16x32_bf16 v[160:163], a[192:195], v[128:131], 0
    s_mul_i32 s41, s17, 6144
    s_add_u32 m0, s41, 65536
    s_nop 0
    buffer_load_dwordx4 v0, s[8:11], s53 offen sc1 lds
    v_mfma_f32_16x16x32_bf16 v[164:167], a[192:195], v[132:135], 0
    s_waitcnt lgkmcnt(2)
    v_mfma_f32_16x16x32_bf16 v[152:155], a[132:135], v[136:139], v[152:155]
    ds_read_b128 v[128:131], v7 offset:34816
    v_mfma_f32_16x16x32_bf16 v[156:159], a[132:135], v[140:143], v[156:159]
    ds_read_b128 v[132:135], v7 offset:51200
    v_mfma_f32_16x16x32_bf16 v[160:163], a[196:199], v[136:139], v[160:163]
    buffer_load_dwordx4 v0, s[8:11], s53 offen offset:1024 sc1 lds
    v_mfma_f32_16x16x32_bf16 v[164:167], a[196:199], v[140:143], v[164:167]
    s_waitcnt lgkmcnt(2)
    v_mfma_f32_16x16x32_bf16 v[152:155], a[136:139], v[144:147], v[152:155]
    ds_read_b128 v[136:139], v6 offset:36864
    v_mfma_f32_16x16x32_bf16 v[156:159], a[136:139], v[148:151], v[156:159]
    ds_read_b128 v[140:143], v6 offset:53248
    v_mfma_f32_16x16x32_bf16 v[160:163], a[200:203], v[144:147], v[160:163]
    buffer_load_dwordx4 v0, s[8:11], s53 offen offset:2048 sc1 lds
    v_mfma_f32_16x16x32_bf16 v[164:167], a[200:203], v[148:151], v[164:167]
    s_waitcnt lgkmcnt(2)
    v_mfma_f32_16x16x32_bf16 v[152:155], a[140:143], v[128:131], v[152:155]
    ds_read_b128 v[144:147], v7 offset:36864
    v_mfma_f32_16x16x32_bf16 v[156:159], a[140:143], v[132:135], v[156:159]
    ds_read_b128 v[148:151], v7 offset:53248
    v_mfma_f32_16x16x32_bf16 v[160:163], a[204:207], v[128:131], v[160:163]
    s_mul_i32 s41, s17, 6144
    s_add_u32 m0, s41, 68608
    s_nop 0
    buffer_load_dwordx4 v0, s[8:11], s54 offen sc1 lds
    v_mfma_f32_16x16x32_bf16 v[164:167], a[204:207], v[132:135], v[164:167]
    s_waitcnt lgkmcnt(2)
    v_mfma_f32_16x16x32_bf16 v[152:155], a[144:147], v[136:139], v[152:155]
    ds_read_b128 v[128:131], v6 offset:38912
    v_mfma_f32_16x16x32_bf16 v[156:159], a[144:147], v[140:143], v[156:159]
    ds_read_b128 v[132:135], v6 offset:55296
    v_mfma_f32_16x16x32_bf16 v[160:163], a[208:211], v[136:139], v[160:163]
    buffer_load_dwordx4 v0, s[8:11], s54 offen offset:1024 sc1 lds
    v_mfma_f32_16x16x32_bf16 v[164:167], a[208:211], v[140:143], v[164:167]
    s_waitcnt lgkmcnt(2)
    v_mfma_f32_16x16x32_bf16 v[152:155], a[148:151], v[144:147], v[152:155]
    ds_read_b128 v[136:139], v7 offset:38912
    v_mfma_f32_16x16x32_bf16 v[156:159], a[148:151], v[148:151], v[156:159]
    ds_read_b128 v[140:143], v7 offset:55296
    v_mfma_f32_16x16x32_bf16 v[160:163], a[212:215], v[144:147], v[160:163]
    buffer_load_dwordx4 v0, s[8:11], s54 offen offset:2048 sc1 lds
    v_mfma_f32_16x16x32_bf16 v[164:167], a[212:215], v[148:151], v[164:167]
    s_waitcnt lgkmcnt(2)
    v_mfma_f32_16x16x32_bf16 v[152:155], a[152:155], v[128:131], v[152:155]
    ds_read_b128 v[144:147], v6 offset:40960
    v_mfma_f32_16x16x32_bf16 v[156:159], a[152:155], v[132:135], v[156:159]
    ds_read_b128 v[148:151], v6 offset:57344
    v_mfma_f32_16x16x32_bf16 v[160:163], a[216:219], v[128:131], v[160:163]
    s_lshl_b32 s41, s17, 12
    s_add_u32 m0, s41, 0
    s_nop 0
    buffer_load_dwordx4 v0, s[8:11], s55 offen offset:0 sc1 lds
    v_mfma_f32_16x16x32_bf16 v[164:167], a[216:219], v[132:135], v[164:167]
    s_waitcnt lgkmcnt(2)
    v_mfma_f32_16x16x32_bf16 v[152:155], a[156:159], v[136:139], v[152:155]
    ds_read_b128 v[128:131], v7 offset:40960
    v_mfma_f32_16x16x32_bf16 v[156:159], a[156:159], v[140:143], v[156:159]
    ds_read_b128 v[132:135], v7 offset:57344
    v_mfma_f32_16x16x32_bf16 v[160:163], a[220:223], v[136:139], v[160:163]
    buffer_load_dwordx4 v0, s[8:11], s55 offen offset:1024 sc1 lds
    v_mfma_f32_16x16x32_bf16 v[164:167], a[220:223], v[140:143], v[164:167]
    s_waitcnt lgkmcnt(2)
    v_mfma_f32_16x16x32_bf16 v[152:155], a[160:163], v[144:147], v[152:155]
    ds_read_b128 v[136:139], v6 offset:43008
    v_mfma_f32_16x16x32_bf16 v[156:159], a[160:163], v[148:151], v[156:159]
    ds_read_b128 v[140:143], v6 offset:59392
    v_mfma_f32_16x16x32_bf16 v[160:163], a[224:227], v[144:147], v[160:163]
    buffer_load_dwordx4 v0, s[8:11], s55 offen offset:2048 sc1 lds
    v_mfma_f32_16x16x32_bf16 v[164:167], a[224:227], v[148:151], v[164:167]
    s_waitcnt lgkmcnt(2)
    v_mfma_f32_16x16x32_bf16 v[152:155], a[164:167], v[128:131], v[152:155]
    ds_read_b128 v[144:147], v7 offset:43008
    v_mfma_f32_16x16x32_bf16 v[156:159], a[164:167], v[132:135], v[156:159]
    ds_read_b128 v[148:151], v7 offset:59392
    v_mfma_f32_16x16x32_bf16 v[160:163], a[228:231], v[128:131], v[160:163]
    buffer_load_dwordx4 v0, s[8:11], s55 offen offset:3072 sc1 lds
    v_mfma_f32_16x16x32_bf16 v[164:167], a[228:231], v[132:135], v[164:167]
    s_waitcnt lgkmcnt(2)
    v_mfma_f32_16x16x32_bf16 v[152:155], a[168:171], v[136:139], v[152:155]
    ds_read_b128 v[128:131], v6 offset:45056
    v_mfma_f32_16x16x32_bf16 v[156:159], a[168:171], v[140:143], v[156:159]
    ds_read_b128 v[132:135], v6 offset:61440
    v_mfma_f32_16x16x32_bf16 v[160:163], a[232:235], v[136:139], v[160:163]
    v_mfma_f32_16x16x32_bf16 v[164:167], a[232:235], v[140:143], v[164:167]
    s_waitcnt lgkmcnt(2)
    v_mfma_f32_16x16x32_bf16 v[152:155], a[172:175], v[144:147], v[152:155]
    ds_read_b128 v[136:139], v7 offset:45056
    v_mfma_f32_16x16x32_bf16 v[156:159], a[172:175], v[148:151], v[156:159]
    ds_read_b128 v[140:143], v7 offset:61440
    v_mfma_f32_16x16x32_bf16 v[160:163], a[236:239], v[144:147], v[160:163]
    v_mfma_f32_16x16x32_bf16 v[164:167], a[236:239], v[148:151], v[164:167]
    s_waitcnt lgkmcnt(2)
    v_mfma_f32_16x16x32_bf16 v[152:155], a[176:179], v[128:131], v[152:155]
    ds_read_b128 v[144:147], v6 offset:47104
    v_mfma_f32_16x16x32_bf16 v[156:159], a[176:179], v[132:135], v[156:159]
    ds_read_b128 v[148:151], v6 offset:63488
    v_mfma_f32_16x16x32_bf16 v[160:163], a[240:243], v[128:131], v[160:163]
    v_mfma_f32_16x16x32_bf16 v[164:167], a[240:243], v[132:135], v[164:167]
    s_waitcnt lgkmcnt(2)
    v_mfma_f32_16x16x32_bf16 v[152:155], a[180:183], v[136:139], v[152:155]
    ds_read_b128 v[128:131], v7 offset:47104
    v_mfma_f32_16x16x32_bf16 v[156:159], a[180:183], v[140:143], v[156:159]
    ds_read_b128 v[132:135], v7 offset:63488
    v_mfma_f32_16x16x32_bf16 v[160:163], a[244:247], v[136:139], v[160:163]
    v_mfma_f32_16x16x32_bf16 v[164:167], a[244:247], v[140:143], v[164:167]
    s_waitcnt lgkmcnt(2)
    v_mfma_f32_16x16x32_bf16 v[152:155], a[184:187], v[144:147], v[152:155]
    v_mfma_f32_16x16x32_bf16 v[156:159], a[184:187], v[148:151], v[156:159]
    v_mfma_f32_16x16x32_bf16 v[160:163], a[248:251], v[144:147], v[160:163]
    v_mfma_f32_16x16x32_bf16 v[164:167], a[248:251], v[148:151], v[164:167]
    s_waitcnt lgkmcnt(0)
    v_mfma_f32_16x16x32_bf16 v[152:155], a[188:191], v[128:131], v[152:155]
    v_mfma_f32_16x16x32_bf16 v[156:159], a[188:191], v[132:135], v[156:159]
    v_mfma_f32_16x16x32_bf16 v[160:163], a[252:255], v[128:131], v[160:163]
    v_mfma_f32_16x16x32_bf16 v[164:167], a[252:255], v[132:135], v[164:167]
    s_mov_b32 s60, 3184710632
    s_mov_b32 s61, 3184710632
    v_mov_b32 v128, 3222493025
    v_mov_b32 v130, 1.0
    s_nop 0
    v_pk_mul_f32 v[168:169], v[152:153], v[152:153]
    v_pk_mul_f32 v[170:171], v[154:155], v[154:155]
    v_pk_mul_f32 v[172:173], v[156:157], v[156:157]
    v_pk_mul_f32 v[174:175], v[158:159], v[158:159]
    v_pk_fma_f32 v[168:169], v[168:169], s[60:61], v[128:129] op_sel_hi:[1,1,0]
    v_pk_fma_f32 v[170:171], v[170:171], s[60:61], v[128:129] op_sel_hi:[1,1,0]
    v_pk_fma_f32 v[172:173], v[172:173], s[60:61], v[128:129] op_sel_hi:[1,1,0]
    v_pk_fma_f32 v[174:175], v[174:175], s[60:61], v[128:129] op_sel_hi:[1,1,0]
    v_pk_mul_f32 v[168:169], v[168:169], v[152:153]
    v_pk_mul_f32 v[170:171], v[170:171], v[154:155]
    v_pk_mul_f32 v[172:173], v[172:173], v[156:157]
    v_pk_mul_f32 v[174:175], v[174:175], v[158:159]
    v_exp_f32 v168, v168
    v_exp_f32 v169, v169
    v_exp_f32 v170, v170
    v_exp_f32 v171, v171
    v_exp_f32 v172, v172
    v_exp_f32 v173, v173
    v_exp_f32 v174, v174
    v_exp_f32 v175, v175
    v_pk_add_f32 v[168:169], v[168:169], v[130:131] op_sel_hi:[1,0]
    v_pk_add_f32 v[170:171], v[170:171], v[130:131] op_sel_hi:[1,0]
    v_pk_add_f32 v[172:173], v[172:173], v[130:131] op_sel_hi:[1,0]
    v_pk_add_f32 v[174:175], v[174:175], v[130:131] op_sel_hi:[1,0]
    v_rcp_f32 v168, v168
    v_rcp_f32 v169, v169
    v_rcp_f32 v170, v170
    v_rcp_f32 v171, v171
    v_rcp_f32 v172, v172
    v_rcp_f32 v173, v173
    v_rcp_f32 v174, v174
    v_rcp_f32 v175, v175
    v_pk_mul_f32 v[152:153], v[152:153], v[160:161]
    v_pk_mul_f32 v[154:155], v[154:155], v[162:163]
    v_pk_mul_f32 v[156:157], v[156:157], v[164:165]
    v_pk_mul_f32 v[158:159], v[158:159], v[166:167]
    v_pk_mul_f32 v[168:169], v[168:169], v[152:153]
    v_pk_mul_f32 v[170:171], v[170:171], v[154:155]
    v_pk_mul_f32 v[172:173], v[172:173], v[156:157]
    v_pk_mul_f32 v[174:175], v[174:175], v[158:159]
    v_cvt_pk_bf16_f32 v168, v168, v169
    v_cvt_pk_bf16_f32 v169, v170, v171
    v_cvt_pk_bf16_f32 v170, v172, v173
    v_cvt_pk_bf16_f32 v171, v174, v175
    ds_write_b64 v13, v[168:169] offset:24576
    ds_write_b64 v13, v[170:171] offset:26624
    s_waitcnt lgkmcnt(0)
    s_barrier
    ds_read_b128 v[96:99], v0 offset:24576
    ds_read_b128 v[100:103], v0 offset:25600
    ds_read_b128 v[104:107], v0 offset:26624
    ds_read_b128 v[108:111], v0 offset:27648
    s_add_u32 s40, s28, 0
    s_waitcnt lgkmcnt(2)
    s_add_u32 s56, s40, 0
    s_add_u32 s57, s40, 263168
    s_add_u32 s58, s40, 526336
    s_add_u32 s59, s40, 789504
    v_mfma_f32_16x16x32_bf16 v[128:131], v[192:195], v[96:99], 0
    v_mfma_f32_16x16x32_bf16 v[132:135], v[200:203], v[96:99], 0
    v_mfma_f32_16x16x32_bf16 v[128:131], v[196:199], v[100:103], v[128:131]
    v_mfma_f32_16x16x32_bf16 v[132:135], v[204:207], v[100:103], v[132:135]
    v_mfma_f32_16x16x32_bf16 v[136:139], v[208:211], v[96:99], 0
    s_nop 1
    v_mfma_f32_16x16x32_bf16 v[140:143], v[216:219], v[96:99], 0
    s_nop 1
    v_mfma_f32_16x16x32_bf16 v[136:139], v[212:215], v[100:103], v[136:139]
    v_cvt_pk_bf16_f32 v128, v128, v129
    v_cvt_pk_bf16_f32 v129, v130, v131
    v_mfma_f32_16x16x32_bf16 v[140:143], v[220:223], v[100:103], v[140:143]
    v_cvt_pk_bf16_f32 v130, v132, v133
    v_cvt_pk_bf16_f32 v131, v134, v135
    v_mfma_f32_16x16x32_bf16 v[144:147], v[224:227], v[96:99], 0
    ds_write_b128 v82, v[128:131] offset:0
    s_nop 0
    v_mfma_f32_16x16x32_bf16 v[148:151], v[232:235], v[96:99], 0
    s_nop 1
    v_mfma_f32_16x16x32_bf16 v[144:147], v[228:231], v[100:103], v[144:147]
    v_cvt_pk_bf16_f32 v136, v136, v137
    v_cvt_pk_bf16_f32 v137, v138, v139
    v_mfma_f32_16x16x32_bf16 v[148:151], v[236:239], v[100:103], v[148:151]
    v_cvt_pk_bf16_f32 v138, v140, v141
    v_cvt_pk_bf16_f32 v139, v142, v143
    v_mfma_f32_16x16x32_bf16 v[152:155], v[240:243], v[96:99], 0
    ds_write_b128 v82, v[136:139] offset:64
    v_mfma_f32_16x16x32_bf16 v[156:159], v[248:251], v[96:99], 0
    ds_read_b128 v[48:51], v83 offset:0
    v_mfma_f32_16x16x32_bf16 v[152:155], v[244:247], v[100:103], v[152:155]
    ds_read_b128 v[52:55], v83 offset:2176
    s_nop 0
    v_mfma_f32_16x16x32_bf16 v[156:159], v[252:255], v[100:103], v[156:159]
    s_nop 1
    s_waitcnt lgkmcnt(4)
    v_mfma_f32_16x16x32_bf16 v[160:163], v[192:195], v[104:107], 0
    s_nop 1
    v_mfma_f32_16x16x32_bf16 v[164:167], v[200:203], v[104:107], 0
    s_nop 1
    v_mfma_f32_16x16x32_bf16 v[160:163], v[196:199], v[108:111], v[160:163]
    s_waitcnt lgkmcnt(1)
    buffer_store_dwordx4 v[48:51], v2, s[8:11], s56 offen offset:0 sc1
    v_mfma_f32_16x16x32_bf16 v[164:167], v[204:207], v[108:111], v[164:167]
    s_waitcnt lgkmcnt(0)
    buffer_store_dwordx4 v[52:55], v2, s[8:11], s57 offen offset:0 sc1
    v_cvt_pk_bf16_f32 v144, v144, v145
    v_mfma_f32_16x16x32_bf16 v[168:171], v[208:211], v[104:107], 0
    v_cvt_pk_bf16_f32 v145, v146, v147
    v_cvt_pk_bf16_f32 v146, v148, v149
    v_mfma_f32_16x16x32_bf16 v[172:175], v[216:219], v[104:107], 0
    v_cvt_pk_bf16_f32 v147, v150, v151
    v_mfma_f32_16x16x32_bf16 v[168:171], v[212:215], v[108:111], v[168:171]
    ds_write_b128 v82, v[144:147] offset:128
    v_cvt_pk_bf16_f32 v152, v152, v153
    v_mfma_f32_16x16x32_bf16 v[172:175], v[220:223], v[108:111], v[172:175]
    v_cvt_pk_bf16_f32 v153, v154, v155
    v_cvt_pk_bf16_f32 v154, v156, v157
    v_mfma_f32_16x16x32_bf16 v[176:179], v[224:227], v[104:107], 0
    v_cvt_pk_bf16_f32 v155, v158, v159
    v_mfma_f32_16x16x32_bf16 v[180:183], v[232:235], v[104:107], 0
    ds_write_b128 v82, v[152:155] offset:192
    v_mfma_f32_16x16x32_bf16 v[176:179], v[228:231], v[108:111], v[176:179]
    ds_read_b128 v[56:59], v83 offset:128
    v_mfma_f32_16x16x32_bf16 v[180:183], v[236:239], v[108:111], v[180:183]
    ds_read_b128 v[60:63], v83 offset:2304
    v_mfma_f32_16x16x32_bf16 v[184:187], v[240:243], v[104:107], 0
    s_waitcnt lgkmcnt(1)
    buffer_store_dwordx4 v[56:59], v2, s[8:11], s56 offen offset:128 sc1
    v_mfma_f32_16x16x32_bf16 v[188:191], v[248:251], v[104:107], 0
    s_waitcnt lgkmcnt(0)
    buffer_store_dwordx4 v[60:63], v2, s[8:11], s57 offen offset:128 sc1
    v_cvt_pk_bf16_f32 v160, v160, v161
    v_mfma_f32_16x16x32_bf16 v[184:187], v[244:247], v[108:111], v[184:187]
    v_cvt_pk_bf16_f32 v161, v162, v163
    v_cvt_pk_bf16_f32 v162, v164, v165
    v_mfma_f32_16x16x32_bf16 v[188:191], v[252:255], v[108:111], v[188:191]
    v_cvt_pk_bf16_f32 v163, v166, v167
    ds_write_b128 v82, v[160:163] offset:4352
    v_cvt_pk_bf16_f32 v168, v168, v169
    v_cvt_pk_bf16_f32 v169, v170, v171
    v_cvt_pk_bf16_f32 v170, v172, v173
    v_cvt_pk_bf16_f32 v171, v174, v175
    ds_write_b128 v82, v[168:171] offset:4416
    ds_read_b128 v[64:67], v83 offset:4352
    ds_read_b128 v[68:71], v83 offset:6528
    s_waitcnt lgkmcnt(1)
    buffer_store_dwordx4 v[64:67], v2, s[8:11], s58 offen offset:0 sc1
    s_waitcnt lgkmcnt(0)
    buffer_store_dwordx4 v[68:71], v2, s[8:11], s59 offen offset:0 sc1
    v_cvt_pk_bf16_f32 v176, v176, v177
    v_cvt_pk_bf16_f32 v177, v178, v179
    v_cvt_pk_bf16_f32 v178, v180, v181
    v_cvt_pk_bf16_f32 v179, v182, v183
    ds_write_b128 v82, v[176:179] offset:4480
    v_cvt_pk_bf16_f32 v184, v184, v185
    v_cvt_pk_bf16_f32 v185, v186, v187
    v_cvt_pk_bf16_f32 v186, v188, v189
    v_cvt_pk_bf16_f32 v187, v190, v191
    ds_write_b128 v82, v[184:187] offset:4544
    ds_read_b128 v[72:75], v83 offset:4480
    ds_read_b128 v[76:79], v83 offset:6656
    s_waitcnt lgkmcnt(1)
    buffer_store_dwordx4 v[72:75], v2, s[8:11], s58 offen offset:128 sc1
    s_waitcnt lgkmcnt(0)
    buffer_store_dwordx4 v[76:79], v2, s[8:11], s59 offen offset:128 sc1
    s_waitcnt vmcnt(0)
    v_mov_b32 v15, s25
    buffer_store_dword v15, v11, s[8:11], s32 offen offset:1024 sc1
    s_branch C_join_s
C_noffn_s:
    s_waitcnt vmcnt(0)
    s_add_u32 s24, s24, s63
    s_mul_i32 s41, s63, 786432
    s_add_u32 s26, s26, s41
    s_mul_i32 s41, s63, 131072
    s_add_u32 s27, s27, s41
    s_add_u32 s41, s24, 0
    s_lshr_b32 s40, s41, 1
    s_add_u32 s40, s40, 1
    s_max_u32 s40, s40, 2
    s_and_b32 s41, s41, 1
    s_lshl_b32 s41, s41, 12
    s_add_u32 s42, s41, s34
    s_cmp_lt_u32 s24, 64
    s_cselect_b32 s40, s40, 0
    v_cmp_gt_u32 vcc, s40, v84
    s_nop 0
    s_cbranch_vccz C_lb_s_ok
    s_mov_b32 s37, 0
C_lb_s:
    buffer_load_dword v15, v12, s[8:11], s42 offen offset:0 sc1
    s_add_u32 s37, s37, 1
    s_cmp_gt_u32 s37, 400000
    s_cbranch_scc1 L_fail
    s_waitcnt vmcnt(0)
    v_cmp_gt_u32 vcc, s40, v15
    s_nop 0
    s_cbranch_vccz C_lb_s_ok
    s_branch C_lb_s
C_lb_s_ok:
    v_cmp_ge_u32 vcc, s24, v25
    s_mul_i32 s41, s17, 6144
    s_add_u32 s53, s26, s41
    s_cmp_lt_u32 s24, 64
    s_cselect_b32 s53, s53, 0x40000000
    s_add_u32 s54, s53, 3072
    s_cmp_eq_u64 vcc, 0
    s_cselect_b32 s43, 1, 0
    s_cselect_b32 s55, s27, 0x40000000
    s_mul_i32 s41, s17, 6144
    s_add_u32 m0, s41, 65536
    s_nop 0
    buffer_load_dwordx4 v0, s[8:11], s53 offen sc1 lds
    buffer_load_dwordx4 v0, s[8:11], s53 offen offset:1024 sc1 lds
    buffer_load_dwordx4 v0, s[8:11], s53 offen offset:2048 sc1 lds
    s_mul_i32 s41, s17, 6144
    s_add_u32 m0, s41, 68608
    s_nop 0
    buffer_load_dwordx4 v0, s[8:11], s54 offen sc1 lds
    buffer_load_dwordx4 v0, s[8:11], s54 offen offset:1024 sc1 lds
    buffer_load_dwordx4 v0, s[8:11], s54 offen offset:2048 sc1 lds
    s_lshl_b32 s41, s17, 12
    s_add_u32 m0, s41, 0
    s_nop 0
    buffer_load_dwordx4 v0, s[8:11], s55 offen offset:0 sc1 lds
    buffer_load_dwordx4 v0, s[8:11], s55 offen offset:1024 sc1 lds
    buffer_load_dwordx4 v0, s[8:11], s55 offen offset:2048 sc1 lds
    buffer_load_dwordx4 v0, s[8:11], s55 offen offset:3072 sc1 lds
C_join_s:
    s_mov_b32 s37, 0
C_w3_s:
    buffer_load_dword v15, v10, s[8:11], s33 offen offset:1024 sc1
    s_add_u32 s37, s37, 1
    s_cmp_gt_u32 s37, 400000
    s_cbranch_scc1 L_fail
    s_waitcnt vmcnt(0)
    v_cmp_gt_u32 vcc, s25, v15
    s_nop 0
    s_and_b32 vcc_lo, vcc_lo, 0x0fffffff
    s_mov_b32 vcc_hi, 0
    s_cmp_eq_u32 vcc_lo, 0
    s_cbranch_scc1 C_w3_s_ok
    s_branch C_w3_s
C_w3_s_ok:
    s_add_u32 s40, s29, 0
    buffer_load_dwordx4 v[96:99], v3, s[8:11], s40 offen sc1
    s_add_u32 s41, s40, 4096
    buffer_load_dwordx4 v[100:103], v3, s[8:11], s41 offen sc1
    s_add_u32 s41, s40, 8192
    buffer_load_dwordx4 v[104:107], v3, s[8:11], s41 offen sc1
    s_add_u32 s41, s40, 12288
    buffer_load_dwordx4 v[108:111], v3, s[8:11], s41 offen sc1
    s_add_u32 s41, s40, 16384
    buffer_load_dwordx4 v[112:115], v3, s[8:11], s41 offen sc1
    s_add_u32 s41, s40, 20480
    buffer_load_dwordx4 v[116:119], v3, s[8:11], s41 offen sc1
    s_add_u32 s41, s40, 24576
    buffer_load_dwordx4 v[120:123], v3, s[8:11], s41 offen sc1
    s_waitcnt vmcnt(6)
    v_mfma_f32_16x16x32_bf16 v[128:131], v[28:31], v[96:99], 0
    s_waitcnt vmcnt(5)
    v_mfma_f32_16x16x32_bf16 v[128:131], v[28:31], v[100:103], v[128:131]
    s_waitcnt vmcnt(4)
    v_mfma_f32_16x16x32_bf16 v[128:131], v[28:31], v[104:107], v[128:131]
    s_waitcnt vmcnt(3)
    v_mfma_f32_16x16x32_bf16 v[128:131], v[28:31], v[108:111], v[128:131]
    s_waitcnt vmcnt(2)
    v_mfma_f32_16x16x32_bf16 v[128:131], v[28:31], v[112:115], v[128:131]
    s_waitcnt vmcnt(1)
    v_mfma_f32_16x16x32_bf16 v[128:131], v[28:31], v[116:119], v[128:131]
    s_waitcnt vmcnt(0)
    v_mfma_f32_16x16x32_bf16 v[128:131], v[28:31], v[120:123], v[128:131]
    v_mov_b32 v15, s25
    buffer_store_dword v15, v11, s[8:11], s32 offen offset:1536 sc1
    v_lshlrev_b32 v132, 16, v26
    v_and_b32 v133, 0xffff0000, v26
    v_lshlrev_b32 v134, 16, v27
    v_and_b32 v135, 0xffff0000, v27
    s_nop 1
    v_cvt_pk_bf16_f32 v128, v128, v129
    v_cvt_pk_bf16_f32 v130, v130, v131
    v_and_b32 v129, 0xffff0000, v128
    v_and_b32 v131, 0xffff0000, v130
    v_lshlrev_b32 v128, 16, v128
    v_lshlrev_b32 v130, 16, v130
    v_pk_add_f32 v[132:133], v[132:133], v[128:129]
    v_pk_add_f32 v[134:135], v[134:135], v[130:131]
    v_cvt_pk_bf16_f32 v136, v132, v133
    v_cvt_pk_bf16_f32 v137, v134, v135
    buffer_store_dwordx2 v[136:137], v4, s[48:51], s36 offen
    s_lshl_b32 s41, s63, 15
    s_add_u32 s36, s36, s41
    s_cmp_lt_u32 s24, 64
    s_cbranch_scc1 C_loop_s
    s_branch L_exit
L_ws:
    s_cmp_eq_u32 s17, 1
    s_cbranch_scc1 L_w1s
    s_cmp_eq_u32 s17, 2
    s_cbranch_scc1 L_w2s
    s_cmp_eq_u32 s17, 3
    s_cbranch_scc1 L_w3s
L_w0s:
    v_mov_b64 v[16:17], v[64:65]
    v_mov_b64 v[18:19], v[66:67]
    v_mov_b64 v[20:21], v[68:69]
    v_mov_b64 v[22:23], v[70:71]
    ds_read_b128 v[48:51], v0 offset:0
    ds_read_b128 v[52:55], v0 offset:1024
    ds_read_b128 v[56:59], v0 offset:2048
    ds_read_b128 v[60:63], v0 offset:3072
    ds_read_b128 v[64:67], v0 offset:4096
    ds_read_b128 v[68:71], v0 offset:5120
    ds_read_b128 v[72:75], v0 offset:6144
    ds_read_b128 v[76:79], v0 offset:7168
    ds_read_b128 v[80:83], v0 offset:32768
    ds_read_b128 v[84:87], v0 offset:33792
    ds_read_b128 v[88:91], v0 offset:34816
    ds_read_b128 v[92:95], v0 offset:35840
    v_mov_b64 v[96:97], 0
    v_mov_b64 v[98:99], 0
    v_mov_b64 v[100:101], 0
    v_mov_b64 v[102:103], 0
    v_mov_b64 v[104:105], 0
    v_mov_b64 v[106:107], 0
    v_mov_b64 v[108:109], 0
    v_mov_b64 v[110:111], 0
    v_mov_b64 v[112:113], 0
    v_mov_b64 v[114:115], 0
    v_mov_b64 v[116:117], 0
    v_mov_b64 v[118:119], 0
    v_mov_b32 v15, -1
    v_mov_b32 v11, 0
    s_waitcnt lgkmcnt(0)
    s_branch R0s_top
.p2align 6
    s_nop 0
    s_nop 0
R0s_h2a:
    s_waitcnt lgkmcnt(0)
    s_waitcnt vmcnt(3)
    v_max3_u32 v12, v16, v17, v18
    s_waitcnt vmcnt(2)
    v_max3_u32 v13, v19, v20, v21
    v_max3_u32 v12, v12, v22, v23
    v_max_u32 v12, v12, v13
    v_cmp_eq_u32 vcc, -1, v12
    v_smfmac_f32_16x16x64_bf16 v[96:99], v[16:19], a[0:7], v8
    ds_write_b128 v2, v[16:19] offset:16384
    s_cbranch_vccnz R0s_h2
R0s_top1:
    v_smfmac_f32_16x16x64_bf16 v[100:103], v[16:19], a[8:15], v8
    ds_write_b128 v2, v[20:23] offset:17408
    s_xor_b32 s33, s33, 8192
    v_smfmac_f32_16x16x64_bf16 v[96:99], v[20:23], a[16:23], v8
    v_add_u32 v15, 2176, v6
    v_smfmac_f32_16x16x64_bf16 v[100:103], v[20:23], a[24:31], v8
    v_cndmask_b32 v15, v6, v15, s[60:61]
    v_smfmac_f32_16x16x64_bf16 v[104:107], v[16:19], a[128:135], v8
    v_smfmac_f32_16x16x64_bf16 v[108:111], v[16:19], a[136:143], v8
    v_smfmac_f32_16x16x64_bf16 v[104:107], v[20:23], a[144:151], v8
    s_waitcnt vmcnt(0) lgkmcnt(0)
    s_barrier
    ds_read_b128 v[32:35], v2 offset:20480
    v_smfmac_f32_16x16x64_bf16 v[108:111], v[20:23], a[152:159], v8
    ds_read_b128 v[36:39], v2 offset:21504
    v_smfmac_f32_16x16x64_bf16 v[112:115], v[16:19], v[128:135], v8
    ds_read_b128 v[40:43], v2 offset:22528
    v_smfmac_f32_16x16x64_bf16 v[116:119], v[16:19], v[136:143], v8
    ds_read_b128 v[24:27], v2 offset:18432
    v_smfmac_f32_16x16x64_bf16 v[112:115], v[20:23], v[144:151], v8
    ds_read_b128 v[28:31], v2 offset:19456
    s_waitcnt lgkmcnt(4)
    v_smfmac_f32_16x16x64_bf16 v[96:99], v[32:35], v[48:55], v8
    ds_read_b128 v[44:47], v2 offset:23552
    v_smfmac_f32_16x16x64_bf16 v[100:103], v[32:35], v[56:63], v8
    ds_read_b128 v[48:51], v0 offset:36864
    s_waitcnt lgkmcnt(5)
    v_smfmac_f32_16x16x64_bf16 v[96:99], v[36:39], v[64:71], v8
    ds_read_b128 v[52:55], v0 offset:37888
    v_smfmac_f32_16x16x64_bf16 v[100:103], v[36:39], v[72:79], v8
    ds_read_b128 v[56:59], v0 offset:38912
    s_waitcnt lgkmcnt(6)
    v_smfmac_f32_16x16x64_bf16 v[96:99], v[40:43], v[80:87], v8
    ds_read_b128 v[60:63], v0 offset:39936
    v_smfmac_f32_16x16x64_bf16 v[100:103], v[40:43], v[88:95], v8
    ds_read_b128 v[64:67], v2 offset:4096
    s_waitcnt lgkmcnt(7)
    v_smfmac_f32_16x16x64_bf16 v[96:99], v[24:27], a[32:39], v8
    ds_read_b128 v[68:71], v2 offset:5120
    v_smfmac_f32_16x16x64_bf16 v[100:103], v[24:27], a[40:47], v8
    ds_read_b128 v[72:75], v2 offset:6144
    s_waitcnt lgkmcnt(8)
    v_smfmac_f32_16x16x64_bf16 v[96:99], v[28:31], a[48:55], v8
    ds_read_b128 v[76:79], v2 offset:7168
    v_smfmac_f32_16x16x64_bf16 v[100:103], v[28:31], a[56:63], v8
    s_waitcnt lgkmcnt(8)
    s_waitcnt lgkmcnt(6)
    v_smfmac_f32_16x16x64_bf16 v[96:99], v[44:47], v[48:55], v8
    ds_read_b128 v[48:51], v2 offset:0
    s_waitcnt lgkmcnt(5)
    v_smfmac_f32_16x16x64_bf16 v[100:103], v[44:47], v[56:63], v8
    ds_read_b128 v[52:55], v2 offset:1024
    v_smfmac_f32_16x16x64_bf16 v[104:107], v[32:35], a[192:199], v8
    ds_read_b128 v[56:59], v2 offset:2048
    buffer_store_dwordx4 v[120:123], v0, s[8:11], s37 offen sc1
    s_add_u32 s36, s36, 786432
    v_smfmac_f32_16x16x64_bf16 v[108:111], v[32:35], a[200:207], v8
    ds_read_b128 v[60:63], v2 offset:3072
    s_mov_b32 m0, s43
    s_add_u32 s42, s42, 786432
    v_smfmac_f32_16x16x64_bf16 v[104:107], v[36:39], a[208:215], v8
    v_add_f32 v96, v96, v97
    v_add_f32 v98, v98, v99
    v_smfmac_f32_16x16x64_bf16 v[108:111], v[36:39], a[216:223], v8
    v_add_f32 v100, v100, v101
    v_add_f32 v102, v102, v103
    v_smfmac_f32_16x16x64_bf16 v[104:107], v[40:43], a[224:231], v8
    v_cvt_pk_bf16_f32 v124, v96, v98
    v_cvt_pk_bf16_f32 v125, v100, v102
    v_smfmac_f32_16x16x64_bf16 v[108:111], v[40:43], a[232:239], v8
    ds_write2st64_b32 v9, v124, v125 offset0:0 offset1:2
    v_smfmac_f32_16x16x64_bf16 v[104:107], v[24:27], a[160:167], v8
    s_mov_b32 s94, s24
    v_smfmac_f32_16x16x64_bf16 v[108:111], v[24:27], a[168:175], v8
    buffer_load_dword v11, v7, s[8:11], s92 offen sc1
    v_smfmac_f32_16x16x64_bf16 v[104:107], v[28:31], a[176:183], v8
    v_smfmac_f32_16x16x64_bf16 v[108:111], v[28:31], a[184:191], v8
    s_add_u32 s37, s37, 131072
    s_waitcnt lgkmcnt(0)
    s_barrier
    v_smfmac_f32_16x16x64_bf16 v[104:107], v[44:47], a[240:247], v8
    ds_read_b64_tr_b16 v[80:81], v6 offset:0
    ds_read_b64_tr_b16 v[82:83], v6 offset:512
    v_smfmac_f32_16x16x64_bf16 v[108:111], v[44:47], a[248:255], v8
    ds_read_b64_tr_b16 v[84:85], v6 offset:128
    ds_read_b64_tr_b16 v[86:87], v6 offset:640
    v_smfmac_f32_16x16x64_bf16 v[116:119], v[20:23], v[152:159], v8
    ds_read_b64_tr_b16 v[88:89], v6 offset:256
    ds_read_b64_tr_b16 v[90:91], v6 offset:768
    v_smfmac_f32_16x16x64_bf16 v[112:115], v[32:35], v[192:199], v8
    ds_read_b64_tr_b16 v[92:93], v6 offset:384
    ds_read_b64_tr_b16 v[94:95], v6 offset:896
    v_add_f32 v104, v104, v105
    v_add_f32 v106, v106, v107
    v_add_f32 v108, v108, v109
    v_add_f32 v110, v110, v111
    v_cvt_pk_bf16_f32 v120, v104, v106
    v_cvt_pk_bf16_f32 v121, v108, v110
    s_waitcnt lgkmcnt(4)
    v_mfma_f32_16x16x32_bf16 v[96:99], v[48:51], v[80:83], 0
    ds_write2st64_b32 v10, v120, v121 offset0:9 offset1:11
    v_mfma_f32_16x16x32_bf16 v[100:103], v[64:67], v[80:83], 0
    v_mfma_f32_16x16x32_bf16 v[96:99], v[52:55], v[84:87], v[96:99]
    buffer_load_dwordx4 v0, s[8:11], s36 offen offset:0 sc1 lds
    v_mov_b64 v[126:127], s[26:27]
    v_mfma_f32_16x16x32_bf16 v[100:103], v[68:71], v[84:87], v[100:103]
    s_waitcnt lgkmcnt(0)
    s_barrier
    v_mfma_f32_16x16x32_bf16 v[96:99], v[56:59], v[88:91], v[96:99]
    ds_read_b64_tr_b16 v[48:49], v15 offset:2304
    ds_read_b64_tr_b16 v[50:51], v15 offset:2816
    v_mfma_f32_16x16x32_bf16 v[100:103], v[72:75], v[88:91], v[100:103]
    ds_read_b64_tr_b16 v[64:65], v15 offset:2432
    ds_read_b64_tr_b16 v[66:67], v15 offset:2944
    v_mfma_f32_16x16x32_bf16 v[96:99], v[60:63], v[92:95], v[96:99]
    ds_read_b64_tr_b16 v[52:53], v15 offset:2560
    ds_read_b64_tr_b16 v[54:55], v15 offset:3072
    v_mfma_f32_16x16x32_bf16 v[100:103], v[76:79], v[92:95], v[100:103]
    ds_read_b64_tr_b16 v[68:69], v15 offset:2688
    ds_read_b64_tr_b16 v[70:71], v15 offset:3200
    s_waitcnt lgkmcnt(6)
    v_mfma_f32_16x16x32_bf16 v[104:107], v[48:51], v[80:83], 0
    ds_read_b128 v[56:59], v2 offset:8192
    v_mov_b64 v[124:125], s[26:27]
    s_waitcnt lgkmcnt(5)
    v_mfma_f32_16x16x32_bf16 v[104:107], v[64:67], v[84:87], v[104:107]
    ds_read_b128 v[60:63], v2 offset:9216
    v_max3_f32 v12, v96, v97, v98
    s_waitcnt lgkmcnt(4)
    v_mfma_f32_16x16x32_bf16 v[104:107], v[52:55], v[88:91], v[104:107]
    buffer_load_dwordx4 v0, s[8:11], s36 offen offset:1024 sc1 lds
    v_max3_f32 v13, v99, v100, v101
    v_max3_f32 v12, v12, v102, v103
    s_waitcnt lgkmcnt(2)
    v_mfma_f32_16x16x32_bf16 v[104:107], v[68:71], v[92:95], v[104:107]
    v_max_f32 v12, v12, v13
    v_smfmac_f32_16x16x64_bf16 v[116:119], v[32:35], v[200:207], v8
    ds_read_b128 v[80:83], v1 offset:0
    s_add_u32 m0, s43, 8192
    v_smfmac_f32_16x16x64_bf16 v[112:115], v[36:39], v[208:215], v8
    ds_read_b128 v[84:87], v1 offset:1024
    s_add_u32 s24, s24, 1
    s_nop 0
    v_max3_f32 v12, v12, v104, v105
    v_mov_b32 v13, v12
    v_smfmac_f32_16x16x64_bf16 v[116:119], v[36:39], v[216:223], v8
    ds_read_b128 v[88:91], v1 offset:32768
    v_permlane32_swap_b32 v12, v13
    v_max_f32 v12, v12, v13
    v_mov_b32 v13, v12
    v_smfmac_f32_16x16x64_bf16 v[112:115], v[40:43], v[224:231], v8
    ds_read_b128 v[92:95], v1 offset:33792
    v_permlane16_swap_b32 v12, v13
    v_max_f32 v12, v12, v13
    v_mul_f32 v12, s40, v12
    v_pk_fma_f32 v[96:97], v[96:97], s[40:41], v[12:13] op_sel_hi:[1,1,0] neg_lo:[0,0,1] neg_hi:[0,0,1]
    v_pk_fma_f32 v[98:99], v[98:99], s[40:41], v[12:13] op_sel_hi:[1,1,0] neg_lo:[0,0,1] neg_hi:[0,0,1]
    v_pk_fma_f32 v[100:101], v[100:101], s[40:41], v[12:13] op_sel_hi:[1,1,0] neg_lo:[0,0,1] neg_hi:[0,0,1]
    v_pk_fma_f32 v[102:103], v[102:103], s[40:41], v[12:13] op_sel_hi:[1,1,0] neg_lo:[0,0,1] neg_hi:[0,0,1]
    v_pk_fma_f32 v[104:105], v[104:105], s[40:41], v[12:13] op_sel_hi:[1,1,0] neg_lo:[0,0,1] neg_hi:[0,0,1]
    v_smfmac_f32_16x16x64_bf16 v[116:119], v[40:43], v[232:239], v8
    ds_read_b128 v[48:51], v1 offset:2048
    v_exp_f32 v96, v96
    v_smfmac_f32_16x16x64_bf16 v[112:115], v[24:27], v[160:167], v8
    ds_read_b128 v[52:55], v1 offset:3072
    v_exp_f32 v97, v97
    v_smfmac_f32_16x16x64_bf16 v[116:119], v[24:27], v[168:175], v8
    ds_read_b128 v[64:67], v1 offset:34816
    v_exp_f32 v98, v98
    v_smfmac_f32_16x16x64_bf16 v[112:115], v[28:31], v[176:183], v8
    ds_read_b128 v[68:71], v1 offset:35840
    v_exp_f32 v99, v99
    s_waitcnt lgkmcnt(8)
    v_smfmac_f32_16x16x64_bf16 v[116:119], v[28:31], v[184:191], v8
    buffer_load_dwordx4 v0, s[8:11], s42 offen offset:0 sc1 lds
    v_exp_f32 v100, v100
    v_smfmac_f32_16x16x64_bf16 v[112:115], v[44:47], v[240:247], v8
    v_exp_f32 v101, v101
    v_smfmac_f32_16x16x64_bf16 v[116:119], v[44:47], v[248:255], v8
    buffer_load_dwordx4 v0, s[8:11], s42 offen offset:1024 sc1 lds
    v_exp_f32 v102, v102
    v_exp_f32 v103, v103
    v_mov_b64 v[12:13], 0
    v_mov_b64 v[14:15], 0
    v_cvt_pk_bf16_f32 v72, v96, v97
    v_cvt_pk_bf16_f32 v73, v98, v99
    v_cvt_pk_bf16_f32 v74, v100, v101
    v_cvt_pk_bf16_f32 v75, v102, v103
    v_exp_f32 v104, v104
    v_exp_f32 v105, v105
    v_mfma_f32_16x16x32_bf16 v[108:111], v[72:75], v[124:127], 0
    v_cvt_pk_bf16_f32 v104, v104, v105
    v_add_f32 v112, v112, v113
    v_smfmac_f32_16x16x64_bf16 v[12:15], v[72:75], v[56:63], v8 abid:1
    v_cndmask_b32 v76, v104, 0, s[78:79]
    v_cndmask_b32 v77, 0, v104, s[78:79]
    v_add_f32 v114, v114, v115
    v_add_f32 v116, v116, v117
    v_mfma_f32_16x16x16_bf16 v[108:111], v[76:77], v[124:125], v[108:111]
    v_add_f32 v118, v118, v119
    v_cvt_pk_bf16_f32 v122, v112, v114
    v_cvt_pk_bf16_f32 v123, v116, v118
    s_nop 1
    v_mfma_f32_16x16x16_bf16 v[12:15], v[76:77], v[122:123], v[12:15]
    s_nop 1
    v_rcp_f32 v108, v108
    s_nop 0
    v_rcp_f32 v109, v109
    s_nop 0
    v_rcp_f32 v110, v110
    s_nop 0
    v_rcp_f32 v111, v111
    s_nop 0
    v_pk_mul_f32 v[12:13], v[12:13], v[108:109]
    v_pk_mul_f32 v[14:15], v[14:15], v[110:111]
    v_cvt_pk_bf16_f32 v12, v12, v13
    v_cvt_pk_bf16_f32 v13, v14, v15
    ds_write_b64 v5, v[12:13] offset:0
    v_mov_b64 v[72:73], 0
    v_mov_b64 v[74:75], 0
    v_mov_b64 v[76:77], 0
    v_mov_b64 v[78:79], 0
    v_mov_b64 v[56:57], 0
    v_mov_b64 v[58:59], 0
    v_mov_b64 v[60:61], 0
    v_mov_b64 v[62:63], 0
    s_waitcnt lgkmcnt(0)
    s_barrier
    ds_read_b64_tr_b16 v[96:97], v6 offset:0
    ds_read_b64_tr_b16 v[98:99], v6 offset:512
    ds_read_b64_tr_b16 v[100:101], v6 offset:128
    ds_read_b64_tr_b16 v[102:103], v6 offset:640
    ds_read_b64_tr_b16 v[104:105], v6 offset:256
    ds_read_b64_tr_b16 v[106:107], v6 offset:768
    ds_read_b64_tr_b16 v[108:109], v6 offset:384
    ds_read_b64_tr_b16 v[110:111], v6 offset:896
    s_waitcnt lgkmcnt(6)
    v_smfmac_f32_16x16x64_bf16 v[72:75], v[96:99], a[64:71], v8 abid:1
    ds_read_b128 v[16:19], v1 offset:4096
    s_waitcnt lgkmcnt(5)
    v_smfmac_f32_16x16x64_bf16 v[72:75], v[100:103], a[96:103], v8 abid:1
    ds_read_b128 v[20:23], v1 offset:5120
    s_waitcnt lgkmcnt(4)
    v_smfmac_f32_16x16x64_bf16 v[72:75], v[104:107], v[80:87], v8 abid:1
    ds_read_b128 v[24:27], v1 offset:36864
    s_waitcnt lgkmcnt(3)
    v_smfmac_f32_16x16x64_bf16 v[72:75], v[108:111], v[88:95], v8 abid:1
    ds_read_b128 v[28:31], v1 offset:37888
    v_smfmac_f32_16x16x64_bf16 v[76:79], v[96:99], a[72:79], v8 abid:1
    ds_read_b128 v[32:35], v1 offset:6144
    s_nop 0
    v_mov_b64 v[112:113], 0
    v_smfmac_f32_16x16x64_bf16 v[76:79], v[100:103], a[104:111], v8 abid:1
    ds_read_b128 v[36:39], v1 offset:7168
    s_nop 0
    v_cvt_pk_bf16_f32 v72, v72, v73
    v_cvt_pk_bf16_f32 v73, v74, v75
    v_and_or_b32 v72, v72, -2, s38
    v_smfmac_f32_16x16x64_bf16 v[76:79], v[104:107], v[48:55], v8 abid:1
    buffer_store_dwordx2 v[72:73], v3, s[8:11], s28 offen sc1
    v_smfmac_f32_16x16x64_bf16 v[76:79], v[108:111], v[64:71], v8 abid:1
    ds_read_b128 v[40:43], v1 offset:38912
    v_smfmac_f32_16x16x64_bf16 v[56:59], v[96:99], a[80:87], v8 abid:1
    ds_read_b128 v[44:47], v1 offset:39936
    s_nop 0
    v_mov_b64 v[114:115], 0
    v_smfmac_f32_16x16x64_bf16 v[56:59], v[100:103], a[112:119], v8 abid:1
    s_nop 0
    s_nop 0
    v_cvt_pk_bf16_f32 v76, v76, v77
    v_cvt_pk_bf16_f32 v77, v78, v79
    v_and_or_b32 v76, v76, -2, s38
    s_waitcnt lgkmcnt(4)
    v_smfmac_f32_16x16x64_bf16 v[56:59], v[104:107], v[16:23], v8 abid:1
    buffer_store_dwordx2 v[76:77], v3, s[8:11], s29 offen sc1
    v_smfmac_f32_16x16x64_bf16 v[56:59], v[108:111], v[24:31], v8 abid:1
    v_smfmac_f32_16x16x64_bf16 v[60:63], v[96:99], a[88:95], v8 abid:1
    s_nop 1
    v_mov_b64 v[116:117], 0
    v_smfmac_f32_16x16x64_bf16 v[60:63], v[100:103], a[120:127], v8 abid:1
    s_nop 0
    s_nop 1
    v_cvt_pk_bf16_f32 v56, v56, v57
    v_cvt_pk_bf16_f32 v57, v58, v59
    v_and_or_b32 v56, v56, -2, s38
    s_waitcnt lgkmcnt(0)
    v_smfmac_f32_16x16x64_bf16 v[60:63], v[104:107], v[32:39], v8 abid:1
    buffer_store_dwordx2 v[56:57], v3, s[8:11], s30 offen sc1
    ds_read_b128 v[32:35], v2 offset:31232
    v_smfmac_f32_16x16x64_bf16 v[60:63], v[108:111], v[40:47], v8 abid:1
    s_mov_b32 s39, 0
    v_mov_b64 v[96:97], 0
    v_mov_b64 v[98:99], 0
    s_nop 4
    v_cvt_pk_bf16_f32 v60, v60, v61
    v_cvt_pk_bf16_f32 v61, v62, v63
    v_and_or_b32 v60, v60, -2, s38
    buffer_store_dwordx2 v[60:61], v3, s[8:11], s31 offen sc1
    v_mov_b64 v[100:101], 0
    v_mov_b64 v[102:103], 0
    v_mov_b64 v[104:105], 0
    v_mov_b64 v[106:107], 0
    v_mov_b64 v[108:109], 0
    v_mov_b64 v[110:111], 0
    v_mov_b64 v[118:119], 0
    buffer_load_dwordx4 v[24:27], v0, s[8:11], s32 offen offset:0 sc1
    buffer_load_dwordx4 v[28:31], v0, s[8:11], s32 offen offset:1024 sc1
    s_waitcnt vmcnt(3)
    buffer_load_dwordx4 v[16:19], v0, s[8:11], s32 offen offset:0 sc1
    buffer_load_dwordx4 v[20:23], v0, s[8:11], s32 offen offset:1024 sc1
    v_pk_min_u16 v120, v120, s45
    v_pk_min_u16 v121, v121, s45
    v_pk_min_u16 v122, v122, s45
    v_pk_min_u16 v123, v123, s45
    v_mov_b32 v15, -1
    s_waitcnt lgkmcnt(0)
R0s_h1a:
    s_waitcnt vmcnt(3)
    v_mfma_f32_16x16x32_bf16 v[36:39], v[24:27], v[32:35], 0
    v_bitop3_b32 v12, v24, v26, s38 bitop3:0x7e
    s_waitcnt vmcnt(2)
    v_mfma_f32_16x16x32_bf16 v[36:39], v[28:31], v[32:35], v[36:39]
    v_bitop3_b32 v13, v28, v30, s38 bitop3:0x7e
    v_bitop3_b32 v12, v12, v13, 1 bitop3:0xa8
    v_cmp_ne_u32 vcc, 0, v12
    s_nop 0
    s_cbranch_vccnz R0s_h1
R0s_h1ok:
    s_nop 3
    v_permlane32_swap_b32 v36, v38
    v_permlane32_swap_b32 v37, v39
    v_add_f32 v36, v36, v38
    v_add_f32 v37, v37, v39
    s_nop 1
    v_permlane16_swap_b32 v36, v37
    v_add_f32 v12, v36, v37
    s_nop 1
    v_mov_b32_dpp v13, v12 row_shl:4 row_mask:0xf bank_mask:0xf
    v_cvt_pk_bf16_f32 v12, v12, v13
    v_min_u32 v12, -2, v12
    buffer_store_dword v12, v4, s[8:11], s34 offen sc1
    s_xor_b32 s32, s32, 1048576
    s_lshr_b32 s38, s24, 1
    buffer_store_dword v15, v4, s[8:11], s35 offen sc1
    s_xor_b32 s35, s35, 8192
    s_xor_b32 s28, s28, 1048576
    s_xor_b32 s29, s29, 1048576
    s_xor_b32 s30, s30, 1048576
    s_xor_b32 s31, s31, 1048576
    s_xor_b32 s34, s34, 8192
    s_and_b32 s38, s38, 1
    s_lshl_b32 s39, s39, 16
    ds_read_b128 v[48:51], v0 offset:0
    ds_read_b128 v[52:55], v0 offset:1024
    ds_read_b128 v[56:59], v0 offset:2048
    s_add_u32 s95, s24, 3
    s_lshr_b32 s95, s95, 1
    s_cmp_lt_u32 s24, 63
    s_cselect_b32 s95, s95, 0
    v_cmp_gt_u32 vcc, s95, v11
    s_nop 0
    s_cbranch_vccnz R0s_fw
R0s_fok:
    s_xor_b32 s92, s92, 4096
    s_mov_b32 s25, 0
    s_cmp_eq_u32 s24, 63
    s_cbranch_scc1 R0s_last
    s_waitcnt vmcnt(0)
    buffer_load_dwordx4 v[16:19], v0, s[8:11], s33 offen sc1
    buffer_load_dwordx4 v[20:23], v0, s[8:11], s33 offen offset:1024 sc1
    ds_read_b128 v[60:63], v0 offset:3072
    ds_read_b128 v[64:67], v0 offset:4096
    ds_read_b128 v[68:71], v0 offset:5120
    ds_read_b128 v[72:75], v0 offset:6144
    ds_read_b128 v[76:79], v0 offset:7168
    ds_read_b128 v[80:83], v0 offset:32768
    ds_read_b128 v[84:87], v0 offset:33792
    ds_read_b128 v[88:91], v0 offset:34816
    ds_read_b128 v[92:95], v0 offset:35840
    s_waitcnt lgkmcnt(0)
    buffer_load_dwordx4 v[24:27], v0, s[8:11], s33 offen sc1
    buffer_load_dwordx4 v[28:31], v0, s[8:11], s33 offen offset:1024 sc1
    s_branch R0s_h2a
R0s_h1:
    buffer_load_dwordx4 v[24:27], v0, s[8:11], s32 offen offset:0 sc1
    buffer_load_dwordx4 v[28:31], v0, s[8:11], s32 offen offset:1024 sc1
    s_add_u32 s39, s39, 1
    s_cmp_gt_u32 s39, 60000
    s_cbranch_scc1 L_fail
    s_waitcnt vmcnt(3)
    v_mfma_f32_16x16x32_bf16 v[36:39], v[16:19], v[32:35], 0
    v_bitop3_b32 v12, v16, v18, s38 bitop3:0x7e
    s_waitcnt vmcnt(2)
    v_mfma_f32_16x16x32_bf16 v[36:39], v[20:23], v[32:35], v[36:39]
    v_bitop3_b32 v13, v20, v22, s38 bitop3:0x7e
    v_bitop3_b32 v12, v12, v13, 1 bitop3:0xa8
    v_cmp_ne_u32 vcc, 0, v12
    s_nop 0
    s_cbranch_vccz R0s_h1ok
    buffer_load_dwordx4 v[16:19], v0, s[8:11], s32 offen offset:0 sc1
    buffer_load_dwordx4 v[20:23], v0, s[8:11], s32 offen offset:1024 sc1
    s_add_u32 s39, s39, 1
    s_branch R0s_h1a
R0s_h2:
    s_nop 5
    v_mov_b64 v[96:97], 0
    v_mov_b64 v[98:99], 0
    s_add_u32 s25, s25, 1
    s_cmp_gt_u32 s25, 60000
    s_cbranch_scc1 L_fail
    s_waitcnt vmcnt(1)
    v_max3_u32 v12, v24, v25, v26
    s_waitcnt vmcnt(0)
    v_max3_u32 v13, v27, v28, v29
    v_max3_u32 v12, v12, v30, v31
    v_max_u32 v12, v12, v13
    v_cmp_eq_u32 vcc, -1, v12
    s_nop 0
    s_cbranch_vccnz R0s_h2b
    v_mov_b64 v[16:17], v[24:25]
    v_mov_b64 v[18:19], v[26:27]
    v_mov_b64 v[20:21], v[28:29]
    v_mov_b64 v[22:23], v[30:31]
    s_branch R0s_top
R0s_h2b:
    buffer_load_dwordx4 v[16:19], v0, s[8:11], s33 offen sc1
    buffer_load_dwordx4 v[20:23], v0, s[8:11], s33 offen offset:1024 sc1
    s_waitcnt vmcnt(1)
    buffer_load_dwordx4 v[24:27], v0, s[8:11], s33 offen sc1
    buffer_load_dwordx4 v[28:31], v0, s[8:11], s33 offen offset:1024 sc1
    s_add_u32 s25, s25, 1
    s_branch R0s_h2a
R0s_top:
    v_smfmac_f32_16x16x64_bf16 v[96:99], v[16:19], a[0:7], v8
    ds_write_b128 v2, v[16:19] offset:16384
    s_branch R0s_top1
R0s_fw:
    s_mov_b32 s39, 0
R0s_fw2:
    buffer_load_dword v11, v7, s[8:11], s92 offen sc1
    s_add_u32 s39, s39, 1
    s_cmp_gt_u32 s39, 400000
    s_cbranch_scc1 L_fail
    s_waitcnt vmcnt(0)
    v_cmp_gt_u32 vcc, s95, v11
    s_nop 0
    s_cbranch_vccnz R0s_fw2
    s_branch R0s_fok
R0s_last:
    s_waitcnt vmcnt(0)
R0s_l2:
    buffer_load_dwordx4 v[16:19], v0, s[8:11], s33 offen sc1
    buffer_load_dwordx4 v[20:23], v0, s[8:11], s33 offen offset:1024 sc1
    s_add_u32 s25, s25, 1
    s_cmp_gt_u32 s25, 60000
    s_cbranch_scc1 L_fail
    s_waitcnt vmcnt(1)
    v_max3_u32 v12, v16, v17, v18
    s_waitcnt vmcnt(0)
    v_max3_u32 v13, v19, v20, v21
    v_max3_u32 v12, v12, v22, v23
    v_max_u32 v12, v12, v13
    v_cmp_eq_u32 vcc, -1, v12
    s_nop 0
    s_cbranch_vccnz R0s_l2
    v_smfmac_f32_16x16x64_bf16 v[104:107], v[16:19], a[128:135], v8
    ds_write_b128 v2, v[16:19] offset:16384
    v_smfmac_f32_16x16x64_bf16 v[108:111], v[16:19], a[136:143], v8
    ds_write_b128 v2, v[20:23] offset:17408
    v_smfmac_f32_16x16x64_bf16 v[112:115], v[16:19], v[128:135], v8
    v_smfmac_f32_16x16x64_bf16 v[116:119], v[16:19], v[136:143], v8
    v_smfmac_f32_16x16x64_bf16 v[104:107], v[20:23], a[144:151], v8
    v_smfmac_f32_16x16x64_bf16 v[108:111], v[20:23], a[152:159], v8
    v_smfmac_f32_16x16x64_bf16 v[112:115], v[20:23], v[144:151], v8
    s_waitcnt lgkmcnt(0)
    s_barrier
    ds_read_b128 v[32:35], v2 offset:20480
    ds_read_b128 v[36:39], v2 offset:21504
    ds_read_b128 v[40:43], v2 offset:22528
    ds_read_b128 v[24:27], v2 offset:18432
    ds_read_b128 v[28:31], v2 offset:19456
    ds_read_b128 v[44:47], v2 offset:23552
    v_smfmac_f32_16x16x64_bf16 v[116:119], v[20:23], v[152:159], v8
    buffer_store_dwordx4 v[120:123], v0, s[8:11], s37 offen sc1
    s_add_u32 s37, s37, 131072
    s_waitcnt lgkmcnt(5)
    v_smfmac_f32_16x16x64_bf16 v[104:107], v[32:35], a[192:199], v8
    v_smfmac_f32_16x16x64_bf16 v[108:111], v[32:35], a[200:207], v8
    v_smfmac_f32_16x16x64_bf16 v[112:115], v[32:35], v[192:199], v8
    v_smfmac_f32_16x16x64_bf16 v[116:119], v[32:35], v[200:207], v8
    s_waitcnt lgkmcnt(4)
    v_smfmac_f32_16x16x64_bf16 v[104:107], v[36:39], a[208:215], v8
    v_smfmac_f32_16x16x64_bf16 v[108:111], v[36:39], a[216:223], v8
    v_smfmac_f32_16x16x64_bf16 v[112:115], v[36:39], v[208:215], v8
    v_smfmac_f32_16x16x64_bf16 v[116:119], v[36:39], v[216:223], v8
    s_waitcnt lgkmcnt(3)
    v_smfmac_f32_16x16x64_bf16 v[104:107], v[40:43], a[224:231], v8
    v_smfmac_f32_16x16x64_bf16 v[108:111], v[40:43], a[232:239], v8
    v_smfmac_f32_16x16x64_bf16 v[112:115], v[40:43], v[224:231], v8
    v_smfmac_f32_16x16x64_bf16 v[116:119], v[40:43], v[232:239], v8
    s_waitcnt lgkmcnt(2)
    v_smfmac_f32_16x16x64_bf16 v[104:107], v[24:27], a[160:167], v8
    v_smfmac_f32_16x16x64_bf16 v[108:111], v[24:27], a[168:175], v8
    v_smfmac_f32_16x16x64_bf16 v[112:115], v[24:27], v[160:167], v8
    v_smfmac_f32_16x16x64_bf16 v[116:119], v[24:27], v[168:175], v8
    s_waitcnt lgkmcnt(1)
    v_smfmac_f32_16x16x64_bf16 v[104:107], v[28:31], a[176:183], v8
    v_smfmac_f32_16x16x64_bf16 v[108:111], v[28:31], a[184:191], v8
    v_smfmac_f32_16x16x64_bf16 v[112:115], v[28:31], v[176:183], v8
    v_smfmac_f32_16x16x64_bf16 v[116:119], v[28:31], v[184:191], v8
    s_waitcnt lgkmcnt(0)
    v_smfmac_f32_16x16x64_bf16 v[104:107], v[44:47], a[240:247], v8
    v_smfmac_f32_16x16x64_bf16 v[108:111], v[44:47], a[248:255], v8
    v_smfmac_f32_16x16x64_bf16 v[112:115], v[44:47], v[240:247], v8
    v_smfmac_f32_16x16x64_bf16 v[116:119], v[44:47], v[248:255], v8
    s_nop 4
    v_add_f32 v104, v104, v105
    v_add_f32 v106, v106, v107
    v_add_f32 v108, v108, v109
    v_add_f32 v110, v110, v111
    v_cvt_pk_bf16_f32 v120, v104, v106
    v_cvt_pk_bf16_f32 v121, v108, v110
    v_add_f32 v112, v112, v113
    v_add_f32 v114, v114, v115
    v_add_f32 v116, v116, v117
    v_add_f32 v118, v118, v119
    v_cvt_pk_bf16_f32 v122, v112, v114
    v_cvt_pk_bf16_f32 v123, v116, v118
    v_pk_min_u16 v120, v120, s45
    v_pk_min_u16 v121, v121, s45
    v_pk_min_u16 v122, v122, s45
    v_pk_min_u16 v123, v123, s45
    buffer_store_dwordx4 v[120:123], v0, s[8:11], s37 offen sc1
    v_mov_b32 v15, 64
    s_waitcnt vmcnt(0)
    s_barrier
    s_branch L_exit_r
L_w1s:
    v_mov_b64 v[24:25], v[64:65]
    v_mov_b64 v[26:27], v[66:67]
    v_mov_b64 v[28:29], v[68:69]
    v_mov_b64 v[30:31], v[70:71]
    ds_read_b128 v[48:51], v0 offset:8192
    ds_read_b128 v[52:55], v0 offset:9216
    ds_read_b128 v[56:59], v0 offset:10240
    ds_read_b128 v[60:63], v0 offset:11264
    ds_read_b128 v[64:67], v0 offset:12288
    ds_read_b128 v[68:71], v0 offset:13312
    ds_read_b128 v[72:75], v0 offset:14336
    ds_read_b128 v[76:79], v0 offset:15360
    ds_read_b128 v[80:83], v0 offset:40960
    ds_read_b128 v[84:87], v0 offset:41984
    ds_read_b128 v[88:91], v0 offset:43008
    ds_read_b128 v[92:95], v0 offset:44032
    v_mov_b64 v[96:97], 0
    v_mov_b64 v[98:99], 0
    v_mov_b64 v[100:101], 0
    v_mov_b64 v[102:103], 0
    v_mov_b64 v[104:105], 0
    v_mov_b64 v[106:107], 0
    v_mov_b64 v[108:109], 0
    v_mov_b64 v[110:111], 0
    v_mov_b64 v[112:113], 0
    v_mov_b64 v[114:115], 0
    v_mov_b64 v[116:117], 0
    v_mov_b64 v[118:119], 0
    v_mov_b32 v15, -1
    v_mov_b32 v11, 0
    s_waitcnt lgkmcnt(0)
    s_branch R1s_top
.p2align 6
    s_nop 0
    s_nop 0
R1s_h2a:
    s_waitcnt lgkmcnt(0)
    s_waitcnt vmcnt(3)
    v_max3_u32 v12, v24, v25, v26
    s_waitcnt vmcnt(2)
    v_max3_u32 v13, v27, v28, v29
    v_max3_u32 v12, v12, v30, v31
    v_max_u32 v12, v12, v13
    v_cmp_eq_u32 vcc, -1, v12
    v_smfmac_f32_16x16x64_bf16 v[96:99], v[24:27], a[32:39], v8
    ds_write_b128 v2, v[24:27] offset:18432
    s_cbranch_vccnz R1s_h2
R1s_top1:
    v_smfmac_f32_16x16x64_bf16 v[100:103], v[24:27], a[40:47], v8
    ds_write_b128 v2, v[28:31] offset:19456
    s_xor_b32 s33, s33, 8192
    v_smfmac_f32_16x16x64_bf16 v[96:99], v[28:31], a[48:55], v8
    v_add_u32 v15, 2176, v6
    v_smfmac_f32_16x16x64_bf16 v[100:103], v[28:31], a[56:63], v8
    v_cndmask_b32 v15, v6, v15, s[60:61]
    v_smfmac_f32_16x16x64_bf16 v[104:107], v[24:27], a[160:167], v8
    v_smfmac_f32_16x16x64_bf16 v[108:111], v[24:27], a[168:175], v8
    v_smfmac_f32_16x16x64_bf16 v[104:107], v[28:31], a[176:183], v8
    s_waitcnt vmcnt(0) lgkmcnt(0)
    s_barrier
    ds_read_b128 v[32:35], v2 offset:20480
    v_smfmac_f32_16x16x64_bf16 v[108:111], v[28:31], a[184:191], v8
    ds_read_b128 v[36:39], v2 offset:21504
    v_smfmac_f32_16x16x64_bf16 v[112:115], v[24:27], v[160:167], v8
    ds_read_b128 v[40:43], v2 offset:22528
    v_smfmac_f32_16x16x64_bf16 v[116:119], v[24:27], v[168:175], v8
    ds_read_b128 v[16:19], v2 offset:16384
    v_smfmac_f32_16x16x64_bf16 v[112:115], v[28:31], v[176:183], v8
    ds_read_b128 v[20:23], v2 offset:17408
    s_waitcnt lgkmcnt(4)
    v_smfmac_f32_16x16x64_bf16 v[96:99], v[32:35], v[48:55], v8
    ds_read_b128 v[44:47], v2 offset:23552
    v_smfmac_f32_16x16x64_bf16 v[100:103], v[32:35], v[56:63], v8
    ds_read_b128 v[48:51], v0 offset:45056
    s_waitcnt lgkmcnt(5)
    v_smfmac_f32_16x16x64_bf16 v[96:99], v[36:39], v[64:71], v8
    ds_read_b128 v[52:55], v0 offset:46080
    v_smfmac_f32_16x16x64_bf16 v[100:103], v[36:39], v[72:79], v8
    ds_read_b128 v[56:59], v0 offset:47104
    s_waitcnt lgkmcnt(6)
    v_smfmac_f32_16x16x64_bf16 v[96:99], v[40:43], v[80:87], v8
    ds_read_b128 v[60:63], v0 offset:48128
    v_smfmac_f32_16x16x64_bf16 v[100:103], v[40:43], v[88:95], v8
    ds_read_b128 v[64:67], v2 offset:4096
    s_waitcnt lgkmcnt(7)
    v_smfmac_f32_16x16x64_bf16 v[96:99], v[16:19], a[0:7], v8
    ds_read_b128 v[68:71], v2 offset:5120
    v_smfmac_f32_16x16x64_bf16 v[100:103], v[16:19], a[8:15], v8
    ds_read_b128 v[72:75], v2 offset:6144
    s_waitcnt lgkmcnt(8)
    v_smfmac_f32_16x16x64_bf16 v[96:99], v[20:23], a[16:23], v8
    ds_read_b128 v[76:79], v2 offset:7168
    v_smfmac_f32_16x16x64_bf16 v[100:103], v[20:23], a[24:31], v8
    s_waitcnt lgkmcnt(8)
    s_waitcnt lgkmcnt(6)
    v_smfmac_f32_16x16x64_bf16 v[96:99], v[44:47], v[48:55], v8
    ds_read_b128 v[48:51], v2 offset:0
    s_waitcnt lgkmcnt(5)
    v_smfmac_f32_16x16x64_bf16 v[100:103], v[44:47], v[56:63], v8
    ds_read_b128 v[52:55], v2 offset:1024
    v_smfmac_f32_16x16x64_bf16 v[104:107], v[32:35], a[192:199], v8
    ds_read_b128 v[56:59], v2 offset:2048
    s_add_u32 s36, s36, 786432
    s_mov_b32 m0, s43
    v_smfmac_f32_16x16x64_bf16 v[108:111], v[32:35], a[200:207], v8
    ds_read_b128 v[60:63], v2 offset:3072
    buffer_store_dwordx4 v[120:123], v0, s[8:11], s37 offen sc1
    s_add_u32 s42, s42, 786432
    v_smfmac_f32_16x16x64_bf16 v[104:107], v[36:39], a[208:215], v8
    v_add_f32 v96, v96, v97
    v_add_f32 v98, v98, v99
    v_smfmac_f32_16x16x64_bf16 v[108:111], v[36:39], a[216:223], v8
    v_add_f32 v100, v100, v101
    v_add_f32 v102, v102, v103
    v_smfmac_f32_16x16x64_bf16 v[104:107], v[40:43], a[224:231], v8
    v_cvt_pk_bf16_f32 v124, v96, v98
    v_cvt_pk_bf16_f32 v125, v100, v102
    v_smfmac_f32_16x16x64_bf16 v[108:111], v[40:43], a[232:239], v8
    ds_write2st64_b32 v9, v124, v125 offset0:0 offset1:2
    v_smfmac_f32_16x16x64_bf16 v[104:107], v[16:19], a[128:135], v8
    s_mov_b32 s94, s24
    v_smfmac_f32_16x16x64_bf16 v[108:111], v[16:19], a[136:143], v8
    buffer_store_dword v11, v7, s[8:11], s93 offen sc1
    v_smfmac_f32_16x16x64_bf16 v[104:107], v[20:23], a[144:151], v8
    v_smfmac_f32_16x16x64_bf16 v[108:111], v[20:23], a[152:159], v8
    s_add_u32 s37, s37, 131072
    s_waitcnt lgkmcnt(0)
    s_barrier
    v_smfmac_f32_16x16x64_bf16 v[104:107], v[44:47], a[240:247], v8
    ds_read_b64_tr_b16 v[80:81], v6 offset:0
    ds_read_b64_tr_b16 v[82:83], v6 offset:512
    v_smfmac_f32_16x16x64_bf16 v[108:111], v[44:47], a[248:255], v8
    ds_read_b64_tr_b16 v[84:85], v6 offset:128
    ds_read_b64_tr_b16 v[86:87], v6 offset:640
    v_smfmac_f32_16x16x64_bf16 v[116:119], v[28:31], v[184:191], v8
    ds_read_b64_tr_b16 v[88:89], v6 offset:256
    ds_read_b64_tr_b16 v[90:91], v6 offset:768
    v_smfmac_f32_16x16x64_bf16 v[112:115], v[32:35], v[192:199], v8
    ds_read_b64_tr_b16 v[92:93], v6 offset:384
    ds_read_b64_tr_b16 v[94:95], v6 offset:896
    v_add_f32 v104, v104, v105
    v_add_f32 v106, v106, v107
    v_add_f32 v108, v108, v109
    v_add_f32 v110, v110, v111
    v_cvt_pk_bf16_f32 v120, v104, v106
    v_cvt_pk_bf16_f32 v121, v108, v110
    s_waitcnt lgkmcnt(4)
    v_mfma_f32_16x16x32_bf16 v[96:99], v[48:51], v[80:83], 0
    ds_write2st64_b32 v10, v120, v121 offset0:9 offset1:11
    v_mfma_f32_16x16x32_bf16 v[100:103], v[64:67], v[80:83], 0
    v_mfma_f32_16x16x32_bf16 v[96:99], v[52:55], v[84:87], v[96:99]
    buffer_load_dwordx4 v0, s[8:11], s36 offen offset:0 sc1 lds
    v_mov_b64 v[126:127], s[26:27]
    v_mfma_f32_16x16x32_bf16 v[100:103], v[68:71], v[84:87], v[100:103]
    s_waitcnt lgkmcnt(0)
    s_barrier
    v_mfma_f32_16x16x32_bf16 v[96:99], v[56:59], v[88:91], v[96:99]
    ds_read_b64_tr_b16 v[48:49], v15 offset:2304
    ds_read_b64_tr_b16 v[50:51], v15 offset:2816
    v_mfma_f32_16x16x32_bf16 v[100:103], v[72:75], v[88:91], v[100:103]
    ds_read_b64_tr_b16 v[64:65], v15 offset:2432
    ds_read_b64_tr_b16 v[66:67], v15 offset:2944
    v_mfma_f32_16x16x32_bf16 v[96:99], v[60:63], v[92:95], v[96:99]
    ds_read_b64_tr_b16 v[52:53], v15 offset:2560
    ds_read_b64_tr_b16 v[54:55], v15 offset:3072
    v_mfma_f32_16x16x32_bf16 v[100:103], v[76:79], v[92:95], v[100:103]
    ds_read_b64_tr_b16 v[68:69], v15 offset:2688
    ds_read_b64_tr_b16 v[70:71], v15 offset:3200
    s_waitcnt lgkmcnt(6)
    v_mfma_f32_16x16x32_bf16 v[104:107], v[48:51], v[80:83], 0
    ds_read_b128 v[56:59], v2 offset:10240
    v_mov_b64 v[124:125], s[26:27]
    s_waitcnt lgkmcnt(5)
    v_mfma_f32_16x16x32_bf16 v[104:107], v[64:67], v[84:87], v[104:107]
    ds_read_b128 v[60:63], v2 offset:11264
    v_max3_f32 v12, v96, v97, v98
    s_waitcnt lgkmcnt(4)
    v_mfma_f32_16x16x32_bf16 v[104:107], v[52:55], v[88:91], v[104:107]
    buffer_load_dwordx4 v0, s[8:11], s36 offen offset:1024 sc1 lds
    v_max3_f32 v13, v99, v100, v101
    v_max3_f32 v12, v12, v102, v103
    s_waitcnt lgkmcnt(2)
    v_mfma_f32_16x16x32_bf16 v[104:107], v[68:71], v[92:95], v[104:107]
    v_max_f32 v12, v12, v13
    v_smfmac_f32_16x16x64_bf16 v[116:119], v[32:35], v[200:207], v8
    ds_read_b128 v[80:83], v1 offset:8192
    s_add_u32 m0, s43, 8192
    v_smfmac_f32_16x16x64_bf16 v[112:115], v[36:39], v[208:215], v8
    ds_read_b128 v[84:87], v1 offset:9216
    s_add_u32 s24, s24, 1
    s_nop 0
    v_max3_f32 v12, v12, v104, v105
    v_mov_b32 v13, v12
    v_smfmac_f32_16x16x64_bf16 v[116:119], v[36:39], v[216:223], v8
    ds_read_b128 v[88:91], v1 offset:40960
    v_permlane32_swap_b32 v12, v13
    v_max_f32 v12, v12, v13
    v_mov_b32 v13, v12
    v_smfmac_f32_16x16x64_bf16 v[112:115], v[40:43], v[224:231], v8
    ds_read_b128 v[92:95], v1 offset:41984
    v_permlane16_swap_b32 v12, v13
    v_max_f32 v12, v12, v13
    v_mul_f32 v12, s40, v12
    v_pk_fma_f32 v[96:97], v[96:97], s[40:41], v[12:13] op_sel_hi:[1,1,0] neg_lo:[0,0,1] neg_hi:[0,0,1]
    v_pk_fma_f32 v[98:99], v[98:99], s[40:41], v[12:13] op_sel_hi:[1,1,0] neg_lo:[0,0,1] neg_hi:[0,0,1]
    v_pk_fma_f32 v[100:101], v[100:101], s[40:41], v[12:13] op_sel_hi:[1,1,0] neg_lo:[0,0,1] neg_hi:[0,0,1]
    v_pk_fma_f32 v[102:103], v[102:103], s[40:41], v[12:13] op_sel_hi:[1,1,0] neg_lo:[0,0,1] neg_hi:[0,0,1]
    v_pk_fma_f32 v[104:105], v[104:105], s[40:41], v[12:13] op_sel_hi:[1,1,0] neg_lo:[0,0,1] neg_hi:[0,0,1]
    v_smfmac_f32_16x16x64_bf16 v[116:119], v[40:43], v[232:239], v8
    ds_read_b128 v[48:51], v1 offset:10240
    v_exp_f32 v96, v96
    v_smfmac_f32_16x16x64_bf16 v[112:115], v[16:19], v[128:135], v8
    ds_read_b128 v[52:55], v1 offset:11264
    v_exp_f32 v97, v97
    v_smfmac_f32_16x16x64_bf16 v[116:119], v[16:19], v[136:143], v8
    ds_read_b128 v[64:67], v1 offset:43008
    v_exp_f32 v98, v98
    s_waitcnt lgkmcnt(7)
    v_smfmac_f32_16x16x64_bf16 v[112:115], v[20:23], v[144:151], v8
    buffer_load_dwordx4 v0, s[8:11], s42 offen offset:0 sc1 lds
    v_exp_f32 v99, v99
    v_smfmac_f32_16x16x64_bf16 v[116:119], v[20:23], v[152:159], v8
    ds_read_b128 v[68:71], v1 offset:44032
    v_exp_f32 v100, v100
    v_smfmac_f32_16x16x64_bf16 v[112:115], v[44:47], v[240:247], v8
    buffer_load_dwordx4 v0, s[8:11], s42 offen offset:1024 sc1 lds
    v_exp_f32 v101, v101
    v_smfmac_f32_16x16x64_bf16 v[116:119], v[44:47], v[248:255], v8
    v_exp_f32 v102, v102
    v_exp_f32 v103, v103
    v_mov_b64 v[12:13], 0
    v_mov_b64 v[14:15], 0
    v_cvt_pk_bf16_f32 v72, v96, v97
    v_cvt_pk_bf16_f32 v73, v98, v99
    v_cvt_pk_bf16_f32 v74, v100, v101
    v_cvt_pk_bf16_f32 v75, v102, v103
    v_exp_f32 v104, v104
    v_exp_f32 v105, v105
    v_mfma_f32_16x16x32_bf16 v[108:111], v[72:75], v[124:127], 0
    v_cvt_pk_bf16_f32 v104, v104, v105
    v_add_f32 v112, v112, v113
    v_smfmac_f32_16x16x64_bf16 v[12:15], v[72:75], v[56:63], v8 abid:1
    v_cndmask_b32 v76, v104, 0, s[78:79]
    v_cndmask_b32 v77, 0, v104, s[78:79]
    v_add_f32 v114, v114, v115
    v_add_f32 v116, v116, v117
    v_mfma_f32_16x16x16_bf16 v[108:111], v[76:77], v[124:125], v[108:111]
    v_add_f32 v118, v118, v119
    v_cvt_pk_bf16_f32 v122, v112, v114
    v_cvt_pk_bf16_f32 v123, v116, v118
    s_nop 1
    v_mfma_f32_16x16x16_bf16 v[12:15], v[76:77], v[122:123], v[12:15]
    s_nop 1
    v_rcp_f32 v108, v108
    s_nop 0
    v_rcp_f32 v109, v109
    s_nop 0
    v_rcp_f32 v110, v110
    s_nop 0
    v_rcp_f32 v111, v111
    s_nop 0
    v_pk_mul_f32 v[12:13], v[12:13], v[108:109]
    v_pk_mul_f32 v[14:15], v[14:15], v[110:111]
    v_cvt_pk_bf16_f32 v12, v12, v13
    v_cvt_pk_bf16_f32 v13, v14, v15
    ds_write_b64 v5, v[12:13] offset:128
    v_mov_b64 v[72:73], 0
    v_mov_b64 v[74:75], 0
    v_mov_b64 v[76:77], 0
    v_mov_b64 v[78:79], 0
    v_mov_b64 v[56:57], 0
    v_mov_b64 v[58:59], 0
    v_mov_b64 v[60:61], 0
    v_mov_b64 v[62:63], 0
    s_waitcnt lgkmcnt(0)
    s_barrier
    ds_read_b64_tr_b16 v[96:97], v6 offset:0
    ds_read_b64_tr_b16 v[98:99], v6 offset:512
    ds_read_b64_tr_b16 v[100:101], v6 offset:128
    ds_read_b64_tr_b16 v[102:103], v6 offset:640
    ds_read_b64_tr_b16 v[104:105], v6 offset:256
    ds_read_b64_tr_b16 v[106:107], v6 offset:768
    ds_read_b64_tr_b16 v[108:109], v6 offset:384
    ds_read_b64_tr_b16 v[110:111], v6 offset:896
    s_waitcnt lgkmcnt(6)
    v_smfmac_f32_16x16x64_bf16 v[72:75], v[96:99], a[64:71], v8 abid:1
    ds_read_b128 v[16:19], v1 offset:12288
    s_waitcnt lgkmcnt(5)
    v_smfmac_f32_16x16x64_bf16 v[72:75], v[100:103], a[96:103], v8 abid:1
    ds_read_b128 v[20:23], v1 offset:13312
    s_waitcnt lgkmcnt(4)
    v_smfmac_f32_16x16x64_bf16 v[72:75], v[104:107], v[80:87], v8 abid:1
    ds_read_b128 v[24:27], v1 offset:45056
    s_waitcnt lgkmcnt(3)
    v_smfmac_f32_16x16x64_bf16 v[72:75], v[108:111], v[88:95], v8 abid:1
    ds_read_b128 v[28:31], v1 offset:46080
    v_smfmac_f32_16x16x64_bf16 v[76:79], v[96:99], a[72:79], v8 abid:1
    ds_read_b128 v[32:35], v1 offset:14336
    s_nop 0
    v_mov_b64 v[112:113], 0
    v_smfmac_f32_16x16x64_bf16 v[76:79], v[100:103], a[104:111], v8 abid:1
    ds_read_b128 v[36:39], v1 offset:15360
    s_nop 0
    v_cvt_pk_bf16_f32 v72, v72, v73
    v_cvt_pk_bf16_f32 v73, v74, v75
    v_and_or_b32 v72, v72, -2, s38
    v_smfmac_f32_16x16x64_bf16 v[76:79], v[104:107], v[48:55], v8 abid:1
    buffer_store_dwordx2 v[72:73], v3, s[8:11], s28 offen sc1
    v_smfmac_f32_16x16x64_bf16 v[76:79], v[108:111], v[64:71], v8 abid:1
    ds_read_b128 v[40:43], v1 offset:47104
    v_smfmac_f32_16x16x64_bf16 v[56:59], v[96:99], a[80:87], v8 abid:1
    ds_read_b128 v[44:47], v1 offset:48128
    s_nop 0
    v_mov_b64 v[114:115], 0
    v_smfmac_f32_16x16x64_bf16 v[56:59], v[100:103], a[112:119], v8 abid:1
    s_nop 0
    s_nop 0
    v_cvt_pk_bf16_f32 v76, v76, v77
    v_cvt_pk_bf16_f32 v77, v78, v79
    v_and_or_b32 v76, v76, -2, s38
    s_waitcnt lgkmcnt(4)
    v_smfmac_f32_16x16x64_bf16 v[56:59], v[104:107], v[16:23], v8 abid:1
    buffer_store_dwordx2 v[76:77], v3, s[8:11], s29 offen sc1
    v_smfmac_f32_16x16x64_bf16 v[56:59], v[108:111], v[24:31], v8 abid:1
    v_smfmac_f32_16x16x64_bf16 v[60:63], v[96:99], a[88:95], v8 abid:1
    s_nop 1
    v_mov_b64 v[116:117], 0
    v_smfmac_f32_16x16x64_bf16 v[60:63], v[100:103], a[120:127], v8 abid:1
    s_nop 0
    s_nop 1
    v_cvt_pk_bf16_f32 v56, v56, v57
    v_cvt_pk_bf16_f32 v57, v58, v59
    v_and_or_b32 v56, v56, -2, s38
    s_waitcnt lgkmcnt(0)
    v_smfmac_f32_16x16x64_bf16 v[60:63], v[104:107], v[32:39], v8 abid:1
    buffer_store_dwordx2 v[56:57], v3, s[8:11], s30 offen sc1
    ds_read_b128 v[32:35], v2 offset:31232
    v_smfmac_f32_16x16x64_bf16 v[60:63], v[108:111], v[40:47], v8 abid:1
    s_mov_b32 s39, 0
    v_mov_b64 v[96:97], 0
    v_mov_b64 v[98:99], 0
    s_nop 4
    v_cvt_pk_bf16_f32 v60, v60, v61
    v_cvt_pk_bf16_f32 v61, v62, v63
    v_and_or_b32 v60, v60, -2, s38
    buffer_store_dwordx2 v[60:61], v3, s[8:11], s31 offen sc1
    v_mov_b64 v[100:101], 0
    v_mov_b64 v[102:103], 0
    v_mov_b64 v[104:105], 0
    v_mov_b64 v[106:107], 0
    v_mov_b64 v[108:109], 0
    v_mov_b64 v[110:111], 0
    v_mov_b64 v[118:119], 0
    s_waitcnt vmcnt(3)
    buffer_load_dwordx4 v[24:27], v0, s[8:11], s32 offen offset:0 sc1
    buffer_load_dwordx4 v[28:31], v0, s[8:11], s32 offen offset:1024 sc1
    ds_read_b128 v[48:51], v0 offset:8192
    ds_read_b128 v[52:55], v0 offset:9216
    ds_read_b128 v[56:59], v0 offset:10240
    s_waitcnt vmcnt(3)
    buffer_load_dwordx4 v[16:19], v0, s[8:11], s32 offen offset:0 sc1
    buffer_load_dwordx4 v[20:23], v0, s[8:11], s32 offen offset:1024 sc1
    v_pk_min_u16 v120, v120, s45
    v_pk_min_u16 v121, v121, s45
    v_pk_min_u16 v122, v122, s45
    v_pk_min_u16 v123, v123, s45
    v_mov_b32 v15, -1
    s_waitcnt lgkmcnt(3)
R1s_h1a:
    s_waitcnt vmcnt(3)
    v_mfma_f32_16x16x32_bf16 v[36:39], v[24:27], v[32:35], 0
    v_bitop3_b32 v12, v24, v26, s38 bitop3:0x7e
    s_waitcnt vmcnt(2)
    v_mfma_f32_16x16x32_bf16 v[36:39], v[28:31], v[32:35], v[36:39]
    v_bitop3_b32 v13, v28, v30, s38 bitop3:0x7e
    v_bitop3_b32 v12, v12, v13, 1 bitop3:0xa8
    v_cmp_ne_u32 vcc, 0, v12
    s_nop 0
    s_cbranch_vccnz R1s_h1
R1s_h1ok:
    s_nop 3
    v_permlane32_swap_b32 v36, v38
    v_permlane32_swap_b32 v37, v39
    v_add_f32 v36, v36, v38
    v_add_f32 v37, v37, v39
    s_nop 1
    v_permlane16_swap_b32 v36, v37
    v_add_f32 v12, v36, v37
    s_nop 1
    v_mov_b32_dpp v13, v12 row_shl:4 row_mask:0xf bank_mask:0xf
    v_cvt_pk_bf16_f32 v12, v12, v13
    v_min_u32 v12, -2, v12
    buffer_store_dword v12, v4, s[8:11], s34 offen sc1
    s_xor_b32 s32, s32, 1048576
    s_lshr_b32 s38, s24, 1
    buffer_store_dword v15, v4, s[8:11], s35 offen sc1
    s_xor_b32 s35, s35, 8192
    v_mov_b32 v11, s94
    s_xor_b32 s28, s28, 1048576
    s_xor_b32 s29, s29, 1048576
    s_xor_b32 s30, s30, 1048576
    s_xor_b32 s31, s31, 1048576
    s_xor_b32 s34, s34, 8192
    s_and_b32 s38, s38, 1
    s_lshl_b32 s39, s39, 16
    s_xor_b32 s92, s92, 4096
    s_mov_b32 s25, 0
    s_cmp_eq_u32 s24, 63
    s_cbranch_scc1 R1s_last
    s_waitcnt vmcnt(1)
    buffer_load_dwordx4 v[24:27], v0, s[8:11], s33 offen sc1
    buffer_load_dwordx4 v[28:31], v0, s[8:11], s33 offen offset:1024 sc1
    ds_read_b128 v[60:63], v0 offset:11264
    ds_read_b128 v[64:67], v0 offset:12288
    ds_read_b128 v[68:71], v0 offset:13312
    ds_read_b128 v[72:75], v0 offset:14336
    ds_read_b128 v[76:79], v0 offset:15360
    ds_read_b128 v[80:83], v0 offset:40960
    ds_read_b128 v[84:87], v0 offset:41984
    ds_read_b128 v[88:91], v0 offset:43008
    ds_read_b128 v[92:95], v0 offset:44032
    s_waitcnt lgkmcnt(0)
    buffer_load_dwordx4 v[32:35], v0, s[8:11], s33 offen sc1
    buffer_load_dwordx4 v[36:39], v0, s[8:11], s33 offen offset:1024 sc1
    s_branch R1s_h2a
R1s_h1:
    buffer_load_dwordx4 v[24:27], v0, s[8:11], s32 offen offset:0 sc1
    buffer_load_dwordx4 v[28:31], v0, s[8:11], s32 offen offset:1024 sc1
    s_add_u32 s39, s39, 1
    s_cmp_gt_u32 s39, 60000
    s_cbranch_scc1 L_fail
    s_waitcnt vmcnt(3)
    v_mfma_f32_16x16x32_bf16 v[36:39], v[16:19], v[32:35], 0
    v_bitop3_b32 v12, v16, v18, s38 bitop3:0x7e
    s_waitcnt vmcnt(2)
    v_mfma_f32_16x16x32_bf16 v[36:39], v[20:23], v[32:35], v[36:39]
    v_bitop3_b32 v13, v20, v22, s38 bitop3:0x7e
    v_bitop3_b32 v12, v12, v13, 1 bitop3:0xa8
    v_cmp_ne_u32 vcc, 0, v12
    s_nop 0
    s_cbranch_vccz R1s_h1ok
    buffer_load_dwordx4 v[16:19], v0, s[8:11], s32 offen offset:0 sc1
    buffer_load_dwordx4 v[20:23], v0, s[8:11], s32 offen offset:1024 sc1
    s_add_u32 s39, s39, 1
    s_branch R1s_h1a
R1s_h2:
    s_nop 5
    v_mov_b64 v[96:97], 0
    v_mov_b64 v[98:99], 0
    s_add_u32 s25, s25, 1
    s_cmp_gt_u32 s25, 60000
    s_cbranch_scc1 L_fail
    s_waitcnt vmcnt(1)
    v_max3_u32 v12, v32, v33, v34
    s_waitcnt vmcnt(0)
    v_max3_u32 v13, v35, v36, v37
    v_max3_u32 v12, v12, v38, v39
    v_max_u32 v12, v12, v13
    v_cmp_eq_u32 vcc, -1, v12
    s_nop 0
    s_cbranch_vccnz R1s_h2b
    v_mov_b64 v[24:25], v[32:33]
    v_mov_b64 v[26:27], v[34:35]
    v_mov_b64 v[28:29], v[36:37]
    v_mov_b64 v[30:31], v[38:39]
    s_branch R1s_top
R1s_h2b:
    buffer_load_dwordx4 v[24:27], v0, s[8:11], s33 offen sc1
    buffer_load_dwordx4 v[28:31], v0, s[8:11], s33 offen offset:1024 sc1
    s_waitcnt vmcnt(1)
    buffer_load_dwordx4 v[32:35], v0, s[8:11], s33 offen sc1
    buffer_load_dwordx4 v[36:39], v0, s[8:11], s33 offen offset:1024 sc1
    s_add_u32 s25, s25, 1
    s_branch R1s_h2a
R1s_top:
    v_smfmac_f32_16x16x64_bf16 v[96:99], v[24:27], a[32:39], v8
    ds_write_b128 v2, v[24:27] offset:18432
    s_branch R1s_top1
R1s_last:
    s_waitcnt vmcnt(0)
R1s_l2:
    buffer_load_dwordx4 v[24:27], v0, s[8:11], s33 offen sc1
    buffer_load_dwordx4 v[28:31], v0, s[8:11], s33 offen offset:1024 sc1
    s_add_u32 s25, s25, 1
    s_cmp_gt_u32 s25, 60000
    s_cbranch_scc1 L_fail
    s_waitcnt vmcnt(1)
    v_max3_u32 v12, v24, v25, v26
    s_waitcnt vmcnt(0)
    v_max3_u32 v13, v27, v28, v29
    v_max3_u32 v12, v12, v30, v31
    v_max_u32 v12, v12, v13
    v_cmp_eq_u32 vcc, -1, v12
    s_nop 0
    s_cbranch_vccnz R1s_l2
    v_smfmac_f32_16x16x64_bf16 v[104:107], v[24:27], a[160:167], v8
    ds_write_b128 v2, v[24:27] offset:18432
    v_smfmac_f32_16x16x64_bf16 v[108:111], v[24:27], a[168:175], v8
    ds_write_b128 v2, v[28:31] offset:19456
    v_smfmac_f32_16x16x64_bf16 v[112:115], v[24:27], v[160:167], v8
    v_smfmac_f32_16x16x64_bf16 v[116:119], v[24:27], v[168:175], v8
    v_smfmac_f32_16x16x64_bf16 v[104:107], v[28:31], a[176:183], v8
    v_smfmac_f32_16x16x64_bf16 v[108:111], v[28:31], a[184:191], v8
    v_smfmac_f32_16x16x64_bf16 v[112:115], v[28:31], v[176:183], v8
    s_waitcnt lgkmcnt(0)
    s_barrier
    ds_read_b128 v[32:35], v2 offset:20480
    ds_read_b128 v[36:39], v2 offset:21504
    ds_read_b128 v[40:43], v2 offset:22528
    ds_read_b128 v[16:19], v2 offset:16384
    ds_read_b128 v[20:23], v2 offset:17408
    ds_read_b128 v[44:47], v2 offset:23552
    v_smfmac_f32_16x16x64_bf16 v[116:119], v[28:31], v[184:191], v8
    buffer_store_dwordx4 v[120:123], v0, s[8:11], s37 offen sc1
    s_add_u32 s37, s37, 131072
    s_waitcnt lgkmcnt(5)
    v_smfmac_f32_16x16x64_bf16 v[104:107], v[32:35], a[192:199], v8
    v_smfmac_f32_16x16x64_bf16 v[108:111], v[32:35], a[200:207], v8
    v_smfmac_f32_16x16x64_bf16 v[112:115], v[32:35], v[192:199], v8
    v_smfmac_f32_16x16x64_bf16 v[116:119], v[32:35], v[200:207], v8
    s_waitcnt lgkmcnt(4)
    v_smfmac_f32_16x16x64_bf16 v[104:107], v[36:39], a[208:215], v8
    v_smfmac_f32_16x16x64_bf16 v[108:111], v[36:39], a[216:223], v8
    v_smfmac_f32_16x16x64_bf16 v[112:115], v[36:39], v[208:215], v8
    v_smfmac_f32_16x16x64_bf16 v[116:119], v[36:39], v[216:223], v8
    s_waitcnt lgkmcnt(3)
    v_smfmac_f32_16x16x64_bf16 v[104:107], v[40:43], a[224:231], v8
    v_smfmac_f32_16x16x64_bf16 v[108:111], v[40:43], a[232:239], v8
    v_smfmac_f32_16x16x64_bf16 v[112:115], v[40:43], v[224:231], v8
    v_smfmac_f32_16x16x64_bf16 v[116:119], v[40:43], v[232:239], v8
    s_waitcnt lgkmcnt(2)
    v_smfmac_f32_16x16x64_bf16 v[104:107], v[16:19], a[128:135], v8
    v_smfmac_f32_16x16x64_bf16 v[108:111], v[16:19], a[136:143], v8
    v_smfmac_f32_16x16x64_bf16 v[112:115], v[16:19], v[128:135], v8
    v_smfmac_f32_16x16x64_bf16 v[116:119], v[16:19], v[136:143], v8
    s_waitcnt lgkmcnt(1)
    v_smfmac_f32_16x16x64_bf16 v[104:107], v[20:23], a[144:151], v8
    v_smfmac_f32_16x16x64_bf16 v[108:111], v[20:23], a[152:159], v8
    v_smfmac_f32_16x16x64_bf16 v[112:115], v[20:23], v[144:151], v8
    v_smfmac_f32_16x16x64_bf16 v[116:119], v[20:23], v[152:159], v8
    s_waitcnt lgkmcnt(0)
    v_smfmac_f32_16x16x64_bf16 v[104:107], v[44:47], a[240:247], v8
    v_smfmac_f32_16x16x64_bf16 v[108:111], v[44:47], a[248:255], v8
    v_smfmac_f32_16x16x64_bf16 v[112:115], v[44:47], v[240:247], v8
    v_smfmac_f32_16x16x64_bf16 v[116:119], v[44:47], v[248:255], v8
    s_nop 4
    v_add_f32 v104, v104, v105
    v_add_f32 v106, v106, v107
    v_add_f32 v108, v108, v109
    v_add_f32 v110, v110, v111
    v_cvt_pk_bf16_f32 v120, v104, v106
    v_cvt_pk_bf16_f32 v121, v108, v110
    v_add_f32 v112, v112, v113
    v_add_f32 v114, v114, v115
    v_add_f32 v116, v116, v117
    v_add_f32 v118, v118, v119
    v_cvt_pk_bf16_f32 v122, v112, v114
    v_cvt_pk_bf16_f32 v123, v116, v118
    v_pk_min_u16 v120, v120, s45
    v_pk_min_u16 v121, v121, s45
    v_pk_min_u16 v122, v122, s45
    v_pk_min_u16 v123, v123, s45
    buffer_store_dwordx4 v[120:123], v0, s[8:11], s37 offen sc1
    v_mov_b32 v15, 64
    s_waitcnt vmcnt(0)
    s_barrier
    buffer_store_dword v15, v7, s[8:11], s93 offen sc1
    s_branch L_exit_r
L_w2s:
    v_mov_b64 v[32:33], v[64:65]
    v_mov_b64 v[34:35], v[66:67]
    v_mov_b64 v[36:37], v[68:69]
    v_mov_b64 v[38:39], v[70:71]
    ds_read_b128 v[48:51], v0 offset:16384
    ds_read_b128 v[52:55], v0 offset:17408
    ds_read_b128 v[56:59], v0 offset:18432
    ds_read_b128 v[60:63], v0 offset:19456
    ds_read_b128 v[64:67], v0 offset:20480
    ds_read_b128 v[68:71], v0 offset:21504
    ds_read_b128 v[72:75], v0 offset:22528
    ds_read_b128 v[76:79], v0 offset:23552
    ds_read_b128 v[80:83], v0 offset:49152
    ds_read_b128 v[84:87], v0 offset:50176
    ds_read_b128 v[88:91], v0 offset:51200
    ds_read_b128 v[92:95], v0 offset:52224
    v_mov_b64 v[96:97], 0
    v_mov_b64 v[98:99], 0
    v_mov_b64 v[100:101], 0
    v_mov_b64 v[102:103], 0
    v_mov_b64 v[104:105], 0
    v_mov_b64 v[106:107], 0
    v_mov_b64 v[108:109], 0
    v_mov_b64 v[110:111], 0
    v_mov_b64 v[112:113], 0
    v_mov_b64 v[114:115], 0
    v_mov_b64 v[116:117], 0
    v_mov_b64 v[118:119], 0
    v_mov_b32 v15, -1
    v_mov_b32 v11, 0
    s_waitcnt lgkmcnt(0)
    s_branch R2s_top
.p2align 6
    s_nop 0
    s_nop 0
R2s_h2a:
    s_waitcnt lgkmcnt(0)
    s_waitcnt vmcnt(3)
    v_max3_u32 v12, v32, v33, v34
    s_waitcnt vmcnt(2)
    v_max3_u32 v13, v35, v36, v37
    v_max3_u32 v12, v12, v38, v39
    v_max_u32 v12, v12, v13
    v_cmp_eq_u32 vcc, -1, v12
    v_smfmac_f32_16x16x64_bf16 v[96:99], v[32:35], v[48:55], v8
    ds_write_b128 v2, v[32:35] offset:20480
    s_cbranch_vccnz R2s_h2
R2s_top1:
    v_smfmac_f32_16x16x64_bf16 v[100:103], v[32:35], v[56:63], v8
    ds_write_b128 v2, v[36:39] offset:21504
    s_xor_b32 s33, s33, 8192
    v_smfmac_f32_16x16x64_bf16 v[96:99], v[36:39], v[64:71], v8
    v_add_u32 v15, 2176, v6
    v_smfmac_f32_16x16x64_bf16 v[100:103], v[36:39], v[72:79], v8
    v_cndmask_b32 v15, v6, v15, s[60:61]
    v_smfmac_f32_16x16x64_bf16 v[104:107], v[32:35], a[192:199], v8
    v_smfmac_f32_16x16x64_bf16 v[108:111], v[32:35], a[200:207], v8
    v_smfmac_f32_16x16x64_bf16 v[104:107], v[36:39], a[208:215], v8
    s_waitcnt vmcnt(0) lgkmcnt(0)
    s_barrier
    ds_read_b128 v[40:43], v2 offset:22528
    v_smfmac_f32_16x16x64_bf16 v[108:111], v[36:39], a[216:223], v8
    ds_read_b128 v[16:19], v2 offset:16384
    v_smfmac_f32_16x16x64_bf16 v[112:115], v[32:35], v[192:199], v8
    ds_read_b128 v[20:23], v2 offset:17408
    v_smfmac_f32_16x16x64_bf16 v[116:119], v[32:35], v[200:207], v8
    ds_read_b128 v[24:27], v2 offset:18432
    v_smfmac_f32_16x16x64_bf16 v[112:115], v[36:39], v[208:215], v8
    ds_read_b128 v[28:31], v2 offset:19456
    s_waitcnt lgkmcnt(4)
    v_smfmac_f32_16x16x64_bf16 v[96:99], v[40:43], v[80:87], v8
    ds_read_b128 v[44:47], v2 offset:23552
    v_smfmac_f32_16x16x64_bf16 v[100:103], v[40:43], v[88:95], v8
    ds_read_b128 v[48:51], v0 offset:53248
    s_waitcnt lgkmcnt(5)
    v_smfmac_f32_16x16x64_bf16 v[96:99], v[16:19], a[0:7], v8
    ds_read_b128 v[52:55], v0 offset:54272
    v_smfmac_f32_16x16x64_bf16 v[100:103], v[16:19], a[8:15], v8
    ds_read_b128 v[56:59], v0 offset:55296
    s_waitcnt lgkmcnt(6)
    v_smfmac_f32_16x16x64_bf16 v[96:99], v[20:23], a[16:23], v8
    ds_read_b128 v[60:63], v0 offset:56320
    v_smfmac_f32_16x16x64_bf16 v[100:103], v[20:23], a[24:31], v8
    ds_read_b128 v[64:67], v2 offset:4096
    s_waitcnt lgkmcnt(7)
    v_smfmac_f32_16x16x64_bf16 v[96:99], v[24:27], a[32:39], v8
    ds_read_b128 v[68:71], v2 offset:5120
    v_smfmac_f32_16x16x64_bf16 v[100:103], v[24:27], a[40:47], v8
    ds_read_b128 v[72:75], v2 offset:6144
    s_waitcnt lgkmcnt(8)
    v_smfmac_f32_16x16x64_bf16 v[96:99], v[28:31], a[48:55], v8
    ds_read_b128 v[76:79], v2 offset:7168
    v_smfmac_f32_16x16x64_bf16 v[100:103], v[28:31], a[56:63], v8
    s_waitcnt lgkmcnt(8)
    s_waitcnt lgkmcnt(6)
    v_smfmac_f32_16x16x64_bf16 v[96:99], v[44:47], v[48:55], v8
    ds_read_b128 v[48:51], v2 offset:0
    s_waitcnt lgkmcnt(5)
    v_smfmac_f32_16x16x64_bf16 v[100:103], v[44:47], v[56:63], v8
    ds_read_b128 v[52:55], v2 offset:1024
    v_smfmac_f32_16x16x64_bf16 v[104:107], v[40:43], a[224:231], v8
    ds_read_b128 v[56:59], v2 offset:2048
    buffer_store_dwordx4 v[120:123], v0, s[8:11], s37 offen sc1
    s_add_u32 s36, s36, 786432
    v_smfmac_f32_16x16x64_bf16 v[108:111], v[40:43], a[232:239], v8
    ds_read_b128 v[60:63], v2 offset:3072
    s_mov_b32 m0, s43
    s_add_u32 s42, s42, 786432
    v_smfmac_f32_16x16x64_bf16 v[104:107], v[16:19], a[128:135], v8
    v_add_f32 v96, v96, v97
    v_add_f32 v98, v98, v99
    v_smfmac_f32_16x16x64_bf16 v[108:111], v[16:19], a[136:143], v8
    v_add_f32 v100, v100, v101
    v_add_f32 v102, v102, v103
    v_smfmac_f32_16x16x64_bf16 v[104:107], v[20:23], a[144:151], v8
    v_cvt_pk_bf16_f32 v124, v96, v98
    v_cvt_pk_bf16_f32 v125, v100, v102
    v_smfmac_f32_16x16x64_bf16 v[108:111], v[20:23], a[152:159], v8
    ds_write2st64_b32 v9, v124, v125 offset0:0 offset1:2
    v_smfmac_f32_16x16x64_bf16 v[104:107], v[24:27], a[160:167], v8
    s_mov_b32 s94, s24
    v_smfmac_f32_16x16x64_bf16 v[108:111], v[24:27], a[168:175], v8
    v_smfmac_f32_16x16x64_bf16 v[104:107], v[28:31], a[176:183], v8
    v_smfmac_f32_16x16x64_bf16 v[108:111], v[28:31], a[184:191], v8
    s_add_u32 s37, s37, 131072
    s_waitcnt lgkmcnt(0)
    s_barrier
    v_smfmac_f32_16x16x64_bf16 v[104:107], v[44:47], a[240:247], v8
    ds_read_b64_tr_b16 v[80:81], v6 offset:0
    ds_read_b64_tr_b16 v[82:83], v6 offset:512
    v_smfmac_f32_16x16x64_bf16 v[108:111], v[44:47], a[248:255], v8
    ds_read_b64_tr_b16 v[84:85], v6 offset:128
    ds_read_b64_tr_b16 v[86:87], v6 offset:640
    v_smfmac_f32_16x16x64_bf16 v[116:119], v[36:39], v[216:223], v8
    ds_read_b64_tr_b16 v[88:89], v6 offset:256
    ds_read_b64_tr_b16 v[90:91], v6 offset:768
    v_smfmac_f32_16x16x64_bf16 v[112:115], v[40:43], v[224:231], v8
    ds_read_b64_tr_b16 v[92:93], v6 offset:384
    ds_read_b64_tr_b16 v[94:95], v6 offset:896
    v_add_f32 v104, v104, v105
    v_add_f32 v106, v106, v107
    v_add_f32 v108, v108, v109
    v_add_f32 v110, v110, v111
    v_cvt_pk_bf16_f32 v120, v104, v106
    v_cvt_pk_bf16_f32 v121, v108, v110
    s_waitcnt lgkmcnt(4)
    v_mfma_f32_16x16x32_bf16 v[96:99], v[48:51], v[80:83], 0
    ds_write2st64_b32 v10, v120, v121 offset0:9 offset1:11
    v_mfma_f32_16x16x32_bf16 v[100:103], v[64:67], v[80:83], 0
    v_mfma_f32_16x16x32_bf16 v[96:99], v[52:55], v[84:87], v[96:99]
    v_mov_b64 v[126:127], s[26:27]
    v_mfma_f32_16x16x32_bf16 v[100:103], v[68:71], v[84:87], v[100:103]
    buffer_load_dwordx4 v0, s[8:11], s36 offen offset:0 sc1 lds
    s_waitcnt lgkmcnt(0)
    s_barrier
    v_mfma_f32_16x16x32_bf16 v[96:99], v[56:59], v[88:91], v[96:99]
    ds_read_b64_tr_b16 v[48:49], v15 offset:2304
    ds_read_b64_tr_b16 v[50:51], v15 offset:2816
    v_mfma_f32_16x16x32_bf16 v[100:103], v[72:75], v[88:91], v[100:103]
    ds_read_b64_tr_b16 v[64:65], v15 offset:2432
    ds_read_b64_tr_b16 v[66:67], v15 offset:2944
    v_mfma_f32_16x16x32_bf16 v[96:99], v[60:63], v[92:95], v[96:99]
    ds_read_b64_tr_b16 v[52:53], v15 offset:2560
    ds_read_b64_tr_b16 v[54:55], v15 offset:3072
    v_mfma_f32_16x16x32_bf16 v[100:103], v[76:79], v[92:95], v[100:103]
    ds_read_b64_tr_b16 v[68:69], v15 offset:2688
    ds_read_b64_tr_b16 v[70:71], v15 offset:3200
    s_waitcnt lgkmcnt(6)
    v_mfma_f32_16x16x32_bf16 v[104:107], v[48:51], v[80:83], 0
    ds_read_b128 v[56:59], v2 offset:12288
    v_mov_b64 v[124:125], s[26:27]
    s_waitcnt lgkmcnt(5)
    v_mfma_f32_16x16x32_bf16 v[104:107], v[64:67], v[84:87], v[104:107]
    ds_read_b128 v[60:63], v2 offset:13312
    v_max3_f32 v12, v96, v97, v98
    s_waitcnt lgkmcnt(4)
    v_mfma_f32_16x16x32_bf16 v[104:107], v[52:55], v[88:91], v[104:107]
    v_max3_f32 v13, v99, v100, v101
    v_max3_f32 v12, v12, v102, v103
    s_waitcnt lgkmcnt(2)
    v_mfma_f32_16x16x32_bf16 v[104:107], v[68:71], v[92:95], v[104:107]
    buffer_load_dwordx4 v0, s[8:11], s36 offen offset:1024 sc1 lds
    v_max_f32 v12, v12, v13
    v_smfmac_f32_16x16x64_bf16 v[116:119], v[40:43], v[232:239], v8
    ds_read_b128 v[80:83], v1 offset:16384
    s_add_u32 m0, s43, 8192
    v_smfmac_f32_16x16x64_bf16 v[112:115], v[16:19], v[128:135], v8
    ds_read_b128 v[84:87], v1 offset:17408
    s_add_u32 s24, s24, 1
    v_max3_f32 v12, v12, v104, v105
    v_mov_b32 v13, v12
    v_smfmac_f32_16x16x64_bf16 v[116:119], v[16:19], v[136:143], v8
    ds_read_b128 v[88:91], v1 offset:49152
    v_permlane32_swap_b32 v12, v13
    v_max_f32 v12, v12, v13
    v_mov_b32 v13, v12
    v_smfmac_f32_16x16x64_bf16 v[112:115], v[20:23], v[144:151], v8
    ds_read_b128 v[92:95], v1 offset:50176
    v_permlane16_swap_b32 v12, v13
    v_max_f32 v12, v12, v13
    v_mul_f32 v12, s40, v12
    v_pk_fma_f32 v[96:97], v[96:97], s[40:41], v[12:13] op_sel_hi:[1,1,0] neg_lo:[0,0,1] neg_hi:[0,0,1]
    v_pk_fma_f32 v[98:99], v[98:99], s[40:41], v[12:13] op_sel_hi:[1,1,0] neg_lo:[0,0,1] neg_hi:[0,0,1]
    v_pk_fma_f32 v[100:101], v[100:101], s[40:41], v[12:13] op_sel_hi:[1,1,0] neg_lo:[0,0,1] neg_hi:[0,0,1]
    v_pk_fma_f32 v[102:103], v[102:103], s[40:41], v[12:13] op_sel_hi:[1,1,0] neg_lo:[0,0,1] neg_hi:[0,0,1]
    v_pk_fma_f32 v[104:105], v[104:105], s[40:41], v[12:13] op_sel_hi:[1,1,0] neg_lo:[0,0,1] neg_hi:[0,0,1]
    v_smfmac_f32_16x16x64_bf16 v[116:119], v[20:23], v[152:159], v8
    ds_read_b128 v[48:51], v1 offset:18432
    v_exp_f32 v96, v96
    v_smfmac_f32_16x16x64_bf16 v[112:115], v[24:27], v[160:167], v8
    ds_read_b128 v[52:55], v1 offset:19456
    v_exp_f32 v97, v97
    v_smfmac_f32_16x16x64_bf16 v[116:119], v[24:27], v[168:175], v8
    ds_read_b128 v[64:67], v1 offset:51200
    v_exp_f32 v98, v98
    v_smfmac_f32_16x16x64_bf16 v[112:115], v[28:31], v[176:183], v8
    ds_read_b128 v[68:71], v1 offset:52224
    v_exp_f32 v99, v99
    s_waitcnt lgkmcnt(8)
    v_smfmac_f32_16x16x64_bf16 v[116:119], v[28:31], v[184:191], v8
    buffer_load_dwordx4 v0, s[8:11], s42 offen offset:0 sc1 lds
    v_exp_f32 v100, v100
    v_smfmac_f32_16x16x64_bf16 v[112:115], v[44:47], v[240:247], v8
    v_exp_f32 v101, v101
    v_smfmac_f32_16x16x64_bf16 v[116:119], v[44:47], v[248:255], v8
    buffer_load_dwordx4 v0, s[8:11], s42 offen offset:1024 sc1 lds
    v_exp_f32 v102, v102
    v_exp_f32 v103, v103
    v_mov_b64 v[12:13], 0
    v_mov_b64 v[14:15], 0
    v_cvt_pk_bf16_f32 v72, v96, v97
    v_cvt_pk_bf16_f32 v73, v98, v99
    v_cvt_pk_bf16_f32 v74, v100, v101
    v_cvt_pk_bf16_f32 v75, v102, v103
    v_exp_f32 v104, v104
    v_exp_f32 v105, v105
    v_mfma_f32_16x16x32_bf16 v[108:111], v[72:75], v[124:127], 0
    v_cvt_pk_bf16_f32 v104, v104, v105
    v_add_f32 v112, v112, v113
    v_smfmac_f32_16x16x64_bf16 v[12:15], v[72:75], v[56:63], v8 abid:1
    v_cndmask_b32 v76, v104, 0, s[78:79]
    v_cndmask_b32 v77, 0, v104, s[78:79]
    v_add_f32 v114, v114, v115
    v_add_f32 v116, v116, v117
    v_mfma_f32_16x16x16_bf16 v[108:111], v[76:77], v[124:125], v[108:111]
    v_add_f32 v118, v118, v119
    v_cvt_pk_bf16_f32 v122, v112, v114
    v_cvt_pk_bf16_f32 v123, v116, v118
    s_nop 1
    v_mfma_f32_16x16x16_bf16 v[12:15], v[76:77], v[122:123], v[12:15]
    s_nop 1
    v_rcp_f32 v108, v108
    s_nop 0
    v_rcp_f32 v109, v109
    s_nop 0
    v_rcp_f32 v110, v110
    s_nop 0
    v_rcp_f32 v111, v111
    s_nop 0
    v_pk_mul_f32 v[12:13], v[12:13], v[108:109]
    v_pk_mul_f32 v[14:15], v[14:15], v[110:111]
    v_cvt_pk_bf16_f32 v12, v12, v13
    v_cvt_pk_bf16_f32 v13, v14, v15
    ds_write_b64 v5, v[12:13] offset:256
    v_mov_b64 v[72:73], 0
    v_mov_b64 v[74:75], 0
    v_mov_b64 v[76:77], 0
    v_mov_b64 v[78:79], 0
    v_mov_b64 v[56:57], 0
    v_mov_b64 v[58:59], 0
    v_mov_b64 v[60:61], 0
    v_mov_b64 v[62:63], 0
    s_waitcnt lgkmcnt(0)
    s_barrier
    ds_read_b64_tr_b16 v[96:97], v6 offset:0
    ds_read_b64_tr_b16 v[98:99], v6 offset:512
    ds_read_b64_tr_b16 v[100:101], v6 offset:128
    ds_read_b64_tr_b16 v[102:103], v6 offset:640
    ds_read_b64_tr_b16 v[104:105], v6 offset:256
    ds_read_b64_tr_b16 v[106:107], v6 offset:768
    ds_read_b64_tr_b16 v[108:109], v6 offset:384
    ds_read_b64_tr_b16 v[110:111], v6 offset:896
    s_waitcnt lgkmcnt(6)
    v_smfmac_f32_16x16x64_bf16 v[72:75], v[96:99], a[64:71], v8 abid:1
    ds_read_b128 v[16:19], v1 offset:20480
    s_waitcnt lgkmcnt(5)
    v_smfmac_f32_16x16x64_bf16 v[72:75], v[100:103], a[96:103], v8 abid:1
    ds_read_b128 v[20:23], v1 offset:21504
    s_waitcnt lgkmcnt(4)
    v_smfmac_f32_16x16x64_bf16 v[72:75], v[104:107], v[80:87], v8 abid:1
    ds_read_b128 v[24:27], v1 offset:53248
    s_waitcnt lgkmcnt(3)
    v_smfmac_f32_16x16x64_bf16 v[72:75], v[108:111], v[88:95], v8 abid:1
    ds_read_b128 v[28:31], v1 offset:54272
    v_smfmac_f32_16x16x64_bf16 v[76:79], v[96:99], a[72:79], v8 abid:1
    ds_read_b128 v[32:35], v1 offset:22528
    s_nop 0
    v_mov_b64 v[112:113], 0
    v_smfmac_f32_16x16x64_bf16 v[76:79], v[100:103], a[104:111], v8 abid:1
    ds_read_b128 v[36:39], v1 offset:23552
    s_nop 0
    v_cvt_pk_bf16_f32 v72, v72, v73
    v_cvt_pk_bf16_f32 v73, v74, v75
    v_and_or_b32 v72, v72, -2, s38
    v_smfmac_f32_16x16x64_bf16 v[76:79], v[104:107], v[48:55], v8 abid:1
    buffer_store_dwordx2 v[72:73], v3, s[8:11], s28 offen sc1
    v_smfmac_f32_16x16x64_bf16 v[76:79], v[108:111], v[64:71], v8 abid:1
    ds_read_b128 v[40:43], v1 offset:55296
    v_smfmac_f32_16x16x64_bf16 v[56:59], v[96:99], a[80:87], v8 abid:1
    ds_read_b128 v[44:47], v1 offset:56320
    s_nop 0
    v_mov_b64 v[114:115], 0
    v_smfmac_f32_16x16x64_bf16 v[56:59], v[100:103], a[112:119], v8 abid:1
    s_nop 0
    s_nop 0
    v_cvt_pk_bf16_f32 v76, v76, v77
    v_cvt_pk_bf16_f32 v77, v78, v79
    v_and_or_b32 v76, v76, -2, s38
    s_waitcnt lgkmcnt(4)
    v_smfmac_f32_16x16x64_bf16 v[56:59], v[104:107], v[16:23], v8 abid:1
    buffer_store_dwordx2 v[76:77], v3, s[8:11], s29 offen sc1
    v_smfmac_f32_16x16x64_bf16 v[56:59], v[108:111], v[24:31], v8 abid:1
    v_smfmac_f32_16x16x64_bf16 v[60:63], v[96:99], a[88:95], v8 abid:1
    s_nop 1
    v_mov_b64 v[116:117], 0
    v_smfmac_f32_16x16x64_bf16 v[60:63], v[100:103], a[120:127], v8 abid:1
    s_nop 0
    s_nop 1
    v_cvt_pk_bf16_f32 v56, v56, v57
    v_cvt_pk_bf16_f32 v57, v58, v59
    v_and_or_b32 v56, v56, -2, s38
    s_waitcnt lgkmcnt(0)
    v_smfmac_f32_16x16x64_bf16 v[60:63], v[104:107], v[32:39], v8 abid:1
    buffer_store_dwordx2 v[56:57], v3, s[8:11], s30 offen sc1
    ds_read_b128 v[32:35], v2 offset:31232
    v_smfmac_f32_16x16x64_bf16 v[60:63], v[108:111], v[40:47], v8 abid:1
    s_mov_b32 s39, 0
    v_mov_b64 v[96:97], 0
    v_mov_b64 v[98:99], 0
    s_nop 4
    v_cvt_pk_bf16_f32 v60, v60, v61
    v_cvt_pk_bf16_f32 v61, v62, v63
    v_and_or_b32 v60, v60, -2, s38
    buffer_store_dwordx2 v[60:61], v3, s[8:11], s31 offen sc1
    v_mov_b64 v[100:101], 0
    v_mov_b64 v[102:103], 0
    v_mov_b64 v[104:105], 0
    v_mov_b64 v[106:107], 0
    v_mov_b64 v[108:109], 0
    v_mov_b64 v[110:111], 0
    v_mov_b64 v[118:119], 0
    ds_read_b128 v[48:51], v0 offset:16384
    ds_read_b128 v[52:55], v0 offset:17408
    ds_read_b128 v[56:59], v0 offset:18432
    s_waitcnt vmcnt(2)
    buffer_load_dwordx4 v[24:27], v0, s[8:11], s32 offen offset:0 sc1
    buffer_load_dwordx4 v[28:31], v0, s[8:11], s32 offen offset:1024 sc1
    s_waitcnt vmcnt(2)
    ds_read_b128 v[60:63], v0 offset:19456
    ds_read_b128 v[64:67], v0 offset:20480
    buffer_load_dwordx4 v[16:19], v0, s[8:11], s32 offen offset:0 sc1
    buffer_load_dwordx4 v[20:23], v0, s[8:11], s32 offen offset:1024 sc1
    v_pk_min_u16 v120, v120, s45
    v_pk_min_u16 v121, v121, s45
    v_pk_min_u16 v122, v122, s45
    v_pk_min_u16 v123, v123, s45
    v_mov_b32 v15, -1
    s_waitcnt lgkmcnt(5)
R2s_h1a:
    s_waitcnt vmcnt(3)
    v_mfma_f32_16x16x32_bf16 v[36:39], v[24:27], v[32:35], 0
    v_bitop3_b32 v12, v24, v26, s38 bitop3:0x7e
    s_waitcnt vmcnt(2)
    v_mfma_f32_16x16x32_bf16 v[36:39], v[28:31], v[32:35], v[36:39]
    v_bitop3_b32 v13, v28, v30, s38 bitop3:0x7e
    v_bitop3_b32 v12, v12, v13, 1 bitop3:0xa8
    v_cmp_ne_u32 vcc, 0, v12
    s_nop 0
    s_cbranch_vccnz R2s_h1
R2s_h1ok:
    s_nop 3
    v_permlane32_swap_b32 v36, v38
    v_permlane32_swap_b32 v37, v39
    v_add_f32 v36, v36, v38
    v_add_f32 v37, v37, v39
    s_nop 1
    v_permlane16_swap_b32 v36, v37
    v_add_f32 v12, v36, v37
    s_nop 1
    v_mov_b32_dpp v13, v12 row_shl:4 row_mask:0xf bank_mask:0xf
    v_cvt_pk_bf16_f32 v12, v12, v13
    v_min_u32 v12, -2, v12
    buffer_store_dword v12, v4, s[8:11], s34 offen sc1
    s_xor_b32 s32, s32, 1048576
    s_lshr_b32 s38, s24, 1
    buffer_store_dword v15, v4, s[8:11], s35 offen sc1
    s_xor_b32 s35, s35, 8192
    s_xor_b32 s28, s28, 1048576
    s_xor_b32 s29, s29, 1048576
    s_xor_b32 s30, s30, 1048576
    s_xor_b32 s31, s31, 1048576
    s_xor_b32 s34, s34, 8192
    s_and_b32 s38, s38, 1
    s_lshl_b32 s39, s39, 16
    s_xor_b32 s92, s92, 4096
    s_mov_b32 s25, 0
    s_cmp_eq_u32 s24, 63
    s_cbranch_scc1 R2s_last
    s_waitcnt vmcnt(1)
    buffer_load_dwordx4 v[32:35], v0, s[8:11], s33 offen sc1
    buffer_load_dwordx4 v[36:39], v0, s[8:11], s33 offen offset:1024 sc1
    ds_read_b128 v[68:71], v0 offset:21504
    ds_read_b128 v[72:75], v0 offset:22528
    ds_read_b128 v[76:79], v0 offset:23552
    ds_read_b128 v[80:83], v0 offset:49152
    ds_read_b128 v[84:87], v0 offset:50176
    ds_read_b128 v[88:91], v0 offset:51200
    ds_read_b128 v[92:95], v0 offset:52224
    s_waitcnt lgkmcnt(0)
    buffer_load_dwordx4 v[40:43], v0, s[8:11], s33 offen sc1
    buffer_load_dwordx4 v[44:47], v0, s[8:11], s33 offen offset:1024 sc1
    s_branch R2s_h2a
R2s_h1:
    buffer_load_dwordx4 v[24:27], v0, s[8:11], s32 offen offset:0 sc1
    buffer_load_dwordx4 v[28:31], v0, s[8:11], s32 offen offset:1024 sc1
    s_add_u32 s39, s39, 1
    s_cmp_gt_u32 s39, 60000
    s_cbranch_scc1 L_fail
    s_waitcnt vmcnt(3)
    v_mfma_f32_16x16x32_bf16 v[36:39], v[16:19], v[32:35], 0
    v_bitop3_b32 v12, v16, v18, s38 bitop3:0x7e
    s_waitcnt vmcnt(2)
    v_mfma_f32_16x16x32_bf16 v[36:39], v[20:23], v[32:35], v[36:39]
    v_bitop3_b32 v13, v20, v22, s38 bitop3:0x7e
    v_bitop3_b32 v12, v12, v13, 1 bitop3:0xa8
    v_cmp_ne_u32 vcc, 0, v12
    s_nop 0
    s_cbranch_vccz R2s_h1ok
    buffer_load_dwordx4 v[16:19], v0, s[8:11], s32 offen offset:0 sc1
    buffer_load_dwordx4 v[20:23], v0, s[8:11], s32 offen offset:1024 sc1
    s_add_u32 s39, s39, 1
    s_branch R2s_h1a
R2s_h2:
    s_nop 5
    v_mov_b64 v[96:97], 0
    v_mov_b64 v[98:99], 0
    s_add_u32 s25, s25, 1
    s_cmp_gt_u32 s25, 60000
    s_cbranch_scc1 L_fail
    s_waitcnt vmcnt(1)
    v_max3_u32 v12, v40, v41, v42
    s_waitcnt vmcnt(0)
    v_max3_u32 v13, v43, v44, v45
    v_max3_u32 v12, v12, v46, v47
    v_max_u32 v12, v12, v13
    v_cmp_eq_u32 vcc, -1, v12
    s_nop 0
    s_cbranch_vccnz R2s_h2b
    v_mov_b64 v[32:33], v[40:41]
    v_mov_b64 v[34:35], v[42:43]
    v_mov_b64 v[36:37], v[44:45]
    v_mov_b64 v[38:39], v[46:47]
    s_branch R2s_top
R2s_h2b:
    buffer_load_dwordx4 v[32:35], v0, s[8:11], s33 offen sc1
    buffer_load_dwordx4 v[36:39], v0, s[8:11], s33 offen offset:1024 sc1
    s_waitcnt vmcnt(1)
    buffer_load_dwordx4 v[40:43], v0, s[8:11], s33 offen sc1
    buffer_load_dwordx4 v[44:47], v0, s[8:11], s33 offen offset:1024 sc1
    s_add_u32 s25, s25, 1
    s_branch R2s_h2a
R2s_top:
    v_smfmac_f32_16x16x64_bf16 v[96:99], v[32:35], v[48:55], v8
    ds_write_b128 v2, v[32:35] offset:20480
    s_branch R2s_top1
R2s_last:
    s_waitcnt vmcnt(0)
R2s_l2:
    buffer_load_dwordx4 v[32:35], v0, s[8:11], s33 offen sc1
    buffer_load_dwordx4 v[36:39], v0, s[8:11], s33 offen offset:1024 sc1
    s_add_u32 s25, s25, 1
    s_cmp_gt_u32 s25, 60000
    s_cbranch_scc1 L_fail
    s_waitcnt vmcnt(1)
    v_max3_u32 v12, v32, v33, v34
    s_waitcnt vmcnt(0)
    v_max3_u32 v13, v35, v36, v37
    v_max3_u32 v12, v12, v38, v39
    v_max_u32 v12, v12, v13
    v_cmp_eq_u32 vcc, -1, v12
    s_nop 0
    s_cbranch_vccnz R2s_l2
    v_smfmac_f32_16x16x64_bf16 v[104:107], v[32:35], a[192:199], v8
    ds_write_b128 v2, v[32:35] offset:20480
    v_smfmac_f32_16x16x64_bf16 v[108:111], v[32:35], a[200:207], v8
    ds_write_b128 v2, v[36:39] offset:21504
    v_smfmac_f32_16x16x64_bf16 v[112:115], v[32:35], v[192:199], v8
    v_smfmac_f32_16x16x64_bf16 v[116:119], v[32:35], v[200:207], v8
    v_smfmac_f32_16x16x64_bf16 v[104:107], v[36:39], a[208:215], v8
    v_smfmac_f32_16x16x64_bf16 v[108:111], v[36:39], a[216:223], v8
    v_smfmac_f32_16x16x64_bf16 v[112:115], v[36:39], v[208:215], v8
    s_waitcnt lgkmcnt(0)
    s_barrier
    ds_read_b128 v[40:43], v2 offset:22528
    ds_read_b128 v[16:19], v2 offset:16384
    ds_read_b128 v[20:23], v2 offset:17408
    ds_read_b128 v[24:27], v2 offset:18432
    ds_read_b128 v[28:31], v2 offset:19456
    ds_read_b128 v[44:47], v2 offset:23552
    v_smfmac_f32_16x16x64_bf16 v[116:119], v[36:39], v[216:223], v8
    buffer_store_dwordx4 v[120:123], v0, s[8:11], s37 offen sc1
    s_add_u32 s37, s37, 131072
    s_waitcnt lgkmcnt(5)
    v_smfmac_f32_16x16x64_bf16 v[104:107], v[40:43], a[224:231], v8
    v_smfmac_f32_16x16x64_bf16 v[108:111], v[40:43], a[232:239], v8
    v_smfmac_f32_16x16x64_bf16 v[112:115], v[40:43], v[224:231], v8
    v_smfmac_f32_16x16x64_bf16 v[116:119], v[40:43], v[232:239], v8
    s_waitcnt lgkmcnt(4)
    v_smfmac_f32_16x16x64_bf16 v[104:107], v[16:19], a[128:135], v8
    v_smfmac_f32_16x16x64_bf16 v[108:111], v[16:19], a[136:143], v8
    v_smfmac_f32_16x16x64_bf16 v[112:115], v[16:19], v[128:135], v8
    v_smfmac_f32_16x16x64_bf16 v[116:119], v[16:19], v[136:143], v8
    s_waitcnt lgkmcnt(3)
    v_smfmac_f32_16x16x64_bf16 v[104:107], v[20:23], a[144:151], v8
    v_smfmac_f32_16x16x64_bf16 v[108:111], v[20:23], a[152:159], v8
    v_smfmac_f32_16x16x64_bf16 v[112:115], v[20:23], v[144:151], v8
    v_smfmac_f32_16x16x64_bf16 v[116:119], v[20:23], v[152:159], v8
    s_waitcnt lgkmcnt(2)
    v_smfmac_f32_16x16x64_bf16 v[104:107], v[24:27], a[160:167], v8
    v_smfmac_f32_16x16x64_bf16 v[108:111], v[24:27], a[168:175], v8
    v_smfmac_f32_16x16x64_bf16 v[112:115], v[24:27], v[160:167], v8
    v_smfmac_f32_16x16x64_bf16 v[116:119], v[24:27], v[168:175], v8
    s_waitcnt lgkmcnt(1)
    v_smfmac_f32_16x16x64_bf16 v[104:107], v[28:31], a[176:183], v8
    v_smfmac_f32_16x16x64_bf16 v[108:111], v[28:31], a[184:191], v8
    v_smfmac_f32_16x16x64_bf16 v[112:115], v[28:31], v[176:183], v8
    v_smfmac_f32_16x16x64_bf16 v[116:119], v[28:31], v[184:191], v8
    s_waitcnt lgkmcnt(0)
    v_smfmac_f32_16x16x64_bf16 v[104:107], v[44:47], a[240:247], v8
    v_smfmac_f32_16x16x64_bf16 v[108:111], v[44:47], a[248:255], v8
    v_smfmac_f32_16x16x64_bf16 v[112:115], v[44:47], v[240:247], v8
    v_smfmac_f32_16x16x64_bf16 v[116:119], v[44:47], v[248:255], v8
    s_nop 4
    v_add_f32 v104, v104, v105
    v_add_f32 v106, v106, v107
    v_add_f32 v108, v108, v109
    v_add_f32 v110, v110, v111
    v_cvt_pk_bf16_f32 v120, v104, v106
    v_cvt_pk_bf16_f32 v121, v108, v110
    v_add_f32 v112, v112, v113
    v_add_f32 v114, v114, v115
    v_add_f32 v116, v116, v117
    v_add_f32 v118, v118, v119
    v_cvt_pk_bf16_f32 v122, v112, v114
    v_cvt_pk_bf16_f32 v123, v116, v118
    v_pk_min_u16 v120, v120, s45
    v_pk_min_u16 v121, v121, s45
    v_pk_min_u16 v122, v122, s45
    v_pk_min_u16 v123, v123, s45
    buffer_store_dwordx4 v[120:123], v0, s[8:11], s37 offen sc1
    v_mov_b32 v15, 64
    s_waitcnt vmcnt(0)
    s_barrier
    s_branch L_exit_r
L_w3s:
    v_mov_b64 v[40:41], v[64:65]
    v_mov_b64 v[42:43], v[66:67]
    v_mov_b64 v[44:45], v[68:69]
    v_mov_b64 v[46:47], v[70:71]
    ds_read_b128 v[48:51], v0 offset:57344
    ds_read_b128 v[52:55], v0 offset:58368
    ds_read_b128 v[56:59], v0 offset:59392
    ds_read_b128 v[60:63], v0 offset:60416
    ds_read_b128 v[64:67], v0 offset:61440
    ds_read_b128 v[68:71], v0 offset:62464
    ds_read_b128 v[72:75], v0 offset:63488
    ds_read_b128 v[76:79], v0 offset:64512
    ds_read_b128 v[80:83], v0 offset:24576
    ds_read_b128 v[84:87], v0 offset:25600
    ds_read_b128 v[88:91], v0 offset:26624
    ds_read_b128 v[92:95], v0 offset:27648
    v_mov_b64 v[96:97], 0
    v_mov_b64 v[98:99], 0
    v_mov_b64 v[100:101], 0
    v_mov_b64 v[102:103], 0
    v_mov_b64 v[104:105], 0
    v_mov_b64 v[106:107], 0
    v_mov_b64 v[108:109], 0
    v_mov_b64 v[110:111], 0
    v_mov_b64 v[112:113], 0
    v_mov_b64 v[114:115], 0
    v_mov_b64 v[116:117], 0
    v_mov_b64 v[118:119], 0
    v_mov_b32 v15, -1
    v_mov_b32 v11, 0
    s_waitcnt lgkmcnt(0)
    s_branch R3s_top
.p2align 6
    s_nop 0
    s_nop 0
R3s_h2a:
    s_waitcnt lgkmcnt(0)
    s_waitcnt vmcnt(3)
    v_max3_u32 v12, v40, v41, v42
    s_waitcnt vmcnt(2)
    v_max3_u32 v13, v43, v44, v45
    v_max3_u32 v12, v12, v46, v47
    v_max_u32 v12, v12, v13
    v_cmp_eq_u32 vcc, -1, v12
    v_smfmac_f32_16x16x64_bf16 v[96:99], v[40:43], v[48:55], v8
    ds_write_b128 v2, v[40:43] offset:22528
    s_cbranch_vccnz R3s_h2
R3s_top1:
    v_smfmac_f32_16x16x64_bf16 v[100:103], v[40:43], v[56:63], v8
    ds_write_b128 v2, v[44:47] offset:23552
    s_xor_b32 s33, s33, 8192
    v_smfmac_f32_16x16x64_bf16 v[96:99], v[44:47], v[64:71], v8
    v_add_u32 v15, 2176, v6
    v_smfmac_f32_16x16x64_bf16 v[100:103], v[44:47], v[72:79], v8
    v_cndmask_b32 v15, v6, v15, s[60:61]
    v_smfmac_f32_16x16x64_bf16 v[104:107], v[40:43], a[224:231], v8
    v_smfmac_f32_16x16x64_bf16 v[108:111], v[40:43], a[232:239], v8
    v_smfmac_f32_16x16x64_bf16 v[104:107], v[44:47], a[240:247], v8
    s_waitcnt vmcnt(0) lgkmcnt(0)
    s_barrier
    ds_read_b128 v[32:35], v2 offset:20480
    v_smfmac_f32_16x16x64_bf16 v[108:111], v[44:47], a[248:255], v8
    ds_read_b128 v[16:19], v2 offset:16384
    v_smfmac_f32_16x16x64_bf16 v[112:115], v[40:43], v[224:231], v8
    ds_read_b128 v[20:23], v2 offset:17408
    v_smfmac_f32_16x16x64_bf16 v[116:119], v[40:43], v[232:239], v8
    ds_read_b128 v[24:27], v2 offset:18432
    v_smfmac_f32_16x16x64_bf16 v[112:115], v[44:47], v[240:247], v8
    ds_read_b128 v[28:31], v2 offset:19456
    s_waitcnt lgkmcnt(4)
    v_smfmac_f32_16x16x64_bf16 v[96:99], v[32:35], v[80:87], v8
    ds_read_b128 v[36:39], v2 offset:21504
    v_smfmac_f32_16x16x64_bf16 v[100:103], v[32:35], v[88:95], v8
    ds_read_b128 v[48:51], v0 offset:28672
    s_waitcnt lgkmcnt(5)
    v_smfmac_f32_16x16x64_bf16 v[96:99], v[16:19], a[0:7], v8
    ds_read_b128 v[52:55], v0 offset:29696
    v_smfmac_f32_16x16x64_bf16 v[100:103], v[16:19], a[8:15], v8
    ds_read_b128 v[56:59], v0 offset:30720
    s_waitcnt lgkmcnt(6)
    v_smfmac_f32_16x16x64_bf16 v[96:99], v[20:23], a[16:23], v8
    ds_read_b128 v[60:63], v0 offset:31744
    v_smfmac_f32_16x16x64_bf16 v[100:103], v[20:23], a[24:31], v8
    ds_read_b128 v[64:67], v2 offset:4096
    s_waitcnt lgkmcnt(7)
    v_smfmac_f32_16x16x64_bf16 v[96:99], v[24:27], a[32:39], v8
    ds_read_b128 v[68:71], v2 offset:5120
    v_smfmac_f32_16x16x64_bf16 v[100:103], v[24:27], a[40:47], v8
    ds_read_b128 v[72:75], v2 offset:6144
    s_waitcnt lgkmcnt(8)
    v_smfmac_f32_16x16x64_bf16 v[96:99], v[28:31], a[48:55], v8
    ds_read_b128 v[76:79], v2 offset:7168
    v_smfmac_f32_16x16x64_bf16 v[100:103], v[28:31], a[56:63], v8
    s_waitcnt lgkmcnt(8)
    s_waitcnt lgkmcnt(6)
    v_smfmac_f32_16x16x64_bf16 v[96:99], v[36:39], v[48:55], v8
    ds_read_b128 v[48:51], v2 offset:0
    s_waitcnt lgkmcnt(5)
    v_smfmac_f32_16x16x64_bf16 v[100:103], v[36:39], v[56:63], v8
    ds_read_b128 v[52:55], v2 offset:1024
    v_smfmac_f32_16x16x64_bf16 v[104:107], v[32:35], a[192:199], v8
    ds_read_b128 v[56:59], v2 offset:2048
    s_add_u32 s36, s36, 786432
    s_mov_b32 m0, s43
    v_smfmac_f32_16x16x64_bf16 v[108:111], v[32:35], a[200:207], v8
    ds_read_b128 v[60:63], v2 offset:3072
    buffer_store_dwordx4 v[120:123], v0, s[8:11], s37 offen sc1
    s_add_u32 s42, s42, 786432
    v_smfmac_f32_16x16x64_bf16 v[104:107], v[16:19], a[128:135], v8
    v_add_f32 v96, v96, v97
    v_add_f32 v98, v98, v99
    v_smfmac_f32_16x16x64_bf16 v[108:111], v[16:19], a[136:143], v8
    v_add_f32 v100, v100, v101
    v_add_f32 v102, v102, v103
    v_smfmac_f32_16x16x64_bf16 v[104:107], v[20:23], a[144:151], v8
    v_cvt_pk_bf16_f32 v124, v96, v98
    v_cvt_pk_bf16_f32 v125, v100, v102
    v_smfmac_f32_16x16x64_bf16 v[108:111], v[20:23], a[152:159], v8
    ds_write2st64_b32 v9, v124, v125 offset0:0 offset1:2
    v_smfmac_f32_16x16x64_bf16 v[104:107], v[24:27], a[160:167], v8
    s_mov_b32 s94, s24
    v_smfmac_f32_16x16x64_bf16 v[108:111], v[24:27], a[168:175], v8
    v_smfmac_f32_16x16x64_bf16 v[104:107], v[28:31], a[176:183], v8
    v_smfmac_f32_16x16x64_bf16 v[108:111], v[28:31], a[184:191], v8
    s_add_u32 s37, s37, 131072
    s_waitcnt lgkmcnt(0)
    s_barrier
    v_smfmac_f32_16x16x64_bf16 v[104:107], v[36:39], a[208:215], v8
    ds_read_b64_tr_b16 v[80:81], v6 offset:0
    ds_read_b64_tr_b16 v[82:83], v6 offset:512
    v_smfmac_f32_16x16x64_bf16 v[108:111], v[36:39], a[216:223], v8
    ds_read_b64_tr_b16 v[84:85], v6 offset:128
    ds_read_b64_tr_b16 v[86:87], v6 offset:640
    v_smfmac_f32_16x16x64_bf16 v[116:119], v[44:47], v[248:255], v8
    ds_read_b64_tr_b16 v[88:89], v6 offset:256
    ds_read_b64_tr_b16 v[90:91], v6 offset:768
    v_smfmac_f32_16x16x64_bf16 v[112:115], v[32:35], v[192:199], v8
    ds_read_b64_tr_b16 v[92:93], v6 offset:384
    ds_read_b64_tr_b16 v[94:95], v6 offset:896
    v_add_f32 v104, v104, v105
    v_add_f32 v106, v106, v107
    v_add_f32 v108, v108, v109
    v_add_f32 v110, v110, v111
    v_cvt_pk_bf16_f32 v120, v104, v106
    v_cvt_pk_bf16_f32 v121, v108, v110
    s_waitcnt lgkmcnt(4)
    v_mfma_f32_16x16x32_bf16 v[96:99], v[48:51], v[80:83], 0
    ds_write2st64_b32 v10, v120, v121 offset0:9 offset1:11
    v_mfma_f32_16x16x32_bf16 v[100:103], v[64:67], v[80:83], 0
    v_mfma_f32_16x16x32_bf16 v[96:99], v[52:55], v[84:87], v[96:99]
    v_mov_b64 v[126:127], s[26:27]
    v_mfma_f32_16x16x32_bf16 v[100:103], v[68:71], v[84:87], v[100:103]
    buffer_load_dwordx4 v0, s[8:11], s36 offen offset:0 sc1 lds
    s_waitcnt lgkmcnt(0)
    s_barrier
    v_mfma_f32_16x16x32_bf16 v[96:99], v[56:59], v[88:91], v[96:99]
    ds_read_b64_tr_b16 v[48:49], v15 offset:2304
    ds_read_b64_tr_b16 v[50:51], v15 offset:2816
    v_mfma_f32_16x16x32_bf16 v[100:103], v[72:75], v[88:91], v[100:103]
    ds_read_b64_tr_b16 v[64:65], v15 offset:2432
    ds_read_b64_tr_b16 v[66:67], v15 offset:2944
    v_mfma_f32_16x16x32_bf16 v[96:99], v[60:63], v[92:95], v[96:99]
    ds_read_b64_tr_b16 v[52:53], v15 offset:2560
    ds_read_b64_tr_b16 v[54:55], v15 offset:3072
    v_mfma_f32_16x16x32_bf16 v[100:103], v[76:79], v[92:95], v[100:103]
    ds_read_b64_tr_b16 v[68:69], v15 offset:2688
    ds_read_b64_tr_b16 v[70:71], v15 offset:3200
    s_waitcnt lgkmcnt(6)
    v_mfma_f32_16x16x32_bf16 v[104:107], v[48:51], v[80:83], 0
    ds_read_b128 v[56:59], v2 offset:14336
    v_mov_b64 v[124:125], s[26:27]
    s_waitcnt lgkmcnt(5)
    v_mfma_f32_16x16x32_bf16 v[104:107], v[64:67], v[84:87], v[104:107]
    ds_read_b128 v[60:63], v2 offset:15360
    v_max3_f32 v12, v96, v97, v98
    s_waitcnt lgkmcnt(4)
    v_mfma_f32_16x16x32_bf16 v[104:107], v[52:55], v[88:91], v[104:107]
    v_max3_f32 v13, v99, v100, v101
    v_max3_f32 v12, v12, v102, v103
    s_waitcnt lgkmcnt(2)
    v_mfma_f32_16x16x32_bf16 v[104:107], v[68:71], v[92:95], v[104:107]
    buffer_load_dwordx4 v0, s[8:11], s36 offen offset:1024 sc1 lds
    v_max_f32 v12, v12, v13
    v_smfmac_f32_16x16x64_bf16 v[116:119], v[32:35], v[200:207], v8
    ds_read_b128 v[80:83], v1 offset:24576
    s_add_u32 m0, s43, 8192
    v_smfmac_f32_16x16x64_bf16 v[112:115], v[16:19], v[128:135], v8
    ds_read_b128 v[84:87], v1 offset:25600
    s_add_u32 s24, s24, 1
    v_max3_f32 v12, v12, v104, v105
    v_mov_b32 v13, v12
    v_smfmac_f32_16x16x64_bf16 v[116:119], v[16:19], v[136:143], v8
    ds_read_b128 v[88:91], v1 offset:57344
    v_permlane32_swap_b32 v12, v13
    v_max_f32 v12, v12, v13
    v_mov_b32 v13, v12
    v_smfmac_f32_16x16x64_bf16 v[112:115], v[20:23], v[144:151], v8
    ds_read_b128 v[92:95], v1 offset:58368
    v_permlane16_swap_b32 v12, v13
    v_max_f32 v12, v12, v13
    v_mul_f32 v12, s40, v12
    v_pk_fma_f32 v[96:97], v[96:97], s[40:41], v[12:13] op_sel_hi:[1,1,0] neg_lo:[0,0,1] neg_hi:[0,0,1]
    v_pk_fma_f32 v[98:99], v[98:99], s[40:41], v[12:13] op_sel_hi:[1,1,0] neg_lo:[0,0,1] neg_hi:[0,0,1]
    v_pk_fma_f32 v[100:101], v[100:101], s[40:41], v[12:13] op_sel_hi:[1,1,0] neg_lo:[0,0,1] neg_hi:[0,0,1]
    v_pk_fma_f32 v[102:103], v[102:103], s[40:41], v[12:13] op_sel_hi:[1,1,0] neg_lo:[0,0,1] neg_hi:[0,0,1]
    v_pk_fma_f32 v[104:105], v[104:105], s[40:41], v[12:13] op_sel_hi:[1,1,0] neg_lo:[0,0,1] neg_hi:[0,0,1]
    v_smfmac_f32_16x16x64_bf16 v[116:119], v[20:23], v[152:159], v8
    ds_read_b128 v[48:51], v1 offset:26624
    v_exp_f32 v96, v96
    v_smfmac_f32_16x16x64_bf16 v[112:115], v[24:27], v[160:167], v8
    ds_read_b128 v[52:55], v1 offset:27648
    v_exp_f32 v97, v97
    v_smfmac_f32_16x16x64_bf16 v[116:119], v[24:27], v[168:175], v8
    ds_read_b128 v[64:67], v1 offset:59392
    v_exp_f32 v98, v98
    s_waitcnt lgkmcnt(7)
    v_smfmac_f32_16x16x64_bf16 v[112:115], v[28:31], v[176:183], v8
    buffer_load_dwordx4 v0, s[8:11], s42 offen offset:0 sc1 lds
    v_exp_f32 v99, v99
    v_smfmac_f32_16x16x64_bf16 v[116:119], v[28:31], v[184:191], v8
    ds_read_b128 v[68:71], v1 offset:60416
    v_exp_f32 v100, v100
    v_smfmac_f32_16x16x64_bf16 v[112:115], v[36:39], v[208:215], v8
    buffer_load_dwordx4 v0, s[8:11], s42 offen offset:1024 sc1 lds
    v_exp_f32 v101, v101
    v_smfmac_f32_16x16x64_bf16 v[116:119], v[36:39], v[216:223], v8
    v_exp_f32 v102, v102
    v_exp_f32 v103, v103
    v_mov_b64 v[12:13], 0
    v_mov_b64 v[14:15], 0
    v_cvt_pk_bf16_f32 v72, v96, v97
    v_cvt_pk_bf16_f32 v73, v98, v99
    v_cvt_pk_bf16_f32 v74, v100, v101
    v_cvt_pk_bf16_f32 v75, v102, v103
    v_exp_f32 v104, v104
    v_exp_f32 v105, v105
    v_mfma_f32_16x16x32_bf16 v[108:111], v[72:75], v[124:127], 0
    v_cvt_pk_bf16_f32 v104, v104, v105
    v_add_f32 v112, v112, v113
    v_smfmac_f32_16x16x64_bf16 v[12:15], v[72:75], v[56:63], v8 abid:1
    v_cndmask_b32 v76, v104, 0, s[78:79]
    v_cndmask_b32 v77, 0, v104, s[78:79]
    v_add_f32 v114, v114, v115
    v_add_f32 v116, v116, v117
    v_mfma_f32_16x16x16_bf16 v[108:111], v[76:77], v[124:125], v[108:111]
    v_add_f32 v118, v118, v119
    v_cvt_pk_bf16_f32 v122, v112, v114
    v_cvt_pk_bf16_f32 v123, v116, v118
    s_nop 1
    v_mfma_f32_16x16x16_bf16 v[12:15], v[76:77], v[122:123], v[12:15]
    s_nop 1
    v_rcp_f32 v108, v108
    s_nop 0
    v_rcp_f32 v109, v109
    s_nop 0
    v_rcp_f32 v110, v110
    s_nop 0
    v_rcp_f32 v111, v111
    s_nop 0
    v_pk_mul_f32 v[12:13], v[12:13], v[108:109]
    v_pk_mul_f32 v[14:15], v[14:15], v[110:111]
    v_cvt_pk_bf16_f32 v12, v12, v13
    v_cvt_pk_bf16_f32 v13, v14, v15
    ds_write_b64 v5, v[12:13] offset:384
    v_mov_b64 v[72:73], 0
    v_mov_b64 v[74:75], 0
    v_mov_b64 v[76:77], 0
    v_mov_b64 v[78:79], 0
    v_mov_b64 v[56:57], 0
    v_mov_b64 v[58:59], 0
    v_mov_b64 v[60:61], 0
    v_mov_b64 v[62:63], 0
    s_waitcnt lgkmcnt(0)
    s_barrier
    ds_read_b64_tr_b16 v[96:97], v6 offset:0
    ds_read_b64_tr_b16 v[98:99], v6 offset:512
    ds_read_b64_tr_b16 v[100:101], v6 offset:128
    ds_read_b64_tr_b16 v[102:103], v6 offset:640
    ds_read_b64_tr_b16 v[104:105], v6 offset:256
    ds_read_b64_tr_b16 v[106:107], v6 offset:768
    ds_read_b64_tr_b16 v[108:109], v6 offset:384
    ds_read_b64_tr_b16 v[110:111], v6 offset:896
    s_waitcnt lgkmcnt(6)
    v_smfmac_f32_16x16x64_bf16 v[72:75], v[96:99], a[64:71], v8 abid:1
    ds_read_b128 v[16:19], v1 offset:28672
    s_waitcnt lgkmcnt(5)
    v_smfmac_f32_16x16x64_bf16 v[72:75], v[100:103], a[96:103], v8 abid:1
    ds_read_b128 v[20:23], v1 offset:29696
    s_waitcnt lgkmcnt(4)
    v_smfmac_f32_16x16x64_bf16 v[72:75], v[104:107], v[80:87], v8 abid:1
    ds_read_b128 v[24:27], v1 offset:61440
    s_waitcnt lgkmcnt(3)
    v_smfmac_f32_16x16x64_bf16 v[72:75], v[108:111], v[88:95], v8 abid:1
    ds_read_b128 v[28:31], v1 offset:62464
    v_smfmac_f32_16x16x64_bf16 v[76:79], v[96:99], a[72:79], v8 abid:1
    ds_read_b128 v[32:35], v1 offset:30720
    s_nop 0
    v_mov_b64 v[112:113], 0
    v_smfmac_f32_16x16x64_bf16 v[76:79], v[100:103], a[104:111], v8 abid:1
    ds_read_b128 v[36:39], v1 offset:31744
    s_nop 0
    v_cvt_pk_bf16_f32 v72, v72, v73
    v_cvt_pk_bf16_f32 v73, v74, v75
    v_and_or_b32 v72, v72, -2, s38
    v_smfmac_f32_16x16x64_bf16 v[76:79], v[104:107], v[48:55], v8 abid:1
    buffer_store_dwordx2 v[72:73], v3, s[8:11], s28 offen sc1
    v_smfmac_f32_16x16x64_bf16 v[76:79], v[108:111], v[64:71], v8 abid:1
    ds_read_b128 v[40:43], v1 offset:63488
    v_smfmac_f32_16x16x64_bf16 v[56:59], v[96:99], a[80:87], v8 abid:1
    ds_read_b128 v[44:47], v1 offset:64512
    s_nop 0
    v_mov_b64 v[114:115], 0
    v_smfmac_f32_16x16x64_bf16 v[56:59], v[100:103], a[112:119], v8 abid:1
    s_nop 0
    s_nop 0
    v_cvt_pk_bf16_f32 v76, v76, v77
    v_cvt_pk_bf16_f32 v77, v78, v79
    v_and_or_b32 v76, v76, -2, s38
    s_waitcnt lgkmcnt(4)
    v_smfmac_f32_16x16x64_bf16 v[56:59], v[104:107], v[16:23], v8 abid:1
    buffer_store_dwordx2 v[76:77], v3, s[8:11], s29 offen sc1
    v_smfmac_f32_16x16x64_bf16 v[56:59], v[108:111], v[24:31], v8 abid:1
    v_smfmac_f32_16x16x64_bf16 v[60:63], v[96:99], a[88:95], v8 abid:1
    s_nop 1
    v_mov_b64 v[116:117], 0
    v_smfmac_f32_16x16x64_bf16 v[60:63], v[100:103], a[120:127], v8 abid:1
    s_nop 0
    s_nop 1
    v_cvt_pk_bf16_f32 v56, v56, v57
    v_cvt_pk_bf16_f32 v57, v58, v59
    v_and_or_b32 v56, v56, -2, s38
    s_waitcnt lgkmcnt(0)
    v_smfmac_f32_16x16x64_bf16 v[60:63], v[104:107], v[32:39], v8 abid:1
    buffer_store_dwordx2 v[56:57], v3, s[8:11], s30 offen sc1
    ds_read_b128 v[32:35], v2 offset:31232
    v_smfmac_f32_16x16x64_bf16 v[60:63], v[108:111], v[40:47], v8 abid:1
    s_mov_b32 s39, 0
    v_mov_b64 v[96:97], 0
    v_mov_b64 v[98:99], 0
    s_nop 4
    v_cvt_pk_bf16_f32 v60, v60, v61
    v_cvt_pk_bf16_f32 v61, v62, v63
    v_and_or_b32 v60, v60, -2, s38
    buffer_store_dwordx2 v[60:61], v3, s[8:11], s31 offen sc1
    v_mov_b64 v[100:101], 0
    v_mov_b64 v[102:103], 0
    v_mov_b64 v[104:105], 0
    v_mov_b64 v[106:107], 0
    v_mov_b64 v[108:109], 0
    v_mov_b64 v[110:111], 0
    v_mov_b64 v[118:119], 0
    s_waitcnt vmcnt(2)
    buffer_load_dwordx4 v[24:27], v0, s[8:11], s32 offen offset:0 sc1
    buffer_load_dwordx4 v[28:31], v0, s[8:11], s32 offen offset:1024 sc1
    ds_read_b128 v[48:51], v0 offset:57344
    ds_read_b128 v[52:55], v0 offset:58368
    ds_read_b128 v[56:59], v0 offset:59392
    s_waitcnt vmcnt(2)
    ds_read_b128 v[60:63], v0 offset:60416
    ds_read_b128 v[64:67], v0 offset:61440
    ds_read_b128 v[68:71], v0 offset:62464
    ds_read_b128 v[72:75], v0 offset:63488
    buffer_load_dwordx4 v[16:19], v0, s[8:11], s32 offen offset:0 sc1
    buffer_load_dwordx4 v[20:23], v0, s[8:11], s32 offen offset:1024 sc1
    v_pk_min_u16 v120, v120, s45
    v_pk_min_u16 v121, v121, s45
    v_pk_min_u16 v122, v122, s45
    v_pk_min_u16 v123, v123, s45
    v_mov_b32 v15, -1
    s_waitcnt lgkmcnt(7)
R3s_h1a:
    s_waitcnt vmcnt(3)
    v_mfma_f32_16x16x32_bf16 v[36:39], v[24:27], v[32:35], 0
    v_bitop3_b32 v12, v24, v26, s38 bitop3:0x7e
    s_waitcnt vmcnt(2)
    v_mfma_f32_16x16x32_bf16 v[36:39], v[28:31], v[32:35], v[36:39]
    v_bitop3_b32 v13, v28, v30, s38 bitop3:0x7e
    v_bitop3_b32 v12, v12, v13, 1 bitop3:0xa8
    v_cmp_ne_u32 vcc, 0, v12
    s_nop 0
    s_cbranch_vccnz R3s_h1
R3s_h1ok:
    s_nop 3
    v_permlane32_swap_b32 v36, v38
    v_permlane32_swap_b32 v37, v39
    v_add_f32 v36, v36, v38
    v_add_f32 v37, v37, v39
    s_nop 1
    v_permlane16_swap_b32 v36, v37
    v_add_f32 v12, v36, v37
    s_nop 1
    v_mov_b32_dpp v13, v12 row_shl:4 row_mask:0xf bank_mask:0xf
    v_cvt_pk_bf16_f32 v12, v12, v13
    v_min_u32 v12, -2, v12
    buffer_store_dword v12, v4, s[8:11], s34 offen sc1
    s_xor_b32 s32, s32, 1048576
    s_lshr_b32 s38, s24, 1
    buffer_store_dword v15, v4, s[8:11], s35 offen sc1
    s_xor_b32 s35, s35, 8192
    s_xor_b32 s28, s28, 1048576
    s_xor_b32 s29, s29, 1048576
    s_xor_b32 s30, s30, 1048576
    s_xor_b32 s31, s31, 1048576
    s_xor_b32 s34, s34, 8192
    s_and_b32 s38, s38, 1
    s_lshl_b32 s39, s39, 16
    s_xor_b32 s92, s92, 4096
    s_mov_b32 s25, 0
    s_cmp_eq_u32 s24, 63
    s_cbranch_scc1 R3s_last
    s_waitcnt vmcnt(1)
    buffer_load_dwordx4 v[40:43], v0, s[8:11], s33 offen sc1
    buffer_load_dwordx4 v[44:47], v0, s[8:11], s33 offen offset:1024 sc1
    ds_read_b128 v[76:79], v0 offset:64512
    ds_read_b128 v[80:83], v0 offset:24576
    ds_read_b128 v[84:87], v0 offset:25600
    ds_read_b128 v[88:91], v0 offset:26624
    ds_read_b128 v[92:95], v0 offset:27648
    s_waitcnt vmcnt(2)
    s_waitcnt lgkmcnt(0)
    buffer_load_dwordx4 v[16:19], v0, s[8:11], s33 offen sc1
    buffer_load_dwordx4 v[20:23], v0, s[8:11], s33 offen offset:1024 sc1
    s_branch R3s_h2a
R3s_h1:
    buffer_load_dwordx4 v[24:27], v0, s[8:11], s32 offen offset:0 sc1
    buffer_load_dwordx4 v[28:31], v0, s[8:11], s32 offen offset:1024 sc1
    s_add_u32 s39, s39, 1
    s_cmp_gt_u32 s39, 60000
    s_cbranch_scc1 L_fail
    s_waitcnt vmcnt(3)
    v_mfma_f32_16x16x32_bf16 v[36:39], v[16:19], v[32:35], 0
    v_bitop3_b32 v12, v16, v18, s38 bitop3:0x7e
    s_waitcnt vmcnt(2)
    v_mfma_f32_16x16x32_bf16 v[36:39], v[20:23], v[32:35], v[36:39]
    v_bitop3_b32 v13, v20, v22, s38 bitop3:0x7e
    v_bitop3_b32 v12, v12, v13, 1 bitop3:0xa8
    v_cmp_ne_u32 vcc, 0, v12
    s_nop 0
    s_cbranch_vccz R3s_h1ok
    buffer_load_dwordx4 v[16:19], v0, s[8:11], s32 offen offset:0 sc1
    buffer_load_dwordx4 v[20:23], v0, s[8:11], s32 offen offset:1024 sc1
    s_add_u32 s39, s39, 1
    s_branch R3s_h1a
R3s_h2:
    s_nop 5
    v_mov_b64 v[96:97], 0
    v_mov_b64 v[98:99], 0
    s_add_u32 s25, s25, 1
    s_cmp_gt_u32 s25, 60000
    s_cbranch_scc1 L_fail
    s_waitcnt vmcnt(1)
    v_max3_u32 v12, v16, v17, v18
    s_waitcnt vmcnt(0)
    v_max3_u32 v13, v19, v20, v21
    v_max3_u32 v12, v12, v22, v23
    v_max_u32 v12, v12, v13
    v_cmp_eq_u32 vcc, -1, v12
    s_nop 0
    s_cbranch_vccnz R3s_h2b
    v_mov_b64 v[40:41], v[16:17]
    v_mov_b64 v[42:43], v[18:19]
    v_mov_b64 v[44:45], v[20:21]
    v_mov_b64 v[46:47], v[22:23]
    s_branch R3s_top
R3s_h2b:
    buffer_load_dwordx4 v[40:43], v0, s[8:11], s33 offen sc1
    buffer_load_dwordx4 v[44:47], v0, s[8:11], s33 offen offset:1024 sc1
    s_waitcnt vmcnt(1)
    buffer_load_dwordx4 v[16:19], v0, s[8:11], s33 offen sc1
    buffer_load_dwordx4 v[20:23], v0, s[8:11], s33 offen offset:1024 sc1
    s_add_u32 s25, s25, 1
    s_branch R3s_h2a
R3s_top:
    v_smfmac_f32_16x16x64_bf16 v[96:99], v[40:43], v[48:55], v8
    ds_write_b128 v2, v[40:43] offset:22528
    s_branch R3s_top1
R3s_last:
    s_waitcnt vmcnt(0)
R3s_l2:
    buffer_load_dwordx4 v[40:43], v0, s[8:11], s33 offen sc1
    buffer_load_dwordx4 v[44:47], v0, s[8:11], s33 offen offset:1024 sc1
    s_add_u32 s25, s25, 1
    s_cmp_gt_u32 s25, 60000
    s_cbranch_scc1 L_fail
    s_waitcnt vmcnt(1)
    v_max3_u32 v12, v40, v41, v42
    s_waitcnt vmcnt(0)
    v_max3_u32 v13, v43, v44, v45
    v_max3_u32 v12, v12, v46, v47
    v_max_u32 v12, v12, v13
    v_cmp_eq_u32 vcc, -1, v12
    s_nop 0
    s_cbranch_vccnz R3s_l2
    v_smfmac_f32_16x16x64_bf16 v[104:107], v[40:43], a[224:231], v8
    ds_write_b128 v2, v[40:43] offset:22528
    v_smfmac_f32_16x16x64_bf16 v[108:111], v[40:43], a[232:239], v8
    ds_write_b128 v2, v[44:47] offset:23552
    v_smfmac_f32_16x16x64_bf16 v[112:115], v[40:43], v[224:231], v8
    v_smfmac_f32_16x16x64_bf16 v[116:119], v[40:43], v[232:239], v8
    v_smfmac_f32_16x16x64_bf16 v[104:107], v[44:47], a[240:247], v8
    v_smfmac_f32_16x16x64_bf16 v[108:111], v[44:47], a[248:255], v8
    v_smfmac_f32_16x16x64_bf16 v[112:115], v[44:47], v[240:247], v8
    s_waitcnt lgkmcnt(0)
    s_barrier
    ds_read_b128 v[32:35], v2 offset:20480
    ds_read_b128 v[16:19], v2 offset:16384
    ds_read_b128 v[20:23], v2 offset:17408
    ds_read_b128 v[24:27], v2 offset:18432
    ds_read_b128 v[28:31], v2 offset:19456
    ds_read_b128 v[36:39], v2 offset:21504
    v_smfmac_f32_16x16x64_bf16 v[116:119], v[44:47], v[248:255], v8
    buffer_store_dwordx4 v[120:123], v0, s[8:11], s37 offen sc1
    s_add_u32 s37, s37, 131072
    s_waitcnt lgkmcnt(5)
    v_smfmac_f32_16x16x64_bf16 v[104:107], v[32:35], a[192:199], v8
    v_smfmac_f32_16x16x64_bf16 v[108:111], v[32:35], a[200:207], v8
    v_smfmac_f32_16x16x64_bf16 v[112:115], v[32:35], v[192:199], v8
    v_smfmac_f32_16x16x64_bf16 v[116:119], v[32:35], v[200:207], v8
    s_waitcnt lgkmcnt(4)
    v_smfmac_f32_16x16x64_bf16 v[104:107], v[16:19], a[128:135], v8
    v_smfmac_f32_16x16x64_bf16 v[108:111], v[16:19], a[136:143], v8
    v_smfmac_f32_16x16x64_bf16 v[112:115], v[16:19], v[128:135], v8
    v_smfmac_f32_16x16x64_bf16 v[116:119], v[16:19], v[136:143], v8
    s_waitcnt lgkmcnt(3)
    v_smfmac_f32_16x16x64_bf16 v[104:107], v[20:23], a[144:151], v8
    v_smfmac_f32_16x16x64_bf16 v[108:111], v[20:23], a[152:159], v8
    v_smfmac_f32_16x16x64_bf16 v[112:115], v[20:23], v[144:151], v8
    v_smfmac_f32_16x16x64_bf16 v[116:119], v[20:23], v[152:159], v8
    s_waitcnt lgkmcnt(2)
    v_smfmac_f32_16x16x64_bf16 v[104:107], v[24:27], a[160:167], v8
    v_smfmac_f32_16x16x64_bf16 v[108:111], v[24:27], a[168:175], v8
    v_smfmac_f32_16x16x64_bf16 v[112:115], v[24:27], v[160:167], v8
    v_smfmac_f32_16x16x64_bf16 v[116:119], v[24:27], v[168:175], v8
    s_waitcnt lgkmcnt(1)
    v_smfmac_f32_16x16x64_bf16 v[104:107], v[28:31], a[176:183], v8
    v_smfmac_f32_16x16x64_bf16 v[108:111], v[28:31], a[184:191], v8
    v_smfmac_f32_16x16x64_bf16 v[112:115], v[28:31], v[176:183], v8
    v_smfmac_f32_16x16x64_bf16 v[116:119], v[28:31], v[184:191], v8
    s_waitcnt lgkmcnt(0)
    v_smfmac_f32_16x16x64_bf16 v[104:107], v[36:39], a[208:215], v8
    v_smfmac_f32_16x16x64_bf16 v[108:111], v[36:39], a[216:223], v8
    v_smfmac_f32_16x16x64_bf16 v[112:115], v[36:39], v[208:215], v8
    v_smfmac_f32_16x16x64_bf16 v[116:119], v[36:39], v[216:223], v8
    s_nop 4
    v_add_f32 v104, v104, v105
    v_add_f32 v106, v106, v107
    v_add_f32 v108, v108, v109
    v_add_f32 v110, v110, v111
    v_cvt_pk_bf16_f32 v120, v104, v106
    v_cvt_pk_bf16_f32 v121, v108, v110
    v_add_f32 v112, v112, v113
    v_add_f32 v114, v114, v115
    v_add_f32 v116, v116, v117
    v_add_f32 v118, v118, v119
    v_cvt_pk_bf16_f32 v122, v112, v114
    v_cvt_pk_bf16_f32 v123, v116, v118
    v_pk_min_u16 v120, v120, s45
    v_pk_min_u16 v121, v121, s45
    v_pk_min_u16 v122, v122, s45
    v_pk_min_u16 v123, v123, s45
    buffer_store_dwordx4 v[120:123], v0, s[8:11], s37 offen sc1
    v_mov_b32 v15, 64
    s_waitcnt vmcnt(0)
    s_barrier
    s_branch L_exit_r
.section .rodata,"a"
.p2align 6
.amdhsa_kernel sequential_preLN__memory_aug_recurrent_mem_tr__glu_gated_geglu__prompt_kernel
  .amdhsa_next_free_vgpr 512
  .amdhsa_next_free_sgpr 102
  .amdhsa_accum_offset 256
  .amdhsa_group_segment_fixed_size 0
  .amdhsa_kernarg_size 112
  .amdhsa_user_sgpr_count 2
  .amdhsa_user_sgpr_kernarg_segment_ptr 1
  .amdhsa_system_sgpr_workgroup_id_x 1
  .amdhsa_float_denorm_mode_32 3
.end_amdhsa_kernel
```
